```python
import torch

def _softmax(x, axis=-1):
    return torch.softmax(x, dim=axis)
def _gelu(x):
    return torch.nn.functional.gelu(x, approximate="tanh")
def _silu(x):
    return torch.nn.functional.silu(x)
def _sigmoid(x):
    return torch.sigmoid(x)
def _layernorm(x, axis=-1, eps=1e-5):
    m = x.mean(dim=axis, keepdim=True)
    v = x.var(dim=axis, keepdim=True, unbiased=False)
    return (x - m) / torch.sqrt(v + eps)
def _scatter_add(tgt, idx, src, axis=0):
    return tgt.clone().index_add_(axis, idx, src)
def _segment_sum(src, seg, n):
    out = torch.zeros((n,) + src.shape[1:], dtype=src.dtype)
    return out.index_add_(0, seg, src)
def _pad(x, pw):
    flat = tuple(v for pair in reversed(pw) for v in pair)
    return torch.nn.functional.pad(x, flat)

kernel_name = 'interleave_layers__sliding_block__linear_attn_block__prompt'

def setup_inputs():

    _w = (lambda a: (lambda t: t.to(torch.bfloat16) if t.is_floating_point() else t)(torch.as_tensor(a)))
    def _A_setup():
        B, S, D = 1, 2048, 512
        return {
            "x": _w((lambda *s: torch.randn(*s, dtype=torch.bfloat16) * 0.05)(B, S, D)),
            "wqkv": _w((lambda *s: torch.randn(*s, dtype=torch.bfloat16) * 0.1)(D, 3 * D)),
            "wo": _w((lambda *s: torch.randn(*s, dtype=torch.bfloat16) * 0.1)(D, D)),
        }
    _A_in = _A_setup()

    def _B_setup():
        B, S, D = 1, 2048, 512
        return {
            "x": _w((lambda *s: torch.randn(*s, dtype=torch.bfloat16) * 0.05)(B, S, D)),
            "wqkv": _w((lambda *s: torch.randn(*s, dtype=torch.bfloat16) * 1.6)(D, 3 * D)),
            "wo": _w((lambda *s: torch.randn(*s, dtype=torch.bfloat16) * 0.1)(D, D)),
        }
    _B_in = _B_setup()

    return {
        "A_x": _A_in["x"],
        "A_wqkv": _A_in["wqkv"],
        "A_wo": _A_in["wo"],
        "B_x": _B_in["x"],
        "B_wqkv": _B_in["wqkv"],
        "B_wo": _B_in["wo"],
    }

def reference(A_x, A_wqkv, A_wo, B_x, B_wqkv, B_wo):
    def _A_ref(x, wqkv, wo):
        B, S, D = x.shape
        H = 32; Dh = D // H; W = 256
        qkv = (lambda x, *d: x.permute(*d))((x @ wqkv).reshape(B, S, 3, H, Dh), 2, 0, 3, 1, 4)
        q, k, v = qkv[0], qkv[1], qkv[2]
        scores = torch.einsum("bhqd,bhkd->bhqk", q, k) * (Dh ** -0.5)
        idx = torch.arange(S)
        mask = (idx[:, None] - idx[None, :] >= 0) & (idx[:, None] - idx[None, :] < W)
        scores = torch.where(mask[None, None], scores, -1e9)
        p = _softmax(scores, axis=-1)
        o = torch.einsum("bhqk,bhkd->bhqd", p, v)
        return (lambda x, *d: x.permute(*d))(o, 0, 2, 1, 3).reshape(B, S, D) @ wo

    def _B_ref(x, wqkv, wo):
        B, S, D = x.shape
        H = 32; Dh = D // H
        qkv = (lambda x, *d: x.permute(*d))((x @ wqkv).reshape(B, S, 3, H, Dh), 2, 0, 3, 1, 4)
        q, k, v = qkv[0], qkv[1], qkv[2]
        phi = lambda t: torch.where(t > 0, t + 1, torch.exp(t)) + 1e-6
        pq, pk = phi(q), phi(k)
        kv = torch.einsum("bhsd,bhse->bhde", pk, v)
        z = torch.einsum("bhsd->bhd", pk)
        num = torch.einsum("bhqd,bhde->bhqe", pq, kv)
        den = torch.einsum("bhqd,bhd->bhq", pq, z)[..., None] + 1e-6
        o = num / den
        return (lambda x, *d: x.permute(*d))(o, 0, 2, 1, 3).reshape(B, S, D) @ wo

    x = A_x
    x = x + _A_ref(_layernorm(x, axis=-1), A_wqkv, A_wo)
    x = x + _B_ref(_layernorm(x, axis=-1), B_wqkv, B_wo)
    x = x + _A_ref(_layernorm(x, axis=-1), A_wqkv, A_wo)
    x = x + _B_ref(_layernorm(x, axis=-1), B_wqkv, B_wo)
    return x
```

```asm
; @launch grid=(256,1,1) block=(256,1,1) lds=163840
.amdgcn_target "amdgcn-amd-amdhsa--gfx950"
.text
.globl interleave_layers__sliding_block__linear_attn_block__prompt_kernel
.p2align 8
.type interleave_layers__sliding_block__linear_attn_block__prompt_kernel,@function
interleave_layers__sliding_block__linear_attn_block__prompt_kernel:
    s_cmp_ge_u32 s2, 256
    s_cbranch_scc1 L_end
    s_load_dwordx2 s[24:25], s[0:1], 0
    s_load_dwordx2 s[28:29], s[0:1], 8
    s_load_dwordx2 s[48:49], s[0:1], 64
    s_load_dwordx2 s[32:33], s[0:1], 32
    s_load_dwordx2 s[36:37], s[0:1], 16
    s_load_dwordx2 s[40:41], s[0:1], 40
    s_load_dwordx2 s[44:45], s[0:1], 48
    s_getpc_b64 s[4:5]
L_pc:
    s_lshr_b32 s6, s2, 3
    v_lshlrev_b32 v64, 5, v0
    v_add_u32 v64, s6, v64
    v_lshlrev_b32 v64, 7, v64
    v_cmp_gt_u32 vcc, L_codeend-L_pc-4, v64
    s_nop 1
    s_and_b64 exec, exec, vcc
    s_cbranch_execz L_pcs
    global_load_dword a255, v64, s[4:5]
L_pcs:
    s_mov_b64 exec, -1
    v_lshrrev_b32 v1, 6, v0
    v_and_b32 v0, 63, v0
    v_readfirstlane_b32 s58, v1
    s_and_b32 s3, s2, 7
    s_lshr_b32 s57, s2, 3
    s_lshr_b32 s56, s57, 4
    s_lshl_b32 s3, s3, 1
    s_add_u32 s56, s56, s3
    s_and_b32 s57, s57, 15
    s_lshl_b32 s59, s56, 2
    s_add_u32 s59, s59, s58
    v_lshlrev_b32 v1, 4, v0
    s_lshl_b32 s60, s59, 15
    s_lshl_b32 s61, s57, 11
    s_add_u32 s61, s61, s60
    v_lshrrev_b32 v64, 5, v0
    v_and_b32 v65, 31, v0
    v_xor_b32 v66, v64, v65
    v_lshlrev_b32 v66, 4, v66
    v_lshl_add_u32 v24, v64, 10, v66
    v_xor_b32 v25, 32, v24
    v_xor_b32_e64 v26, 64, v24
    v_xor_b32 v27, 96, v24
    v_xor_b32 v28, 128, v24
    v_xor_b32 v29, 160, v24
    v_xor_b32 v30, 192, v24
    v_xor_b32 v31, 224, v24
    s_lshl_b32 s22, s58, 14
    s_add_u32 s22, s22, 65536
    v_lshlrev_b32 v67, 7, v0
    v_accvgpr_write_b32 a112, 0
    v_accvgpr_write_b32 a113, 0
    v_accvgpr_write_b32 a114, 0
    v_accvgpr_write_b32 a115, 0
    s_load_dwordx2 s[52:53], s[0:1], 56
    s_mov_b32 s26, 0x200000
    s_mov_b32 s27, 0x00020000
    s_mov_b32 s30, 0x180000
    s_mov_b32 s31, 0x00020000
    s_mov_b32 s50, 0x2000000
    s_mov_b32 s51, 0x00020000
    s_mov_b32 s34, 0x180000
    s_mov_b32 s35, 0x00020000
    s_mov_b32 s38, 0x80000
    s_mov_b32 s39, 0x00020000
    s_mov_b32 s42, 0x80000
    s_mov_b32 s43, 0x00020000
    s_mov_b32 s46, 0x200000
    s_mov_b32 s47, 0x00020000
    s_mov_b32 s54, 0x100
    s_mov_b32 s55, 0x00020000
    s_mul_i32 s8, s2, 6144
    s_lshl_b32 s9, s56, 17
    s_lshl_b32 s7, s57, 13
    s_add_u32 s9, s9, s7
    s_lshl_b32 s7, s2, 11
    v_lshlrev_b32 v66, 21, v0
    s_lshl_b32 s12, s2, 10
    s_add_u32 s12, s12, 0x440000
    s_cmp_lt_u32 s2, 48
    s_cselect_b32 s12, s12, 0x7f000000
    s_waitcnt lgkmcnt(0)
    s_cmp_ge_u32 s58, 2
    s_cbranch_scc1 t_2
    s_cmp_eq_u32 s58, 1
    s_cbranch_scc1 t_1
    s_mov_b32 exec_hi, 0xffff
    buffer_load_dword a255, v67, s[28:31], s8 offen
    s_branch tj_4
t_1:
    buffer_load_dword a255, v67, s[24:27], s9 offen
    s_branch tj_4
t_2:
    s_cmp_eq_u32 s58, 3
    s_cbranch_scc1 t_3
    s_mov_b32 exec_hi, 0xffff
    s_mov_b64 exec, 0x3f
    buffer_load_dword a255, v66, s[48:51], 0 offen
    buffer_load_dword a255, off, s[44:47], 0
    s_branch tj_4
t_3:
    buffer_store_dwordx4 a[112:115], v1, s[48:51], s12 offen sc0 sc1
    s_mov_b64 exec, 0xffff
    s_nop 0
tj_4:
    s_mov_b64 exec, -1
    s_add_u32 m0, s22, 0
    s_add_u32 s10, s60, 0
    buffer_load_dwordx4 v24, s[24:27], s10 offen lds
    s_add_u32 m0, s22, 1024
    s_add_u32 s10, s60, 2048
    buffer_load_dwordx4 v25, s[24:27], s10 offen lds
    s_add_u32 m0, s22, 2048
    s_add_u32 s10, s60, 4096
    buffer_load_dwordx4 v26, s[24:27], s10 offen lds
    s_add_u32 m0, s22, 3072
    s_add_u32 s10, s60, 6144
    buffer_load_dwordx4 v27, s[24:27], s10 offen lds
    s_add_u32 m0, s22, 4096
    s_add_u32 s10, s60, 8192
    buffer_load_dwordx4 v28, s[24:27], s10 offen lds
    v_lshrrev_b32 v64, 2, v0
    v_and_b32 v65, 3, v0
    v_lshlrev_b32 v65, 4, v65
    s_lshl_b32 s3, s57, 6
    s_xor_b32 s3, s3, 512
    v_add_u32 v65, s3, v65
    v_mul_u32_u24 v4, 3072, v64
    v_add_u32 v4, v4, v65
    v_lshrrev_b32 v64, 5, v0
    v_and_b32 v65, 31, v0
    v_and_b32 v66, 15, v65
    v_xor_b32 v66, v64, v66
    v_lshlrev_b32 v66, 4, v66
    v_lshl_add_u32 v16, v65, 9, v66
    v_add_u32 v16, s22, v16
    v_xor_b32 v17, 32, v16
    v_xor_b32 v18, 64, v16
    v_xor_b32 v19, 96, v16
    v_xor_b32 v20, 128, v16
    v_xor_b32 v21, 160, v16
    v_xor_b32 v22, 192, v16
    v_xor_b32 v23, 224, v16
    s_mul_i32 s8, s58, 49152
    s_lshl_b32 s9, s58, 10
    s_and_b32 s4, s57, 1
    s_and_b32 s5, s56, 1
    s_lshl_b32 s5, s5, 1
    s_add_u32 s4, s4, s5
    s_add_u32 s0, s4, 0
    s_and_b32 s0, s0, 3
    s_add_u32 s1, s4, 1
    s_and_b32 s1, s1, 3
    s_add_u32 s14, s4, 2
    s_and_b32 s14, s14, 3
    s_add_u32 s15, s4, 3
    s_and_b32 s15, s15, 3
    s_and_b32 s5, s0, 1
    s_lshr_b32 s10, s0, 1
    s_mul_i32 s0, s5, 196608
    s_lshl_b32 s11, s10, 10
    s_add_u32 s0, s0, s11
    s_add_u32 s0, s0, s8
    s_add_u32 s0, s0, 1024
    s_lshl_b32 s16, s5, 12
    s_lshl_b32 s11, s10, 15
    s_add_u32 s16, s16, s11
    s_add_u32 s16, s16, s9
    s_and_b32 s5, s1, 1
    s_lshr_b32 s10, s1, 1
    s_mul_i32 s1, s5, 196608
    s_lshl_b32 s11, s10, 10
    s_add_u32 s1, s1, s11
    s_add_u32 s1, s1, s8
    s_add_u32 s1, s1, 1024
    s_lshl_b32 s17, s5, 12
    s_lshl_b32 s11, s10, 15
    s_add_u32 s17, s17, s11
    s_add_u32 s17, s17, s9
    s_and_b32 s5, s14, 1
    s_lshr_b32 s10, s14, 1
    s_mul_i32 s14, s5, 196608
    s_lshl_b32 s11, s10, 10
    s_add_u32 s14, s14, s11
    s_add_u32 s14, s14, s8
    s_add_u32 s14, s14, 1024
    s_lshl_b32 s3, s5, 12
    s_lshl_b32 s11, s10, 15
    s_add_u32 s3, s3, s11
    s_add_u32 s3, s3, s9
    s_and_b32 s5, s15, 1
    s_lshr_b32 s10, s15, 1
    s_mul_i32 s15, s5, 196608
    s_lshl_b32 s11, s10, 10
    s_add_u32 s15, s15, s11
    s_add_u32 s15, s15, s8
    s_add_u32 s15, s15, 1024
    s_lshl_b32 s99, s5, 12
    s_lshl_b32 s11, s10, 15
    s_add_u32 s99, s99, s11
    s_add_u32 s99, s99, s9
    s_lshl_b32 s8, s8, 3
    s_mov_b32 s63, 0
    s_getreg_b32 s6, hwreg(HW_REG_XCC_ID)
    s_and_b32 s6, s6, 15
    s_add_u32 s100, s60, 0x200000
    s_add_u32 s62, s61, 0x200000
    s_xor_b32 s62, s62, 16384
    s_lshl_b32 s101, s59, 12
    s_add_u32 s101, s101, 0x400000
    v_lshrrev_b32 v64, 5, v0
    v_lshlrev_b32 v2, 9, v64
    v_bfe_u32 v65, v0, 2, 2
    v_lshl_add_u32 v2, v65, 6, v2
    v_bfe_u32 v65, v0, 4, 1
    v_lshl_add_u32 v2, v65, 5, v2
    v_and_b32 v65, 3, v0
    v_lshl_add_u32 v2, v65, 3, v2
    v_add_u32 v3, 0x10000, v2
    s_lshl_b32 s98, s59, 7
    s_add_u32 s98, s98, 0x440000
    s_lshl_b32 s4, s58, 12
    s_add_u32 s4, s4, 98304
    v_add_u32 v7, s4, v1
    s_mov_b32 s96, 0xffff
    s_mov_b32 s97, 0xffff
    s_mov_b32 s12, 0
    s_mov_b32 s13, -1
    s_lshr_b32 s4, s57, 1
    s_and_b32 s4, s4, 3
    s_lshl_b32 s4, s4, 10
    s_lshr_b32 s5, s57, 3
    s_lshl_b32 s5, s5, 9
    s_add_u32 s4, s4, s5
    s_and_b32 s5, s57, 1
    s_lshl_b32 s5, s5, 3
    s_add_u32 s4, s4, s5
    v_add_u32 v6, s4, v1
    v_mov_b32 v67, 0x7f000000
    v_cndmask_b32 v6, v6, v67, s[12:13]
    v_lshrrev_b32 v64, 4, v0
    v_lshlrev_b32 v64, 5, v64
    s_lshl_b32 s5, s58, 4
    s_add_u32 s5, s5, 2016
    v_add_u32 v64, s5, v64
    v_and_b32 v65, 15, v0
    v_cmp_eq_u32 vcc, 0, v65
    v_mov_b32 v65, 0x70000000
    s_nop 0
    v_cndmask_b32 v64, v65, v64, vcc
    v_add_u32 v65, s9, v1
    s_cmp_lt_u32 s58, 2
    s_cselect_b64 vcc, -1, 0
    v_cndmask_b32 v5, v64, v65, vcc
    s_lshl_b32 s5, s57, 16
    s_add_u32 s5, s5, 0x500000
    v_add_u32 v5, s5, v5
    s_and_b32 s4, s57, 3
    s_lshl_b32 s4, s4, 6
    s_bfe_u32 s5, s57, 0x10002
    s_lshl_b32 s5, s5, 8
    s_or_b32 s4, s4, s5
    v_xor_b32 v88, s4, v16
    v_xor_b32 v89, 32, v88
    v_mov_b32 v11, 0
    v_mov_b32 v12, 0
    v_mov_b32 v13, 0
    v_mov_b32 v14, 0
    v_mov_b32 v15, 0
    s_lshl_b32 s4, s58, 11
    v_add_u32 v10, s4, v2
    v_and_b32 v66, 31, v0
    v_lshlrev_b32 v66, 5, v66
    v_lshrrev_b32 v9, 5, v0
    v_lshl_add_u32 v9, v9, 2, v66
    s_lshl_b32 s4, s58, 3
    s_add_u32 s4, s4, 0x24800
    v_add_u32 v9, s4, v9
    v_lshrrev_b32 v64, 5, v0
    v_and_b32 v65, 31, v0
    v_lshlrev_b32 v64, 2, v64
    v_sub_u32 v65, v65, v64
    v_cmp_le_i32 s[64:65], 0, v65
    v_cmp_le_i32 s[66:67], 1, v65
    v_cmp_le_i32 s[68:69], 2, v65
    v_cmp_le_i32 s[70:71], 3, v65
    v_cmp_le_i32 s[72:73], 8, v65
    v_cmp_le_i32 s[74:75], 9, v65
    v_cmp_le_i32 s[76:77], 10, v65
    v_cmp_le_i32 s[78:79], 11, v65
    v_cmp_le_i32 s[80:81], 16, v65
    v_cmp_le_i32 s[82:83], 17, v65
    v_cmp_le_i32 s[84:85], 18, v65
    v_cmp_le_i32 s[86:87], 19, v65
    v_cmp_le_i32 s[88:89], 24, v65
    v_cmp_le_i32 s[90:91], 25, v65
    v_cmp_le_i32 s[92:93], 26, v65
    v_cmp_le_i32 s[94:95], 27, v65
    v_mov_b32 v108, 0xffff
    v_mov_b32 v109, 0xffff0000
    v_cndmask_b32 v32, 0, v108, s[64:65]
    v_cndmask_b32 v110, 0, v109, s[66:67]
    v_or_b32 v32, v32, v110
    v_cndmask_b32 v33, 0, v108, s[68:69]
    v_cndmask_b32 v110, 0, v109, s[70:71]
    v_or_b32 v33, v33, v110
    v_cndmask_b32 v34, 0, v108, s[72:73]
    v_cndmask_b32 v110, 0, v109, s[74:75]
    v_or_b32 v34, v34, v110
    v_cndmask_b32 v35, 0, v108, s[76:77]
    v_cndmask_b32 v110, 0, v109, s[78:79]
    v_or_b32 v35, v35, v110
    v_cndmask_b32 v36, 0, v108, s[80:81]
    v_cndmask_b32 v110, 0, v109, s[82:83]
    v_or_b32 v36, v36, v110
    v_cndmask_b32 v37, 0, v108, s[84:85]
    v_cndmask_b32 v110, 0, v109, s[86:87]
    v_or_b32 v37, v37, v110
    v_cndmask_b32 v38, 0, v108, s[88:89]
    v_cndmask_b32 v110, 0, v109, s[90:91]
    v_or_b32 v38, v38, v110
    v_cndmask_b32 v39, 0, v108, s[92:93]
    v_cndmask_b32 v110, 0, v109, s[94:95]
    v_or_b32 v39, v39, v110
    s_lshl_b32 s4, s57, 4
    s_add_u32 s4, s4, s56
    s_lshl_b32 s4, s4, 5
    s_add_u32 s4, s4, s58
    s_lshl_b32 s4, s4, 2
    s_add_u32 s4, s4, 0x444000
    v_mov_b32 v42, s4
    s_lshl_b32 s4, s57, 2
    s_add_u32 s5, s4, s98
    v_writelane_b32 v42, s5, 1
    s_lshr_b32 s4, s58, 1
    s_add_u32 s4, s4, s56
    s_sub_u32 s7, s4, 2
    s_and_b32 s10, s58, 1
    s_lshl_b32 s5, s7, 1
    s_add_u32 s5, s5, s10
    s_lshl_b32 s5, s5, 5
    s_add_u32 s5, s5, s57
    s_lshl_b32 s5, s5, 12
    s_add_u32 s20, s5, 0x800000
    s_cmp_lt_u32 s7, 16
    s_cselect_b32 s20, s20, 0x7f000000
    s_add_u32 s21, s20, 65536
    s_lshl_b32 s5, s57, 4
    s_add_u32 s5, s5, s7
    s_lshl_b32 s5, s5, 7
    s_add_u32 s5, s5, 0x444000
    s_lshl_b32 s10, s10, 3
    s_add_u32 s5, s5, s10
    s_cmp_lt_u32 s7, 16
    s_cselect_b32 s5, s5, 0x7f000000
    s_cselect_b32 s10, 1, 0
    v_and_b32 v40, 1, v0
    v_lshl_add_u32 v40, v40, 2, s5
    v_and_b32 v41, 15, v0
    v_lshl_add_u32 v41, v41, 2, s98
    v_mov_b32 v41, s10
    v_mov_b32 v43, 0x100
    v_lshrrev_b32 v43, 2, v0
    v_mul_u32_u24 v43, 3072, v43
    v_and_b32 v44, 3, v0
    v_lshl_add_u32 v43, v44, 4, v43
    s_mul_i32 s11, s58, 393216
    s_lshl_b32 s10, s57, 6
    s_xor_b32 s10, s10, 512
    s_add_u32 s11, s11, s10
    v_add_u32 v43, s11, v43
    v_lshrrev_b32 v44, 5, v0
    v_lshlrev_b32 v44, 8, v44
    v_sub_u32 v44, v2, v44
    v_accvgpr_write_b32 a128, v32
    v_accvgpr_write_b32 a129, v33
    v_accvgpr_write_b32 a130, v34
    v_accvgpr_write_b32 a131, v35
    v_accvgpr_write_b32 a132, v36
    v_accvgpr_write_b32 a133, v37
    v_accvgpr_write_b32 a134, v38
    v_accvgpr_write_b32 a135, v39
    v_accvgpr_write_b32 a136, v40
    v_accvgpr_write_b32 a137, v41
    v_accvgpr_write_b32 a138, v42
    v_accvgpr_write_b32 a139, v43
    v_accvgpr_write_b32 a140, v44
    s_add_u32 m0, s22, 5120
    s_add_u32 s10, s60, 10240
    buffer_load_dwordx4 v29, s[24:27], s10 offen lds
    s_add_u32 m0, s22, 6144
    s_add_u32 s10, s60, 12288
    buffer_load_dwordx4 v30, s[24:27], s10 offen lds
    s_add_u32 m0, s22, 7168
    s_add_u32 s10, s60, 14336
    buffer_load_dwordx4 v31, s[24:27], s10 offen lds
    s_add_u32 m0, s22, 8192
    s_add_u32 s10, s60, 16384
    buffer_load_dwordx4 v24, s[24:27], s10 offen lds
    s_add_u32 m0, s22, 9216
    s_add_u32 s10, s60, 18432
    buffer_load_dwordx4 v25, s[24:27], s10 offen lds
    s_add_u32 m0, s22, 10240
    s_add_u32 s10, s60, 20480
    buffer_load_dwordx4 v26, s[24:27], s10 offen lds
    s_add_u32 m0, s22, 11264
    s_add_u32 s10, s60, 22528
    buffer_load_dwordx4 v27, s[24:27], s10 offen lds
    s_add_u32 m0, s22, 12288
    s_add_u32 s10, s60, 24576
    buffer_load_dwordx4 v28, s[24:27], s10 offen lds
    s_add_u32 m0, s22, 13312
    s_add_u32 s10, s60, 26624
    buffer_load_dwordx4 v29, s[24:27], s10 offen lds
    s_add_u32 m0, s22, 14336
    s_add_u32 s10, s60, 28672
    buffer_load_dwordx4 v30, s[24:27], s10 offen lds
    s_add_u32 m0, s22, 15360
    s_add_u32 s10, s60, 30720
    buffer_load_dwordx4 v31, s[24:27], s10 offen lds
    s_add_u32 m0, s16, 0
    s_add_u32 s10, s0, 0
    buffer_load_dwordx4 v4, s[28:31], s10 offen lds
    s_add_u32 m0, s17, 0
    s_add_u32 s10, s1, 0
    buffer_load_dwordx4 v4, s[28:31], s10 offen lds
    s_add_u32 m0, s3, 0
    s_add_u32 s10, s14, 0
    buffer_load_dwordx4 v4, s[28:31], s10 offen lds
    s_add_u32 m0, s99, 0
    s_add_u32 s10, s15, 0
    buffer_load_dwordx4 v4, s[28:31], s10 offen lds
    s_waitcnt vmcnt(4)
    s_lshr_b32 s4, s57, 3
    s_cmp_lg_u32 s4, 0
    s_cbranch_scc1 rs_5
    ds_read_b128 a[240:243], v88
    ds_read_b128 a[244:247], v89
rs_5:
    ds_read_b128 v[128:131], v16 offset:0
    ds_read_b128 v[132:135], v17 offset:0
    ds_read_b128 v[136:139], v18 offset:0
    ds_read_b128 v[140:143], v19 offset:0
    ds_read_b128 v[144:147], v20 offset:0
    ds_read_b128 v[148:151], v21 offset:0
    ds_read_b128 v[152:155], v22 offset:0
    ds_read_b128 v[156:159], v23 offset:0
    ds_read_b128 v[160:163], v16 offset:256
    ds_read_b128 v[164:167], v17 offset:256
    ds_read_b128 v[168:171], v18 offset:256
    ds_read_b128 v[172:175], v19 offset:256
    ds_read_b128 v[176:179], v20 offset:256
    ds_read_b128 v[180:183], v21 offset:256
    ds_read_b128 v[184:187], v22 offset:256
    ds_read_b128 v[188:191], v23 offset:256
    s_lshl_b32 s5, s2, 2
    s_cmp_eq_u32 s58, 3
    s_cselect_b32 s5, s5, 0x1000
    s_cmp_lt_u32 s2, 48
    s_cselect_b32 s5, s5, 0x1000
    v_mov_b32 v8, 1
    s_mov_b64 exec, 1
    buffer_store_dword v8, off, s[52:55], s5 sc0 sc1
    s_mov_b64 exec, -1
    s_add_u32 m0, s16, 8192
    s_add_u32 s10, s0, 393216
    buffer_load_dwordx4 v4, s[28:31], s10 offen lds
    s_waitcnt lgkmcnt(15)
    v_dot2c_f32_bf16 v14, 0x3f803f80, v128
    v_dot2c_f32_bf16 v15, v128, v128
    v_dot2c_f32_bf16 v14, 0x3f803f80, v129
    v_dot2c_f32_bf16 v15, v129, v129
    v_dot2c_f32_bf16 v14, 0x3f803f80, v130
    v_dot2c_f32_bf16 v15, v130, v130
    v_dot2c_f32_bf16 v14, 0x3f803f80, v131
    v_dot2c_f32_bf16 v15, v131, v131
    s_waitcnt lgkmcnt(14)
    v_dot2c_f32_bf16 v14, 0x3f803f80, v132
    v_dot2c_f32_bf16 v15, v132, v132
    v_dot2c_f32_bf16 v14, 0x3f803f80, v133
    s_add_u32 m0, s17, 8192
    s_add_u32 s10, s1, 393216
    buffer_load_dwordx4 v4, s[28:31], s10 offen lds
    v_dot2c_f32_bf16 v15, v133, v133
    v_dot2c_f32_bf16 v14, 0x3f803f80, v134
    v_dot2c_f32_bf16 v15, v134, v134
    v_dot2c_f32_bf16 v14, 0x3f803f80, v135
    v_dot2c_f32_bf16 v15, v135, v135
    s_waitcnt lgkmcnt(13)
    v_dot2c_f32_bf16 v14, 0x3f803f80, v136
    v_dot2c_f32_bf16 v15, v136, v136
    v_dot2c_f32_bf16 v14, 0x3f803f80, v137
    v_dot2c_f32_bf16 v15, v137, v137
    v_dot2c_f32_bf16 v14, 0x3f803f80, v138
    v_dot2c_f32_bf16 v15, v138, v138
    v_dot2c_f32_bf16 v14, 0x3f803f80, v139
    v_dot2c_f32_bf16 v15, v139, v139
    s_add_u32 m0, s3, 8192
    s_add_u32 s10, s14, 393216
    buffer_load_dwordx4 v4, s[28:31], s10 offen lds
    s_waitcnt lgkmcnt(12)
    v_dot2c_f32_bf16 v14, 0x3f803f80, v140
    v_dot2c_f32_bf16 v15, v140, v140
    v_dot2c_f32_bf16 v14, 0x3f803f80, v141
    v_dot2c_f32_bf16 v15, v141, v141
    v_dot2c_f32_bf16 v14, 0x3f803f80, v142
    v_dot2c_f32_bf16 v15, v142, v142
    v_dot2c_f32_bf16 v14, 0x3f803f80, v143
    v_dot2c_f32_bf16 v15, v143, v143
    s_waitcnt lgkmcnt(11)
    v_dot2c_f32_bf16 v14, 0x3f803f80, v144
    v_dot2c_f32_bf16 v15, v144, v144
    v_dot2c_f32_bf16 v14, 0x3f803f80, v145
    s_add_u32 m0, s99, 8192
    s_add_u32 s10, s15, 393216
    buffer_load_dwordx4 v4, s[28:31], s10 offen lds
    v_dot2c_f32_bf16 v15, v145, v145
    v_dot2c_f32_bf16 v14, 0x3f803f80, v146
    v_dot2c_f32_bf16 v15, v146, v146
    v_dot2c_f32_bf16 v14, 0x3f803f80, v147
    v_dot2c_f32_bf16 v15, v147, v147
    s_waitcnt lgkmcnt(10)
    v_dot2c_f32_bf16 v14, 0x3f803f80, v148
    v_dot2c_f32_bf16 v15, v148, v148
    v_dot2c_f32_bf16 v14, 0x3f803f80, v149
    v_dot2c_f32_bf16 v15, v149, v149
    v_dot2c_f32_bf16 v14, 0x3f803f80, v150
    v_dot2c_f32_bf16 v15, v150, v150
    v_dot2c_f32_bf16 v14, 0x3f803f80, v151
    v_dot2c_f32_bf16 v15, v151, v151
    s_waitcnt lgkmcnt(0)
    v_dot2c_f32_bf16 v14, 0x3f803f80, v152
    v_dot2c_f32_bf16 v15, v152, v152
    v_dot2c_f32_bf16 v14, 0x3f803f80, v153
    v_dot2c_f32_bf16 v15, v153, v153
    v_dot2c_f32_bf16 v14, 0x3f803f80, v154
    v_dot2c_f32_bf16 v15, v154, v154
    v_dot2c_f32_bf16 v14, 0x3f803f80, v155
    v_dot2c_f32_bf16 v15, v155, v155
    v_dot2c_f32_bf16 v14, 0x3f803f80, v156
    s_add_u32 m0, s22, 0
    s_add_u32 s10, s60, 512
    buffer_load_dwordx4 v24, s[24:27], s10 offen lds
    v_dot2c_f32_bf16 v15, v156, v156
    v_dot2c_f32_bf16 v14, 0x3f803f80, v157
    v_dot2c_f32_bf16 v15, v157, v157
    v_dot2c_f32_bf16 v14, 0x3f803f80, v158
    v_dot2c_f32_bf16 v15, v158, v158
    v_dot2c_f32_bf16 v14, 0x3f803f80, v159
    v_dot2c_f32_bf16 v15, v159, v159
    v_dot2c_f32_bf16 v14, 0x3f803f80, v160
    v_dot2c_f32_bf16 v15, v160, v160
    v_dot2c_f32_bf16 v14, 0x3f803f80, v161
    s_add_u32 m0, s22, 1024
    s_add_u32 s10, s60, 2560
    buffer_load_dwordx4 v25, s[24:27], s10 offen lds
    v_dot2c_f32_bf16 v15, v161, v161
    v_dot2c_f32_bf16 v14, 0x3f803f80, v162
    v_dot2c_f32_bf16 v15, v162, v162
    v_dot2c_f32_bf16 v14, 0x3f803f80, v163
    v_dot2c_f32_bf16 v15, v163, v163
    v_dot2c_f32_bf16 v14, 0x3f803f80, v164
    v_dot2c_f32_bf16 v15, v164, v164
    v_dot2c_f32_bf16 v14, 0x3f803f80, v165
    v_dot2c_f32_bf16 v15, v165, v165
    v_dot2c_f32_bf16 v14, 0x3f803f80, v166
    s_add_u32 m0, s22, 2048
    s_add_u32 s10, s60, 4608
    buffer_load_dwordx4 v26, s[24:27], s10 offen lds
    v_dot2c_f32_bf16 v15, v166, v166
    v_dot2c_f32_bf16 v14, 0x3f803f80, v167
    v_dot2c_f32_bf16 v15, v167, v167
    v_dot2c_f32_bf16 v14, 0x3f803f80, v168
    v_dot2c_f32_bf16 v15, v168, v168
    v_dot2c_f32_bf16 v14, 0x3f803f80, v169
    v_dot2c_f32_bf16 v15, v169, v169
    v_dot2c_f32_bf16 v14, 0x3f803f80, v170
    v_dot2c_f32_bf16 v15, v170, v170
    v_dot2c_f32_bf16 v14, 0x3f803f80, v171
    v_dot2c_f32_bf16 v15, v171, v171
    s_add_u32 m0, s22, 3072
    s_add_u32 s10, s60, 6656
    buffer_load_dwordx4 v27, s[24:27], s10 offen lds
    v_dot2c_f32_bf16 v14, 0x3f803f80, v172
    v_dot2c_f32_bf16 v15, v172, v172
    v_dot2c_f32_bf16 v14, 0x3f803f80, v173
    v_dot2c_f32_bf16 v15, v173, v173
    v_dot2c_f32_bf16 v14, 0x3f803f80, v174
    v_dot2c_f32_bf16 v15, v174, v174
    v_dot2c_f32_bf16 v14, 0x3f803f80, v175
    v_dot2c_f32_bf16 v15, v175, v175
    v_dot2c_f32_bf16 v14, 0x3f803f80, v176
    s_add_u32 m0, s22, 4096
    s_add_u32 s10, s60, 8704
    buffer_load_dwordx4 v28, s[24:27], s10 offen lds
    v_dot2c_f32_bf16 v15, v176, v176
    v_dot2c_f32_bf16 v14, 0x3f803f80, v177
    v_dot2c_f32_bf16 v15, v177, v177
    v_dot2c_f32_bf16 v14, 0x3f803f80, v178
    v_dot2c_f32_bf16 v15, v178, v178
    v_dot2c_f32_bf16 v14, 0x3f803f80, v179
    v_dot2c_f32_bf16 v15, v179, v179
    v_dot2c_f32_bf16 v14, 0x3f803f80, v180
    v_dot2c_f32_bf16 v15, v180, v180
    v_dot2c_f32_bf16 v14, 0x3f803f80, v181
    s_waitcnt vmcnt(10)
    s_barrier
    v_dot2c_f32_bf16 v15, v181, v181
    v_dot2c_f32_bf16 v14, 0x3f803f80, v182
    v_dot2c_f32_bf16 v15, v182, v182
    v_dot2c_f32_bf16 v14, 0x3f803f80, v183
    v_dot2c_f32_bf16 v15, v183, v183
    v_dot2c_f32_bf16 v14, 0x3f803f80, v184
    v_dot2c_f32_bf16 v15, v184, v184
    v_dot2c_f32_bf16 v14, 0x3f803f80, v185
    v_dot2c_f32_bf16 v15, v185, v185
    v_dot2c_f32_bf16 v14, 0x3f803f80, v186
    ds_read_b64_tr_b16 v[64:65], v2 offset:0
    ds_read_b64_tr_b16 v[66:67], v2 offset:256
    ds_read_b64_tr_b16 v[68:69], v2 offset:32768
    ds_read_b64_tr_b16 v[70:71], v2 offset:33024
    ds_read_b64_tr_b16 v[72:73], v2 offset:1024
    ds_read_b64_tr_b16 v[74:75], v2 offset:1280
    ds_read_b64_tr_b16 v[76:77], v2 offset:33792
    ds_read_b64_tr_b16 v[78:79], v2 offset:34048
    ds_read_b64_tr_b16 v[80:81], v2 offset:2048
    ds_read_b64_tr_b16 v[82:83], v2 offset:2304
    ds_read_b64_tr_b16 v[84:85], v2 offset:34816
    ds_read_b64_tr_b16 v[86:87], v2 offset:35072
    v_dot2c_f32_bf16 v15, v186, v186
    v_dot2c_f32_bf16 v14, 0x3f803f80, v187
    v_dot2c_f32_bf16 v15, v187, v187
    v_dot2c_f32_bf16 v14, 0x3f803f80, v188
    v_dot2c_f32_bf16 v15, v188, v188
    v_dot2c_f32_bf16 v14, 0x3f803f80, v189
    v_dot2c_f32_bf16 v15, v189, v189
    v_dot2c_f32_bf16 v14, 0x3f803f80, v190
    v_dot2c_f32_bf16 v15, v190, v190
    v_dot2c_f32_bf16 v14, 0x3f803f80, v191
    v_dot2c_f32_bf16 v15, v191, v191
    s_waitcnt lgkmcnt(8)
    v_mfma_f32_32x32x16_bf16 v[32:47], v[64:67], v[128:131], 0
    ds_read_b64_tr_b16 v[64:65], v2 offset:3072
    ds_read_b64_tr_b16 v[66:67], v2 offset:3328
    ds_read_b64_tr_b16 v[96:97], v10 offset:0
    ds_read_b64_tr_b16 v[98:99], v10 offset:256
    ds_read_b64_tr_b16 v[100:101], v10 offset:1024
    ds_read_b64_tr_b16 v[102:103], v10 offset:1280
    v_mfma_f32_32x32x16_bf16 v[48:63], v[128:131], v[68:71], 0
    ds_read_b64_tr_b16 v[68:69], v2 offset:35840
    ds_read_b64_tr_b16 v[70:71], v2 offset:36096
    ds_read_b64_tr_b16 v[104:105], v10 offset:32768
    ds_read_b64_tr_b16 v[106:107], v10 offset:33024
    ds_read_b64_tr_b16 v[108:109], v10 offset:33792
    s_waitcnt lgkmcnt(15)
    v_mfma_f32_32x32x16_bf16 v[32:47], v[72:75], v[132:135], v[32:47]
    ds_read_b64_tr_b16 v[72:73], v2 offset:4096
    ds_read_b64_tr_b16 v[74:75], v2 offset:4352
    ds_read_b64_tr_b16 v[110:111], v10 offset:34048
    s_add_u32 m0, s22, 5120
    s_add_u32 s10, s60, 10752
    buffer_load_dwordx4 v29, s[24:27], s10 offen lds
    v_mfma_f32_32x32x16_bf16 v[48:63], v[132:135], v[76:79], v[48:63]
    ds_read_b64_tr_b16 v[76:77], v2 offset:36864
    ds_read_b64_tr_b16 v[78:79], v2 offset:37120
    s_add_u32 m0, s22, 6144
    s_add_u32 s10, s60, 12800
    buffer_load_dwordx4 v30, s[24:27], s10 offen lds
    s_waitcnt lgkmcnt(15)
    v_mfma_f32_32x32x16_bf16 v[32:47], v[80:83], v[136:139], v[32:47]
    ds_read_b64_tr_b16 v[80:81], v2 offset:5120
    ds_read_b64_tr_b16 v[82:83], v2 offset:5376
    s_add_u32 m0, s22, 7168
    s_add_u32 s10, s60, 14848
    buffer_load_dwordx4 v31, s[24:27], s10 offen lds
    v_mfma_f32_32x32x16_bf16 v[48:63], v[136:139], v[84:87], v[48:63]
    ds_read_b64_tr_b16 v[84:85], v2 offset:37888
    ds_read_b64_tr_b16 v[86:87], v2 offset:38144
    s_add_u32 m0, s22, 8192
    s_add_u32 s10, s60, 16896
    buffer_load_dwordx4 v24, s[24:27], s10 offen lds
    s_waitcnt lgkmcnt(12)
    v_mfma_f32_32x32x16_bf16 v[32:47], v[64:67], v[140:143], v[32:47]
    ds_read_b64_tr_b16 v[64:65], v2 offset:6144
    ds_read_b64_tr_b16 v[66:67], v2 offset:6400
    v_mfma_f32_32x32x16_bf16 v[48:63], v[140:143], v[68:71], v[48:63]
    ds_read_b64_tr_b16 v[68:69], v2 offset:38912
    ds_read_b64_tr_b16 v[70:71], v2 offset:39168
    s_add_u32 m0, s22, 9216
    s_add_u32 s10, s60, 18944
    buffer_load_dwordx4 v25, s[24:27], s10 offen lds
    s_waitcnt lgkmcnt(8)
    v_mfma_f32_32x32x16_bf16 v[32:47], v[72:75], v[144:147], v[32:47]
    ds_read_b64_tr_b16 v[72:73], v2 offset:7168
    ds_read_b64_tr_b16 v[74:75], v2 offset:7424
    s_add_u32 m0, s22, 10240
    s_add_u32 s10, s60, 20992
    buffer_load_dwordx4 v26, s[24:27], s10 offen lds
    v_mfma_f32_32x32x16_bf16 v[48:63], v[144:147], v[76:79], v[48:63]
    ds_read_b64_tr_b16 v[76:77], v2 offset:39936
    ds_read_b64_tr_b16 v[78:79], v2 offset:40192
    s_waitcnt lgkmcnt(8)
    v_mfma_f32_32x32x16_bf16 v[32:47], v[80:83], v[148:151], v[32:47]
    s_waitcnt vmcnt(11)
    s_barrier
    ds_read_b64_tr_b16 v[80:81], v2 offset:8192
    ds_read_b64_tr_b16 v[82:83], v2 offset:8448
    s_add_u32 m0, s22, 11264
    s_add_u32 s10, s60, 23040
    buffer_load_dwordx4 v27, s[24:27], s10 offen lds
    v_mfma_f32_32x32x16_bf16 v[48:63], v[148:151], v[84:87], v[48:63]
    ds_read_b64_tr_b16 v[84:85], v2 offset:40960
    ds_read_b64_tr_b16 v[86:87], v2 offset:41216
    s_add_u32 m0, s22, 12288
    s_add_u32 s10, s60, 25088
    buffer_load_dwordx4 v28, s[24:27], s10 offen lds
    s_waitcnt lgkmcnt(8)
    v_mfma_f32_32x32x16_bf16 v[32:47], v[64:67], v[152:155], v[32:47]
    ds_read_b64_tr_b16 v[64:65], v2 offset:9216
    ds_read_b64_tr_b16 v[66:67], v2 offset:9472
    v_mfma_f32_32x32x16_bf16 v[48:63], v[152:155], v[68:71], v[48:63]
    ds_read_b64_tr_b16 v[68:69], v2 offset:41984
    ds_read_b64_tr_b16 v[70:71], v2 offset:42240
    s_add_u32 m0, s22, 13312
    s_add_u32 s10, s60, 27136
    buffer_load_dwordx4 v29, s[24:27], s10 offen lds
    s_waitcnt lgkmcnt(8)
    v_mfma_f32_32x32x16_bf16 v[32:47], v[72:75], v[156:159], v[32:47]
    ds_read_b64_tr_b16 v[72:73], v2 offset:10240
    ds_read_b64_tr_b16 v[74:75], v2 offset:10496
    s_add_u32 m0, s22, 14336
    s_add_u32 s10, s60, 29184
    buffer_load_dwordx4 v30, s[24:27], s10 offen lds
    v_mfma_f32_32x32x16_bf16 v[48:63], v[156:159], v[76:79], v[48:63]
    ds_read_b64_tr_b16 v[76:77], v2 offset:43008
    ds_read_b64_tr_b16 v[78:79], v2 offset:43264
    s_waitcnt lgkmcnt(8)
    v_mfma_f32_32x32x16_bf16 v[32:47], v[80:83], v[160:163], v[32:47]
    ds_read_b64_tr_b16 v[80:81], v2 offset:11264
    ds_read_b64_tr_b16 v[82:83], v2 offset:11520
    s_add_u32 m0, s22, 15360
    s_add_u32 s10, s60, 31232
    buffer_load_dwordx4 v31, s[24:27], s10 offen lds
    v_mfma_f32_32x32x16_bf16 v[48:63], v[160:163], v[84:87], v[48:63]
    ds_read_b64_tr_b16 v[84:85], v2 offset:44032
    ds_read_b64_tr_b16 v[86:87], v2 offset:44288
    s_waitcnt lgkmcnt(8)
    v_mfma_f32_32x32x16_bf16 v[32:47], v[64:67], v[164:167], v[32:47]
    ds_read_b64_tr_b16 v[64:65], v2 offset:12288
    ds_read_b64_tr_b16 v[66:67], v2 offset:12544
    s_add_u32 m0, s16, 16384
    s_add_u32 s10, s0, 786432
    buffer_load_dwordx4 v4, s[28:31], s10 offen lds
    v_mfma_f32_32x32x16_bf16 v[48:63], v[164:167], v[68:71], v[48:63]
    ds_read_b64_tr_b16 v[68:69], v2 offset:45056
    ds_read_b64_tr_b16 v[70:71], v2 offset:45312
    s_waitcnt lgkmcnt(8)
    v_mfma_f32_32x32x16_bf16 v[32:47], v[72:75], v[168:171], v[32:47]
    ds_read_b64_tr_b16 v[72:73], v2 offset:13312
    ds_read_b64_tr_b16 v[74:75], v2 offset:13568
    s_add_u32 m0, s17, 16384
    s_add_u32 s10, s1, 786432
    buffer_load_dwordx4 v4, s[28:31], s10 offen lds
    ds_read_b64_tr_b16 v[112:113], v10 offset:8192
    v_mfma_f32_32x32x16_bf16 v[48:63], v[168:171], v[76:79], v[48:63]
    ds_read_b64_tr_b16 v[76:77], v2 offset:46080
    ds_read_b64_tr_b16 v[78:79], v2 offset:46336
    ds_read_b64_tr_b16 v[114:115], v10 offset:8448
    ds_read_b64_tr_b16 v[116:117], v10 offset:9216
    ds_read_b64_tr_b16 v[118:119], v10 offset:9472
    s_waitcnt lgkmcnt(12)
    v_mfma_f32_32x32x16_bf16 v[32:47], v[80:83], v[172:175], v[32:47]
    ds_read_b64_tr_b16 v[80:81], v2 offset:14336
    ds_read_b64_tr_b16 v[82:83], v2 offset:14592
    ds_read_b64_tr_b16 v[120:121], v10 offset:40960
    ds_read_b64_tr_b16 v[122:123], v10 offset:41216
    ds_read_b64_tr_b16 v[124:125], v10 offset:41984
    ds_read_b64_tr_b16 v[126:127], v10 offset:42240
    v_mfma_f32_32x32x16_bf16 v[48:63], v[172:175], v[84:87], v[48:63]
    ds_read_b64_tr_b16 v[84:85], v2 offset:47104
    ds_read_b64_tr_b16 v[86:87], v2 offset:47360
    s_add_u32 m0, s3, 16384
    s_add_u32 s10, s14, 786432
    buffer_load_dwordx4 v4, s[28:31], s10 offen lds
    s_waitcnt lgkmcnt(15)
    v_mfma_f32_32x32x16_bf16 v[32:47], v[64:67], v[176:179], v[32:47]
    ds_read_b64_tr_b16 v[64:65], v2 offset:15360
    ds_read_b64_tr_b16 v[66:67], v2 offset:15616
    s_add_u32 m0, s99, 16384
    s_add_u32 s10, s15, 786432
    buffer_load_dwordx4 v4, s[28:31], s10 offen lds
    v_mfma_f32_32x32x16_bf16 v[48:63], v[176:179], v[68:71], v[48:63]
    ds_read_b64_tr_b16 v[68:69], v2 offset:48128
    ds_read_b64_tr_b16 v[70:71], v2 offset:48384
    s_waitcnt lgkmcnt(15)
    v_mfma_f32_32x32x16_bf16 v[32:47], v[72:75], v[180:183], v[32:47]
    s_waitcnt vmcnt(4)
    s_lshr_b32 s4, s57, 3
    s_cmp_lg_u32 s4, 1
    s_cbranch_scc1 rs_6
    ds_read_b128 a[240:243], v88
    ds_read_b128 a[244:247], v89
rs_6:
    v_mfma_f32_32x32x16_bf16 v[48:63], v[180:183], v[76:79], v[48:63]
    ds_read_b128 v[192:195], v16 offset:0
    ds_read_b128 v[196:199], v17 offset:0
    ds_read_b128 v[200:203], v18 offset:0
    ds_read_b128 v[204:207], v19 offset:0
    ds_read_b128 v[208:211], v20 offset:0
    s_waitcnt lgkmcnt(9)
    v_mfma_f32_32x32x16_bf16 v[32:47], v[80:83], v[184:187], v[32:47]
    ds_read_b128 v[212:215], v21 offset:0
    ds_read_b128 v[216:219], v22 offset:0
    ds_read_b128 v[220:223], v23 offset:0
    ds_read_b128 v[224:227], v16 offset:256
    ds_read_b128 v[228:231], v17 offset:256
    ds_read_b128 v[232:235], v18 offset:256
    v_mfma_f32_32x32x16_bf16 v[48:63], v[184:187], v[84:87], v[48:63]
    ds_read_b128 v[236:239], v19 offset:256
    ds_read_b128 v[240:243], v20 offset:256
    ds_read_b128 v[244:247], v21 offset:256
    ds_read_b128 v[248:251], v22 offset:256
    ds_read_b128 v[252:255], v23 offset:256
    s_waitcnt lgkmcnt(15)
    v_mfma_f32_32x32x16_bf16 v[32:47], v[64:67], v[188:191], v[32:47]
    v_mfma_f32_32x32x16_bf16 v[48:63], v[188:191], v[68:71], v[48:63]
    s_add_u32 m0, s16, 24576
    s_add_u32 s10, s0, 1179648
    buffer_load_dwordx4 v4, s[28:31], s10 offen lds
    v_dot2c_f32_bf16 v12, 0x3f803f80, v96
    v_dot2c_f32_bf16 v13, 0x3f803f80, v104
    v_dot2c_f32_bf16 v12, 0x3f803f80, v97
    v_dot2c_f32_bf16 v13, 0x3f803f80, v105
    v_dot2c_f32_bf16 v12, 0x3f803f80, v98
    v_dot2c_f32_bf16 v13, 0x3f803f80, v106
    v_dot2c_f32_bf16 v12, 0x3f803f80, v99
    v_dot2c_f32_bf16 v13, 0x3f803f80, v107
    v_dot2c_f32_bf16 v12, 0x3f803f80, v100
    v_dot2c_f32_bf16 v13, 0x3f803f80, v108
    v_dot2c_f32_bf16 v12, 0x3f803f80, v101
    v_dot2c_f32_bf16 v13, 0x3f803f80, v109
    v_dot2c_f32_bf16 v12, 0x3f803f80, v102
    v_dot2c_f32_bf16 v13, 0x3f803f80, v110
    v_dot2c_f32_bf16 v12, 0x3f803f80, v103
    v_dot2c_f32_bf16 v13, 0x3f803f80, v111
    v_dot2c_f32_bf16 v12, 0x3f803f80, v112
    s_add_u32 m0, s17, 24576
    s_add_u32 s10, s1, 1179648
    buffer_load_dwordx4 v4, s[28:31], s10 offen lds
    v_dot2c_f32_bf16 v13, 0x3f803f80, v120
    v_dot2c_f32_bf16 v12, 0x3f803f80, v113
    v_dot2c_f32_bf16 v13, 0x3f803f80, v121
    v_dot2c_f32_bf16 v12, 0x3f803f80, v114
    v_dot2c_f32_bf16 v13, 0x3f803f80, v122
    v_dot2c_f32_bf16 v12, 0x3f803f80, v115
    v_dot2c_f32_bf16 v13, 0x3f803f80, v123
    v_dot2c_f32_bf16 v12, 0x3f803f80, v116
    v_dot2c_f32_bf16 v13, 0x3f803f80, v124
    v_dot2c_f32_bf16 v12, 0x3f803f80, v117
    v_dot2c_f32_bf16 v13, 0x3f803f80, v125
    v_dot2c_f32_bf16 v12, 0x3f803f80, v118
    v_dot2c_f32_bf16 v13, 0x3f803f80, v126
    v_dot2c_f32_bf16 v12, 0x3f803f80, v119
    v_dot2c_f32_bf16 v13, 0x3f803f80, v127
    s_waitcnt lgkmcnt(15)
    v_dot2c_f32_bf16 v14, 0x3f803f80, v192
    v_dot2c_f32_bf16 v15, v192, v192
    v_dot2c_f32_bf16 v14, 0x3f803f80, v193
    v_dot2c_f32_bf16 v15, v193, v193
    s_add_u32 m0, s3, 24576
    s_add_u32 s10, s14, 1179648
    buffer_load_dwordx4 v4, s[28:31], s10 offen lds
    v_dot2c_f32_bf16 v14, 0x3f803f80, v194
    v_dot2c_f32_bf16 v15, v194, v194
    v_dot2c_f32_bf16 v14, 0x3f803f80, v195
    v_dot2c_f32_bf16 v15, v195, v195
    s_waitcnt lgkmcnt(14)
    v_dot2c_f32_bf16 v14, 0x3f803f80, v196
    v_dot2c_f32_bf16 v15, v196, v196
    v_dot2c_f32_bf16 v14, 0x3f803f80, v197
    v_dot2c_f32_bf16 v15, v197, v197
    v_dot2c_f32_bf16 v14, 0x3f803f80, v198
    v_dot2c_f32_bf16 v15, v198, v198
    v_dot2c_f32_bf16 v14, 0x3f803f80, v199
    v_dot2c_f32_bf16 v15, v199, v199
    s_waitcnt lgkmcnt(13)
    v_dot2c_f32_bf16 v14, 0x3f803f80, v200
    v_dot2c_f32_bf16 v15, v200, v200
    v_dot2c_f32_bf16 v14, 0x3f803f80, v201
    v_dot2c_f32_bf16 v15, v201, v201
    v_dot2c_f32_bf16 v14, 0x3f803f80, v202
    v_dot2c_f32_bf16 v15, v202, v202
    s_add_u32 m0, s99, 24576
    s_add_u32 s10, s15, 1179648
    buffer_load_dwordx4 v4, s[28:31], s10 offen lds
    v_dot2c_f32_bf16 v14, 0x3f803f80, v203
    v_dot2c_f32_bf16 v15, v203, v203
    s_waitcnt lgkmcnt(12)
    v_dot2c_f32_bf16 v14, 0x3f803f80, v204
    v_dot2c_f32_bf16 v15, v204, v204
    v_dot2c_f32_bf16 v14, 0x3f803f80, v205
    v_dot2c_f32_bf16 v15, v205, v205
    v_dot2c_f32_bf16 v14, 0x3f803f80, v206
    v_dot2c_f32_bf16 v15, v206, v206
    v_dot2c_f32_bf16 v14, 0x3f803f80, v207
    v_dot2c_f32_bf16 v15, v207, v207
    s_waitcnt lgkmcnt(11)
    v_dot2c_f32_bf16 v14, 0x3f803f80, v208
    v_dot2c_f32_bf16 v15, v208, v208
    v_dot2c_f32_bf16 v14, 0x3f803f80, v209
    v_dot2c_f32_bf16 v15, v209, v209
    v_dot2c_f32_bf16 v14, 0x3f803f80, v210
    v_dot2c_f32_bf16 v15, v210, v210
    v_dot2c_f32_bf16 v14, 0x3f803f80, v211
    v_dot2c_f32_bf16 v15, v211, v211
    s_lshl_b32 s4, s2, 2
    s_add_u32 s4, s4, s58
    s_mul_i32 s5, s4, 1536
    s_lshl_b32 s4, s4, 9
    v_lshlrev_b32_e64 v90, 7, v0
    s_mov_b64 exec, 0xfff
    buffer_load_dword a255, v90, s[32:35], s5 offen
    s_mov_b64 exec, 0xf
    buffer_load_dword a255, v90, s[36:39], s4 offen
    buffer_load_dword a255, v90, s[40:43], s4 offen
    s_mov_b64 exec, -1
    s_waitcnt lgkmcnt(10)
    v_dot2c_f32_bf16 v14, 0x3f803f80, v212
    v_dot2c_f32_bf16 v15, v212, v212
    v_dot2c_f32_bf16 v14, 0x3f803f80, v213
    v_dot2c_f32_bf16 v15, v213, v213
    v_dot2c_f32_bf16 v14, 0x3f803f80, v214
    v_dot2c_f32_bf16 v15, v214, v214
    v_dot2c_f32_bf16 v14, 0x3f803f80, v215
    v_dot2c_f32_bf16 v15, v215, v215
    s_waitcnt lgkmcnt(9)
    v_dot2c_f32_bf16 v14, 0x3f803f80, v216
    v_dot2c_f32_bf16 v15, v216, v216
    v_dot2c_f32_bf16 v14, 0x3f803f80, v217
    v_dot2c_f32_bf16 v15, v217, v217
    v_dot2c_f32_bf16 v14, 0x3f803f80, v218
    v_dot2c_f32_bf16 v15, v218, v218
    v_dot2c_f32_bf16 v14, 0x3f803f80, v219
    v_dot2c_f32_bf16 v15, v219, v219
    s_waitcnt lgkmcnt(8)
    s_waitcnt vmcnt(7)
    s_barrier
    v_dot2c_f32_bf16 v14, 0x3f803f80, v220
    v_dot2c_f32_bf16 v15, v220, v220
    v_dot2c_f32_bf16 v14, 0x3f803f80, v221
    v_dot2c_f32_bf16 v15, v221, v221
    v_dot2c_f32_bf16 v14, 0x3f803f80, v222
    v_dot2c_f32_bf16 v15, v222, v222
    v_dot2c_f32_bf16 v14, 0x3f803f80, v223
    v_dot2c_f32_bf16 v15, v223, v223
    s_waitcnt lgkmcnt(7)
    v_dot2c_f32_bf16 v14, 0x3f803f80, v224
    v_dot2c_f32_bf16 v15, v224, v224
    v_dot2c_f32_bf16 v14, 0x3f803f80, v225
    v_dot2c_f32_bf16 v15, v225, v225
    v_dot2c_f32_bf16 v14, 0x3f803f80, v226
    v_dot2c_f32_bf16 v15, v226, v226
    v_dot2c_f32_bf16 v14, 0x3f803f80, v227
    v_dot2c_f32_bf16 v15, v227, v227
    s_waitcnt lgkmcnt(6)
    v_dot2c_f32_bf16 v14, 0x3f803f80, v228
    v_dot2c_f32_bf16 v15, v228, v228
    ds_read_b64_tr_b16 v[112:113], v10 offset:16384
    ds_read_b64_tr_b16 v[114:115], v10 offset:16640
    ds_read_b64_tr_b16 v[116:117], v10 offset:17408
    ds_read_b64_tr_b16 v[118:119], v10 offset:17664
    ds_read_b64_tr_b16 v[120:121], v10 offset:49152
    ds_read_b64_tr_b16 v[122:123], v10 offset:49408
    ds_read_b64_tr_b16 v[124:125], v10 offset:50176
    ds_read_b64_tr_b16 v[126:127], v10 offset:50432
    v_dot2c_f32_bf16 v14, 0x3f803f80, v229
    v_dot2c_f32_bf16 v15, v229, v229
    v_dot2c_f32_bf16 v14, 0x3f803f80, v230
    v_dot2c_f32_bf16 v15, v230, v230
    v_dot2c_f32_bf16 v14, 0x3f803f80, v231
    v_dot2c_f32_bf16 v15, v231, v231
    s_waitcnt lgkmcnt(13)
    v_dot2c_f32_bf16 v14, 0x3f803f80, v232
    v_dot2c_f32_bf16 v15, v232, v232
    v_dot2c_f32_bf16 v14, 0x3f803f80, v233
    v_dot2c_f32_bf16 v15, v233, v233
    v_dot2c_f32_bf16 v14, 0x3f803f80, v234
    v_dot2c_f32_bf16 v15, v234, v234
    v_dot2c_f32_bf16 v14, 0x3f803f80, v235
    v_dot2c_f32_bf16 v15, v235, v235
    s_waitcnt lgkmcnt(12)
    v_dot2c_f32_bf16 v14, 0x3f803f80, v236
    v_dot2c_f32_bf16 v15, v236, v236
    v_dot2c_f32_bf16 v14, 0x3f803f80, v237
    v_dot2c_f32_bf16 v15, v237, v237
    s_add_u32 s10, s8, 0
    buffer_load_dwordx4 a[0:3], v4, s[28:31], s10 offen
    v_dot2c_f32_bf16 v14, 0x3f803f80, v238
    v_dot2c_f32_bf16 v15, v238, v238
    v_dot2c_f32_bf16 v14, 0x3f803f80, v239
    v_dot2c_f32_bf16 v15, v239, v239
    s_waitcnt lgkmcnt(11)
    v_dot2c_f32_bf16 v14, 0x3f803f80, v240
    v_dot2c_f32_bf16 v15, v240, v240
    v_dot2c_f32_bf16 v14, 0x3f803f80, v241
    v_dot2c_f32_bf16 v15, v241, v241
    v_dot2c_f32_bf16 v14, 0x3f803f80, v242
    v_dot2c_f32_bf16 v15, v242, v242
    v_dot2c_f32_bf16 v14, 0x3f803f80, v243
    v_dot2c_f32_bf16 v15, v243, v243
    s_waitcnt lgkmcnt(10)
    v_dot2c_f32_bf16 v14, 0x3f803f80, v244
    v_dot2c_f32_bf16 v15, v244, v244
    v_dot2c_f32_bf16 v14, 0x3f803f80, v245
    v_dot2c_f32_bf16 v15, v245, v245
    v_dot2c_f32_bf16 v14, 0x3f803f80, v246
    v_dot2c_f32_bf16 v15, v246, v246
    ds_read_b64_tr_b16 v[72:73], v2 offset:16384
    ds_read_b64_tr_b16 v[74:75], v2 offset:16640
    ds_read_b64_tr_b16 v[76:77], v2 offset:49152
    ds_read_b64_tr_b16 v[78:79], v2 offset:49408
    ds_read_b64_tr_b16 v[80:81], v2 offset:17408
    ds_read_b64_tr_b16 v[82:83], v2 offset:17664
    ds_read_b64_tr_b16 v[84:85], v2 offset:50176
    ds_read_b64_tr_b16 v[86:87], v2 offset:50432
    ds_read_b64_tr_b16 v[64:65], v2 offset:18432
    ds_read_b64_tr_b16 v[66:67], v2 offset:18688
    ds_read_b64_tr_b16 v[68:69], v2 offset:51200
    ds_read_b64_tr_b16 v[70:71], v2 offset:51456
    v_dot2c_f32_bf16 v14, 0x3f803f80, v247
    v_dot2c_f32_bf16 v15, v247, v247
    s_waitcnt lgkmcnt(15)
    v_dot2c_f32_bf16 v14, 0x3f803f80, v248
    v_dot2c_f32_bf16 v15, v248, v248
    v_dot2c_f32_bf16 v14, 0x3f803f80, v249
    v_dot2c_f32_bf16 v15, v249, v249
    v_dot2c_f32_bf16 v14, 0x3f803f80, v250
    v_dot2c_f32_bf16 v15, v250, v250
    v_dot2c_f32_bf16 v14, 0x3f803f80, v251
    v_dot2c_f32_bf16 v15, v251, v251
    s_waitcnt lgkmcnt(15)
    v_dot2c_f32_bf16 v14, 0x3f803f80, v252
    v_dot2c_f32_bf16 v15, v252, v252
    v_dot2c_f32_bf16 v14, 0x3f803f80, v253
    v_dot2c_f32_bf16 v15, v253, v253
    v_dot2c_f32_bf16 v14, 0x3f803f80, v254
    v_dot2c_f32_bf16 v15, v254, v254
    v_dot2c_f32_bf16 v14, 0x3f803f80, v255
    v_dot2c_f32_bf16 v15, v255, v255
    s_waitcnt lgkmcnt(12)
    v_dot2c_f32_bf16 v12, 0x3f803f80, v112
    v_dot2c_f32_bf16 v13, 0x3f803f80, v120
    v_dot2c_f32_bf16 v12, 0x3f803f80, v113
    v_dot2c_f32_bf16 v13, 0x3f803f80, v121
    v_dot2c_f32_bf16 v12, 0x3f803f80, v114
    v_dot2c_f32_bf16 v13, 0x3f803f80, v122
    v_dot2c_f32_bf16 v12, 0x3f803f80, v115
    v_dot2c_f32_bf16 v13, 0x3f803f80, v123
    v_dot2c_f32_bf16 v12, 0x3f803f80, v116
    v_dot2c_f32_bf16 v13, 0x3f803f80, v124
    v_dot2c_f32_bf16 v12, 0x3f803f80, v117
    v_dot2c_f32_bf16 v13, 0x3f803f80, v125
    v_dot2c_f32_bf16 v12, 0x3f803f80, v118
    v_dot2c_f32_bf16 v13, 0x3f803f80, v126
    v_dot2c_f32_bf16 v12, 0x3f803f80, v119
    v_dot2c_f32_bf16 v13, 0x3f803f80, v127
    s_mov_b32 s22, 0x3f803f80
    v_mov_b32 v96, v14
    v_mov_b32 v97, v15
    v_mov_b32 v98, v14
    v_mov_b32 v99, v15
    s_waitcnt lgkmcnt(8)
    v_mfma_f32_32x32x16_bf16 v[32:47], v[72:75], v[192:195], v[32:47]
    ds_read_b64_tr_b16 v[72:73], v2 offset:19456
    ds_read_b64_tr_b16 v[74:75], v2 offset:19712
    v_permlane32_swap_b32 v98, v96
    v_permlane32_swap_b32 v99, v97
    v_add_f32 v96, v96, v98
    v_add_f32 v97, v97, v99
    v_mfma_f32_32x32x16_bf16 v[48:63], v[192:195], v[76:79], v[48:63]
    ds_read_b64_tr_b16 v[76:77], v2 offset:52224
    ds_read_b64_tr_b16 v[78:79], v2 offset:52480
    v_mul_f32 v96, 0x3b000000, v96
    v_mul_f32 v97, 0x3b000000, v97
    v_fma_f32 v97, -v96, v96, v97
    s_waitcnt lgkmcnt(8)
    v_mfma_f32_32x32x16_bf16 v[32:47], v[80:83], v[196:199], v[32:47]
    ds_read_b64_tr_b16 v[80:81], v2 offset:20480
    ds_read_b64_tr_b16 v[82:83], v2 offset:20736
    v_max_f32 v97, 0, v97
    v_add_f32 v97, 0x3727c5ac, v97
    v_rsq_f32 v88, v97
    s_nop 0
    v_mul_f32 v90, v96, v88
    v_mfma_f32_32x32x16_bf16 v[48:63], v[196:199], v[84:87], v[48:63]
    ds_read_b64_tr_b16 v[84:85], v2 offset:53248
    ds_read_b64_tr_b16 v[86:87], v2 offset:53504
    s_lshl_b32 s5, s58, 8
    s_add_u32 s5, s5, 147456
    v_lshl_add_u32 v98, v0, 2, s5
    s_waitcnt lgkmcnt(8)
    v_mfma_f32_32x32x16_bf16 v[32:47], v[64:67], v[200:203], v[32:47]
    ds_read_b64_tr_b16 v[64:65], v2 offset:21504
    ds_read_b64_tr_b16 v[66:67], v2 offset:21760
    v_cndmask_b32 v99, v88, v90, s[12:13]
    ds_write_b32 v98, v99
    v_lshrrev_b32 v89, 5, v0
    v_lshlrev_b32 v91, 4, v89
    v_mfma_f32_32x32x16_bf16 v[48:63], v[200:203], v[68:71], v[48:63]
    ds_read_b64_tr_b16 v[68:69], v2 offset:54272
    ds_read_b64_tr_b16 v[70:71], v2 offset:54528
    v_add_u32_e64 v89, s5, v91
    v_add_u32 v91, 0x24400, v91
    ds_read_b128 v[96:99], v89 offset:0
    s_waitcnt lgkmcnt(10)
    v_mfma_f32_32x32x16_bf16 v[32:47], v[72:75], v[204:207], v[32:47]
    ds_read_b64_tr_b16 v[72:73], v2 offset:22528
    ds_read_b64_tr_b16 v[74:75], v2 offset:22784
    ds_read_b128 v[16:19], v89 offset:128
    ds_read_b128 v[100:103], v89 offset:32
    ds_read_b128 v[20:23], v89 offset:160
    ds_read_b128 v[104:107], v89 offset:64
    v_mfma_f32_32x32x16_bf16 v[48:63], v[204:207], v[76:79], v[48:63]
    ds_read_b64_tr_b16 v[76:77], v2 offset:55296
    ds_read_b64_tr_b16 v[78:79], v2 offset:55552
    ds_read_b128 v[24:27], v89 offset:192
    ds_read_b128 v[108:111], v89 offset:96
    ds_read_b128 v[28:31], v89 offset:224
    s_waitcnt lgkmcnt(15)
    v_mfma_f32_32x32x16_bf16 v[32:47], v[80:83], v[208:211], v[32:47]
    ds_read_b64_tr_b16 v[80:81], v2 offset:23552
    ds_read_b64_tr_b16 v[82:83], v2 offset:23808
    v_and_b32 v92, 31, v0
    v_lshlrev_b32 v93, 5, v92
    v_add_u32 v93, 0x24800, v93
    v_lshlrev_b32_e64 v92, 2, v92
    v_mfma_f32_32x32x16_bf16 v[48:63], v[208:211], v[84:87], v[48:63]
    ds_read_b64_tr_b16 v[84:85], v2 offset:56320
    ds_read_b64_tr_b16 v[86:87], v2 offset:56576
    v_add_u32 v92, 0x24400, v92
    s_add_u32 s10, s8, 49152
    buffer_load_dwordx4 a[4:7], v4, s[28:31], s10 offen
    s_waitcnt lgkmcnt(15)
    v_mfma_f32_32x32x16_bf16 v[32:47], v[64:67], v[212:215], v[32:47]
    s_waitcnt vmcnt(5)
    s_barrier
    ds_read_b64_tr_b16 v[112:113], v10 offset:24576
    ds_read_b64_tr_b16 v[114:115], v10 offset:24832
    ds_read_b64_tr_b16 v[116:117], v10 offset:25600
    ds_read_b64_tr_b16 v[118:119], v10 offset:25856
    ds_read_b64_tr_b16 v[120:121], v10 offset:57344
    ds_read_b64_tr_b16 v[122:123], v10 offset:57600
    ds_read_b64_tr_b16 v[124:125], v10 offset:58368
    ds_read_b64_tr_b16 v[126:127], v10 offset:58624
    ds_read_b64_tr_b16 v[64:65], v2 offset:24576
    ds_read_b64_tr_b16 v[66:67], v2 offset:24832
    v_mfma_f32_32x32x16_bf16 v[48:63], v[212:215], v[68:71], v[48:63]
    ds_read_b64_tr_b16 v[68:69], v2 offset:57344
    ds_read_b64_tr_b16 v[70:71], v2 offset:57600
    s_add_u32 s10, s8, 98304
    buffer_load_dwordx4 a[8:11], v4, s[28:31], s10 offen
    s_add_u32 s10, s8, 147456
    buffer_load_dwordx4 a[12:15], v4, s[28:31], s10 offen
    s_waitcnt lgkmcnt(15)
    v_mfma_f32_32x32x16_bf16 v[32:47], v[72:75], v[216:219], v[32:47]
    ds_read_b64_tr_b16 v[72:73], v2 offset:25600
    ds_read_b64_tr_b16 v[74:75], v2 offset:25856
    s_add_u32 s10, s8, 196608
    buffer_load_dwordx4 a[16:19], v4, s[28:31], s10 offen
    s_add_u32 s10, s8, 245760
    buffer_load_dwordx4 a[20:23], v4, s[28:31], s10 offen
    v_mfma_f32_32x32x16_bf16 v[48:63], v[216:219], v[76:79], v[48:63]
    ds_read_b64_tr_b16 v[76:77], v2 offset:58368
    ds_read_b64_tr_b16 v[78:79], v2 offset:58624
    s_add_u32 s10, s8, 294912
    buffer_load_dwordx4 a[24:27], v4, s[28:31], s10 offen
    s_waitcnt lgkmcnt(15)
    v_mfma_f32_32x32x16_bf16 v[32:47], v[80:83], v[220:223], v[32:47]
    s_waitcnt lgkmcnt(8)
    v_dot2c_f32_bf16 v12, 0x3f803f80, v112
    v_dot2c_f32_bf16 v13, 0x3f803f80, v120
    v_dot2c_f32_bf16 v12, 0x3f803f80, v113
    v_dot2c_f32_bf16 v13, 0x3f803f80, v121
    v_dot2c_f32_bf16 v12, 0x3f803f80, v114
    v_dot2c_f32_bf16 v13, 0x3f803f80, v122
    v_dot2c_f32_bf16 v12, 0x3f803f80, v115
    v_dot2c_f32_bf16 v13, 0x3f803f80, v123
    v_dot2c_f32_bf16 v12, 0x3f803f80, v116
    v_dot2c_f32_bf16 v13, 0x3f803f80, v124
    v_dot2c_f32_bf16 v12, 0x3f803f80, v117
    v_dot2c_f32_bf16 v13, 0x3f803f80, v125
    v_dot2c_f32_bf16 v12, 0x3f803f80, v118
    v_dot2c_f32_bf16 v13, 0x3f803f80, v126
    v_dot2c_f32_bf16 v12, 0x3f803f80, v119
    v_dot2c_f32_bf16 v13, 0x3f803f80, v127
    s_nop 0
    s_nop 0
    ds_write_b32 v9, v12 offset:1024
    ds_write_b32 v9, v13 offset:2048
    ds_read_b64_tr_b16 v[80:81], v2 offset:26624
    ds_read_b64_tr_b16 v[82:83], v2 offset:26880
    v_mfma_f32_32x32x16_bf16 v[48:63], v[220:223], v[84:87], v[48:63]
    ds_read_b64_tr_b16 v[84:85], v2 offset:59392
    ds_read_b64_tr_b16 v[86:87], v2 offset:59648
    s_waitcnt lgkmcnt(10)
    v_mfma_f32_32x32x16_bf16 v[32:47], v[64:67], v[224:227], v[32:47]
    ds_read_b64_tr_b16 v[64:65], v2 offset:27648
    ds_read_b64_tr_b16 v[66:67], v2 offset:27904
    s_add_u32 s10, s8, 344064
    buffer_load_dwordx4 a[28:31], v4, s[28:31], s10 offen
    v_mfma_f32_32x32x16_bf16 v[48:63], v[224:227], v[68:71], v[48:63]
    ds_read_b64_tr_b16 v[68:69], v2 offset:60416
    ds_read_b64_tr_b16 v[70:71], v2 offset:60672
    s_waitcnt lgkmcnt(10)
    v_mfma_f32_32x32x16_bf16 v[32:47], v[72:75], v[228:231], v[32:47]
    s_waitcnt lgkmcnt(8)
    s_barrier
    ds_read_b64_tr_b16 v[72:73], v2 offset:28672
    ds_read_b64_tr_b16 v[74:75], v2 offset:28928
    v_min_u32 v8, 47, v0
    v_lshlrev_b32 v8, 2, v8
    buffer_load_dword v8, v8, s[52:55], 0 offen sc1
    v_mfma_f32_32x32x16_bf16 v[48:63], v[228:231], v[76:79], v[48:63]
    ds_read_b64_tr_b16 v[76:77], v2 offset:61440
    ds_read_b64_tr_b16 v[78:79], v2 offset:61696
    s_lshr_b32 s11, s2, 3
    s_cmp_ge_u32 s58, 2
    s_cbranch_scc1 tt_7
    s_lshl_b32 s11, s11, 1
    s_add_u32 s11, s11, s58
    s_mul_i32 s11, s11, 24576
    v_lshrrev_b32 v14, 3, v0
    v_mul_u32_u24 v14, 3072, v14
    v_and_b32_e64 v15, 7, v0
    v_lshl_add_u32 v14, v15, 7, v14
    buffer_load_dword a255, v14, s[32:35], s11 offen offset:1024
tt_7:
    s_waitcnt lgkmcnt(8)
    v_mfma_f32_32x32x16_bf16 v[32:47], v[80:83], v[232:235], v[32:47]
    ds_read_b64_tr_b16 v[80:81], v2 offset:29696
    ds_read_b64_tr_b16 v[82:83], v2 offset:29952
    ds_read_b128 v[112:115], v93 offset:1024
    ds_read_b128 v[116:119], v93 offset:1040
    ds_read_b128 v[120:123], v93 offset:2048
    ds_read_b128 v[124:127], v93 offset:2064
    v_mfma_f32_32x32x16_bf16 v[48:63], v[232:235], v[84:87], v[48:63]
    ds_read_b64_tr_b16 v[84:85], v2 offset:62464
    ds_read_b64_tr_b16 v[86:87], v2 offset:62720
    s_waitcnt lgkmcnt(12)
    v_mfma_f32_32x32x16_bf16 v[32:47], v[64:67], v[236:239], v[32:47]
    ds_read_b64_tr_b16 v[64:65], v2 offset:30720
    ds_read_b64_tr_b16 v[66:67], v2 offset:30976
    v_mfma_f32_32x32x16_bf16 v[48:63], v[236:239], v[68:71], v[48:63]
    ds_read_b64_tr_b16 v[68:69], v2 offset:63488
    ds_read_b64_tr_b16 v[70:71], v2 offset:63744
    s_waitcnt lgkmcnt(8)
    v_add_f32 v112, v112, v114
    v_add_f32 v113, v113, v115
    v_mfma_f32_32x32x16_bf16 v[32:47], v[72:75], v[240:243], v[32:47]
    ds_read_b64_tr_b16 v[72:73], v2 offset:31744
    ds_read_b64_tr_b16 v[74:75], v2 offset:32000
    v_add_f32 v116, v116, v118
    v_add_f32 v117, v117, v119
    v_add_f32 v112, v112, v116
    v_add_f32 v113, v113, v117
    v_mfma_f32_32x32x16_bf16 v[48:63], v[240:243], v[76:79], v[48:63]
    ds_read_b64_tr_b16 v[76:77], v2 offset:64512
    ds_read_b64_tr_b16 v[78:79], v2 offset:64768
    v_add_f32 v112, v112, v113
    ds_write_b32 v92, v112 offset:128
    s_waitcnt lgkmcnt(11)
    s_waitcnt lgkmcnt(9)
    v_mfma_f32_32x32x16_bf16 v[32:47], v[80:83], v[244:247], v[32:47]
    v_add_f32 v120, v120, v122
    v_add_f32 v121, v121, v123
    v_add_f32 v124, v124, v126
    v_add_f32 v125, v125, v127
    v_add_f32 v120, v120, v124
    v_add_f32 v121, v121, v125
    v_mfma_f32_32x32x16_bf16 v[48:63], v[244:247], v[84:87], v[48:63]
    v_add_f32 v120, v120, v121
    ds_write_b32 v92, v120 offset:256
    v_and_b32 v93, 31, v0
    v_lshlrev_b32_e64 v93, 2, v93
    v_add_u32 v93, 0x24400, v93
    s_waitcnt lgkmcnt(6)
    v_mfma_f32_32x32x16_bf16 v[32:47], v[64:67], v[248:251], v[32:47]
    ds_read_b32 v92, v93 offset:256
    ds_read_b128 v[112:115], v91 offset:128
    ds_read_b128 v[116:119], v91 offset:160
    ds_read_b128 v[120:123], v91 offset:192
    ds_read_b128 v[124:127], v91 offset:224
    v_mfma_f32_32x32x16_bf16 v[48:63], v[248:251], v[68:71], v[48:63]
    s_waitcnt lgkmcnt(7)
    v_mfma_f32_32x32x16_bf16 v[32:47], v[72:75], v[252:255], v[32:47]
    v_mfma_f32_32x32x16_bf16 v[48:63], v[252:255], v[76:79], v[48:63]
    s_waitcnt lgkmcnt(0)
    s_lshl_b32 s4, s59, 4
    s_add_u32 s4, s4, s57
    s_lshl_b32 s4, s4, 12
    s_add_u32 s4, s4, 0x800000
    s_nop 5
    v_pk_mul_f32 v[32:33], v[32:33], v[88:89] op_sel_hi:[1,0]
    v_pk_mul_f32 v[34:35], v[34:35], v[88:89] op_sel_hi:[1,0]
    v_pk_mul_f32 v[36:37], v[36:37], v[88:89] op_sel_hi:[1,0]
    v_pk_mul_f32 v[38:39], v[38:39], v[88:89] op_sel_hi:[1,0]
    v_pk_mul_f32 v[40:41], v[40:41], v[88:89] op_sel_hi:[1,0]
    v_pk_mul_f32 v[42:43], v[42:43], v[88:89] op_sel_hi:[1,0]
    v_pk_mul_f32 v[44:45], v[44:45], v[88:89] op_sel_hi:[1,0]
    v_pk_mul_f32 v[46:47], v[46:47], v[88:89] op_sel_hi:[1,0]
    v_pk_fma_f32 v[32:33], v[112:113], v[90:91], v[32:33] op_sel_hi:[1,0,1] neg_lo:[0,1,0] neg_hi:[0,1,0]
    v_pk_fma_f32 v[34:35], v[114:115], v[90:91], v[34:35] op_sel_hi:[1,0,1] neg_lo:[0,1,0] neg_hi:[0,1,0]
    v_pk_fma_f32 v[36:37], v[116:117], v[90:91], v[36:37] op_sel_hi:[1,0,1] neg_lo:[0,1,0] neg_hi:[0,1,0]
    v_pk_fma_f32 v[38:39], v[118:119], v[90:91], v[38:39] op_sel_hi:[1,0,1] neg_lo:[0,1,0] neg_hi:[0,1,0]
    v_pk_fma_f32 v[40:41], v[120:121], v[90:91], v[40:41] op_sel_hi:[1,0,1] neg_lo:[0,1,0] neg_hi:[0,1,0]
    v_pk_fma_f32 v[42:43], v[122:123], v[90:91], v[42:43] op_sel_hi:[1,0,1] neg_lo:[0,1,0] neg_hi:[0,1,0]
    v_pk_fma_f32 v[44:45], v[124:125], v[90:91], v[44:45] op_sel_hi:[1,0,1] neg_lo:[0,1,0] neg_hi:[0,1,0]
    v_pk_fma_f32 v[46:47], v[126:127], v[90:91], v[46:47] op_sel_hi:[1,0,1] neg_lo:[0,1,0] neg_hi:[0,1,0]
    v_add_u32 v32, 0x8000, v32
    v_add_u32 v40, 0x8000, v40
    v_cvt_pk_bf16_f32 v32, v32, v33
    v_cvt_pk_bf16_f32 v33, v34, v35
    v_cvt_pk_bf16_f32 v34, v36, v37
    v_cvt_pk_bf16_f32 v35, v38, v39
    v_cvt_pk_bf16_f32 v36, v40, v41
    v_cvt_pk_bf16_f32 v37, v42, v43
    v_cvt_pk_bf16_f32 v38, v44, v45
    v_cvt_pk_bf16_f32 v39, v46, v47
    v_and_b32 v32, -2, v32
    v_and_b32 v36, -2, v36
    buffer_store_dwordx4 v[32:35], v1, s[48:51], s4 offen offset:0 sc0 sc1
    buffer_store_dwordx4 v[36:39], v1, s[48:51], s4 offen offset:1024 sc0 sc1
    v_pk_mul_f32 v[48:49], v[48:49], v[96:97]
    v_pk_mul_f32 v[50:51], v[50:51], v[98:99]
    v_pk_mul_f32 v[52:53], v[52:53], v[100:101]
    v_pk_mul_f32 v[54:55], v[54:55], v[102:103]
    v_pk_mul_f32 v[56:57], v[56:57], v[104:105]
    v_pk_mul_f32 v[58:59], v[58:59], v[106:107]
    v_pk_mul_f32 v[60:61], v[60:61], v[108:109]
    v_pk_mul_f32 v[62:63], v[62:63], v[110:111]
    v_pk_fma_f32 v[48:49], v[16:17], v[92:93], v[48:49] op_sel_hi:[1,0,1] neg_lo:[0,1,0] neg_hi:[0,1,0]
    v_pk_fma_f32 v[50:51], v[18:19], v[92:93], v[50:51] op_sel_hi:[1,0,1] neg_lo:[0,1,0] neg_hi:[0,1,0]
    v_pk_fma_f32 v[52:53], v[20:21], v[92:93], v[52:53] op_sel_hi:[1,0,1] neg_lo:[0,1,0] neg_hi:[0,1,0]
    v_pk_fma_f32 v[54:55], v[22:23], v[92:93], v[54:55] op_sel_hi:[1,0,1] neg_lo:[0,1,0] neg_hi:[0,1,0]
    v_pk_fma_f32 v[56:57], v[24:25], v[92:93], v[56:57] op_sel_hi:[1,0,1] neg_lo:[0,1,0] neg_hi:[0,1,0]
    v_pk_fma_f32 v[58:59], v[26:27], v[92:93], v[58:59] op_sel_hi:[1,0,1] neg_lo:[0,1,0] neg_hi:[0,1,0]
    v_pk_fma_f32 v[60:61], v[28:29], v[92:93], v[60:61] op_sel_hi:[1,0,1] neg_lo:[0,1,0] neg_hi:[0,1,0]
    v_pk_fma_f32 v[62:63], v[30:31], v[92:93], v[62:63] op_sel_hi:[1,0,1] neg_lo:[0,1,0] neg_hi:[0,1,0]
    v_add_u32 v48, 0x8000, v48
    v_add_u32 v56, 0x8000, v56
    v_cvt_pk_bf16_f32 v48, v48, v49
    v_cvt_pk_bf16_f32 v49, v50, v51
    v_cvt_pk_bf16_f32 v50, v52, v53
    v_cvt_pk_bf16_f32 v51, v54, v55
    v_cvt_pk_bf16_f32 v52, v56, v57
    v_cvt_pk_bf16_f32 v53, v58, v59
    v_cvt_pk_bf16_f32 v54, v60, v61
    v_cvt_pk_bf16_f32 v55, v62, v63
    v_and_b32 v48, -2, v48
    v_and_b32 v52, -2, v52
    buffer_store_dwordx4 v[48:51], v1, s[48:51], s4 offen offset:2048 sc0 sc1
    buffer_store_dwordx4 v[52:55], v1, s[48:51], s4 offen offset:3072 sc0 sc1
    v_mul_f32 v88, 0x3eb8aa3b, v88
    v_mul_f32 v90, 0x3eb8aa3b, v90
    s_lshl_b32 s11, s58, 13
    v_add_u32 v86, s11, v1
    v_add_u32 v87, 0x10000, v86
    s_waitcnt vmcnt(12)
    ds_write_b128 v87, a[0:3] offset:0
    s_waitcnt vmcnt(11)
    ds_write_b128 v87, a[4:7] offset:1024
    s_waitcnt vmcnt(10)
    ds_write_b128 v87, a[8:11] offset:2048
    s_waitcnt vmcnt(9)
    ds_write_b128 v87, a[12:15] offset:3072
    s_waitcnt vmcnt(8)
    ds_write_b128 v87, a[16:19] offset:4096
    s_waitcnt vmcnt(7)
    ds_write_b128 v87, a[20:23] offset:5120
    s_waitcnt vmcnt(6)
    ds_write_b128 v87, a[24:27] offset:6144
    s_waitcnt vmcnt(5)
    ds_write_b128 v87, a[28:31] offset:7168
    s_lshl_b32 s11, s58, 13
    v_add_u32 v84, s11, v2
    v_add_u32 v85, 0x10000, v84
    ds_read_b64_tr_b16 v[96:97], v85 offset:0
    ds_read_b64_tr_b16 v[98:99], v85 offset:256
    ds_read_b64_tr_b16 v[100:101], v85 offset:1024
    ds_read_b64_tr_b16 v[102:103], v85 offset:1280
    ds_read_b64_tr_b16 v[104:105], v85 offset:2048
    ds_read_b64_tr_b16 v[106:107], v85 offset:2304
    ds_read_b64_tr_b16 v[108:109], v85 offset:3072
    ds_read_b64_tr_b16 v[110:111], v85 offset:3328
    ds_read_b64_tr_b16 v[112:113], v85 offset:4096
    ds_read_b64_tr_b16 v[114:115], v85 offset:4352
    ds_read_b64_tr_b16 v[116:117], v85 offset:5120
    ds_read_b64_tr_b16 v[118:119], v85 offset:5376
    ds_read_b64_tr_b16 v[120:121], v85 offset:6144
    ds_read_b64_tr_b16 v[122:123], v85 offset:6400
    ds_read_b64_tr_b16 v[124:125], v85 offset:7168
    ds_read_b64_tr_b16 v[126:127], v85 offset:7424
    v_and_b32 v83, 31, v0
    v_lshlrev_b32 v83, 5, v83
    v_lshrrev_b32 v81, 5, v0
    v_lshl_add_u32 v81, v81, 2, v83
    s_lshl_b32 s4, s58, 3
    s_add_u32 s4, s4, 0x24800
    v_add_u32 v81, s4, v81
    v_mov_b32 v82, 0
    v_mov_b32 v83, 0
    s_waitcnt vmcnt(4)
    v_cmp_ne_u32 vcc, 0, v8
    s_nop 0
    s_cmp_eq_u64 vcc, exec
    s_nop 2
    s_cbranch_scc0 zw_9
zok_8:
    v_accvgpr_read_b32 v86, a138
    s_or_b32 s5, s6, 0x100
    v_mov_b32 v87, s5
    s_waitcnt lgkmcnt(14)
    v_dot2c_f32_bf16 v82, s22, v96
    v_dot2c_f32_bf16 v83, s22, v97
    v_dot2c_f32_bf16 v82, s22, v98
    v_dot2c_f32_bf16 v83, s22, v99
    s_waitcnt lgkmcnt(12)
    v_dot2c_f32_bf16 v82, s22, v100
    v_dot2c_f32_bf16 v83, s22, v101
    v_dot2c_f32_bf16 v82, s22, v102
    v_dot2c_f32_bf16 v83, s22, v103
    s_waitcnt lgkmcnt(10)
    v_dot2c_f32_bf16 v82, s22, v104
    v_dot2c_f32_bf16 v83, s22, v105
    v_dot2c_f32_bf16 v82, s22, v106
    v_dot2c_f32_bf16 v83, s22, v107
    s_waitcnt lgkmcnt(8)
    v_dot2c_f32_bf16 v82, s22, v108
    v_dot2c_f32_bf16 v83, s22, v109
    v_dot2c_f32_bf16 v82, s22, v110
    v_dot2c_f32_bf16 v83, s22, v111
    s_waitcnt lgkmcnt(6)
    v_dot2c_f32_bf16 v82, s22, v112
    v_dot2c_f32_bf16 v83, s22, v113
    v_dot2c_f32_bf16 v82, s22, v114
    v_dot2c_f32_bf16 v83, s22, v115
    s_waitcnt lgkmcnt(4)
    v_dot2c_f32_bf16 v82, s22, v116
    v_dot2c_f32_bf16 v83, s22, v117
    v_dot2c_f32_bf16 v82, s22, v118
    v_dot2c_f32_bf16 v83, s22, v119
    s_waitcnt lgkmcnt(2)
    v_dot2c_f32_bf16 v82, s22, v120
    v_dot2c_f32_bf16 v83, s22, v121
    v_dot2c_f32_bf16 v82, s22, v122
    v_dot2c_f32_bf16 v83, s22, v123
    s_waitcnt lgkmcnt(0)
    v_dot2c_f32_bf16 v82, s22, v124
    v_dot2c_f32_bf16 v83, s22, v125
    v_dot2c_f32_bf16 v82, s22, v126
    v_dot2c_f32_bf16 v83, s22, v127
    s_nop 2
    v_add_f32 v82, v82, v83
    ds_write_b32 v81, v82
    s_waitcnt lgkmcnt(0)
    s_barrier
    ds_read_b64_tr_b16 v[64:65], v3 offset:0
    ds_read_b64_tr_b16 v[66:67], v3 offset:256
    ds_read_b64_tr_b16 v[68:69], v3 offset:1024
    ds_read_b64_tr_b16 v[70:71], v3 offset:1280
    ds_read_b64_tr_b16 v[72:73], v3 offset:2048
    ds_read_b64_tr_b16 v[74:75], v3 offset:2304
    s_waitcnt lgkmcnt(4)
    v_mfma_f32_32x32x16_bf16 v[16:31], v[64:67], v[128:131], 0
    ds_read_b64_tr_b16 v[76:77], v3 offset:3072
    ds_read_b64_tr_b16 v[78:79], v3 offset:3328
    v_and_b32 v92, 31, v0
    v_lshlrev_b32 v93, 5, v92
    v_add_u32 v93, 0x24800, v93
    s_waitcnt lgkmcnt(4)
    v_mfma_f32_32x32x16_bf16 v[16:31], v[68:71], v[132:135], v[16:31]
    ds_read_b64_tr_b16 v[64:65], v3 offset:4096
    ds_read_b64_tr_b16 v[66:67], v3 offset:4352
    ds_write_b128 v7, v[32:35] offset:32768
    v_lshlrev_b32 v92, 2, v92
    v_add_u32 v92, 0x24400, v92
    s_waitcnt lgkmcnt(5)
    v_mfma_f32_32x32x16_bf16 v[16:31], v[72:75], v[136:139], v[16:31]
    ds_read_b64_tr_b16 v[68:69], v3 offset:5120
    ds_read_b64_tr_b16 v[70:71], v3 offset:5376
    s_waitcnt vmcnt(0)
    s_mov_b64 exec, 3
    buffer_store_dword v87, v86, s[48:51], 0 offen sc0 sc1
    s_mov_b64 exec, -1
    s_waitcnt lgkmcnt(5)
    v_mfma_f32_32x32x16_bf16 v[16:31], v[76:79], v[140:143], v[16:31]
    ds_read_b64_tr_b16 v[72:73], v3 offset:6144
    ds_read_b64_tr_b16 v[74:75], v3 offset:6400
    ds_read_b128 v[100:103], v93 offset:0
    ds_read_b128 v[104:107], v93 offset:16
    s_waitcnt lgkmcnt(7)
    v_mfma_f32_32x32x16_bf16 v[16:31], v[64:67], v[144:147], v[16:31]
    ds_read_b64_tr_b16 v[76:77], v3 offset:7168
    ds_read_b64_tr_b16 v[78:79], v3 offset:7424
    ds_write_b128 v7, v[36:39] offset:33792
    s_lshr_b32 s11, s2, 3
    s_cmp_ge_u32 s58, 2
    s_cbranch_scc1 tt_12
    s_lshl_b32 s11, s11, 1
    s_add_u32 s11, s11, s58
    s_mul_i32 s11, s11, 24576
    v_lshrrev_b32 v14, 3, v0
    v_mul_u32_u24 v14, 3072, v14
    v_and_b32 v15, 7, v0
    v_lshl_add_u32 v14, v15, 7, v14
    buffer_load_dword a255, v14, s[32:35], s11 offen offset:2048
tt_12:
    s_waitcnt lgkmcnt(7)
    v_mfma_f32_32x32x16_bf16 v[16:31], v[68:71], v[148:151], v[16:31]
    ds_read_b64_tr_b16 v[64:65], v3 offset:8192
    ds_read_b64_tr_b16 v[66:67], v3 offset:8448
    s_waitcnt lgkmcnt(5)
    v_add_f32 v100, v100, v102
    v_add_f32 v101, v101, v103
    v_mfma_f32_32x32x16_bf16 v[16:31], v[72:75], v[152:155], v[16:31]
    ds_read_b64_tr_b16 v[68:69], v3 offset:9216
    ds_read_b64_tr_b16 v[70:71], v3 offset:9472
    v_add_f32 v104, v104, v106
    v_add_f32 v105, v105, v107
    v_add_f32 v100, v100, v104
    s_waitcnt lgkmcnt(5)
    v_mfma_f32_32x32x16_bf16 v[16:31], v[76:79], v[156:159], v[16:31]
    ds_read_b64_tr_b16 v[72:73], v3 offset:10240
    ds_read_b64_tr_b16 v[74:75], v3 offset:10496
    ds_write_b128 v7, v[48:51] offset:34816
    v_add_f32 v101, v101, v105
    v_add_f32 v100, v100, v101
    s_waitcnt lgkmcnt(5)
    v_mfma_f32_32x32x16_bf16 v[16:31], v[64:67], v[160:163], v[16:31]
    ds_read_b64_tr_b16 v[76:77], v3 offset:11264
    ds_read_b64_tr_b16 v[78:79], v3 offset:11520
    ds_write_b32 v92, v100 offset:0
    ds_read_b128 v[112:115], v91 offset:0
    ds_read_b128 v[116:119], v91 offset:32
    s_waitcnt lgkmcnt(8)
    v_mfma_f32_32x32x16_bf16 v[16:31], v[68:71], v[164:167], v[16:31]
    ds_read_b64_tr_b16 v[64:65], v3 offset:12288
    ds_read_b64_tr_b16 v[66:67], v3 offset:12544
    ds_read_b128 v[120:123], v91 offset:64
    ds_read_b128 v[124:127], v91 offset:96
    s_lshl_b32 s5, s58, 13
    s_waitcnt lgkmcnt(10)
    v_mfma_f32_32x32x16_bf16 v[16:31], v[72:75], v[168:171], v[16:31]
    ds_read_b64_tr_b16 v[68:69], v3 offset:13312
    ds_read_b64_tr_b16 v[70:71], v3 offset:13568
    ds_write_b128 v7, v[52:55] offset:35840
    v_accvgpr_read_b32 v80, a140
    v_add_u32 v80, s5, v80
    s_waitcnt lgkmcnt(10)
    v_mfma_f32_32x32x16_bf16 v[16:31], v[76:79], v[172:175], v[16:31]
    ds_read_b64_tr_b16 v[72:73], v3 offset:14336
    ds_read_b64_tr_b16 v[74:75], v3 offset:14592
    v_add_u32 v81, 0x10000, v80
    ds_read_b64_tr_b16 a[0:1], v81 offset:0
    ds_read_b64_tr_b16 a[2:3], v81 offset:512
    s_waitcnt lgkmcnt(9)
    v_mfma_f32_32x32x16_bf16 v[16:31], v[64:67], v[176:179], v[16:31]
    ds_read_b64_tr_b16 v[76:77], v3 offset:15360
    ds_read_b64_tr_b16 v[78:79], v3 offset:15616
    ds_read_b64_tr_b16 a[4:5], v81 offset:1024
    ds_read_b64_tr_b16 a[6:7], v81 offset:1536
    ds_read_b64_tr_b16 a[8:9], v81 offset:2048
    s_waitcnt lgkmcnt(10)
    v_mfma_f32_32x32x16_bf16 v[16:31], v[68:71], v[180:183], v[16:31]
    ds_read_b64_tr_b16 v[64:65], v3 offset:16384
    ds_read_b64_tr_b16 v[66:67], v3 offset:16640
    ds_read_b64_tr_b16 a[10:11], v81 offset:2560
    ds_read_b64_tr_b16 a[12:13], v81 offset:3072
    ds_read_b64_tr_b16 a[14:15], v81 offset:3584
    s_waitcnt lgkmcnt(12)
    v_mfma_f32_32x32x16_bf16 v[16:31], v[72:75], v[184:187], v[16:31]
    ds_read_b64_tr_b16 v[68:69], v3 offset:17408
    ds_read_b64_tr_b16 v[70:71], v3 offset:17664
    ds_read_b64_tr_b16 a[16:17], v81 offset:4096
    ds_read_b64_tr_b16 a[18:19], v81 offset:4608
    ds_read_b64_tr_b16 a[20:21], v81 offset:5120
    s_waitcnt lgkmcnt(13)
    v_mfma_f32_32x32x16_bf16 v[16:31], v[76:79], v[188:191], v[16:31]
    ds_read_b64_tr_b16 v[72:73], v3 offset:18432
    ds_read_b64_tr_b16 v[74:75], v3 offset:18688
    ds_read_b64_tr_b16 a[22:23], v81 offset:5632
    ds_read_b64_tr_b16 a[24:25], v81 offset:6144
    ds_read_b64_tr_b16 a[26:27], v81 offset:6656
    s_waitcnt lgkmcnt(13)
    v_mfma_f32_32x32x16_bf16 v[16:31], v[64:67], v[192:195], v[16:31]
    ds_read_b64_tr_b16 v[76:77], v3 offset:19456
    ds_read_b64_tr_b16 v[78:79], v3 offset:19712
    ds_read_b64_tr_b16 a[28:29], v81 offset:7168
    ds_read_b64_tr_b16 a[30:31], v81 offset:7680
    ds_read_b64_tr_b16 a[32:33], v80 offset:0
    s_waitcnt lgkmcnt(13)
    v_mfma_f32_32x32x16_bf16 v[16:31], v[68:71], v[196:199], v[16:31]
    ds_read_b64_tr_b16 v[64:65], v3 offset:20480
    ds_read_b64_tr_b16 v[66:67], v3 offset:20736
    ds_read_b64_tr_b16 a[34:35], v80 offset:512
    ds_read_b64_tr_b16 a[36:37], v80 offset:1024
    ds_read_b64_tr_b16 a[38:39], v80 offset:1536
    s_waitcnt lgkmcnt(13)
    v_mfma_f32_32x32x16_bf16 v[16:31], v[72:75], v[200:203], v[16:31]
    ds_read_b64_tr_b16 v[68:69], v3 offset:21504
    ds_read_b64_tr_b16 v[70:71], v3 offset:21760
    ds_read_b64_tr_b16 a[40:41], v80 offset:2048
    ds_read_b64_tr_b16 a[42:43], v80 offset:2560
    ds_read_b64_tr_b16 a[44:45], v80 offset:3072
    s_waitcnt lgkmcnt(13)
    v_mfma_f32_32x32x16_bf16 v[16:31], v[76:79], v[204:207], v[16:31]
    ds_read_b64_tr_b16 v[72:73], v3 offset:22528
    ds_read_b64_tr_b16 v[74:75], v3 offset:22784
    ds_read_b64_tr_b16 a[46:47], v80 offset:3584
    ds_read_b64_tr_b16 a[48:49], v80 offset:4096
    ds_read_b64_tr_b16 a[50:51], v80 offset:4608
    s_waitcnt lgkmcnt(13)
    v_mfma_f32_32x32x16_bf16 v[16:31], v[64:67], v[208:211], v[16:31]
    ds_read_b64_tr_b16 v[76:77], v3 offset:23552
    ds_read_b64_tr_b16 v[78:79], v3 offset:23808
    ds_read_b64_tr_b16 a[52:53], v80 offset:5120
    ds_read_b64_tr_b16 a[54:55], v80 offset:5632
    ds_read_b64_tr_b16 a[56:57], v80 offset:6144
    s_waitcnt lgkmcnt(13)
    v_mfma_f32_32x32x16_bf16 v[16:31], v[68:71], v[212:215], v[16:31]
    ds_read_b64_tr_b16 v[64:65], v3 offset:24576
    ds_read_b64_tr_b16 v[66:67], v3 offset:24832
    ds_read_b64_tr_b16 a[58:59], v80 offset:6656
    ds_read_b64_tr_b16 a[60:61], v80 offset:7168
    ds_read_b64_tr_b16 a[62:63], v80 offset:7680
    s_waitcnt lgkmcnt(13)
    v_mfma_f32_32x32x16_bf16 v[16:31], v[72:75], v[216:219], v[16:31]
    ds_read_b64_tr_b16 v[68:69], v3 offset:25600
    ds_read_b64_tr_b16 v[70:71], v3 offset:25856
    ds_read_b64_tr_b16 a[64:65], v80 offset:32768
    ds_read_b64_tr_b16 a[66:67], v80 offset:33280
    ds_read_b64_tr_b16 a[68:69], v80 offset:33792
    s_waitcnt lgkmcnt(13)
    v_mfma_f32_32x32x16_bf16 v[16:31], v[76:79], v[220:223], v[16:31]
    ds_read_b64_tr_b16 v[72:73], v3 offset:26624
    ds_read_b64_tr_b16 v[74:75], v3 offset:26880
    ds_read_b64_tr_b16 a[70:71], v80 offset:34304
    ds_read_b64_tr_b16 a[72:73], v80 offset:34816
    ds_read_b64_tr_b16 a[74:75], v80 offset:35328
    s_waitcnt lgkmcnt(13)
    v_mfma_f32_32x32x16_bf16 v[16:31], v[64:67], v[224:227], v[16:31]
    ds_read_b64_tr_b16 v[76:77], v3 offset:27648
    ds_read_b64_tr_b16 v[78:79], v3 offset:27904
    ds_read_b64_tr_b16 a[76:77], v80 offset:35840
    ds_read_b64_tr_b16 a[78:79], v80 offset:36352
    ds_read_b64_tr_b16 a[80:81], v80 offset:36864
    s_waitcnt lgkmcnt(13)
    v_mfma_f32_32x32x16_bf16 v[16:31], v[68:71], v[228:231], v[16:31]
    ds_read_b64_tr_b16 v[64:65], v3 offset:28672
    ds_read_b64_tr_b16 v[66:67], v3 offset:28928
    ds_read_b64_tr_b16 a[82:83], v80 offset:37376
    ds_read_b64_tr_b16 a[84:85], v80 offset:37888
    ds_read_b64_tr_b16 a[86:87], v80 offset:38400
    s_waitcnt lgkmcnt(13)
    v_mfma_f32_32x32x16_bf16 v[16:31], v[72:75], v[232:235], v[16:31]
    ds_read_b64_tr_b16 v[68:69], v3 offset:29696
    ds_read_b64_tr_b16 v[70:71], v3 offset:29952
    ds_read_b64_tr_b16 a[88:89], v80 offset:38912
    ds_read_b64_tr_b16 a[90:91], v80 offset:39424
    ds_read_b64_tr_b16 a[92:93], v80 offset:39936
    s_waitcnt lgkmcnt(13)
    v_mfma_f32_32x32x16_bf16 v[16:31], v[76:79], v[236:239], v[16:31]
    ds_read_b64_tr_b16 v[72:73], v3 offset:30720
    ds_read_b64_tr_b16 v[74:75], v3 offset:30976
    ds_read_b64_tr_b16 a[94:95], v80 offset:40448
    v_accvgpr_read_b32 v56, a136
    v_accvgpr_read_b32 v57, a137
    s_waitcnt lgkmcnt(11)
    v_mfma_f32_32x32x16_bf16 v[16:31], v[64:67], v[240:243], v[16:31]
    ds_read_b64_tr_b16 v[76:77], v3 offset:31744
    ds_read_b64_tr_b16 v[78:79], v3 offset:32000
    s_waitcnt lgkmcnt(8)
    v_mfma_f32_32x32x16_bf16 v[16:31], v[68:71], v[244:247], v[16:31]
    s_waitcnt lgkmcnt(3)
    v_mfma_f32_32x32x16_bf16 v[16:31], v[72:75], v[248:251], v[16:31]
    s_waitcnt lgkmcnt(0)
    v_mfma_f32_32x32x16_bf16 v[16:31], v[76:79], v[252:255], v[16:31]
    buffer_load_dword v58, v56, s[48:51], 0 offen sc1
    s_nop 9
    s_nop 0
    v_pk_mul_f32 v[16:17], v[16:17], v[88:89] op_sel_hi:[1,0]
    v_pk_mul_f32 v[18:19], v[18:19], v[88:89] op_sel_hi:[1,0]
    v_pk_mul_f32 v[20:21], v[20:21], v[88:89] op_sel_hi:[1,0]
    v_pk_mul_f32 v[22:23], v[22:23], v[88:89] op_sel_hi:[1,0]
    v_pk_mul_f32 v[24:25], v[24:25], v[88:89] op_sel_hi:[1,0]
    v_pk_mul_f32 v[26:27], v[26:27], v[88:89] op_sel_hi:[1,0]
    v_pk_mul_f32 v[28:29], v[28:29], v[88:89] op_sel_hi:[1,0]
    v_pk_mul_f32 v[30:31], v[30:31], v[88:89] op_sel_hi:[1,0]
    v_pk_fma_f32 v[16:17], v[112:113], v[90:91], v[16:17] op_sel_hi:[1,0,1] neg_lo:[0,1,0] neg_hi:[0,1,0]
    v_pk_fma_f32 v[18:19], v[114:115], v[90:91], v[18:19] op_sel_hi:[1,0,1] neg_lo:[0,1,0] neg_hi:[0,1,0]
    v_pk_fma_f32 v[20:21], v[116:117], v[90:91], v[20:21] op_sel_hi:[1,0,1] neg_lo:[0,1,0] neg_hi:[0,1,0]
    v_pk_fma_f32 v[22:23], v[118:119], v[90:91], v[22:23] op_sel_hi:[1,0,1] neg_lo:[0,1,0] neg_hi:[0,1,0]
    v_pk_fma_f32 v[24:25], v[120:121], v[90:91], v[24:25] op_sel_hi:[1,0,1] neg_lo:[0,1,0] neg_hi:[0,1,0]
    v_pk_fma_f32 v[26:27], v[122:123], v[90:91], v[26:27] op_sel_hi:[1,0,1] neg_lo:[0,1,0] neg_hi:[0,1,0]
    v_pk_fma_f32 v[28:29], v[124:125], v[90:91], v[28:29] op_sel_hi:[1,0,1] neg_lo:[0,1,0] neg_hi:[0,1,0]
    v_pk_fma_f32 v[30:31], v[126:127], v[90:91], v[30:31] op_sel_hi:[1,0,1] neg_lo:[0,1,0] neg_hi:[0,1,0]
    v_cvt_pk_bf16_f32 v16, v16, v17
    v_cvt_pk_bf16_f32 v17, v18, v19
    v_cvt_pk_bf16_f32 v18, v20, v21
    v_cvt_pk_bf16_f32 v19, v22, v23
    v_cvt_pk_bf16_f32 v20, v24, v25
    v_cvt_pk_bf16_f32 v21, v26, v27
    v_cvt_pk_bf16_f32 v22, v28, v29
    v_cvt_pk_bf16_f32 v23, v30, v31
    v_mov_b32 v32, s22
    v_mov_b32 v33, s22
    v_mov_b32 v34, s22
    v_mov_b32 v35, s22
    v_mov_b32 v36, s22
    v_mov_b32 v37, s22
    v_mov_b32 v38, s22
    v_mov_b32 v39, s22
    v_mov_b32 v40, s22
    v_mov_b32 v41, s22
    v_mov_b32 v42, s22
    v_mov_b32 v43, s22
    v_mov_b32 v44, s22
    v_mov_b32 v45, s22
    v_mov_b32 v46, s22
    v_mov_b32 v47, s22
    v_accvgpr_read_b32 v24, a128
    v_accvgpr_read_b32 v25, a129
    v_accvgpr_read_b32 v26, a130
    v_accvgpr_read_b32 v27, a131
    v_accvgpr_read_b32 v28, a132
    v_accvgpr_read_b32 v29, a133
    v_accvgpr_read_b32 v30, a134
    v_accvgpr_read_b32 v31, a135
    s_waitcnt vmcnt(0)
    v_cmp_gt_u32 vcc, v57, v58
    s_nop 4
    s_cbranch_vccnz hpb_13
hpo_14:
    s_lshl_b32 s4, s58, 13
    s_add_u32 m0, s4, 98304
    s_nop 0
    buffer_load_dwordx4 v1, s[48:51], s20 offen offset:0 sc1 lds
    buffer_load_dwordx4 v1, s[48:51], s20 offen offset:1024 sc1 lds
    buffer_load_dwordx4 v1, s[48:51], s20 offen offset:2048 sc1 lds
    buffer_load_dwordx4 v1, s[48:51], s20 offen offset:3072 sc1 lds
    s_add_u32 m0, s4, 102400
    s_nop 0
    buffer_load_dwordx4 v1, s[48:51], s21 offen offset:0 sc1 lds
    buffer_load_dwordx4 v1, s[48:51], s21 offen offset:1024 sc1 lds
    buffer_load_dwordx4 v1, s[48:51], s21 offen offset:2048 sc1 lds
    buffer_load_dwordx4 v1, s[48:51], s21 offen offset:3072 sc1 lds
    s_lshl_b32 s4, s56, 12
    s_add_u32 s5, s4, 0x100000
    buffer_store_dwordx4 a[112:115], v5, s[48:51], s4 offen sc0 sc1
    buffer_store_dwordx4 a[112:115], v5, s[48:51], s5 offen sc0 sc1
    v_accvgpr_read_b32 v2, a140
    v_add_u32 v3, 0x10000, v2
    v_add_u32 v4, 0x10000, v1
    v_accvgpr_read_b32 v111, a139
    v_accvgpr_read_b32 v8, a240
    v_accvgpr_read_b32 v9, a241
    v_accvgpr_read_b32 v10, a242
    v_accvgpr_read_b32 v11, a243
    v_accvgpr_read_b32 v12, a244
    v_accvgpr_read_b32 v13, a245
    v_accvgpr_read_b32 v14, a246
    v_accvgpr_read_b32 v15, a247
    v_permlane32_swap_b32 v8, v10
    v_permlane32_swap_b32 v9, v11
    v_permlane32_swap_b32 v12, v14
    v_permlane32_swap_b32 v13, v15
    s_getpc_b64 s[10:11]
pc_17:
    s_lshr_b32 s4, s2, 3
    s_lshl_b32 s4, s4, 2
    s_add_u32 s4, s4, s58
    v_lshlrev_b32 v64, 7, v0
    v_add_u32 v64, s4, v64
    v_lshlrev_b32 v64, 7, v64
    v_cmp_gt_u32 vcc, L_codeend-pc_17-4, v64
    s_nop 4
    s_and_b64 exec, exec, vcc
    global_load_dword a255, v64, s[10:11]
    s_mov_b64 exec, -1
    ds_read_b128 v[76:79], v7 offset:32768
    ds_read_b128 v[80:83], v7 offset:33792
    s_mov_b64 exec, s[96:97]
    ds_read_b128 v[32:35], v7 offset:34816
    ds_read_b128 v[36:39], v7 offset:35840
    s_mov_b64 exec, -1
    s_mov_b64 exec, s[96:97]
    ds_read_b128 v[40:43], v7 offset:35072
    ds_read_b128 v[44:47], v7 offset:36096
    s_mov_b64 exec, -1
    v_mov_b32 v84, 0xff800000
    s_waitcnt lgkmcnt(5)
    v_mfma_f32_32x32x16_bf16 v[240:255], v[76:79], v[16:19], 0
    s_waitcnt lgkmcnt(4)
    v_mfma_f32_32x32x16_bf16 v[176:191], v[80:83], v[20:23], 0
    s_nop 8
    s_nop 0
    v_cndmask_b32 v240, v84, v240, s[64:65]
    v_cndmask_b32 v241, v84, v241, s[66:67]
    v_cndmask_b32 v242, v84, v242, s[68:69]
    v_cndmask_b32 v243, v84, v243, s[70:71]
    v_cndmask_b32 v244, v84, v244, s[72:73]
    v_cndmask_b32 v245, v84, v245, s[74:75]
    v_cndmask_b32 v246, v84, v246, s[76:77]
    v_cndmask_b32 v247, v84, v247, s[78:79]
    v_cndmask_b32 v248, v84, v248, s[80:81]
    v_cndmask_b32 v249, v84, v249, s[82:83]
    v_cndmask_b32 v250, v84, v250, s[84:85]
    v_cndmask_b32 v251, v84, v251, s[86:87]
    v_cndmask_b32 v252, v84, v252, s[88:89]
    v_cndmask_b32 v253, v84, v253, s[90:91]
    v_cndmask_b32 v254, v84, v254, s[92:93]
    v_cndmask_b32 v255, v84, v255, s[94:95]
    v_max_f32 v86, v240, v241
    v_max_f32 v85, v242, v243
    v_max3_f32 v86, v86, v244, v245
    v_max3_f32 v85, v85, v246, v247
    v_max3_f32 v86, v86, v248, v249
    v_max3_f32 v85, v85, v250, v251
    v_max3_f32 v86, v86, v252, v253
    v_max3_f32 v85, v85, v254, v255
    v_max_f32 v86, v86, v85
    v_mov_b32 v85, v86
    s_nop 1
    v_permlane32_swap_b32 v85, v86
    v_max_f32 v86, v86, v85
    v_sub_f32 v86, 0, v86
    v_pk_add_f32 v[240:241], v[240:241], v[86:87] op_sel_hi:[1,0]
    v_pk_add_f32 v[242:243], v[242:243], v[86:87] op_sel_hi:[1,0]
    v_pk_add_f32 v[244:245], v[244:245], v[86:87] op_sel_hi:[1,0]
    v_pk_add_f32 v[246:247], v[246:247], v[86:87] op_sel_hi:[1,0]
    v_pk_add_f32 v[248:249], v[248:249], v[86:87] op_sel_hi:[1,0]
    v_pk_add_f32 v[250:251], v[250:251], v[86:87] op_sel_hi:[1,0]
    v_pk_add_f32 v[252:253], v[252:253], v[86:87] op_sel_hi:[1,0]
    v_pk_add_f32 v[254:255], v[254:255], v[86:87] op_sel_hi:[1,0]
    v_pk_mov_b32 v[192:193], v[86:87], v[86:87] op_sel:[0,0]
    v_pk_mov_b32 v[194:195], v[86:87], v[86:87] op_sel:[0,0]
    v_pk_mov_b32 v[196:197], v[86:87], v[86:87] op_sel:[0,0]
    v_pk_mov_b32 v[198:199], v[86:87], v[86:87] op_sel:[0,0]
    v_pk_mov_b32 v[200:201], v[86:87], v[86:87] op_sel:[0,0]
    v_pk_mov_b32 v[202:203], v[86:87], v[86:87] op_sel:[0,0]
    v_pk_mov_b32 v[204:205], v[86:87], v[86:87] op_sel:[0,0]
    v_pk_mov_b32 v[206:207], v[86:87], v[86:87] op_sel:[0,0]
    v_cndmask_b32 v176, v84, v176, s[64:65]
    v_cndmask_b32 v177, v84, v177, s[66:67]
    v_cndmask_b32 v178, v84, v178, s[68:69]
    v_cndmask_b32 v179, v84, v179, s[70:71]
    v_cndmask_b32 v180, v84, v180, s[72:73]
    v_cndmask_b32 v181, v84, v181, s[74:75]
    v_cndmask_b32 v182, v84, v182, s[76:77]
    v_cndmask_b32 v183, v84, v183, s[78:79]
    v_cndmask_b32 v184, v84, v184, s[80:81]
    v_cndmask_b32 v185, v84, v185, s[82:83]
    v_cndmask_b32 v186, v84, v186, s[84:85]
    v_cndmask_b32 v187, v84, v187, s[86:87]
    v_cndmask_b32 v188, v84, v188, s[88:89]
    v_cndmask_b32 v189, v84, v189, s[90:91]
    v_cndmask_b32 v190, v84, v190, s[92:93]
    v_cndmask_b32 v191, v84, v191, s[94:95]
    v_max_f32 v88, v176, v177
    v_max_f32 v85, v178, v179
    v_max3_f32 v88, v88, v180, v181
    v_max3_f32 v85, v85, v182, v183
    v_max3_f32 v88, v88, v184, v185
    v_max3_f32 v85, v85, v186, v187
    v_max3_f32 v88, v88, v188, v189
    v_max3_f32 v85, v85, v190, v191
    v_max_f32 v88, v88, v85
    v_mov_b32 v85, v88
    s_nop 1
    v_permlane32_swap_b32 v85, v88
    v_max_f32 v88, v88, v85
    v_sub_f32 v88, 0, v88
    v_pk_add_f32 v[176:177], v[176:177], v[88:89] op_sel_hi:[1,0]
    v_pk_add_f32 v[178:179], v[178:179], v[88:89] op_sel_hi:[1,0]
    v_pk_add_f32 v[180:181], v[180:181], v[88:89] op_sel_hi:[1,0]
    v_pk_add_f32 v[182:183], v[182:183], v[88:89] op_sel_hi:[1,0]
    v_pk_add_f32 v[184:185], v[184:185], v[88:89] op_sel_hi:[1,0]
    v_pk_add_f32 v[186:187], v[186:187], v[88:89] op_sel_hi:[1,0]
    v_pk_add_f32 v[188:189], v[188:189], v[88:89] op_sel_hi:[1,0]
    v_pk_add_f32 v[190:191], v[190:191], v[88:89] op_sel_hi:[1,0]
    v_pk_mov_b32 v[208:209], v[88:89], v[88:89] op_sel:[0,0]
    v_pk_mov_b32 v[210:211], v[88:89], v[88:89] op_sel:[0,0]
    v_pk_mov_b32 v[212:213], v[88:89], v[88:89] op_sel:[0,0]
    v_pk_mov_b32 v[214:215], v[88:89], v[88:89] op_sel:[0,0]
    v_pk_mov_b32 v[216:217], v[88:89], v[88:89] op_sel:[0,0]
    v_pk_mov_b32 v[218:219], v[88:89], v[88:89] op_sel:[0,0]
    v_pk_mov_b32 v[220:221], v[88:89], v[88:89] op_sel:[0,0]
    v_pk_mov_b32 v[222:223], v[88:89], v[88:89] op_sel:[0,0]
    v_exp_f32 v240, v240
    v_exp_f32 v241, v241
    v_exp_f32 v242, v242
    v_exp_f32 v243, v243
    v_exp_f32 v244, v244
    v_exp_f32 v245, v245
    v_exp_f32 v246, v246
    v_exp_f32 v247, v247
    v_exp_f32 v248, v248
    v_exp_f32 v249, v249
    v_exp_f32 v250, v250
    v_exp_f32 v251, v251
    v_exp_f32 v252, v252
    v_exp_f32 v253, v253
    v_exp_f32 v254, v254
    v_exp_f32 v255, v255
    v_cvt_pk_bf16_f32 v240, v240, v241
    v_cvt_pk_bf16_f32 v241, v242, v243
    v_cvt_pk_bf16_f32 v242, v244, v245
    v_cvt_pk_bf16_f32 v243, v246, v247
    v_cvt_pk_bf16_f32 v244, v248, v249
    v_cvt_pk_bf16_f32 v245, v250, v251
    v_cvt_pk_bf16_f32 v246, v252, v253
    v_cvt_pk_bf16_f32 v247, v254, v255
    s_waitcnt lgkmcnt(0)
    v_mfma_f32_32x32x16_bf16 v[48:63], v[32:35], v[240:243], 0
    v_mfma_f32_32x32x16_bf16 v[48:63], v[36:39], v[244:247], v[48:63]
    s_mov_b64 s[16:17], 0
    s_waitcnt vmcnt(3)
    s_waitcnt lgkmcnt(0)
    s_barrier
    s_cmp_lt_u32 s59, 8
    s_nop 6
    s_cbranch_scc1 achk_18
    ds_read_b128 v[64:67], v7 offset:28672
    ds_read_b128 v[68:71], v7 offset:24576
    v_exp_f32 v176, v176
    ds_read_b128 v[72:75], v7 offset:20480
    ds_read_b128 v[76:79], v7 offset:16384
    v_exp_f32 v177, v177
    s_mov_b64 exec, s[96:97]
    ds_read_b128 v[32:35], v7 offset:30720
    ds_read_b128 v[36:39], v7 offset:31744
    s_mov_b64 exec, -1
    s_waitcnt lgkmcnt(5)
    v_mfma_f32_32x32x16_bf16 v[112:127], v[64:67], v[16:19], v[192:207]
    v_exp_f32 v178, v178
    v_exp_f32 v179, v179
    v_exp_f32 v180, v180
    s_lshl_b32 s11, s58, 13
    s_add_u32 m0, s11, 65536
    s_mov_b32 s10, 1024
    buffer_load_dwordx4 v111, s[32:35], s10 offen offset:0 lds
    v_exp_f32 v181, v181
    s_waitcnt lgkmcnt(4)
    v_mfma_f32_32x32x16_bf16 v[128:143], v[68:71], v[16:19], v[192:207]
    v_exp_f32 v182, v182
    v_exp_f32 v183, v183
    v_exp_f32 v184, v184
    v_exp_f32 v185, v185
    s_waitcnt lgkmcnt(3)
    v_mfma_f32_32x32x16_bf16 v[144:159], v[72:75], v[16:19], v[192:207]
    ds_read_b128 v[80:83], v7 offset:12288
    v_exp_f32 v186, v186
    ds_read_b128 v[84:87], v7 offset:8192
    ds_read_b128 v[88:91], v7 offset:4096
    v_exp_f32 v187, v187
    v_exp_f32 v188, v188
    v_exp_f32 v189, v189
    v_exp_f32 v190, v190
    v_exp_f32 v191, v191
    v_cvt_pk_bf16_f32 v176, v176, v177
    v_cvt_pk_bf16_f32 v177, v178, v179
    v_cvt_pk_bf16_f32 v178, v180, v181
    v_cvt_pk_bf16_f32 v179, v182, v183
    v_cvt_pk_bf16_f32 v180, v184, v185
    s_mov_b32 s10, 49152
    buffer_load_dwordx4 v111, s[32:35], s10 offen offset:1024 lds
    v_cvt_pk_bf16_f32 v181, v186, v187
    v_cvt_pk_bf16_f32 v182, v188, v189
    v_cvt_pk_bf16_f32 v183, v190, v191
    v_mfma_f32_32x32x16_bf16 v[224:239], v[40:43], v[176:179], 0
    v_exp_f32 v112, v112
    v_exp_f32 v113, v113
    v_exp_f32 v114, v114
    v_exp_f32 v115, v115
    v_mfma_f32_32x32x16_bf16 v[224:239], v[44:47], v[180:183], v[224:239]
    s_mov_b64 exec, s[96:97]
    ds_read_b128 v[40:43], v7 offset:26624
    ds_read_b128 v[44:47], v7 offset:27648
    s_mov_b64 exec, -1
    v_exp_f32 v116, v116
    v_exp_f32 v117, v117
    v_exp_f32 v118, v118
    s_waitcnt lgkmcnt(7)
    v_mfma_f32_32x32x16_bf16 v[160:175], v[76:79], v[16:19], v[192:207]
    v_exp_f32 v119, v119
    v_exp_f32 v120, v120
    v_exp_f32 v121, v121
    v_exp_f32 v122, v122
    v_exp_f32 v123, v123
    buffer_store_dwordx4 a[112:115], v1, s[48:51], s61 offen offset:0 sc0 sc1
    buffer_store_dwordx4 a[112:115], v1, s[48:51], s61 offen offset:1024 sc0 sc1
    s_lshl_b32 s4, s57, 8
    s_add_u32 s4, s4, s101
    s_mov_b64 exec, 0xffff
    buffer_store_dwordx4 a[112:115], v1, s[48:51], s4 offen offset:0 sc0 sc1
    s_mov_b64 exec, -1
    s_mov_b32 s10, 97280
    buffer_load_dwordx4 v111, s[32:35], s10 offen offset:2048 lds
    v_exp_f32 v124, v124
    v_exp_f32 v125, v125
    v_exp_f32 v126, v126
    v_exp_f32 v127, v127
    v_cvt_pk_bf16_f32 v112, v112, v113
    v_cvt_pk_bf16_f32 v113, v114, v115
    v_cvt_pk_bf16_f32 v114, v116, v117
    v_cvt_pk_bf16_f32 v115, v118, v119
    v_cvt_pk_bf16_f32 v116, v120, v121
    v_cvt_pk_bf16_f32 v117, v122, v123
    v_cvt_pk_bf16_f32 v118, v124, v125
    v_cvt_pk_bf16_f32 v119, v126, v127
    s_waitcnt lgkmcnt(5)
    v_mfma_f32_32x32x16_bf16 v[48:63], v[32:35], v[112:115], v[48:63]
    v_exp_f32 v128, v128
    v_exp_f32 v129, v129
    v_exp_f32 v130, v130
    v_exp_f32 v131, v131
    v_mfma_f32_32x32x16_bf16 v[48:63], v[36:39], v[116:119], v[48:63]
    s_mov_b64 exec, s[96:97]
    ds_read_b128 v[32:35], v7 offset:22528
    ds_read_b128 v[36:39], v7 offset:23552
    s_mov_b64 exec, -1
    v_exp_f32 v132, v132
    s_mov_b32 s10, 145408
    buffer_load_dwordx4 v111, s[32:35], s10 offen offset:3072 lds
    v_exp_f32 v133, v133
    v_exp_f32 v134, v134
    s_waitcnt lgkmcnt(6)
    v_mfma_f32_32x32x16_bf16 v[176:191], v[80:83], v[16:19], v[192:207]
    ds_read_b128 v[92:95], v7 offset:0
    v_exp_f32 v135, v135
    v_exp_f32 v136, v136
    v_exp_f32 v137, v137
    v_exp_f32 v138, v138
    v_exp_f32 v139, v139
    v_exp_f32 v140, v140
    v_exp_f32 v141, v141
    v_exp_f32 v142, v142
    v_exp_f32 v143, v143
    v_cvt_pk_bf16_f32 v128, v128, v129
    v_cvt_pk_bf16_f32 v129, v130, v131
    v_cvt_pk_bf16_f32 v130, v132, v133
    v_cvt_pk_bf16_f32 v131, v134, v135
    v_cvt_pk_bf16_f32 v132, v136, v137
    s_lshl_b32 s11, s58, 13
    s_add_u32 m0, s11, 69632
    s_mov_b32 s10, 197632
    buffer_load_dwordx4 v111, s[32:35], s10 offen offset:0 lds
    v_cvt_pk_bf16_f32 v133, v138, v139
    v_cvt_pk_bf16_f32 v134, v140, v141
    v_cvt_pk_bf16_f32 v135, v142, v143
    s_waitcnt lgkmcnt(3)
    v_mfma_f32_32x32x16_bf16 v[48:63], v[40:43], v[128:131], v[48:63]
    v_exp_f32 v144, v144
    v_exp_f32 v145, v145
    v_exp_f32 v146, v146
    v_exp_f32 v147, v147
    v_mfma_f32_32x32x16_bf16 v[48:63], v[44:47], v[132:135], v[48:63]
    s_mov_b64 exec, s[96:97]
    ds_read_b128 v[40:43], v7 offset:18432
    ds_read_b128 v[44:47], v7 offset:19456
    s_mov_b64 exec, -1
    v_exp_f32 v148, v148
    v_exp_f32 v149, v149
    v_exp_f32 v150, v150
    v_mfma_f32_32x32x16_bf16 v[112:127], v[84:87], v[16:19], v[192:207]
    ds_read_b128 v[96:99], v7 offset:29696
    v_exp_f32 v151, v151
    v_exp_f32 v152, v152
    v_exp_f32 v153, v153
    v_exp_f32 v154, v154
    s_mov_b32 s10, 245760
    buffer_load_dwordx4 v111, s[32:35], s10 offen offset:1024 lds
    v_exp_f32 v155, v155
    v_exp_f32 v156, v156
    v_exp_f32 v157, v157
    v_exp_f32 v158, v158
    v_exp_f32 v159, v159
    v_cvt_pk_bf16_f32 v144, v144, v145
    v_cvt_pk_bf16_f32 v145, v146, v147
    v_cvt_pk_bf16_f32 v146, v148, v149
    v_cvt_pk_bf16_f32 v147, v150, v151
    v_cvt_pk_bf16_f32 v148, v152, v153
    v_cvt_pk_bf16_f32 v149, v154, v155
    v_cvt_pk_bf16_f32 v150, v156, v157
    v_cvt_pk_bf16_f32 v151, v158, v159
    s_waitcnt lgkmcnt(4)
    v_mfma_f32_32x32x16_bf16 v[48:63], v[32:35], v[144:147], v[48:63]
    v_exp_f32 v160, v160
    v_exp_f32 v161, v161
    v_exp_f32 v162, v162
    v_exp_f32 v163, v163
    v_mfma_f32_32x32x16_bf16 v[48:63], v[36:39], v[148:151], v[48:63]
    s_mov_b64 exec, s[96:97]
    ds_read_b128 v[32:35], v7 offset:14336
    ds_read_b128 v[36:39], v7 offset:15360
    s_mov_b64 exec, -1
    v_exp_f32 v164, v164
    s_mov_b32 s10, 293888
    buffer_load_dwordx4 v111, s[32:35], s10 offen offset:2048 lds
    v_exp_f32 v165, v165
    v_exp_f32 v166, v166
    v_mfma_f32_32x32x16_bf16 v[128:143], v[88:91], v[16:19], v[192:207]
    ds_read_b128 v[64:67], v7 offset:25600
    v_exp_f32 v167, v167
    v_exp_f32 v168, v168
    v_exp_f32 v169, v169
    v_exp_f32 v170, v170
    v_exp_f32 v171, v171
    v_exp_f32 v172, v172
    v_exp_f32 v173, v173
    v_exp_f32 v174, v174
    v_exp_f32 v175, v175
    v_cvt_pk_bf16_f32 v160, v160, v161
    v_cvt_pk_bf16_f32 v161, v162, v163
    v_cvt_pk_bf16_f32 v162, v164, v165
    v_cvt_pk_bf16_f32 v163, v166, v167
    v_and_b32 v106, 15, v0
    v_lshlrev_b32_e64 v106, 2, v106
    buffer_load_dword v105, v106, s[48:51], s98 offen sc1
    s_mov_b32 s10, 342016
    buffer_load_dwordx4 v111, s[32:35], s10 offen offset:3072 lds
    v_cvt_pk_bf16_f32 v164, v168, v169
    v_cvt_pk_bf16_f32 v165, v170, v171
    v_cvt_pk_bf16_f32 v166, v172, v173
    v_cvt_pk_bf16_f32 v167, v174, v175
    s_waitcnt lgkmcnt(4)
    v_mfma_f32_32x32x16_bf16 v[48:63], v[40:43], v[160:163], v[48:63]
    v_exp_f32 v176, v176
    v_exp_f32 v177, v177
    v_exp_f32 v178, v178
    v_exp_f32 v179, v179
    v_mfma_f32_32x32x16_bf16 v[48:63], v[44:47], v[164:167], v[48:63]
    s_mov_b64 exec, s[96:97]
    ds_read_b128 v[40:43], v7 offset:10240
    ds_read_b128 v[44:47], v7 offset:11264
    s_mov_b64 exec, -1
    v_exp_f32 v180, v180
    v_exp_f32 v181, v181
    v_exp_f32 v182, v182
    v_mfma_f32_32x32x16_bf16 v[144:159], v[92:95], v[16:19], v[192:207]
    ds_read_b128 v[68:71], v7 offset:21504
    v_exp_f32 v183, v183
    v_exp_f32 v184, v184
    v_exp_f32 v185, v185
    v_exp_f32 v186, v186
    s_lshl_b32 s11, s58, 13
    s_add_u32 m0, s11, 32768
    s_mov_b32 s10, 2048
    buffer_load_dwordx4 v111, s[32:35], s10 offen offset:0 lds
    v_exp_f32 v187, v187
    v_exp_f32 v188, v188
    v_exp_f32 v189, v189
    v_exp_f32 v190, v190
    v_exp_f32 v191, v191
    v_cvt_pk_bf16_f32 v176, v176, v177
    v_cvt_pk_bf16_f32 v177, v178, v179
    v_cvt_pk_bf16_f32 v178, v180, v181
    v_cvt_pk_bf16_f32 v179, v182, v183
    v_cvt_pk_bf16_f32 v180, v184, v185
    v_cvt_pk_bf16_f32 v181, v186, v187
    v_cvt_pk_bf16_f32 v182, v188, v189
    v_cvt_pk_bf16_f32 v183, v190, v191
    s_waitcnt lgkmcnt(4)
    v_mfma_f32_32x32x16_bf16 v[48:63], v[32:35], v[176:179], v[48:63]
    v_exp_f32 v112, v112
    v_exp_f32 v113, v113
    v_exp_f32 v114, v114
    v_exp_f32 v115, v115
    v_mfma_f32_32x32x16_bf16 v[48:63], v[36:39], v[180:183], v[48:63]
    s_mov_b64 exec, s[96:97]
    ds_read_b128 v[32:35], v7 offset:6144
    ds_read_b128 v[36:39], v7 offset:7168
    s_mov_b64 exec, -1
    v_exp_f32 v116, v116
    s_mov_b32 s10, 50176
    buffer_load_dwordx4 v111, s[32:35], s10 offen offset:1024 lds
    v_exp_f32 v117, v117
    v_exp_f32 v118, v118
    v_mfma_f32_32x32x16_bf16 v[160:175], v[96:99], v[20:23], v[208:223]
    ds_read_b128 v[72:75], v7 offset:17408
    v_exp_f32 v119, v119
    v_exp_f32 v120, v120
    v_exp_f32 v121, v121
    v_exp_f32 v122, v122
    v_exp_f32 v123, v123
    v_exp_f32 v124, v124
    v_exp_f32 v125, v125
    v_exp_f32 v126, v126
    v_exp_f32_e64 v127, v127
    v_cvt_pk_bf16_f32 v112, v112, v113
    v_cvt_pk_bf16_f32 v113, v114, v115
    v_cvt_pk_bf16_f32 v114, v116, v117
    v_cvt_pk_bf16_f32 v115, v118, v119
    s_mov_b32 s10, 98304
    buffer_load_dwordx4 v111, s[32:35], s10 offen offset:2048 lds
    v_cvt_pk_bf16_f32 v116, v120, v121
    v_cvt_pk_bf16_f32 v117, v122, v123
    v_cvt_pk_bf16_f32 v118, v124, v125
    v_cvt_pk_bf16_f32 v119, v126, v127
    s_waitcnt lgkmcnt(4)
    v_mfma_f32_32x32x16_bf16 v[48:63], v[40:43], v[112:115], v[48:63]
    v_exp_f32 v128, v128
    v_exp_f32 v129, v129
    v_exp_f32 v130, v130
    v_exp_f32 v131, v131
    v_mfma_f32_32x32x16_bf16 v[48:63], v[44:47], v[116:119], v[48:63]
    s_mov_b64 exec, s[96:97]
    ds_read_b128 v[40:43], v7 offset:2048
    ds_read_b128 v[44:47], v7 offset:3072
    s_mov_b64 exec, -1
    v_exp_f32 v132, v132
    v_exp_f32 v133, v133
    v_exp_f32 v134, v134
    v_mfma_f32_32x32x16_bf16 v[176:191], v[64:67], v[20:23], v[208:223]
    ds_read_b128 v[76:79], v7 offset:13312
    v_exp_f32 v135, v135
    v_exp_f32 v136, v136
    v_exp_f32 v137, v137
    v_exp_f32 v138, v138
    s_mov_b32 s10, 146432
    buffer_load_dwordx4 v111, s[32:35], s10 offen offset:3072 lds
    v_exp_f32 v139, v139
    v_exp_f32 v140, v140
    v_exp_f32 v141, v141
    v_exp_f32 v142, v142
    v_exp_f32_e64 v143, v143
    v_cvt_pk_bf16_f32 v128, v128, v129
    v_cvt_pk_bf16_f32 v129, v130, v131
    v_cvt_pk_bf16_f32 v130, v132, v133
    v_cvt_pk_bf16_f32 v131, v134, v135
    v_cvt_pk_bf16_f32 v132, v136, v137
    v_cvt_pk_bf16_f32 v133, v138, v139
    v_cvt_pk_bf16_f32 v134, v140, v141
    v_cvt_pk_bf16_f32 v135, v142, v143
    s_waitcnt lgkmcnt(4)
    v_mfma_f32_32x32x16_bf16 v[48:63], v[32:35], v[128:131], v[48:63]
    v_exp_f32 v144, v144
    v_exp_f32 v145, v145
    v_exp_f32 v146, v146
    v_exp_f32 v147, v147
    s_waitcnt vmcnt(11)
    v_and_b32 v108, 15, v0
    v_lshlrev_b32 v108, 7, v108
    v_add_u32 v108, s61, v108
    v_add_u32 v104, 0x200000, v108
    v_xor_b32 v104, 16384, v104
    v_cndmask_b32 v108, v108, v104, s[96:97]
    s_lshl_b32 s4, s57, 8
    s_add_u32 s4, s4, s101
    v_and_b32 v104, 1, v0
    v_lshl_add_u32 v104, v104, 7, s4
    v_cndmask_b32 v108, v108, v104, s[12:13]
    s_mov_b32 exec_hi, 3
    s_mov_b32 exec_lo, 0xffff0000
    buffer_load_dword a255, v108, s[48:51], 0 offen sc1
    s_mov_b64 exec, -1
    s_lshl_b32 s11, s58, 13
    s_add_u32 m0, s11, 36864
    s_mov_b32 s10, 198656
    buffer_load_dwordx4 v111, s[32:35], s10 offen offset:0 lds
    v_mfma_f32_32x32x16_bf16 v[48:63], v[36:39], v[132:135], v[48:63]
    s_mov_b64 exec, s[96:97]
    ds_read_b128 v[32:35], v7 offset:30976
    ds_read_b128 v[36:39], v7 offset:32000
    s_mov_b64 exec, -1
    v_exp_f32 v148, v148
    v_exp_f32 v149, v149
    v_exp_f32 v150, v150
    v_mfma_f32_32x32x16_bf16 v[112:127], v[68:71], v[20:23], v[208:223]
    ds_read_b128 v[80:83], v7 offset:9216
    v_exp_f32 v151, v151
    v_exp_f32 v152, v152
    v_exp_f32 v153, v153
    v_exp_f32 v154, v154
    v_exp_f32 v155, v155
    v_exp_f32 v156, v156
    v_exp_f32 v157, v157
    v_exp_f32 v158, v158
    v_exp_f32 v159, v159
    v_cvt_pk_bf16_f32 v144, v144, v145
    v_cvt_pk_bf16_f32 v145, v146, v147
    v_cvt_pk_bf16_f32 v146, v148, v149
    v_cvt_pk_bf16_f32 v147, v150, v151
    s_waitcnt vmcnt(7)
    s_movk_i32 s4, 0x100
    v_cmp_gt_u32 vcc, s4, v105
    s_cbranch_vccnz gb_58
go_59:
    v_and_b32 v105, 0xff, v105
    v_cmp_eq_u32 vcc, s6, v105
    s_nop 0
    s_cmp_eq_u64 vcc, exec
    s_cselect_b32 s63, 1, 0
    s_lshl_b32 s4, s57, 2
    s_add_u32 s4, s4, s58
    s_lshl_b32 s4, s4, 5
    s_add_u32 s4, s4, s56
    s_lshl_b32 s4, s4, 2
    s_add_u32 s4, s4, 0x442000
    v_mov_b32_e64 v108, 1
    s_mov_b64 exec, 1
    buffer_store_dword v108, off, s[48:51], s4 sc0 sc1
    s_mov_b64 exec, -1
    s_mov_b32 s10, 246784
    buffer_load_dwordx4 v111, s[32:35], s10 offen offset:1024 lds
    v_cvt_pk_bf16_f32 v148, v152, v153
    v_cvt_pk_bf16_f32 v149, v154, v155
    v_cvt_pk_bf16_f32 v150, v156, v157
    v_cvt_pk_bf16_f32 v151, v158, v159
    v_bfi_b32 v144, v24, 0, v144
    v_bfi_b32 v145, v25, 0, v145
    v_bfi_b32 v146, v26, 0, v146
    v_bfi_b32 v147, v27, 0, v147
    v_bfi_b32 v148, v28, 0, v148
    v_bfi_b32 v149, v29, 0, v149
    v_bfi_b32 v150, v30, 0, v150
    v_bfi_b32 v151, v31, 0, v151
    s_waitcnt lgkmcnt(4)
    v_mfma_f32_32x32x16_bf16 v[48:63], v[40:43], v[144:147], v[48:63]
    v_exp_f32 v160, v160
    v_exp_f32 v161, v161
    v_exp_f32 v162, v162
    v_exp_f32 v163, v163
    v_mfma_f32_32x32x16_bf16 v[48:63], v[44:47], v[148:151], v[48:63]
    s_mov_b64 exec, s[96:97]
    ds_read_b128 v[40:43], v7 offset:26880
    ds_read_b128 v[44:47], v7 offset:27904
    s_mov_b64 exec, -1
    v_exp_f32 v164, v164
    v_exp_f32 v165, v165
    v_exp_f32 v166, v166
    s_mov_b32 s10, 294912
    buffer_load_dwordx4 v111, s[32:35], s10 offen offset:2048 lds
    v_mfma_f32_32x32x16_bf16 v[128:143], v[72:75], v[20:23], v[208:223]
    ds_read_b128 v[84:87], v7 offset:5120
    v_exp_f32 v167, v167
    v_exp_f32 v168, v168
    v_exp_f32 v169, v169
    v_exp_f32 v170, v170
    v_exp_f32 v171, v171
    v_exp_f32 v172, v172
    v_exp_f32 v173, v173
    v_exp_f32 v174, v174
    v_exp_f32_e64 v175, v175
    v_cvt_pk_bf16_f32 v160, v160, v161
    v_cvt_pk_bf16_f32 v161, v162, v163
    v_cvt_pk_bf16_f32 v162, v164, v165
    v_cvt_pk_bf16_f32 v163, v166, v167
    v_cvt_pk_bf16_f32 v164, v168, v169
    v_cvt_pk_bf16_f32 v165, v170, v171
    v_cvt_pk_bf16_f32 v166, v172, v173
    v_cvt_pk_bf16_f32 v167, v174, v175
    s_mov_b32 s10, 343040
    buffer_load_dwordx4 v111, s[32:35], s10 offen offset:3072 lds
    s_waitcnt lgkmcnt(4)
    v_mfma_f32_32x32x16_bf16 v[224:239], v[32:35], v[160:163], v[224:239]
    v_rcp_f32 v57, v56
    v_cmp_ngt_f32 vcc, 0x71800000, v56
    s_nop 0
    s_or_b64 s[16:17], s[16:17], vcc
    v_mul_f32 v48, v48, v57
    v_mul_f32 v49, v49, v57
    v_mul_f32 v50, v50, v57
    v_mfma_f32_32x32x16_bf16 v[224:239], v[36:39], v[164:167], v[224:239]
    s_mov_b64 exec, s[96:97]
    ds_read_b128 v[32:35], v7 offset:22784
    ds_read_b128 v[36:39], v7 offset:23808
    s_mov_b64 exec, -1
    v_mul_f32 v51, v51, v57
    v_mul_f32 v52, v52, v57
    v_mul_f32 v53, v53, v57
    v_mul_f32 v54, v54, v57
    v_mul_f32 v55, v55, v57
    v_add_u32 v48, 0x8000, v48
    v_mfma_f32_32x32x16_bf16 v[144:159], v[76:79], v[20:23], v[208:223]
    ds_read_b128 v[88:91], v7 offset:1024
    v_cvt_pk_bf16_f32 v60, v48, v49
    v_cvt_pk_bf16_f32 v61, v50, v51
    v_cvt_pk_bf16_f32 v62, v52, v53
    v_cvt_pk_bf16_f32 v63, v54, v55
    v_and_b32 v60, -2, v60
    s_cmp_eq_u64 s[16:17], 0
    s_cselect_b32 s7, s62, 0x7f000000
    s_cselect_b32 s54, 0x7f000000, s62
    buffer_store_dwordx4 v[60:63], v1, s[48:51], s7 offen offset:0 sc0 sc1
    v_exp_f32 v176, v176
    v_exp_f32 v177, v177
    v_exp_f32 v178, v178
    v_lshrrev_b32 v108, 2, v0
    s_lshl_b32 s11, s58, 7
    v_add_u32 v108, s11, v108
    v_lshlrev_b32 v108, 11, v108
    v_sub_u32 v111, v111, v108
    v_xor_b32 v111, 512, v111
    s_lshl_b32 s11, s58, 13
    s_add_u32 m0, s11, 0
    s_mov_b32 s10, 0
    buffer_load_dwordx4 v111, s[36:39], s10 offen offset:0 lds
    v_exp_f32 v179, v179
    v_exp_f32 v180, v180
    v_exp_f32 v181, v181
    v_exp_f32 v182, v182
    v_exp_f32 v183, v183
    v_exp_f32 v184, v184
    v_exp_f32 v185, v185
    v_exp_f32 v186, v186
    v_exp_f32 v187, v187
    v_exp_f32 v188, v188
    v_exp_f32 v189, v189
    v_exp_f32 v190, v190
    v_exp_f32 v191, v191
    v_cvt_pk_bf16_f32 v176, v176, v177
    v_cvt_pk_bf16_f32 v177, v178, v179
    s_mov_b32 s10, 15360
    buffer_load_dwordx4 v111, s[36:39], s10 offen offset:1024 lds
    v_cvt_pk_bf16_f32 v178, v180, v181
    v_cvt_pk_bf16_f32 v179, v182, v183
    v_cvt_pk_bf16_f32 v180, v184, v185
    v_cvt_pk_bf16_f32 v181, v186, v187
    v_cvt_pk_bf16_f32 v182, v188, v189
    v_cvt_pk_bf16_f32 v183, v190, v191
    s_waitcnt lgkmcnt(4)
    v_mfma_f32_32x32x16_bf16 v[224:239], v[40:43], v[176:179], v[224:239]
    v_exp_f32 v112, v112
    v_exp_f32 v113, v113
    v_exp_f32 v114, v114
    v_exp_f32 v115, v115
    v_mfma_f32_32x32x16_bf16 v[224:239], v[44:47], v[180:183], v[224:239]
    s_mov_b64 exec, s[96:97]
    ds_read_b128 v[40:43], v7 offset:18688
    ds_read_b128 v[44:47], v7 offset:19712
    s_mov_b64 exec, -1
    v_exp_f32 v116, v116
    v_exp_f32 v117, v117
    v_exp_f32 v118, v118
    v_mfma_f32_32x32x16_bf16 v[160:175], v[80:83], v[20:23], v[208:223]
    v_exp_f32 v119, v119
    v_exp_f32 v120, v120
    v_exp_f32 v121, v121
    s_mov_b32 s10, 30720
    buffer_load_dwordx4 v111, s[36:39], s10 offen offset:2048 lds
    v_exp_f32 v122, v122
    v_exp_f32 v123, v123
    v_exp_f32 v124, v124
    v_exp_f32 v125, v125
    v_exp_f32 v126, v126
    v_exp_f32_e64 v127, v127
    v_cvt_pk_bf16_f32 v112, v112, v113
    v_cvt_pk_bf16_f32 v113, v114, v115
    v_cvt_pk_bf16_f32 v114, v116, v117
    v_cvt_pk_bf16_f32 v115, v118, v119
    v_cvt_pk_bf16_f32 v116, v120, v121
    v_cvt_pk_bf16_f32 v117, v122, v123
    v_cvt_pk_bf16_f32 v118, v124, v125
    v_cvt_pk_bf16_f32 v119, v126, v127
    s_waitcnt lgkmcnt(3)
    v_mfma_f32_32x32x16_bf16 v[224:239], v[32:35], v[112:115], v[224:239]
    v_exp_f32 v128, v128
    v_exp_f32 v129, v129
    v_exp_f32 v130, v130
    s_mov_b32 s10, 46080
    buffer_load_dwordx4 v111, s[36:39], s10 offen offset:3072 lds
    v_exp_f32 v131, v131
    v_mfma_f32_32x32x16_bf16 v[224:239], v[36:39], v[116:119], v[224:239]
    s_mov_b64 exec, s[96:97]
    ds_read_b128 v[32:35], v7 offset:14592
    ds_read_b128 v[36:39], v7 offset:15616
    s_mov_b64 exec, -1
    v_exp_f32 v132, v132
    v_exp_f32 v133, v133
    v_exp_f32 v134, v134
    v_mfma_f32_32x32x16_bf16 v[176:191], v[84:87], v[20:23], v[208:223]
    v_exp_f32 v135, v135
    v_exp_f32 v136, v136
    v_exp_f32 v137, v137
    v_exp_f32 v138, v138
    v_exp_f32 v139, v139
    v_exp_f32 v140, v140
    v_exp_f32 v141, v141
    v_exp_f32 v142, v142
    v_exp_f32 v143, v143
    v_cvt_pk_bf16_f32 v128, v128, v129
    s_lshl_b32 s11, s58, 13
    s_add_u32 m0, s11, 4096
    s_mov_b32 s10, 65536
    buffer_load_dwordx4 v111, s[36:39], s10 offen offset:0 lds
    v_cvt_pk_bf16_f32 v129, v130, v131
    v_cvt_pk_bf16_f32 v130, v132, v133
    v_cvt_pk_bf16_f32 v131, v134, v135
    v_cvt_pk_bf16_f32 v132, v136, v137
    v_cvt_pk_bf16_f32 v133, v138, v139
    v_cvt_pk_bf16_f32 v134, v140, v141
    v_cvt_pk_bf16_f32 v135, v142, v143
    s_waitcnt lgkmcnt(2)
    v_mfma_f32_32x32x16_bf16 v[224:239], v[40:43], v[128:131], v[224:239]
    v_exp_f32 v144, v144
    v_exp_f32 v145, v145
    v_exp_f32 v146, v146
    v_exp_f32 v147, v147
    v_mfma_f32_32x32x16_bf16 v[224:239], v[44:47], v[132:135], v[224:239]
    s_mov_b64 exec, s[96:97]
    ds_read_b128 v[40:43], v7 offset:10496
    ds_read_b128 v[44:47], v7 offset:11520
    s_mov_b64 exec, -1
    v_exp_f32 v148, v148
    v_exp_f32 v149, v149
    v_exp_f32 v150, v150
    v_mfma_f32_32x32x16_bf16 v[112:127], v[88:91], v[20:23], v[208:223]
    v_exp_f32 v151, v151
    v_exp_f32 v152, v152
    v_exp_f32 v153, v153
    s_mov_b32 s10, 80896
    buffer_load_dwordx4 v111, s[36:39], s10 offen offset:1024 lds
    v_exp_f32 v154, v154
    v_exp_f32 v155, v155
    v_exp_f32 v156, v156
    v_exp_f32 v157, v157
    v_exp_f32 v158, v158
    v_exp_f32_e64 v159, v159
    v_cvt_pk_bf16_f32 v144, v144, v145
    v_cvt_pk_bf16_f32 v145, v146, v147
    v_cvt_pk_bf16_f32 v146, v148, v149
    v_cvt_pk_bf16_f32 v147, v150, v151
    v_cvt_pk_bf16_f32 v148, v152, v153
    v_cvt_pk_bf16_f32 v149, v154, v155
    v_cvt_pk_bf16_f32 v150, v156, v157
    v_cvt_pk_bf16_f32 v151, v158, v159
    s_waitcnt lgkmcnt(2)
    v_mfma_f32_32x32x16_bf16 v[224:239], v[32:35], v[144:147], v[224:239]
    v_exp_f32 v160, v160
    v_exp_f32 v161, v161
    v_exp_f32 v162, v162
    s_mov_b32 s10, 96256
    buffer_load_dwordx4 v111, s[36:39], s10 offen offset:2048 lds
    v_exp_f32 v163, v163
    v_mfma_f32_32x32x16_bf16 v[224:239], v[36:39], v[148:151], v[224:239]
    s_mov_b64 exec, s[96:97]
    ds_read_b128 v[32:35], v7 offset:6400
    ds_read_b128 v[36:39], v7 offset:7424
    s_mov_b64 exec, -1
    v_exp_f32 v164, v164
    v_exp_f32 v165, v165
    v_exp_f32 v166, v166
    v_exp_f32 v167, v167
    v_exp_f32 v168, v168
    v_exp_f32 v169, v169
    v_exp_f32 v170, v170
    v_exp_f32 v171, v171
    v_exp_f32 v172, v172
    v_exp_f32 v173, v173
    v_exp_f32 v174, v174
    v_exp_f32_e64 v175, v175
    v_cvt_pk_bf16_f32 v160, v160, v161
    s_mov_b32 s10, 111616
    buffer_load_dwordx4 v111, s[36:39], s10 offen offset:3072 lds
    v_cvt_pk_bf16_f32 v161, v162, v163
    v_cvt_pk_bf16_f32 v162, v164, v165
    v_cvt_pk_bf16_f32 v163, v166, v167
    v_cvt_pk_bf16_f32 v164, v168, v169
    v_cvt_pk_bf16_f32 v165, v170, v171
    v_cvt_pk_bf16_f32 v166, v172, v173
    v_cvt_pk_bf16_f32 v167, v174, v175
    s_waitcnt lgkmcnt(2)
    v_mfma_f32_32x32x16_bf16 v[224:239], v[40:43], v[160:163], v[224:239]
    v_exp_f32 v176, v176
    v_exp_f32 v177, v177
    v_exp_f32 v178, v178
    v_exp_f32 v179, v179
    v_mfma_f32_32x32x16_bf16 v[224:239], v[44:47], v[164:167], v[224:239]
    s_mov_b64 exec, s[96:97]
    ds_read_b128 v[40:43], v7 offset:2304
    ds_read_b128 v[44:47], v7 offset:3328
    s_mov_b64 exec, -1
    v_exp_f32 v180, v180
    v_exp_f32 v181, v181
    v_exp_f32 v182, v182
    v_exp_f32 v183, v183
    v_exp_f32 v184, v184
    v_exp_f32 v185, v185
    v_exp_f32 v186, v186
    v_exp_f32 v187, v187
    v_exp_f32 v188, v188
    v_exp_f32 v189, v189
    v_exp_f32 v190, v190
    v_exp_f32_e64 v191, v191
    v_cvt_pk_bf16_f32 v176, v176, v177
    v_cvt_pk_bf16_f32 v177, v178, v179
    v_cvt_pk_bf16_f32 v178, v180, v181
    v_cvt_pk_bf16_f32 v179, v182, v183
    v_cvt_pk_bf16_f32 v180, v184, v185
    v_cvt_pk_bf16_f32 v181, v186, v187
    v_cvt_pk_bf16_f32 v182, v188, v189
    v_cvt_pk_bf16_f32 v183, v190, v191
    s_waitcnt lgkmcnt(2)
    v_mfma_f32_32x32x16_bf16 v[224:239], v[32:35], v[176:179], v[224:239]
    v_exp_f32 v112, v112
    v_exp_f32 v113, v113
    v_exp_f32 v114, v114
    v_exp_f32 v115, v115
    v_mfma_f32_32x32x16_bf16 v[224:239], v[36:39], v[180:183], v[224:239]
    v_exp_f32 v116, v116
    v_exp_f32 v117, v117
    v_exp_f32 v118, v118
    v_exp_f32 v119, v119
    v_exp_f32 v120, v120
    v_exp_f32 v121, v121
    v_exp_f32 v122, v122
    v_exp_f32 v123, v123
    v_exp_f32 v124, v124
    v_exp_f32 v125, v125
    v_exp_f32 v126, v126
    v_exp_f32_e64 v127, v127
    v_cvt_pk_bf16_f32 v112, v112, v113
    v_cvt_pk_bf16_f32 v113, v114, v115
    v_cvt_pk_bf16_f32 v114, v116, v117
    v_cvt_pk_bf16_f32 v115, v118, v119
    v_cvt_pk_bf16_f32 v116, v120, v121
    v_cvt_pk_bf16_f32 v117, v122, v123
    v_cvt_pk_bf16_f32 v118, v124, v125
    v_cvt_pk_bf16_f32 v119, v126, v127
    v_bfi_b32 v112, v24, 0, v112
    v_bfi_b32 v113, v25, 0, v113
    v_bfi_b32 v114, v26, 0, v114
    v_bfi_b32 v115, v27, 0, v115
    v_bfi_b32 v116, v28, 0, v116
    v_bfi_b32 v117, v29, 0, v117
    v_bfi_b32 v118, v30, 0, v118
    v_bfi_b32 v119, v31, 0, v119
    s_waitcnt lgkmcnt(0)
    v_mfma_f32_32x32x16_bf16 v[224:239], v[40:43], v[112:115], v[224:239]
    v_mfma_f32_32x32x16_bf16 v[224:239], v[44:47], v[116:119], v[224:239]
    s_nop 11
    v_rcp_f32 v233, v232
    v_cmp_ngt_f32 vcc, 0x71800000, v232
    s_nop 0
    s_or_b64 s[16:17], s[16:17], vcc
    v_mul_f32 v224, v224, v233
    v_mul_f32 v225, v225, v233
    v_mul_f32 v226, v226, v233
    v_mul_f32 v227, v227, v233
    v_mul_f32 v228, v228, v233
    v_mul_f32 v229, v229, v233
    v_mul_f32 v230, v230, v233
    v_mul_f32_e64 v231, v231, v233
    v_add_u32 v224, 0x8000, v224
    v_cvt_pk_bf16_f32 v236, v224, v225
    v_cvt_pk_bf16_f32 v237, v226, v227
    v_cvt_pk_bf16_f32 v238, v228, v229
    v_cvt_pk_bf16_f32 v239, v230, v231
    v_and_b32 v236, -2, v236
    s_cmp_eq_u64 s[16:17], 0
    s_cselect_b32 s7, s62, 0x7f000000
    buffer_store_dwordx4 v[236:239], v1, s[48:51], s7 offen offset:1024 sc0 sc1
    s_nop 1
ajoin_19:
    s_cmp_lg_u64 s[16:17], 0
    s_cbranch_scc1 aslow_20
adone_21:
    s_lshl_b32 s11, s58, 13
    v_add_u32 v80, s11, v2
    v_add_u32 v81, 0x10000, v80
    s_lshl_b32 s11, s58, 13
    v_add_u32 v82, s11, v1
    v_add_u32 v83, 0x10000, v82
    s_waitcnt vmcnt(10)
    ds_read_b64_tr_b16 v[32:33], v81 offset:0
    ds_read_b64_tr_b16 v[34:35], v81 offset:512
    ds_read_b64_tr_b16 v[36:37], v81 offset:1024
    ds_read_b64_tr_b16 v[38:39], v81 offset:1536
    ds_read_b64_tr_b16 v[40:41], v81 offset:2048
    ds_read_b64_tr_b16 v[42:43], v81 offset:2560
    ds_read_b64_tr_b16 v[44:45], v81 offset:3072
    ds_read_b64_tr_b16 v[46:47], v81 offset:3584
    v_lshlrev_b32 v16, 16, v8
    v_and_b32 v17, 0xffff0000, v8
    v_lshlrev_b32 v18, 16, v9
    v_and_b32 v19, 0xffff0000, v9
    v_lshlrev_b32 v20, 16, v10
    v_and_b32 v21, 0xffff0000, v10
    v_lshlrev_b32 v22, 16, v11
    v_and_b32 v23, 0xffff0000, v11
    v_lshlrev_b32 v24, 16, v12
    v_and_b32 v25, 0xffff0000, v12
    v_lshlrev_b32 v26, 16, v13
    v_and_b32 v27, 0xffff0000, v13
    v_lshlrev_b32 v28, 16, v14
    v_and_b32 v29, 0xffff0000, v14
    v_lshlrev_b32 v30, 16, v15
    v_and_b32 v31, 0xffff0000, v15
    v_and_b32 v96, 15, v0
    v_lshlrev_b32 v96, 2, v96
    s_movk_i32 s7, 0x200
    v_and_b32 v90, 31, v0
    v_lshlrev_b32 v90, 5, v90
    v_lshrrev_b32 v89, 5, v0
    v_lshl_add_u32 v89, v89, 2, v90
    s_lshl_b32 s4, s58, 3
    s_add_u32 s4, s4, 0x24800
    v_add_u32 v89, s4, v89
    v_mov_b32 v90, 0
    v_mov_b32 v91, 0
    s_waitcnt lgkmcnt(6)
    v_dot2c_f32_bf16 v90, s22, v32
    v_dot2c_f32_bf16 v90, s22, v33
    v_dot2c_f32_bf16 v90, s22, v34
    v_dot2c_f32_bf16 v90, s22, v35
    ds_write_b128 v83, v[32:35] offset:0
    s_waitcnt lgkmcnt(5)
    v_dot2c_f32_bf16 v90, s22, v36
    v_dot2c_f32_bf16 v90, s22, v37
    v_dot2c_f32_bf16 v90, s22, v38
    v_dot2c_f32_bf16 v90, s22, v39
    ds_write_b128 v83, v[36:39] offset:1024
    s_waitcnt lgkmcnt(4)
    v_dot2c_f32_bf16 v90, s22, v40
    v_dot2c_f32_bf16 v90, s22, v41
    v_dot2c_f32_bf16 v90, s22, v42
    v_dot2c_f32_bf16 v90, s22, v43
    ds_write_b128 v83, v[40:43] offset:2048
    s_waitcnt lgkmcnt(3)
    v_dot2c_f32_bf16 v90, s22, v44
    v_dot2c_f32_bf16 v90, s22, v45
    v_dot2c_f32_bf16 v90, s22, v46
    v_dot2c_f32_bf16 v90, s22, v47
    ds_write_b128 v83, v[44:47] offset:3072
    s_lshl_b32 s4, s57, 2
    s_add_u32 s4, s4, s98
    s_or_b32 s5, s6, 0x200
    s_waitcnt vmcnt(0)
    s_cmp_lg_u32 s63, 0
    s_cbranch_scc0 fast_64
    v_mov_b32_e64 v93, s5
    s_mov_b64 exec, 1
    buffer_store_dword v93, off, s[48:51], s4
    s_mov_b64 exec, -1
dend_65:
    s_barrier
    ds_read_b64_tr_b16 v[64:65], v2 offset:0
    ds_read_b64_tr_b16 v[66:67], v2 offset:512
    ds_read_b64_tr_b16 v[68:69], v2 offset:1024
    ds_read_b64_tr_b16 v[70:71], v2 offset:1536
    ds_read_b64_tr_b16 v[72:73], v2 offset:2048
    ds_read_b64_tr_b16 v[74:75], v2 offset:2560
    s_mov_b32 s99, 200000
poll_66:
    buffer_load_dword v97, v96, s[48:51], s98 offen sc1
    s_waitcnt vmcnt(0)
    v_cmp_le_u32 vcc, s7, v97
    s_nop 0
    s_cmp_eq_u64 vcc, exec
    s_nop 1
    s_nop 0
    s_cbranch_scc1 polld_67
    s_sub_u32 s99, s99, 1
    s_cmp_lg_u32 s99, 0
    s_cbranch_scc1 poll_66
polld_67:
    s_mov_b32 s28, 0x3fb8aa3b
    s_mov_b32 s29, s28
    s_mov_b32 s30, 0x358637bd
    s_mov_b32 s31, s30
    s_add_u32 s3, s100, 0
    buffer_load_dwordx4 v[128:131], v1, s[48:51], s3 offen offset:0 sc1
    buffer_load_dwordx4 v[132:135], v1, s[48:51], s3 offen offset:1024 sc1
    buffer_load_dwordx4 v[136:139], v1, s[48:51], s3 offen offset:2048 sc1
    buffer_load_dwordx4 v[140:143], v1, s[48:51], s3 offen offset:3072 sc1
    s_add_u32 s3, s100, 4096
    buffer_load_dwordx4 v[144:147], v1, s[48:51], s3 offen offset:0 sc1
    buffer_load_dwordx4 v[148:151], v1, s[48:51], s3 offen offset:1024 sc1
    buffer_load_dwordx4 v[152:155], v1, s[48:51], s3 offen offset:2048 sc1
    buffer_load_dwordx4 v[156:159], v1, s[48:51], s3 offen offset:3072 sc1
    ds_read_b64_tr_b16 v[76:77], v2 offset:3072
    ds_read_b64_tr_b16 v[78:79], v2 offset:3584
    s_waitcnt vmcnt(7) lgkmcnt(6)
    v_mfma_f32_32x32x16_bf16 v[16:31], v[64:67], v[128:131], v[16:31]
    s_add_u32 s3, s100, 8192
    buffer_load_dwordx4 v[160:163], v1, s[48:51], s3 offen offset:0 sc1
    ds_read_b64_tr_b16 v[48:49], v81 offset:4096
    ds_read_b64_tr_b16 v[50:51], v81 offset:4608
    ds_read_b64_tr_b16 v[64:65], v2 offset:4096
    ds_read_b64_tr_b16 v[66:67], v2 offset:4608
    s_waitcnt vmcnt(7) lgkmcnt(8)
    v_mfma_f32_32x32x16_bf16 v[16:31], v[68:71], v[132:135], v[16:31]
    buffer_load_dwordx4 v[164:167], v1, s[48:51], s3 offen offset:1024 sc1
    ds_read_b64_tr_b16 v[68:69], v2 offset:5120
    ds_read_b64_tr_b16 v[70:71], v2 offset:5632
    s_waitcnt vmcnt(7) lgkmcnt(8)
    v_mfma_f32_32x32x16_bf16 v[16:31], v[72:75], v[136:139], v[16:31]
    buffer_load_dwordx4 v[168:171], v1, s[48:51], s3 offen offset:2048 sc1
    ds_read_b64_tr_b16 v[52:53], v81 offset:5120
    ds_read_b64_tr_b16 v[54:55], v81 offset:5632
    ds_read_b64_tr_b16 v[72:73], v2 offset:6144
    ds_read_b64_tr_b16 v[74:75], v2 offset:6656
    s_waitcnt lgkmcnt(8)
    v_dot2c_f32_bf16 v90, s22, v48
    v_dot2c_f32_bf16 v90, s22, v49
    v_dot2c_f32_bf16 v90, s22, v50
    v_dot2c_f32_bf16 v90, s22, v51
    s_waitcnt vmcnt(7)
    v_mfma_f32_32x32x16_bf16 v[16:31], v[76:79], v[140:143], v[16:31]
    buffer_load_dwordx4 v[172:175], v1, s[48:51], s3 offen offset:3072 sc1
    ds_write_b128 v83, v[48:51] offset:4096
    ds_read_b64_tr_b16 v[76:77], v2 offset:7168
    ds_read_b64_tr_b16 v[78:79], v2 offset:7680
    s_waitcnt vmcnt(7) lgkmcnt(9)
    v_mfma_f32_32x32x16_bf16 v[16:31], v[64:67], v[144:147], v[16:31]
    s_add_u32 s3, s100, 12288
    buffer_load_dwordx4 v[176:179], v1, s[48:51], s3 offen offset:0 sc1
    ds_read_b64_tr_b16 v[56:57], v81 offset:6144
    ds_read_b64_tr_b16 v[58:59], v81 offset:6656
    ds_read_b64_tr_b16 v[64:65], v2 offset:8192
    ds_read_b64_tr_b16 v[66:67], v2 offset:8704
    s_waitcnt lgkmcnt(9)
    v_dot2c_f32_bf16 v90, s22, v52
    v_dot2c_f32_bf16 v90, s22, v53
    v_dot2c_f32_bf16 v90, s22, v54
    v_dot2c_f32_bf16 v90, s22, v55
    s_waitcnt vmcnt(7)
    v_mfma_f32_32x32x16_bf16 v[16:31], v[68:71], v[148:151], v[16:31]
    buffer_load_dwordx4 v[180:183], v1, s[48:51], s3 offen offset:1024 sc1
    ds_write_b128 v83, v[52:55] offset:5120
    ds_read_b64_tr_b16 v[68:69], v2 offset:9216
    ds_read_b64_tr_b16 v[70:71], v2 offset:9728
    s_waitcnt vmcnt(7) lgkmcnt(10)
    v_mfma_f32_32x32x16_bf16 v[16:31], v[72:75], v[152:155], v[16:31]
    buffer_load_dwordx4 v[184:187], v1, s[48:51], s3 offen offset:2048 sc1
    ds_read_b64_tr_b16 v[60:61], v81 offset:7168
    ds_read_b64_tr_b16 v[62:63], v81 offset:7680
    ds_read_b64_tr_b16 v[72:73], v2 offset:10240
    ds_read_b64_tr_b16 v[74:75], v2 offset:10752
    s_waitcnt lgkmcnt(9)
    v_dot2c_f32_bf16 v90, s22, v56
    v_dot2c_f32_bf16 v90, s22, v57
    v_dot2c_f32_bf16 v90, s22, v58
    v_dot2c_f32_bf16 v90, s22, v59
    s_waitcnt vmcnt(7)
    v_mfma_f32_32x32x16_bf16 v[16:31], v[76:79], v[156:159], v[16:31]
    buffer_load_dwordx4 v[188:191], v1, s[48:51], s3 offen offset:3072 sc1
    ds_write_b128 v83, v[56:59] offset:6144
    ds_read_b64_tr_b16 v[76:77], v2 offset:11264
    ds_read_b64_tr_b16 v[78:79], v2 offset:11776
    s_waitcnt vmcnt(7) lgkmcnt(10)
    v_mfma_f32_32x32x16_bf16 v[16:31], v[64:67], v[160:163], v[16:31]
    s_add_u32 s3, s100, 16384
    buffer_load_dwordx4 v[192:195], v1, s[48:51], s3 offen offset:0 sc1
    ds_read_b64_tr_b16 v[32:33], v80 offset:32768
    ds_read_b64_tr_b16 v[34:35], v80 offset:33280
    ds_read_b64_tr_b16 v[64:65], v2 offset:12288
    ds_read_b64_tr_b16 v[66:67], v2 offset:12800
    s_waitcnt lgkmcnt(9)
    v_dot2c_f32_bf16 v90, s22, v60
    v_dot2c_f32_bf16 v90, s22, v61
    v_dot2c_f32_bf16 v90, s22, v62
    v_dot2c_f32_bf16 v90, s22, v63
    s_waitcnt vmcnt(7)
    v_mfma_f32_32x32x16_bf16 v[16:31], v[68:71], v[164:167], v[16:31]
    buffer_load_dwordx4 v[196:199], v1, s[48:51], s3 offen offset:1024 sc1
    ds_write_b128 v83, v[60:63] offset:7168
    ds_read_b64_tr_b16 v[68:69], v2 offset:13312
    ds_read_b64_tr_b16 v[70:71], v2 offset:13824
    s_waitcnt vmcnt(7) lgkmcnt(10)
    v_mfma_f32_32x32x16_bf16 v[16:31], v[72:75], v[168:171], v[16:31]
    buffer_load_dwordx4 v[200:203], v1, s[48:51], s3 offen offset:2048 sc1
    ds_read_b64_tr_b16 v[36:37], v80 offset:33792
    ds_read_b64_tr_b16 v[38:39], v80 offset:34304
    ds_read_b64_tr_b16 v[72:73], v2 offset:14336
    ds_read_b64_tr_b16 v[74:75], v2 offset:14848
    s_waitcnt lgkmcnt(9)
    v_dot2c_f32_bf16 v91, s22, v32
    v_dot2c_f32_bf16 v91, s22, v33
    v_dot2c_f32_bf16 v91, s22, v34
    v_dot2c_f32_bf16 v91, s22, v35
    s_waitcnt vmcnt(7)
    v_mfma_f32_32x32x16_bf16 v[16:31], v[76:79], v[172:175], v[16:31]
    buffer_load_dwordx4 v[204:207], v1, s[48:51], s3 offen offset:3072 sc1
    ds_write_b128 v82, v[32:35] offset:32768
    ds_read_b64_tr_b16 v[76:77], v2 offset:15360
    ds_read_b64_tr_b16 v[78:79], v2 offset:15872
    s_waitcnt vmcnt(7) lgkmcnt(10)
    v_mfma_f32_32x32x16_bf16 v[16:31], v[64:67], v[176:179], v[16:31]
    s_add_u32 s3, s100, 20480
    buffer_load_dwordx4 v[208:211], v1, s[48:51], s3 offen offset:0 sc1
    ds_read_b64_tr_b16 v[64:65], v2 offset:16384
    ds_read_b64_tr_b16 v[66:67], v2 offset:16896
    s_waitcnt lgkmcnt(7)
    v_dot2c_f32_bf16 v91, s22, v36
    v_dot2c_f32_bf16 v91, s22, v37
    v_dot2c_f32_bf16 v91, s22, v38
    v_dot2c_f32_bf16 v91, s22, v39
    s_waitcnt vmcnt(7)
    v_mfma_f32_32x32x16_bf16 v[16:31], v[68:71], v[180:183], v[16:31]
    buffer_load_dwordx4 v[212:215], v1, s[48:51], s3 offen offset:1024 sc1
    ds_write_b128 v82, v[36:39] offset:33792
    ds_read_b64_tr_b16 v[40:41], v80 offset:34816
    ds_read_b64_tr_b16 v[42:43], v80 offset:35328
    ds_read_b64_tr_b16 v[68:69], v2 offset:17408
    ds_read_b64_tr_b16 v[70:71], v2 offset:17920
    s_waitcnt vmcnt(7) lgkmcnt(10)
    v_mfma_f32_32x32x16_bf16 v[16:31], v[72:75], v[184:187], v[16:31]
    buffer_load_dwordx4 v[216:219], v1, s[48:51], s3 offen offset:2048 sc1
    ds_read_b64_tr_b16 v[72:73], v2 offset:18432
    ds_read_b64_tr_b16 v[74:75], v2 offset:18944
    s_waitcnt vmcnt(7) lgkmcnt(9)
    v_mfma_f32_32x32x16_bf16 v[16:31], v[76:79], v[188:191], v[16:31]
    buffer_load_dwordx4 v[220:223], v1, s[48:51], s3 offen offset:3072 sc1
    ds_read_b64_tr_b16 v[44:45], v80 offset:35840
    ds_read_b64_tr_b16 v[46:47], v80 offset:36352
    ds_read_b64_tr_b16 v[76:77], v2 offset:19456
    ds_read_b64_tr_b16 v[78:79], v2 offset:19968
    s_waitcnt lgkmcnt(8)
    v_dot2c_f32_bf16 v91, s22, v40
    v_dot2c_f32_bf16 v91, s22, v41
    v_dot2c_f32_bf16 v91, s22, v42
    v_dot2c_f32_bf16 v91, s22, v43
    s_waitcnt vmcnt(7)
    v_mfma_f32_32x32x16_bf16 v[16:31], v[64:67], v[192:195], v[16:31]
    s_add_u32 s3, s100, 24576
    buffer_load_dwordx4 v[224:227], v1, s[48:51], s3 offen offset:0 sc1
    ds_write_b128 v82, v[40:43] offset:34816
    ds_read_b64_tr_b16 v[64:65], v2 offset:20480
    ds_read_b64_tr_b16 v[66:67], v2 offset:20992
    s_waitcnt vmcnt(7) lgkmcnt(9)
    v_mfma_f32_32x32x16_bf16 v[16:31], v[68:71], v[196:199], v[16:31]
    buffer_load_dwordx4 v[228:231], v1, s[48:51], s3 offen offset:1024 sc1
    ds_read_b64_tr_b16 v[48:49], v80 offset:36864
    ds_read_b64_tr_b16 v[50:51], v80 offset:37376
    ds_read_b64_tr_b16 v[68:69], v2 offset:21504
    ds_read_b64_tr_b16 v[70:71], v2 offset:22016
    s_waitcnt lgkmcnt(9)
    v_dot2c_f32_bf16 v91, s22, v44
    v_dot2c_f32_bf16 v91, s22, v45
    v_dot2c_f32_bf16 v91, s22, v46
    v_dot2c_f32_bf16 v91, s22, v47
    s_waitcnt vmcnt(7)
    v_mfma_f32_32x32x16_bf16 v[16:31], v[72:75], v[200:203], v[16:31]
    buffer_load_dwordx4 v[232:235], v1, s[48:51], s3 offen offset:2048 sc1
    ds_write_b128 v82, v[44:47] offset:35840
    ds_read_b64_tr_b16 v[72:73], v2 offset:22528
    ds_read_b64_tr_b16 v[74:75], v2 offset:23040
    s_waitcnt vmcnt(7) lgkmcnt(10)
    v_mfma_f32_32x32x16_bf16 v[16:31], v[76:79], v[204:207], v[16:31]
    buffer_load_dwordx4 v[236:239], v1, s[48:51], s3 offen offset:3072 sc1
    ds_read_b64_tr_b16 v[52:53], v80 offset:37888
    ds_read_b64_tr_b16 v[54:55], v80 offset:38400
    ds_read_b64_tr_b16 v[76:77], v2 offset:23552
    ds_read_b64_tr_b16 v[78:79], v2 offset:24064
    s_waitcnt lgkmcnt(9)
    v_dot2c_f32_bf16 v91, s22, v48
    v_dot2c_f32_bf16 v91, s22, v49
    v_dot2c_f32_bf16 v91, s22, v50
    v_dot2c_f32_bf16 v91, s22, v51
    s_waitcnt vmcnt(7)
    v_mfma_f32_32x32x16_bf16 v[16:31], v[64:67], v[208:211], v[16:31]
    s_add_u32 s3, s100, 28672
    buffer_load_dwordx4 v[240:243], v1, s[48:51], s3 offen offset:0 sc1
    ds_read_b64_tr_b16 a[192:193], v80 offset:0
    ds_read_b64_tr_b16 a[194:195], v80 offset:512
    ds_write_b128 v82, v[48:51] offset:36864
    ds_read_b64_tr_b16 v[64:65], v2 offset:24576
    ds_read_b64_tr_b16 v[66:67], v2 offset:25088
    s_waitcnt vmcnt(7) lgkmcnt(12)
    v_mfma_f32_32x32x16_bf16 v[16:31], v[68:71], v[212:215], v[16:31]
    buffer_load_dwordx4 v[244:247], v1, s[48:51], s3 offen offset:1024 sc1
    ds_read_b64_tr_b16 a[196:197], v80 offset:1024
    ds_read_b64_tr_b16 a[198:199], v80 offset:1536
    ds_read_b64_tr_b16 v[56:57], v80 offset:38912
    ds_read_b64_tr_b16 v[58:59], v80 offset:39424
    ds_read_b64_tr_b16 v[68:69], v2 offset:25600
    ds_read_b64_tr_b16 v[70:71], v2 offset:26112
    s_waitcnt lgkmcnt(13)
    v_dot2c_f32_bf16 v91, s22, v52
    v_dot2c_f32_bf16 v91, s22, v53
    v_dot2c_f32_bf16 v91, s22, v54
    v_dot2c_f32_bf16 v91, s22, v55
    s_waitcnt vmcnt(7)
    v_mfma_f32_32x32x16_bf16 v[16:31], v[72:75], v[216:219], v[16:31]
    buffer_load_dwordx4 v[248:251], v1, s[48:51], s3 offen offset:2048 sc1
    ds_read_b64_tr_b16 a[200:201], v80 offset:2048
    ds_read_b64_tr_b16 a[202:203], v80 offset:2560
    ds_write_b128 v82, v[52:55] offset:37888
    ds_read_b64_tr_b16 v[72:73], v2 offset:26624
    ds_read_b64_tr_b16 v[74:75], v2 offset:27136
    s_waitcnt vmcnt(7) lgkmcnt(15)
    v_mfma_f32_32x32x16_bf16 v[16:31], v[76:79], v[220:223], v[16:31]
    buffer_load_dwordx4 v[252:255], v1, s[48:51], s3 offen offset:3072 sc1
    ds_read_b64_tr_b16 a[204:205], v80 offset:3072
    ds_read_b64_tr_b16 a[206:207], v80 offset:3584
    ds_read_b64_tr_b16 v[60:61], v80 offset:39936
    ds_read_b64_tr_b16 v[62:63], v80 offset:40448
    ds_read_b64_tr_b16 v[76:77], v2 offset:27648
    ds_read_b64_tr_b16 v[78:79], v2 offset:28160
    s_waitcnt lgkmcnt(13)
    v_dot2c_f32_bf16 v91, s22, v56
    v_dot2c_f32_bf16 v91, s22, v57
    v_dot2c_f32_bf16 v91, s22, v58
    v_dot2c_f32_bf16 v91, s22, v59
    s_waitcnt vmcnt(7)
    v_mfma_f32_32x32x16_bf16 v[16:31], v[64:67], v[224:227], v[16:31]
    ds_read_b64_tr_b16 a[208:209], v80 offset:4096
    ds_read_b64_tr_b16 a[210:211], v80 offset:4608
    ds_write_b128 v82, v[56:59] offset:38912
    ds_read_b64_tr_b16 v[64:65], v2 offset:28672
    ds_read_b64_tr_b16 v[66:67], v2 offset:29184
    s_waitcnt vmcnt(6) lgkmcnt(15)
    v_mfma_f32_32x32x16_bf16 v[16:31], v[68:71], v[228:231], v[16:31]
    ds_read_b64_tr_b16 a[212:213], v80 offset:5120
    ds_read_b64_tr_b16 a[214:215], v80 offset:5632
    ds_read_b64_tr_b16 v[68:69], v2 offset:29696
    ds_read_b64_tr_b16 v[70:71], v2 offset:30208
    s_waitcnt lgkmcnt(11)
    v_dot2c_f32_bf16 v91, s22, v60
    v_dot2c_f32_bf16 v91, s22, v61
    v_dot2c_f32_bf16 v91, s22, v62
    v_dot2c_f32_bf16 v91, s22, v63
    s_waitcnt vmcnt(5)
    v_mfma_f32_32x32x16_bf16 v[16:31], v[72:75], v[232:235], v[16:31]
    ds_read_b64_tr_b16 a[216:217], v80 offset:6144
    ds_read_b64_tr_b16 a[218:219], v80 offset:6656
    ds_write_b128 v82, v[60:63] offset:39936
    ds_read_b64_tr_b16 v[72:73], v2 offset:30720
    ds_read_b64_tr_b16 v[74:75], v2 offset:31232
    s_waitcnt vmcnt(4) lgkmcnt(14)
    v_mfma_f32_32x32x16_bf16 v[16:31], v[76:79], v[236:239], v[16:31]
    ds_read_b64_tr_b16 a[220:221], v80 offset:7168
    ds_read_b64_tr_b16 a[222:223], v80 offset:7680
    ds_read_b64_tr_b16 v[76:77], v2 offset:31744
    ds_read_b64_tr_b16 v[78:79], v2 offset:32256
    s_waitcnt vmcnt(3) lgkmcnt(13)
    v_mfma_f32_32x32x16_bf16 v[16:31], v[64:67], v[240:243], v[16:31]
    s_waitcnt vmcnt(2) lgkmcnt(9)
    v_mfma_f32_32x32x16_bf16 v[16:31], v[68:71], v[244:247], v[16:31]
    s_waitcnt vmcnt(1) lgkmcnt(4)
    v_mfma_f32_32x32x16_bf16 v[16:31], v[72:75], v[248:251], v[16:31]
    ds_write_b32 v89, v90 offset:1024
    ds_write_b32 v89, v91 offset:2048
    s_waitcnt vmcnt(0) lgkmcnt(2)
    v_mfma_f32_32x32x16_bf16 v[16:31], v[76:79], v[252:255], v[16:31]
    s_nop 11
    v_cvt_pk_bf16_f32 v8, v16, v17
    v_cvt_pk_bf16_f32 v12, v24, v25
    v_and_b32 v16, 0xffff0000, v16
    v_and_b32 v24, 0xffff0000, v24
    v_cvt_pk_bf16_f32 v16, v16, v17
    v_cvt_pk_bf16_f32 v17, v18, v19
    v_cvt_pk_bf16_f32 v18, v20, v21
    v_cvt_pk_bf16_f32 v19, v22, v23
    v_cvt_pk_bf16_f32 v20, v24, v25
    v_cvt_pk_bf16_f32 v21, v26, v27
    v_cvt_pk_bf16_f32 v22, v28, v29
    v_cvt_pk_bf16_f32 v23, v30, v31
    v_or_b32 v16, 1, v16
    v_or_b32 v20, 1, v20
    s_cmp_lg_u32 s63, 0
    s_nop 0
    s_cbranch_scc0 fast_68
    buffer_store_dwordx4 v[16:19], v1, s[48:51], s61 offen
    buffer_store_dwordx4 v[20:23], v1, s[48:51], s61 offen offset:1024
    v_mov_b32 v94, 0
    v_mov_b32 v95, 0
    v_dot2c_f32_bf16 v94, s22, v16
    v_dot2c_f32_bf16 v95, v16, v16
    v_dot2c_f32_bf16 v94, s22, v17
    v_dot2c_f32_bf16 v95, v17, v17
    v_dot2c_f32_bf16 v94, s22, v18
    v_dot2c_f32_bf16 v95, v18, v18
    v_dot2c_f32_bf16 v94, s22, v19
    v_dot2c_f32_bf16 v95, v19, v19
    v_dot2c_f32_bf16 v94, s22, v20
    v_dot2c_f32_bf16 v95, v20, v20
    v_dot2c_f32_bf16 v94, s22, v21
    v_dot2c_f32_bf16 v95, v21, v21
    v_dot2c_f32_bf16 v94, s22, v22
    v_dot2c_f32_bf16 v95, v22, v22
    v_dot2c_f32_bf16 v94, s22, v23
    v_dot2c_f32_bf16 v95, v23, v23
    s_nop 1
    v_mov_b32 v92, v94
    v_mov_b32 v93, v95
    s_nop 0
    v_permlane32_swap_b32 v92, v94
    v_permlane32_swap_b32 v93, v95
    v_pk_add_f32 v[94:95], v[94:95], v[92:93]
    v_or_b32 v94, 1, v94
    buffer_store_dwordx2 v[94:95], v6, s[48:51], s101 offen
    s_nop 0
dend_69:
    v_mov_b32 v9, v17
    v_mov_b32 v10, v18
    v_mov_b32 v11, v19
    v_mov_b32 v13, v21
    v_mov_b32 v14, v22
    v_mov_b32_e64 v15, v23
    s_xor_b32 s62, s62, 0
    s_waitcnt lgkmcnt(0)
    s_barrier
    s_add_u32 s3, s60, 0
    buffer_load_dwordx4 v[128:131], v1, s[48:51], s3 offen offset:0 sc1
    buffer_load_dwordx4 v[132:135], v1, s[48:51], s3 offen offset:1024 sc1
    buffer_load_dwordx4 v[136:139], v1, s[48:51], s3 offen offset:2048 sc1
    buffer_load_dwordx4 v[140:143], v1, s[48:51], s3 offen offset:3072 sc1
    s_add_u32 s3, s60, 4096
    buffer_load_dwordx4 v[144:147], v1, s[48:51], s3 offen offset:0 sc1
    buffer_load_dwordx4 v[148:151], v1, s[48:51], s3 offen offset:1024 sc1
    buffer_load_dwordx4 v[152:155], v1, s[48:51], s3 offen offset:2048 sc1
    buffer_load_dwordx4 v[156:159], v1, s[48:51], s3 offen offset:3072 sc1
    ds_read_b128 v[64:67], v4 offset:0
    ds_read_b128 v[68:71], v1 offset:32768
    ds_read_b128 v[72:75], v4 offset:1024
    ds_read_b128 v[76:79], v1 offset:33792
    ds_read_b128 v[80:83], v4 offset:2048
    ds_read_b128 v[84:87], v1 offset:34816
    v_and_b32 v92, 31, v0
    v_lshlrev_b32 v93, 5, v92
    v_add_u32 v93, 0x24800, v93
    v_lshlrev_b32_e64 v92, 2, v92
    v_add_u32 v92, 0x24580, v92
    ds_read_b128 v[96:99], v93 offset:1024
    ds_read_b128 v[100:103], v93 offset:1040
    ds_read_b128 v[104:107], v93 offset:2048
    ds_read_b128 v[108:111], v93 offset:2064
    s_waitcnt lgkmcnt(2)
    v_add_f32 v96, v96, v98
    v_add_f32 v97, v97, v99
    v_add_f32 v100, v100, v102
    v_add_f32 v101, v101, v103
    v_add_f32 v96, v96, v100
    v_add_f32 v97, v97, v101
    v_add_f32 v96, v96, v97
    ds_write_b32 v92, v96 offset:128
    s_waitcnt lgkmcnt(1)
    v_add_f32 v104, v104, v106
    v_add_f32 v105, v105, v107
    v_add_f32 v108, v108, v110
    v_add_f32 v109, v109, v111
    v_add_f32 v104, v104, v108
    v_add_f32 v105, v105, v109
    v_add_f32 v104, v104, v105
    ds_write_b32 v92, v104 offset:256
    s_waitcnt vmcnt(6)
    v_bitop3_b32 v95, v128, v132, 1 bitop3:0x80
    v_cmp_eq_u32 vcc, 0, v95
    s_cbranch_vccnz gst_70
gbk_71:
    v_mfma_f32_32x32x16_bf16 v[32:47], v[128:131], v[64:67], 0
    s_add_u32 s3, s60, 8192
    buffer_load_dwordx4 v[160:163], v1, s[48:51], s3 offen offset:0 sc1
    ds_read_b128 v[64:67], v4 offset:3072
    v_mfma_f32_32x32x16_bf16 v[48:63], v[128:131], v[68:71], 0
    ds_read_b128 v[68:71], v1 offset:35840
    v_mfma_f32_32x32x16_bf16 v[32:47], v[132:135], v[72:75], v[32:47]
    buffer_load_dwordx4 v[164:167], v1, s[48:51], s3 offen offset:1024 sc1
    ds_read_b128 v[72:75], v4 offset:4096
    s_waitcnt vmcnt(6)
    v_bitop3_b32 v95, v136, v140, 1 bitop3:0x80
    v_cmp_eq_u32 vcc, 0, v95
    v_mfma_f32_32x32x16_bf16 v[48:63], v[132:135], v[76:79], v[48:63]
    ds_read_b128 v[76:79], v1 offset:36864
    s_cbranch_vccnz gst_74
gbk_75:
    v_mfma_f32_32x32x16_bf16 v[32:47], v[136:139], v[80:83], v[32:47]
    buffer_load_dwordx4 v[168:171], v1, s[48:51], s3 offen offset:2048 sc1
    ds_read_b128 v[80:83], v4 offset:5120
    v_mfma_f32_32x32x16_bf16 v[48:63], v[136:139], v[84:87], v[48:63]
    ds_read_b128 v[84:87], v1 offset:37888
    s_waitcnt lgkmcnt(4)
    v_mfma_f32_32x32x16_bf16 v[32:47], v[140:143], v[64:67], v[32:47]
    buffer_load_dwordx4 v[172:175], v1, s[48:51], s3 offen offset:3072 sc1
    ds_read_b128 v[64:67], v4 offset:6144
    s_waitcnt vmcnt(6)
    v_bitop3_b32 v95, v144, v148, 1 bitop3:0x80
    v_cmp_eq_u32 vcc, 0, v95
    v_mfma_f32_32x32x16_bf16 v[48:63], v[140:143], v[68:71], v[48:63]
    ds_read_b128 v[68:71], v1 offset:38912
    s_cbranch_vccnz gst_78
gbk_79:
    s_waitcnt lgkmcnt(4)
    v_mfma_f32_32x32x16_bf16 v[32:47], v[144:147], v[72:75], v[32:47]
    s_add_u32 s3, s60, 12288
    buffer_load_dwordx4 v[176:179], v1, s[48:51], s3 offen offset:0 sc1
    ds_read_b128 v[72:75], v4 offset:7168
    v_mfma_f32_32x32x16_bf16 v[48:63], v[144:147], v[76:79], v[48:63]
    ds_read_b128 v[76:79], v1 offset:39936
    buffer_load_dwordx4 v[96:99], v1, s[48:51], s101 offen offset:0 sc1
    buffer_load_dwordx4 v[100:103], v1, s[48:51], s101 offen offset:1024 sc1
    buffer_load_dwordx4 v[104:107], v1, s[48:51], s101 offen offset:2048 sc1
    s_waitcnt lgkmcnt(4)
    v_mfma_f32_32x32x16_bf16 v[32:47], v[148:151], v[80:83], v[32:47]
    buffer_load_dwordx4 v[180:183], v1, s[48:51], s3 offen offset:1024 sc1
    ds_read_b128 v[80:83], v4 offset:8192
    s_waitcnt vmcnt(9)
    v_bitop3_b32 v95, v152, v156, 1 bitop3:0x80
    v_cmp_eq_u32 vcc, 0, v95
    v_mfma_f32_32x32x16_bf16 v[48:63], v[148:151], v[84:87], v[48:63]
    ds_read_b128 v[84:87], v1 offset:40960
    s_cbranch_vccnz gst_82
gbk_83:
    buffer_load_dwordx4 v[108:111], v1, s[48:51], s101 offen offset:3072 sc1
    s_waitcnt lgkmcnt(4)
    v_mfma_f32_32x32x16_bf16 v[32:47], v[152:155], v[64:67], v[32:47]
    buffer_load_dwordx4 v[184:187], v1, s[48:51], s3 offen offset:2048 sc1
    ds_read_b128 v[64:67], v4 offset:9216
    v_mfma_f32_32x32x16_bf16 v[48:63], v[152:155], v[68:71], v[48:63]
    ds_read_b128 v[68:71], v1 offset:41984
    s_waitcnt lgkmcnt(4)
    v_mfma_f32_32x32x16_bf16 v[32:47], v[156:159], v[72:75], v[32:47]
    buffer_load_dwordx4 v[188:191], v1, s[48:51], s3 offen offset:3072 sc1
    ds_read_b128 v[72:75], v4 offset:10240
    s_waitcnt vmcnt(10)
    v_bitop3_b32 v95, v160, v164, 1 bitop3:0x80
    v_cmp_eq_u32 vcc, 0, v95
    v_mfma_f32_32x32x16_bf16 v[48:63], v[156:159], v[76:79], v[48:63]
    ds_read_b128 v[76:79], v1 offset:43008
    s_cbranch_vccnz gst_86
gbk_87:
    s_waitcnt lgkmcnt(4)
    v_mfma_f32_32x32x16_bf16 v[32:47], v[160:163], v[80:83], v[32:47]
    s_add_u32 s3, s60, 16384
    buffer_load_dwordx4 v[192:195], v1, s[48:51], s3 offen offset:0 sc1
    ds_read_b128 v[80:83], v4 offset:11264
    v_mfma_f32_32x32x16_bf16 v[48:63], v[160:163], v[84:87], v[48:63]
    ds_read_b128 v[84:87], v1 offset:44032
    s_waitcnt lgkmcnt(4)
    v_mfma_f32_32x32x16_bf16 v[32:47], v[164:167], v[64:67], v[32:47]
    buffer_load_dwordx4 v[196:199], v1, s[48:51], s3 offen offset:1024 sc1
    ds_read_b128 v[64:67], v4 offset:12288
    s_waitcnt vmcnt(10)
    v_bitop3_b32 v95, v168, v172, 1 bitop3:0x80
    v_cmp_eq_u32 vcc, 0, v95
    v_mfma_f32_32x32x16_bf16 v[48:63], v[164:167], v[68:71], v[48:63]
    ds_read_b128 v[68:71], v1 offset:45056
    s_cbranch_vccnz gst_90
gbk_91:
    s_waitcnt lgkmcnt(4)
    v_mfma_f32_32x32x16_bf16 v[32:47], v[168:171], v[72:75], v[32:47]
    buffer_load_dwordx4 v[200:203], v1, s[48:51], s3 offen offset:2048 sc1
    ds_read_b128 v[72:75], v4 offset:13312
    v_mfma_f32_32x32x16_bf16 v[48:63], v[168:171], v[76:79], v[48:63]
    ds_read_b128 v[76:79], v1 offset:46080
    s_waitcnt lgkmcnt(4)
    v_mfma_f32_32x32x16_bf16 v[32:47], v[172:175], v[80:83], v[32:47]
    buffer_load_dwordx4 v[204:207], v1, s[48:51], s3 offen offset:3072 sc1
    ds_read_b128 v[80:83], v4 offset:14336
    s_waitcnt vmcnt(7)
    v_bitop3_b32 v95, v176, v180, 1 bitop3:0x80
    v_cmp_eq_u32 vcc, 0, v95
    v_mfma_f32_32x32x16_bf16 v[48:63], v[172:175], v[84:87], v[48:63]
    ds_read_b128 v[84:87], v1 offset:47104
    s_cbranch_vccnz gst_94
gbk_95:
    s_waitcnt lgkmcnt(4)
    v_mfma_f32_32x32x16_bf16 v[32:47], v[176:179], v[64:67], v[32:47]
    s_add_u32 s3, s60, 20480
    buffer_load_dwordx4 v[208:211], v1, s[48:51], s3 offen offset:0 sc1
    ds_read_b128 v[64:67], v4 offset:15360
    v_mfma_f32_32x32x16_bf16 v[48:63], v[176:179], v[68:71], v[48:63]
    ds_read_b128 v[68:71], v1 offset:48128
    s_waitcnt lgkmcnt(4)
    v_mfma_f32_32x32x16_bf16 v[32:47], v[180:183], v[72:75], v[32:47]
    buffer_load_dwordx4 v[212:215], v1, s[48:51], s3 offen offset:1024 sc1
    ds_read_b128 v[72:75], v4 offset:16384
    s_waitcnt vmcnt(6)
    v_bitop3_b32 v95, v184, v188, 1 bitop3:0x80
    v_cmp_eq_u32 vcc, 0, v95
    v_mfma_f32_32x32x16_bf16 v[48:63], v[180:183], v[76:79], v[48:63]
    ds_read_b128 v[76:79], v1 offset:49152
    s_cbranch_vccnz gst_98
gbk_99:
    s_waitcnt lgkmcnt(4)
    v_mfma_f32_32x32x16_bf16 v[32:47], v[184:187], v[80:83], v[32:47]
    buffer_load_dwordx4 v[216:219], v1, s[48:51], s3 offen offset:2048 sc1
    ds_read_b128 v[80:83], v4 offset:17408
    v_mfma_f32_32x32x16_bf16 v[48:63], v[184:187], v[84:87], v[48:63]
    ds_read_b128 v[84:87], v1 offset:50176
    s_waitcnt lgkmcnt(4)
    v_mfma_f32_32x32x16_bf16 v[32:47], v[188:191], v[64:67], v[32:47]
    buffer_load_dwordx4 v[220:223], v1, s[48:51], s3 offen offset:3072 sc1
    ds_read_b128 v[64:67], v4 offset:18432
    s_waitcnt vmcnt(6)
    v_bitop3_b32 v95, v192, v196, 1 bitop3:0x80
    v_cmp_eq_u32_e64 vcc, 0, v95
    v_mfma_f32_32x32x16_bf16 v[48:63], v[188:191], v[68:71], v[48:63]
    ds_read_b128 v[68:71], v1 offset:51200
    s_cbranch_vccnz gst_102
gbk_103:
    v_bitop3_b32 v93, v96, v98, v100 bitop3:0x80
    v_bitop3_b32 v93, v93, v102, v104 bitop3:0x80
    s_waitcnt lgkmcnt(4)
    v_mfma_f32_32x32x16_bf16 v[32:47], v[192:195], v[72:75], v[32:47]
    s_add_u32 s3, s60, 24576
    buffer_load_dwordx4 v[224:227], v1, s[48:51], s3 offen offset:0 sc1
    ds_read_b128 v[72:75], v4 offset:19456
    v_bitop3_b32 v93, v93, v106, v108 bitop3:0x80
    v_bitop3_b32 v93, v93, v110, 1 bitop3:0x80
    v_mfma_f32_32x32x16_bf16 v[48:63], v[192:195], v[76:79], v[48:63]
    ds_read_b128 v[76:79], v1 offset:52224
    v_cmp_eq_u32 s[10:11], 0, v93
    s_nop 0
    s_cmp_lg_u64 s[10:11], 0
    s_cbranch_scc1 sst_106
sbk_107:
    s_waitcnt lgkmcnt(4)
    v_mfma_f32_32x32x16_bf16 v[32:47], v[196:199], v[80:83], v[32:47]
    buffer_load_dwordx4 v[228:231], v1, s[48:51], s3 offen offset:1024 sc1
    ds_read_b128 v[80:83], v4 offset:20480
    s_waitcnt vmcnt(6)
    v_bitop3_b32 v95, v200, v204, 1 bitop3:0x80
    v_cmp_eq_u32 vcc, 0, v95
    v_mfma_f32_32x32x16_bf16 v[48:63], v[196:199], v[84:87], v[48:63]
    ds_read_b128 v[84:87], v1 offset:53248
    s_cbranch_vccnz gst_110
gbk_111:
    v_add_f32 v96, v96, v98
    v_add_f32 v97, v97, v99
    s_waitcnt lgkmcnt(4)
    v_mfma_f32_32x32x16_bf16 v[32:47], v[200:203], v[64:67], v[32:47]
    buffer_load_dwordx4 v[232:235], v1, s[48:51], s3 offen offset:2048 sc1
    ds_read_b128 v[64:67], v4 offset:21504
    v_add_f32 v100, v100, v102
    v_add_f32 v101, v101, v103
    v_add_f32 v104, v104, v106
    v_mfma_f32_32x32x16_bf16 v[48:63], v[200:203], v[68:71], v[48:63]
    ds_read_b128 v[68:71], v1 offset:54272
    v_add_f32 v105, v105, v107
    v_add_f32 v108, v108, v110
    v_add_f32 v109, v109, v111
    s_waitcnt lgkmcnt(4)
    v_mfma_f32_32x32x16_bf16 v[32:47], v[204:207], v[72:75], v[32:47]
    buffer_load_dwordx4 v[236:239], v1, s[48:51], s3 offen offset:3072 sc1
    ds_read_b128 v[72:75], v4 offset:22528
    s_waitcnt vmcnt(6)
    v_bitop3_b32 v95, v208, v212, 1 bitop3:0x80
    v_cmp_eq_u32 vcc, 0, v95
    v_mfma_f32_32x32x16_bf16 v[48:63], v[204:207], v[76:79], v[48:63]
    ds_read_b128 v[76:79], v1 offset:55296
    s_cbranch_vccnz gst_114
gbk_115:
    v_add_f32 v96, v96, v100
    v_add_f32 v97, v97, v101
    s_waitcnt lgkmcnt(4)
    v_mfma_f32_32x32x16_bf16 v[32:47], v[208:211], v[80:83], v[32:47]
    s_add_u32 s3, s60, 28672
    buffer_load_dwordx4 v[240:243], v1, s[48:51], s3 offen offset:0 sc1
    ds_read_b128 v[80:83], v4 offset:23552
    v_add_f32 v104, v104, v108
    v_add_f32 v105, v105, v109
    v_mfma_f32_32x32x16_bf16 v[48:63], v[208:211], v[84:87], v[48:63]
    ds_read_b128 v[84:87], v1 offset:56320
    v_add_f32 v96, v96, v104
    v_add_f32 v97, v97, v105
    v_mov_b32 v98, v96
    s_waitcnt lgkmcnt(4)
    v_mfma_f32_32x32x16_bf16 v[32:47], v[212:215], v[64:67], v[32:47]
    buffer_load_dwordx4 v[244:247], v1, s[48:51], s3 offen offset:1024 sc1
    ds_read_b128 v[64:67], v4 offset:24576
    s_waitcnt vmcnt(6)
    v_bitop3_b32 v95, v216, v220, 1 bitop3:0x80
    v_cmp_eq_u32 vcc, 0, v95
    v_mfma_f32_32x32x16_bf16 v[48:63], v[212:215], v[68:71], v[48:63]
    ds_read_b128 v[68:71], v1 offset:57344
    s_cbranch_vccnz gst_118
gbk_119:
    v_mov_b32 v99, v97
    v_permlane32_swap_b32 v98, v96
    s_waitcnt lgkmcnt(4)
    v_mfma_f32_32x32x16_bf16 v[32:47], v[216:219], v[72:75], v[32:47]
    buffer_load_dwordx4 v[248:251], v1, s[48:51], s3 offen offset:2048 sc1
    ds_read_b128 v[72:75], v4 offset:25600
    v_permlane32_swap_b32 v99, v97
    v_add_f32 v96, v96, v98
    v_add_f32 v97, v97, v99
    v_mfma_f32_32x32x16_bf16 v[48:63], v[216:219], v[76:79], v[48:63]
    ds_read_b128 v[76:79], v1 offset:58368
    v_mul_f32 v96, 0x3b000000, v96
    v_mul_f32 v97, 0x3b000000, v97
    v_fma_f32 v97, -v96, v96, v97
    s_waitcnt lgkmcnt(4)
    v_mfma_f32_32x32x16_bf16 v[32:47], v[220:223], v[80:83], v[32:47]
    buffer_load_dwordx4 v[252:255], v1, s[48:51], s3 offen offset:3072 sc1
    ds_read_b128 v[80:83], v4 offset:26624
    s_waitcnt vmcnt(6)
    v_bitop3_b32 v95, v224, v228, 1 bitop3:0x80
    v_cmp_eq_u32 vcc, 0, v95
    v_mfma_f32_32x32x16_bf16 v[48:63], v[220:223], v[84:87], v[48:63]
    ds_read_b128 v[84:87], v1 offset:59392
    s_cbranch_vccnz gst_122
gbk_123:
    v_max_f32 v97, 0, v97
    v_add_f32 v97, 0x3727c5ac, v97
    s_waitcnt lgkmcnt(4)
    v_mfma_f32_32x32x16_bf16 v[32:47], v[224:227], v[64:67], v[32:47]
    ds_read_b128 v[64:67], v4 offset:27648
    v_rsq_f32 v88, v97
    s_nop 0
    v_mul_f32 v90, v96, v88
    s_lshl_b32 s5, s58, 8
    v_mfma_f32_32x32x16_bf16 v[48:63], v[224:227], v[68:71], v[48:63]
    ds_read_b128 v[68:71], v1 offset:60416
    s_add_u32 s5, s5, 147456
    v_lshl_add_u32 v98, v0, 2, s5
    v_cndmask_b32 v99, v88, v90, s[12:13]
    s_waitcnt lgkmcnt(4)
    v_mfma_f32_32x32x16_bf16 v[32:47], v[228:231], v[72:75], v[32:47]
    ds_read_b128 v[72:75], v4 offset:28672
    ds_write_b32 v98, v99
    s_waitcnt vmcnt(4)
    v_bitop3_b32 v95, v232, v236, 1 bitop3:0x80
    v_cmp_eq_u32 vcc, 0, v95
    v_mfma_f32_32x32x16_bf16 v[48:63], v[228:231], v[76:79], v[48:63]
    ds_read_b128 v[76:79], v1 offset:61440
    s_cbranch_vccnz gst_126
gbk_127:
    v_lshrrev_b32 v89, 5, v0
    v_lshlrev_b32 v91, 4, v89
    s_waitcnt lgkmcnt(5)
    v_mfma_f32_32x32x16_bf16 v[32:47], v[232:235], v[80:83], v[32:47]
    ds_read_b128 v[80:83], v4 offset:29696
    v_add_u32 v89, s5, v91
    v_add_u32 v91, 0x24580, v91
    ds_read_b128 v[96:99], v89 offset:0
    ds_read_b128 v[16:19], v89 offset:128
    v_mfma_f32_32x32x16_bf16 v[48:63], v[232:235], v[84:87], v[48:63]
    ds_read_b128 v[84:87], v1 offset:62464
    ds_read_b128 v[100:103], v89 offset:32
    ds_read_b128 v[20:23], v89 offset:160
    ds_read_b128 v[104:107], v89 offset:64
    s_waitcnt lgkmcnt(10)
    v_mfma_f32_32x32x16_bf16 v[32:47], v[236:239], v[64:67], v[32:47]
    ds_read_b128 v[64:67], v4 offset:30720
    ds_read_b128 v[24:27], v89 offset:192
    s_waitcnt vmcnt(2)
    v_bitop3_b32 v95, v240, v244, 1 bitop3:0x80
    v_cmp_eq_u32 vcc, 0, v95
    v_mfma_f32_32x32x16_bf16 v[48:63], v[236:239], v[68:71], v[48:63]
    ds_read_b128 v[68:71], v1 offset:63488
    s_cbranch_vccnz gst_130
gbk_131:
    ds_read_b128 v[108:111], v89 offset:96
    ds_read_b128 v[28:31], v89 offset:224
    s_waitcnt lgkmcnt(12)
    v_mfma_f32_32x32x16_bf16 v[32:47], v[240:243], v[72:75], v[32:47]
    ds_read_b128 v[72:75], v4 offset:31744
    v_and_b32 v93, 31, v0
    v_lshlrev_b32 v93, 2, v93
    v_add_u32 v93, 0x24580, v93
    ds_read_b32 v92, v93 offset:256
    v_mfma_f32_32x32x16_bf16 v[48:63], v[240:243], v[76:79], v[48:63]
    ds_read_b128 v[76:79], v1 offset:64512
    ds_read_b32 v94, v93 offset:128
    v_lshrrev_b32 v114, 2, v0
    v_mul_u32_u24 v114, 3072, v114
    s_waitcnt lgkmcnt(12)
    v_mfma_f32_32x32x16_bf16 v[32:47], v[244:247], v[80:83], v[32:47]
    v_and_b32 v113, 3, v0
    v_lshl_add_u32 v114, v113, 4, v114
    s_waitcnt vmcnt(0)
    v_bitop3_b32 v95, v248, v252, 1 bitop3:0x80
    v_cmp_eq_u32 vcc, 0, v95
    v_mfma_f32_32x32x16_bf16 v[48:63], v[244:247], v[84:87], v[48:63]
    s_cbranch_vccnz gst_134
gbk_135:
    s_mul_i32 s11, s58, 393216
    s_lshl_b32 s10, s57, 6
    s_xor_b32 s10, s10, 512
    s_waitcnt lgkmcnt(6)
    v_mfma_f32_32x32x16_bf16 v[32:47], v[248:251], v[64:67], v[32:47]
    s_add_u32 s11, s11, s10
    v_add_u32_e64 v114, s11, v114
    s_lshl_b32 s11, s58, 13
    s_add_u32 m0, s11, 98304
    s_mov_b32 s10, 0
    buffer_load_dwordx4 v114, s[32:35], s10 offen offset:0 lds
    v_mfma_f32_32x32x16_bf16 v[48:63], v[248:251], v[68:71], v[48:63]
    s_mov_b32 s10, 48128
    buffer_load_dwordx4 v114, s[32:35], s10 offen offset:1024 lds
    s_mov_b32 s10, 96256
    buffer_load_dwordx4 v114, s[32:35], s10 offen offset:2048 lds
    s_waitcnt lgkmcnt(1)
    v_mfma_f32_32x32x16_bf16 v[32:47], v[252:255], v[72:75], v[32:47]
    s_mov_b32 s10, 144384
    buffer_load_dwordx4 v114, s[32:35], s10 offen offset:3072 lds
    s_lshl_b32 s11, s58, 13
    s_add_u32 m0, s11, 102400
    s_mov_b32 s10, 196608
    buffer_load_dwordx4 v114, s[32:35], s10 offen offset:0 lds
    v_mfma_f32_32x32x16_bf16 v[48:63], v[252:255], v[76:79], v[48:63]
    s_mov_b32 s10, 244736
    buffer_load_dwordx4 v114, s[32:35], s10 offen offset:1024 lds
    s_mov_b32 s10, 292864
    buffer_load_dwordx4 v114, s[32:35], s10 offen offset:2048 lds
    s_mov_b32 s10, 340992
    buffer_load_dwordx4 v114, s[32:35], s10 offen offset:3072 lds
    s_waitcnt lgkmcnt(0)
    v_mov_b32 v64, s22
    v_mov_b32 v65, s22
    v_mov_b32 v66, s22
    v_mov_b32 v67, s22
    s_add_u32 s4, s9, 131072
    v_add_u32_e64 v68, s4, v1
    s_mov_b32 s16, 0x0
    s_lshl_b32 s4, s56, 12
    s_add_u32 s4, s4, s16
    v_pk_fma_f32 v[32:33], v[32:33], v[96:97], s[30:31]
    v_pk_fma_f32 v[34:35], v[34:35], v[98:99], s[30:31]
    v_pk_fma_f32 v[36:37], v[36:37], v[100:101], s[30:31]
    v_pk_fma_f32 v[38:39], v[38:39], v[102:103], s[30:31]
    v_pk_fma_f32 v[40:41], v[40:41], v[104:105], s[30:31]
    v_pk_fma_f32 v[42:43], v[42:43], v[106:107], s[30:31]
    v_pk_fma_f32 v[44:45], v[44:45], v[108:109], s[30:31]
    v_pk_fma_f32 v[46:47], v[46:47], v[110:111], s[30:31]
    v_pk_fma_f32 v[32:33], v[16:17], v[94:95], v[32:33] op_sel_hi:[1,0,1] neg_lo:[0,1,0] neg_hi:[0,1,0]
    v_pk_fma_f32 v[34:35], v[18:19], v[94:95], v[34:35] op_sel_hi:[1,0,1] neg_lo:[0,1,0] neg_hi:[0,1,0]
    v_pk_fma_f32 v[36:37], v[20:21], v[94:95], v[36:37] op_sel_hi:[1,0,1] neg_lo:[0,1,0] neg_hi:[0,1,0]
    v_pk_fma_f32 v[38:39], v[22:23], v[94:95], v[38:39] op_sel_hi:[1,0,1] neg_lo:[0,1,0] neg_hi:[0,1,0]
    v_pk_fma_f32 v[40:41], v[24:25], v[94:95], v[40:41] op_sel_hi:[1,0,1] neg_lo:[0,1,0] neg_hi:[0,1,0]
    v_pk_fma_f32 v[42:43], v[26:27], v[94:95], v[42:43] op_sel_hi:[1,0,1] neg_lo:[0,1,0] neg_hi:[0,1,0]
    v_pk_fma_f32 v[44:45], v[28:29], v[94:95], v[44:45] op_sel_hi:[1,0,1] neg_lo:[0,1,0] neg_hi:[0,1,0]
    v_pk_fma_f32 v[46:47], v[30:31], v[94:95], v[46:47] op_sel_hi:[1,0,1] neg_lo:[0,1,0] neg_hi:[0,1,0]
    v_pk_mul_f32 v[48:49], v[48:49], v[96:97]
    v_pk_mul_f32 v[50:51], v[50:51], v[98:99]
    v_pk_mul_f32 v[52:53], v[52:53], v[100:101]
    v_pk_mul_f32 v[54:55], v[54:55], v[102:103]
    v_pk_mul_f32 v[56:57], v[56:57], v[104:105]
    v_pk_mul_f32 v[58:59], v[58:59], v[106:107]
    v_pk_mul_f32 v[60:61], v[60:61], v[108:109]
    v_pk_mul_f32 v[62:63], v[62:63], v[110:111]
    v_pk_fma_f32 v[48:49], v[16:17], v[92:93], v[48:49] op_sel_hi:[1,0,1] neg_lo:[0,1,0] neg_hi:[0,1,0]
    v_pk_fma_f32 v[50:51], v[18:19], v[92:93], v[50:51] op_sel_hi:[1,0,1] neg_lo:[0,1,0] neg_hi:[0,1,0]
    v_pk_fma_f32 v[52:53], v[20:21], v[92:93], v[52:53] op_sel_hi:[1,0,1] neg_lo:[0,1,0] neg_hi:[0,1,0]
    v_pk_fma_f32 v[54:55], v[22:23], v[92:93], v[54:55] op_sel_hi:[1,0,1] neg_lo:[0,1,0] neg_hi:[0,1,0]
    v_pk_fma_f32 v[56:57], v[24:25], v[92:93], v[56:57] op_sel_hi:[1,0,1] neg_lo:[0,1,0] neg_hi:[0,1,0]
    v_pk_fma_f32 v[58:59], v[26:27], v[92:93], v[58:59] op_sel_hi:[1,0,1] neg_lo:[0,1,0] neg_hi:[0,1,0]
    v_pk_fma_f32 v[60:61], v[28:29], v[92:93], v[60:61] op_sel_hi:[1,0,1] neg_lo:[0,1,0] neg_hi:[0,1,0]
    v_pk_fma_f32 v[62:63], v[30:31], v[92:93], v[62:63] op_sel_hi:[1,0,1] neg_lo:[0,1,0] neg_hi:[0,1,0]
    v_cvt_pk_bf16_f32 v48, v48, v49
    v_cvt_pk_bf16_f32 v49, v50, v51
    v_cvt_pk_bf16_f32 v50, v52, v53
    v_cvt_pk_bf16_f32 v51, v54, v55
    v_cvt_pk_bf16_f32 v52, v56, v57
    v_cvt_pk_bf16_f32 v53, v58, v59
    v_cvt_pk_bf16_f32 v54, v60, v61
    v_cvt_pk_bf16_f32 v55, v62, v63
    v_pk_mul_f32 v[96:97], v[32:33], s[28:29]
    v_pk_mul_f32 v[98:99], v[34:35], s[28:29]
    v_pk_mul_f32 v[100:101], v[36:37], s[28:29]
    v_pk_mul_f32 v[102:103], v[38:39], s[28:29]
    v_pk_mul_f32 v[104:105], v[40:41], s[28:29]
    v_pk_mul_f32 v[106:107], v[42:43], s[28:29]
    v_pk_mul_f32 v[108:109], v[44:45], s[28:29]
    v_pk_mul_f32 v[110:111], v[46:47], s[28:29]
    v_exp_f32_e64 v96, v96 clamp
    v_max_f32 v32, s30, v32
    v_exp_f32_e64 v97, v97 clamp
    v_max_f32 v33, s30, v33
    v_exp_f32_e64 v98, v98 clamp
    v_max_f32 v34, s30, v34
    v_exp_f32_e64 v99, v99 clamp
    v_max_f32 v35, s30, v35
    v_exp_f32_e64 v100, v100 clamp
    v_max_f32 v36, s30, v36
    v_exp_f32_e64 v101, v101 clamp
    v_max_f32 v37, s30, v37
    v_exp_f32_e64 v102, v102 clamp
    v_max_f32 v38, s30, v38
    v_exp_f32_e64 v103, v103 clamp
    v_max_f32 v39, s30, v39
    v_exp_f32_e64 v104, v104 clamp
    v_max_f32 v40, s30, v40
    v_exp_f32_e64 v105, v105 clamp
    v_max_f32 v41, s30, v41
    v_exp_f32_e64 v106, v106 clamp
    v_max_f32 v42, s30, v42
    v_exp_f32_e64 v107, v107 clamp
    v_max_f32 v43, s30, v43
    v_exp_f32_e64 v108, v108 clamp
    v_max_f32 v44, s30, v44
    v_exp_f32_e64 v109, v109 clamp
    v_max_f32 v45, s30, v45
    v_exp_f32_e64 v110, v110 clamp
    v_max_f32 v46, s30, v46
    v_exp_f32_e64 v111, v111 clamp
    v_max_f32 v47, s30, v47
    v_pk_add_f32 v[32:33], v[32:33], v[96:97]
    v_pk_add_f32 v[34:35], v[34:35], v[98:99]
    v_pk_add_f32 v[36:37], v[36:37], v[100:101]
    v_pk_add_f32 v[38:39], v[38:39], v[102:103]
    v_pk_add_f32 v[40:41], v[40:41], v[104:105]
    v_pk_add_f32 v[42:43], v[42:43], v[106:107]
    v_pk_add_f32 v[44:45], v[44:45], v[108:109]
    v_pk_add_f32 v[46:47], v[46:47], v[110:111]
    v_cvt_pk_bf16_f32 v32, v32, v33
    v_cvt_pk_bf16_f32 v33, v34, v35
    v_cvt_pk_bf16_f32 v34, v36, v37
    v_cvt_pk_bf16_f32 v35, v38, v39
    v_cvt_pk_bf16_f32 v36, v40, v41
    v_cvt_pk_bf16_f32 v37, v42, v43
    v_mfma_f32_32x32x16_bf16 v[96:111], v[32:35], v[48:51], 0
    v_cvt_pk_bf16_f32 v38, v44, v45
    v_cvt_pk_bf16_f32 v39, v46, v47
    s_nop 1
    v_mfma_f32_32x32x16_bf16 v[96:111], v[36:39], v[52:55], v[96:111]
    v_mfma_f32_32x32x16_bf16 v[112:127], v[32:35], v[64:67], 0
    v_mfma_f32_32x32x16_bf16 v[112:127], v[36:39], v[64:67], v[112:127]
    s_nop 9
    v_cndmask_b32 v32, v104, v96, s[96:97]
    v_cndmask_b32 v33, v105, v97, s[96:97]
    v_cndmask_b32 v34, v106, v98, s[96:97]
    v_cndmask_b32 v35, v107, v99, s[96:97]
    v_cndmask_b32 v36, v108, v100, s[96:97]
    v_cndmask_b32 v37, v109, v101, s[96:97]
    v_cndmask_b32 v38, v110, v102, s[96:97]
    v_cndmask_b32 v39, v111, v103, s[96:97]
    ds_write_b128 v7, v[32:35] offset:32768
    ds_write_b128 v7, v[36:39] offset:33792
    v_cndmask_b32 v40, v112, v120, s[96:97]
    v_cndmask_b32 v41, v113, v121, s[96:97]
    v_cndmask_b32 v42, v114, v122, s[96:97]
    v_cndmask_b32 v43, v115, v123, s[96:97]
    v_cndmask_b32 v44, v116, v124, s[96:97]
    v_cndmask_b32 v45, v117, v125, s[96:97]
    v_cndmask_b32 v46, v118, v126, s[96:97]
    v_cndmask_b32 v47, v119, v127, s[96:97]
    ds_write_b128 v7, v[40:43] offset:34816
    ds_write_b128 v7, v[44:47] offset:35840
    s_waitcnt vmcnt(0)
    s_waitcnt lgkmcnt(0)
    s_barrier
    ds_read_b128 v[32:35], v68 offset:0
    ds_read_b128 v[36:39], v68 offset:4096
    ds_read_b128 v[40:43], v68 offset:8192
    ds_read_b128 v[44:47], v68 offset:12288
    s_waitcnt lgkmcnt(0)
    v_pk_add_f32 v[32:33], v[32:33], v[36:37]
    v_pk_add_f32 v[34:35], v[34:35], v[38:39]
    v_pk_add_f32 v[40:41], v[40:41], v[44:45]
    v_pk_add_f32 v[42:43], v[42:43], v[46:47]
    v_pk_add_f32 v[32:33], v[32:33], v[40:41]
    v_pk_add_f32 v[34:35], v[34:35], v[42:43]
    v_or_b32 v32, 1, v32
    buffer_store_dwordx4 v[32:35], v5, s[48:51], s4 offen sc0 sc1
    v_lshrrev_b32 v48, 2, v0
    v_mul_u32_u24 v48, 1024, v48
    v_and_b32 v49, 3, v0
    v_lshl_add_u32 v48, v49, 4, v48
    s_mul_i32 s11, s58, 131072
    s_lshl_b32 s10, s57, 6
    s_add_u32 s11, s11, s10
    v_add_u32 v48, s11, v48
    s_lshl_b32 s11, s58, 13
    v_add_u32 v84, s11, v2
    v_add_u32 v85, 0x10000, v84
    ds_read_b64_tr_b16 v[96:97], v85 offset:32768
    ds_read_b64_tr_b16 v[98:99], v85 offset:33280
    ds_read_b64_tr_b16 v[100:101], v85 offset:33792
    ds_read_b64_tr_b16 v[102:103], v85 offset:34304
    ds_read_b64_tr_b16 v[104:105], v85 offset:34816
    ds_read_b64_tr_b16 v[106:107], v85 offset:35328
    ds_read_b64_tr_b16 v[108:109], v85 offset:35840
    ds_read_b64_tr_b16 v[110:111], v85 offset:36352
    ds_read_b64_tr_b16 v[112:113], v85 offset:36864
    ds_read_b64_tr_b16 v[114:115], v85 offset:37376
    ds_read_b64_tr_b16 v[116:117], v85 offset:37888
    ds_read_b64_tr_b16 v[118:119], v85 offset:38400
    ds_read_b64_tr_b16 v[120:121], v85 offset:38912
    ds_read_b64_tr_b16 v[122:123], v85 offset:39424
    ds_read_b64_tr_b16 v[124:125], v85 offset:39936
    ds_read_b64_tr_b16 v[126:127], v85 offset:40448
    v_and_b32 v83, 31, v0
    v_lshlrev_b32 v83, 5, v83
    v_lshrrev_b32 v81, 5, v0
    v_lshl_add_u32 v81, v81, 2, v83
    s_lshl_b32 s4, s58, 3
    s_add_u32 s4, s4, 0x24800
    v_add_u32 v81, s4, v81
    v_mov_b32 v82, 0
    v_mov_b32_e64 v83, 0
    ds_read_b64_tr_b16 v[64:65], v3 offset:32768
    ds_read_b64_tr_b16 v[66:67], v3 offset:33280
    ds_read_b64_tr_b16 v[68:69], v3 offset:33792
    ds_read_b64_tr_b16 v[70:71], v3 offset:34304
    ds_read_b64_tr_b16 v[72:73], v3 offset:34816
    ds_read_b64_tr_b16 v[74:75], v3 offset:35328
    s_waitcnt lgkmcnt(15)
    v_dot2c_f32_bf16 v82, s22, v96
    v_dot2c_f32_bf16 v83, s22, v97
    v_dot2c_f32_bf16 v82, s22, v98
    v_dot2c_f32_bf16 v83, s22, v99
    s_waitcnt lgkmcnt(15)
    v_dot2c_f32_bf16 v82, s22, v100
    v_dot2c_f32_bf16 v83, s22, v101
    v_dot2c_f32_bf16 v82, s22, v102
    v_dot2c_f32_bf16 v83, s22, v103
    s_waitcnt lgkmcnt(15)
    v_dot2c_f32_bf16 v82, s22, v104
    v_dot2c_f32_bf16 v83, s22, v105
    v_dot2c_f32_bf16 v82, s22, v106
    v_dot2c_f32_bf16 v83, s22, v107
    s_waitcnt lgkmcnt(14)
    v_dot2c_f32_bf16 v82, s22, v108
    v_dot2c_f32_bf16 v83, s22, v109
    v_dot2c_f32_bf16 v82, s22, v110
    v_dot2c_f32_bf16 v83, s22, v111
    s_waitcnt lgkmcnt(12)
    v_dot2c_f32_bf16 v82, s22, v112
    v_dot2c_f32_bf16 v83, s22, v113
    v_dot2c_f32_bf16 v82, s22, v114
    v_dot2c_f32_bf16 v83, s22, v115
    s_waitcnt lgkmcnt(10)
    v_dot2c_f32_bf16 v82, s22, v116
    v_dot2c_f32_bf16 v83, s22, v117
    v_dot2c_f32_bf16 v82, s22, v118
    v_dot2c_f32_bf16 v83, s22, v119
    s_waitcnt lgkmcnt(8)
    v_dot2c_f32_bf16 v82, s22, v120
    v_dot2c_f32_bf16 v83, s22, v121
    v_dot2c_f32_bf16 v82, s22, v122
    v_dot2c_f32_bf16 v83, s22, v123
    s_waitcnt lgkmcnt(6)
    v_dot2c_f32_bf16 v82, s22, v124
    v_dot2c_f32_bf16 v83, s22, v125
    v_dot2c_f32_bf16 v82, s22, v126
    v_dot2c_f32_bf16 v83, s22, v127
    s_nop 2
    v_add_f32 v82, v82, v83
    ds_write_b32 v81, v82
    s_waitcnt lgkmcnt(5)
    v_mfma_f32_32x32x16_bf16 v[16:31], v[64:67], v[128:131], 0
    ds_read_b64_tr_b16 v[76:77], v3 offset:35840
    ds_read_b64_tr_b16 v[78:79], v3 offset:36352
    v_lshrrev_b32 v60, 4, v0
    v_lshlrev_b32 v60, 7, v60
    v_and_b32_e64 v61, 15, v0
    v_lshl_add_u32 v60, v61, 2, v60
    s_lshl_b32 s7, s57, 9
    s_add_u32 s7, s7, 0x442000
    buffer_load_dword v61, v60, s[48:51], s7 offen sc1
    s_waitcnt lgkmcnt(5)
    v_mfma_f32_32x32x16_bf16 v[16:31], v[68:71], v[132:135], v[16:31]
    ds_read_b64_tr_b16 v[64:65], v3 offset:36864
    ds_read_b64_tr_b16 v[66:67], v3 offset:37376
    s_lshl_b32 s11, s58, 13
    s_add_u32 m0, s11, 0
    s_mov_b32 s10, 0
    buffer_load_dwordx4 v48, s[40:43], s10 offen offset:0 lds
    s_waitcnt lgkmcnt(5)
    v_mfma_f32_32x32x16_bf16 v[16:31], v[72:75], v[136:139], v[16:31]
    ds_read_b64_tr_b16 v[68:69], v3 offset:37888
    ds_read_b64_tr_b16 v[70:71], v3 offset:38400
    s_mov_b32 s10, 15360
    buffer_load_dwordx4 v48, s[40:43], s10 offen offset:1024 lds
    v_accvgpr_write_b32 a96, v96
    s_waitcnt lgkmcnt(4)
    v_mfma_f32_32x32x16_bf16 v[16:31], v[76:79], v[140:143], v[16:31]
    ds_read_b64_tr_b16 v[72:73], v3 offset:38912
    ds_read_b64_tr_b16 v[74:75], v3 offset:39424
    s_mov_b32 s10, 30720
    buffer_load_dwordx4 v48, s[40:43], s10 offen offset:2048 lds
    s_barrier
    s_waitcnt lgkmcnt(4)
    v_mfma_f32_32x32x16_bf16 v[16:31], v[64:67], v[144:147], v[16:31]
    ds_read_b64_tr_b16 v[76:77], v3 offset:39936
    ds_read_b64_tr_b16 v[78:79], v3 offset:40448
    s_mov_b32 s10, 46080
    buffer_load_dwordx4 v48, s[40:43], s10 offen offset:3072 lds
    v_accvgpr_write_b32 a97, v97
    s_waitcnt lgkmcnt(4)
    v_mfma_f32_32x32x16_bf16 v[16:31], v[68:71], v[148:151], v[16:31]
    ds_read_b64_tr_b16 v[64:65], v3 offset:40960
    ds_read_b64_tr_b16 v[66:67], v3 offset:41472
    s_lshl_b32 s11, s58, 13
    s_add_u32 m0, s11, 4096
    s_mov_b32 s10, 65536
    buffer_load_dwordx4 v48, s[40:43], s10 offen offset:0 lds
    s_waitcnt lgkmcnt(4)
    v_mfma_f32_32x32x16_bf16 v[16:31], v[72:75], v[152:155], v[16:31]
    ds_read_b64_tr_b16 v[68:69], v3 offset:41984
    ds_read_b64_tr_b16 v[70:71], v3 offset:42496
    s_mov_b32 s10, 80896
    buffer_load_dwordx4 v48, s[40:43], s10 offen offset:1024 lds
    v_accvgpr_write_b32 a98, v98
    s_waitcnt lgkmcnt(4)
    v_mfma_f32_32x32x16_bf16 v[16:31], v[76:79], v[156:159], v[16:31]
    ds_read_b64_tr_b16 v[72:73], v3 offset:43008
    ds_read_b64_tr_b16 v[74:75], v3 offset:43520
    s_mov_b32 s10, 96256
    buffer_load_dwordx4 v48, s[40:43], s10 offen offset:2048 lds
    v_accvgpr_write_b32 a99, v99
    s_waitcnt lgkmcnt(4)
    v_mfma_f32_32x32x16_bf16 v[16:31], v[64:67], v[160:163], v[16:31]
    ds_read_b64_tr_b16 v[76:77], v3 offset:44032
    ds_read_b64_tr_b16 v[78:79], v3 offset:44544
    s_mov_b32 s10, 111616
    buffer_load_dwordx4 v48, s[40:43], s10 offen offset:3072 lds
    v_accvgpr_write_b32 a100, v100
    s_waitcnt lgkmcnt(4)
    v_mfma_f32_32x32x16_bf16 v[16:31], v[68:71], v[164:167], v[16:31]
    ds_read_b64_tr_b16 v[64:65], v3 offset:45056
    ds_read_b64_tr_b16 v[66:67], v3 offset:45568
    v_accvgpr_write_b32 a101, v101
    v_accvgpr_write_b32 a102, v102
    v_accvgpr_write_b32 a103, v103
    s_waitcnt lgkmcnt(4)
    v_mfma_f32_32x32x16_bf16 v[16:31], v[72:75], v[168:171], v[16:31]
    ds_read_b64_tr_b16 v[68:69], v3 offset:46080
    ds_read_b64_tr_b16 v[70:71], v3 offset:46592
    v_accvgpr_write_b32 a104, v104
    v_accvgpr_write_b32 a105, v105
    v_accvgpr_write_b32 a106, v106
    s_waitcnt lgkmcnt(4)
    v_mfma_f32_32x32x16_bf16 v[16:31], v[76:79], v[172:175], v[16:31]
    ds_read_b64_tr_b16 v[72:73], v3 offset:47104
    ds_read_b64_tr_b16 v[74:75], v3 offset:47616
    v_accvgpr_write_b32 a107, v107
    v_accvgpr_write_b32 a108, v108
    v_accvgpr_write_b32 a109, v109
    s_waitcnt lgkmcnt(4)
    v_mfma_f32_32x32x16_bf16 v[16:31], v[64:67], v[176:179], v[16:31]
    ds_read_b64_tr_b16 v[76:77], v3 offset:48128
    ds_read_b64_tr_b16 v[78:79], v3 offset:48640
    v_accvgpr_write_b32 a110, v110
    v_accvgpr_write_b32 a111, v111
    v_accvgpr_write_b32 a112, v112
    s_waitcnt lgkmcnt(4)
    v_mfma_f32_32x32x16_bf16 v[16:31], v[68:71], v[180:183], v[16:31]
    ds_read_b64_tr_b16 v[64:65], v3 offset:49152
    ds_read_b64_tr_b16 v[66:67], v3 offset:49664
    s_lshl_b32 s4, s57, 16
    s_add_u32 s4, s4, s16
    s_add_u32 s4, s4, 0x500000
    s_lshr_b32 s5, s58, 1
    s_lshl_b32 s5, s5, 15
    s_add_u32 s20, s4, s5
    s_and_b32 s5, s58, 1
    s_lshl_b32 s10, s5, 15
    s_add_u32 s21, s4, s10
    s_waitcnt lgkmcnt(4)
    v_mfma_f32_32x32x16_bf16 v[16:31], v[72:75], v[184:187], v[16:31]
    ds_read_b64_tr_b16 v[68:69], v3 offset:50176
    ds_read_b64_tr_b16 v[70:71], v3 offset:50688
    s_lshl_b32 s5, s5, 10
    s_add_u32 s20, s20, s5
    v_lshrrev_b32 v57, 4, v0
    v_lshlrev_b32 v57, 5, v57
    v_and_b32_e64 v58, 1, v0
    v_lshl_add_u32 v57, v58, 4, v57
    s_waitcnt lgkmcnt(4)
    v_mfma_f32_32x32x16_bf16 v[16:31], v[76:79], v[188:191], v[16:31]
    ds_read_b64_tr_b16 v[72:73], v3 offset:51200
    ds_read_b64_tr_b16 v[74:75], v3 offset:51712
    v_add_u32 v59, 157696, v57
    v_bfe_u32 v58, v0, 1, 3
    v_lshl_add_u32 v57, v58, 12, v57
    s_lshl_b32 s5, s58, 7
    v_add_u32_e64 v59, s5, v59
    s_waitcnt lgkmcnt(4)
    v_mfma_f32_32x32x16_bf16 v[16:31], v[64:67], v[192:195], v[16:31]
    ds_read_b64_tr_b16 v[76:77], v3 offset:52224
    ds_read_b64_tr_b16 v[78:79], v3 offset:52736
    v_accvgpr_write_b32 a113, v113
    v_accvgpr_write_b32 a114, v114
    v_accvgpr_write_b32 a115, v115
    s_waitcnt lgkmcnt(4)
    v_mfma_f32_32x32x16_bf16 v[16:31], v[68:71], v[196:199], v[16:31]
    ds_read_b64_tr_b16 v[64:65], v3 offset:53248
    ds_read_b64_tr_b16 v[66:67], v3 offset:53760
    v_accvgpr_write_b32 a116, v116
    v_accvgpr_write_b32 a117, v117
    v_accvgpr_write_b32 a118, v118
    s_waitcnt lgkmcnt(4)
    v_mfma_f32_32x32x16_bf16 v[16:31], v[72:75], v[200:203], v[16:31]
    ds_read_b64_tr_b16 v[68:69], v3 offset:54272
    ds_read_b64_tr_b16 v[70:71], v3 offset:54784
    v_accvgpr_write_b32 a119, v119
    v_accvgpr_write_b32 a120, v120
    v_accvgpr_write_b32 a121, v121
    s_waitcnt lgkmcnt(4)
    v_mfma_f32_32x32x16_bf16 v[16:31], v[76:79], v[204:207], v[16:31]
    ds_read_b64_tr_b16 v[72:73], v3 offset:55296
    ds_read_b64_tr_b16 v[74:75], v3 offset:55808
    v_accvgpr_write_b32 a122, v122
    v_accvgpr_write_b32 a123, v123
    v_accvgpr_write_b32 a124, v124
    s_waitcnt lgkmcnt(4)
    v_mfma_f32_32x32x16_bf16 v[16:31], v[64:67], v[208:211], v[16:31]
    ds_read_b64_tr_b16 v[76:77], v3 offset:56320
    ds_read_b64_tr_b16 v[78:79], v3 offset:56832
    v_accvgpr_write_b32 a125, v125
    v_accvgpr_write_b32 a126, v126
    v_accvgpr_write_b32 a127, v127
    s_waitcnt lgkmcnt(4)
    v_mfma_f32_32x32x16_bf16 v[16:31], v[68:71], v[212:215], v[16:31]
    ds_read_b64_tr_b16 v[64:65], v3 offset:57344
    ds_read_b64_tr_b16 v[66:67], v3 offset:57856
    v_and_b32 v92, 31, v0
    v_lshlrev_b32 v93, 5, v92
    v_add_u32 v93, 0x24800, v93
    s_waitcnt lgkmcnt(4)
    v_mfma_f32_32x32x16_bf16 v[16:31], v[72:75], v[216:219], v[16:31]
    ds_read_b64_tr_b16 v[68:69], v3 offset:58368
    ds_read_b64_tr_b16 v[70:71], v3 offset:58880
    v_lshlrev_b32 v92, 2, v92
    v_add_u32 v92, 0x24580, v92
    ds_read_b128 v[100:103], v93 offset:0
    s_waitcnt lgkmcnt(5)
    v_mfma_f32_32x32x16_bf16 v[16:31], v[76:79], v[220:223], v[16:31]
    ds_read_b64_tr_b16 v[72:73], v3 offset:59392
    ds_read_b64_tr_b16 v[74:75], v3 offset:59904
    ds_read_b128 v[104:107], v93 offset:16
    s_waitcnt lgkmcnt(0)
    v_add_f32 v100, v100, v102
    v_mfma_f32_32x32x16_bf16 v[16:31], v[64:67], v[224:227], v[16:31]
    ds_read_b64_tr_b16 v[76:77], v3 offset:60416
    ds_read_b64_tr_b16 v[78:79], v3 offset:60928
    v_add_f32 v101, v101, v103
    v_add_f32 v104, v104, v106
    v_add_f32 v105, v105, v107
    v_mfma_f32_32x32x16_bf16 v[16:31], v[68:71], v[228:231], v[16:31]
    ds_read_b64_tr_b16 v[64:65], v3 offset:61440
    ds_read_b64_tr_b16 v[66:67], v3 offset:61952
    s_waitcnt vmcnt(8)
    v_cmp_eq_u32 vcc, 0, v61
    s_cbranch_vccnz kfb_138
kfo_139:
    v_mfma_f32_32x32x16_bf16 v[16:31], v[72:75], v[232:235], v[16:31]
    ds_read_b64_tr_b16 v[68:69], v3 offset:62464
    ds_read_b64_tr_b16 v[70:71], v3 offset:62976
    s_add_u32 s7, s20, 0
    buffer_load_dwordx4 v[128:131], v1, s[48:51], s7 offen sc1
    v_add_f32 v100, v100, v104
    s_waitcnt lgkmcnt(4)
    v_mfma_f32_32x32x16_bf16 v[16:31], v[76:79], v[236:239], v[16:31]
    ds_read_b64_tr_b16 v[72:73], v3 offset:63488
    ds_read_b64_tr_b16 v[74:75], v3 offset:64000
    s_add_u32 s7, s20, 4096
    buffer_load_dwordx4 v[132:135], v1, s[48:51], s7 offen sc1
    v_add_f32 v101, v101, v105
    s_waitcnt lgkmcnt(4)
    v_mfma_f32_32x32x16_bf16 v[16:31], v[64:67], v[240:243], v[16:31]
    ds_read_b64_tr_b16 v[76:77], v3 offset:64512
    ds_read_b64_tr_b16 v[78:79], v3 offset:65024
    s_add_u32 s7, s20, 8192
    buffer_load_dwordx4 v[136:139], v1, s[48:51], s7 offen sc1
    v_add_f32 v100, v100, v101
    s_waitcnt lgkmcnt(4)
    v_mfma_f32_32x32x16_bf16 v[16:31], v[68:71], v[244:247], v[16:31]
    s_add_u32 s7, s20, 12288
    buffer_load_dwordx4 v[140:143], v1, s[48:51], s7 offen sc1
    ds_write_b32 v92, v100 offset:0
    ds_read_b128 v[112:115], v91 offset:0
    ds_read_b128 v[116:119], v91 offset:32
    s_waitcnt lgkmcnt(5)
    v_mfma_f32_32x32x16_bf16 v[16:31], v[72:75], v[248:251], v[16:31]
    s_add_u32 s7, s20, 16384
    buffer_load_dwordx4 v[144:147], v1, s[48:51], s7 offen sc1
    ds_read_b128 v[120:123], v91 offset:64
    ds_read_b128 v[124:127], v91 offset:96
    s_waitcnt lgkmcnt(5)
    v_mfma_f32_32x32x16_bf16 v[16:31], v[76:79], v[252:255], v[16:31]
    s_add_u32 s7, s20, 20480
    buffer_load_dwordx4 v[148:151], v1, s[48:51], s7 offen sc1
    s_add_u32 s7, s20, 24576
    buffer_load_dwordx4 v[152:155], v1, s[48:51], s7 offen sc1
    s_waitcnt lgkmcnt(0)
    s_nop 7
    s_nop 0
    v_pk_fma_f32 v[16:17], v[16:17], v[88:89], s[30:31] op_sel_hi:[1,0,1]
    v_pk_fma_f32 v[18:19], v[18:19], v[88:89], s[30:31] op_sel_hi:[1,0,1]
    s_add_u32 s7, s20, 28672
    buffer_load_dwordx4 v[156:159], v1, s[48:51], s7 offen sc1
    v_pk_fma_f32 v[20:21], v[20:21], v[88:89], s[30:31] op_sel_hi:[1,0,1]
    v_pk_fma_f32 v[22:23], v[22:23], v[88:89], s[30:31] op_sel_hi:[1,0,1]
    v_pk_fma_f32 v[24:25], v[24:25], v[88:89], s[30:31] op_sel_hi:[1,0,1]
    v_pk_fma_f32 v[26:27], v[26:27], v[88:89], s[30:31] op_sel_hi:[1,0,1]
    buffer_load_dwordx4 v[60:63], v57, s[48:51], s21 offen offset:2048 sc1
    v_pk_fma_f32 v[28:29], v[28:29], v[88:89], s[30:31] op_sel_hi:[1,0,1]
    v_pk_fma_f32 v[30:31], v[30:31], v[88:89], s[30:31] op_sel_hi:[1,0,1]
    v_pk_fma_f32 v[16:17], v[112:113], v[90:91], v[16:17] op_sel_hi:[1,0,1] neg_lo:[0,1,0] neg_hi:[0,1,0]
    v_pk_fma_f32 v[18:19], v[114:115], v[90:91], v[18:19] op_sel_hi:[1,0,1] neg_lo:[0,1,0] neg_hi:[0,1,0]
    v_pk_fma_f32 v[20:21], v[116:117], v[90:91], v[20:21] op_sel_hi:[1,0,1] neg_lo:[0,1,0] neg_hi:[0,1,0]
    v_pk_fma_f32 v[22:23], v[118:119], v[90:91], v[22:23] op_sel_hi:[1,0,1] neg_lo:[0,1,0] neg_hi:[0,1,0]
    v_pk_fma_f32 v[24:25], v[120:121], v[90:91], v[24:25] op_sel_hi:[1,0,1] neg_lo:[0,1,0] neg_hi:[0,1,0]
    v_pk_fma_f32 v[26:27], v[122:123], v[90:91], v[26:27] op_sel_hi:[1,0,1] neg_lo:[0,1,0] neg_hi:[0,1,0]
    v_pk_fma_f32 v[28:29], v[124:125], v[90:91], v[28:29] op_sel_hi:[1,0,1] neg_lo:[0,1,0] neg_hi:[0,1,0]
    v_pk_fma_f32 v[30:31], v[126:127], v[90:91], v[30:31] op_sel_hi:[1,0,1] neg_lo:[0,1,0] neg_hi:[0,1,0]
    v_pk_mul_f32 v[96:97], v[16:17], s[28:29]
    v_pk_mul_f32 v[98:99], v[18:19], s[28:29]
    v_pk_mul_f32 v[100:101], v[20:21], s[28:29]
    v_pk_mul_f32 v[102:103], v[22:23], s[28:29]
    v_pk_mul_f32 v[104:105], v[24:25], s[28:29]
    v_pk_mul_f32 v[106:107], v[26:27], s[28:29]
    v_pk_mul_f32 v[108:109], v[28:29], s[28:29]
    v_pk_mul_f32 v[110:111], v[30:31], s[28:29]
    v_exp_f32_e64 v96, v96 clamp
    v_max_f32 v16, s30, v16
    v_exp_f32_e64 v97, v97 clamp
    v_max_f32 v17, s30, v17
    v_exp_f32_e64 v98, v98 clamp
    v_max_f32 v18, s30, v18
    v_exp_f32_e64 v99, v99 clamp
    v_max_f32 v19, s30, v19
    v_exp_f32_e64 v100, v100 clamp
    v_max_f32 v20, s30, v20
    v_exp_f32_e64 v101, v101 clamp
    v_max_f32 v21, s30, v21
    v_exp_f32_e64 v102, v102 clamp
    v_max_f32 v22, s30, v22
    v_exp_f32_e64 v103, v103 clamp
    v_max_f32 v23, s30, v23
    v_exp_f32_e64 v104, v104 clamp
    v_max_f32 v24, s30, v24
    v_exp_f32_e64 v105, v105 clamp
    v_max_f32 v25, s30, v25
    v_exp_f32_e64 v106, v106 clamp
    v_max_f32 v26, s30, v26
    v_exp_f32_e64 v107, v107 clamp
    v_max_f32 v27, s30, v27
    v_exp_f32_e64 v108, v108 clamp
    v_max_f32 v28, s30, v28
    v_exp_f32_e64 v109, v109 clamp
    v_max_f32 v29, s30, v29
    v_exp_f32_e64 v110, v110 clamp
    v_max_f32 v30, s30, v30
    v_exp_f32_e64 v111, v111 clamp
    v_max_f32 v31, s30, v31
    v_pk_add_f32 v[16:17], v[16:17], v[96:97]
    v_pk_add_f32 v[18:19], v[18:19], v[98:99]
    v_pk_add_f32 v[20:21], v[20:21], v[100:101]
    v_pk_add_f32 v[22:23], v[22:23], v[102:103]
    v_pk_add_f32 v[24:25], v[24:25], v[104:105]
    v_pk_add_f32 v[26:27], v[26:27], v[106:107]
    v_pk_add_f32 v[28:29], v[28:29], v[108:109]
    v_pk_add_f32 v[30:31], v[30:31], v[110:111]
    v_cvt_pk_bf16_f32 v16, v16, v17
    v_cvt_pk_bf16_f32 v17, v18, v19
    v_cvt_pk_bf16_f32 v18, v20, v21
    v_cvt_pk_bf16_f32 v19, v22, v23
    v_cvt_pk_bf16_f32 v20, v24, v25
    v_cvt_pk_bf16_f32 v21, v26, v27
    v_cvt_pk_bf16_f32 v22, v28, v29
    v_cvt_pk_bf16_f32 v23, v30, v31
    s_lshl_b32 s11, s58, 13
    v_add_u32 v84, s11, v1
    v_add_u32 v85, 0x10000, v84
    ds_read_b128 a[128:131], v85 offset:0
    ds_read_b128 a[132:135], v85 offset:1024
    ds_read_b128 a[136:139], v85 offset:2048
    ds_read_b128 a[140:143], v85 offset:3072
    ds_read_b128 a[144:147], v85 offset:4096
    ds_read_b128 a[148:151], v85 offset:5120
    ds_read_b128 a[152:155], v85 offset:6144
    ds_read_b128 a[156:159], v85 offset:7168
    ds_read_b128 a[160:163], v84 offset:32768
    ds_read_b128 a[164:167], v84 offset:33792
    ds_read_b128 a[168:171], v84 offset:34816
    ds_read_b128 a[172:175], v84 offset:35840
    ds_read_b128 a[176:179], v84 offset:36864
    ds_read_b128 a[180:183], v84 offset:37888
    ds_read_b128 a[184:187], v84 offset:38912
    ds_read_b128 a[188:191], v84 offset:39936
    ds_write_b128 v85, a[32:35] offset:0
    ds_write_b128 v85, a[36:39] offset:1024
    ds_write_b128 v85, a[40:43] offset:2048
    ds_write_b128 v85, a[44:47] offset:3072
    ds_write_b128 v85, a[48:51] offset:4096
    ds_write_b128 v85, a[52:55] offset:5120
    ds_write_b128 v85, a[56:59] offset:6144
    ds_write_b128 v85, a[60:63] offset:7168
    s_add_u32 s4, s9, 153600
    v_add_u32 v56, s4, v1
    v_add_u32 v58, 153600, v1
    v_lshrrev_b32 v48, 4, v0
    v_lshlrev_b32_e64 v48, 5, v48
    v_add_u32 v48, 157696, v48
    s_mov_b32 s99, 200000
    s_nop 0
klp_142:
    s_waitcnt vmcnt(0)
    v_bitop3_b32 v49, v128, v132, v136 bitop3:0x80
    v_bitop3_b32 v49, v49, v140, v144 bitop3:0x80
    v_bitop3_b32 v49, v49, v148, v152 bitop3:0x80
    v_bitop3_b32 v49, v49, v156, v60 bitop3:0x80
    v_bitop3_b32 v49, v49, v49, 1 bitop3:0x80
    v_cmp_eq_u32 vcc, 0, v49
    s_nop 3
    s_nop 0
    s_cbranch_vccnz kr_144
kd_143:
    v_pk_add_f32 v[128:129], v[128:129], v[144:145]
    v_pk_add_f32 v[130:131], v[130:131], v[146:147]
    v_pk_add_f32 v[132:133], v[132:133], v[148:149]
    v_pk_add_f32 v[134:135], v[134:135], v[150:151]
    v_pk_add_f32 v[136:137], v[136:137], v[152:153]
    v_pk_add_f32 v[138:139], v[138:139], v[154:155]
    v_pk_add_f32 v[140:141], v[140:141], v[156:157]
    v_pk_add_f32 v[142:143], v[142:143], v[158:159]
    v_pk_add_f32 v[128:129], v[128:129], v[136:137]
    v_pk_add_f32 v[130:131], v[130:131], v[138:139]
    v_pk_add_f32 v[132:133], v[132:133], v[140:141]
    v_pk_add_f32 v[134:135], v[134:135], v[142:143]
    v_pk_add_f32 v[128:129], v[128:129], v[132:133]
    v_pk_add_f32 v[130:131], v[130:131], v[134:135]
    ds_write_b128 v56, v[128:131]
    v_add_f32_dpp v60, v60, v60 quad_perm:[2,3,0,1] row_mask:0xf bank_mask:0xf
    v_add_f32_dpp v61, v61, v61 quad_perm:[2,3,0,1] row_mask:0xf bank_mask:0xf
    v_add_f32_dpp v62, v62, v62 quad_perm:[2,3,0,1] row_mask:0xf bank_mask:0xf
    v_add_f32_dpp v63, v63, v63 quad_perm:[2,3,0,1] row_mask:0xf bank_mask:0xf
    v_add_f32_dpp v60, v60, v60 row_ror:4 row_mask:0xf bank_mask:0xf
    v_add_f32_dpp v61, v61, v61 row_ror:4 row_mask:0xf bank_mask:0xf
    v_add_f32_dpp v62, v62, v62 row_ror:4 row_mask:0xf bank_mask:0xf
    v_add_f32_dpp v63, v63, v63 row_ror:4 row_mask:0xf bank_mask:0xf
    v_add_f32_dpp v60, v60, v60 row_ror:8 row_mask:0xf bank_mask:0xf
    v_add_f32_dpp v61, v61, v61 row_ror:8 row_mask:0xf bank_mask:0xf
    v_add_f32_dpp v62, v62, v62 row_ror:8 row_mask:0xf bank_mask:0xf
    v_add_f32_dpp v63, v63, v63 row_ror:8 row_mask:0xf bank_mask:0xf
    ds_write_b128 v59, v[60:63]
    s_waitcnt lgkmcnt(0)
    s_barrier
    ds_read_b128 v[32:35], v58
    ds_read_b128 v[64:67], v58 offset:2048
    ds_read_b128 v[40:43], v48
    ds_read_b128 v[72:75], v48 offset:128
    ds_read_b128 v[36:39], v58 offset:1024
    ds_read_b128 v[68:71], v58 offset:3072
    ds_read_b128 v[44:47], v48 offset:16
    ds_read_b128 v[76:79], v48 offset:144
    s_waitcnt lgkmcnt(4)
    v_pk_add_f32 v[32:33], v[32:33], v[64:65]
    v_pk_add_f32 v[34:35], v[34:35], v[66:67]
    v_pk_add_f32 v[40:41], v[40:41], v[72:73]
    v_pk_add_f32 v[42:43], v[42:43], v[74:75]
    v_cvt_pk_bf16_f32 v80, v32, v33
    v_cvt_pk_bf16_f32 v84, v40, v41
    v_cvt_pk_bf16_f32 v81, v34, v35
    v_cvt_pk_bf16_f32 v85, v42, v43
    s_waitcnt lgkmcnt(0)
    v_pk_add_f32 v[36:37], v[36:37], v[68:69]
    v_pk_add_f32 v[38:39], v[38:39], v[70:71]
    v_pk_add_f32 v[44:45], v[44:45], v[76:77]
    v_pk_add_f32 v[46:47], v[46:47], v[78:79]
    v_cvt_pk_bf16_f32 v82, v36, v37
    v_cvt_pk_bf16_f32 v86, v44, v45
    v_cvt_pk_bf16_f32 v83, v38, v39
    v_cvt_pk_bf16_f32 v87, v46, v47
    v_cndmask_b32 v96, v84, v80, s[96:97]
    v_cndmask_b32 v97, v85, v81, s[96:97]
    v_cndmask_b32 v98, v86, v82, s[96:97]
    v_cndmask_b32 v99, v87, v83, s[96:97]
    v_cndmask_b32 v100, v80, v84, s[96:97]
    v_cndmask_b32 v101, v81, v85, s[96:97]
    v_mfma_f32_32x32x16_bf16 v[64:79], v[96:99], v[16:19], 0
    v_cndmask_b32 v102, v82, v86, s[96:97]
    v_cndmask_b32 v103, v83, v87, s[96:97]
    s_nop 1
    v_mfma_f32_32x32x16_bf16 v[48:63], v[100:103], v[20:23], 0
    s_nop 6
    v_add_f32 v72, 0x358637bd, v72
    v_rcp_f32 v72, v72
    s_nop 0
    v_mul_f32 v64, v64, v72
    v_mul_f32 v65, v65, v72
    v_mul_f32 v66, v66, v72
    v_mul_f32 v67, v67, v72
    v_mul_f32 v68, v68, v72
    v_mul_f32 v69, v69, v72
    v_mul_f32 v70, v70, v72
    v_mul_f32 v71, v71, v72
    v_and_b32 v64, 0xffff0000, v64
    v_cvt_pk_bf16_f32 v104, v64, v65
    v_cvt_pk_bf16_f32 v105, v66, v67
    v_cvt_pk_bf16_f32 v106, v68, v69
    v_cvt_pk_bf16_f32 v107, v70, v71
    v_or_b32 v104, 1, v104
    s_cmp_lg_u32 s63, 0
    s_nop 0
    s_cbranch_scc0 fast_154
    buffer_store_dwordx4 v[104:107], v1, s[48:51], s62 offen offset:0
    s_nop 1
dend_155:
    v_add_f32 v48, 0x358637bd, v48
    v_rcp_f32 v48, v48
    s_nop 0
    v_mul_f32 v56, v56, v48
    v_mul_f32 v57, v57, v48
    v_mul_f32 v58, v58, v48
    v_mul_f32 v59, v59, v48
    v_mul_f32 v60, v60, v48
    v_mul_f32 v61, v61, v48
    v_mul_f32 v62, v62, v48
    v_mul_f32_e64 v63, v63, v48
    v_and_b32 v56, 0xffff0000, v56
    v_cvt_pk_bf16_f32 v108, v56, v57
    v_cvt_pk_bf16_f32 v109, v58, v59
    v_cvt_pk_bf16_f32 v110, v60, v61
    v_cvt_pk_bf16_f32 v111, v62, v63
    v_or_b32 v108, 1, v108
    s_cmp_lg_u32 s63, 0
    s_nop 0
    s_cbranch_scc0 fast_156
    buffer_store_dwordx4 v[108:111], v1, s[48:51], s62 offen offset:1024
    s_nop 1
dend_157:
    s_add_u32 s3, s100, 0
    buffer_load_dwordx4 v[128:131], v1, s[48:51], s3 offen offset:0 sc1
    buffer_load_dwordx4 v[132:135], v1, s[48:51], s3 offen offset:1024 sc1
    buffer_load_dwordx4 v[136:139], v1, s[48:51], s3 offen offset:2048 sc1
    buffer_load_dwordx4 v[140:143], v1, s[48:51], s3 offen offset:3072 sc1
    s_add_u32 s3, s100, 4096
    buffer_load_dwordx4 v[144:147], v1, s[48:51], s3 offen offset:0 sc1
    buffer_load_dwordx4 v[148:151], v1, s[48:51], s3 offen offset:1024 sc1
    buffer_load_dwordx4 v[152:155], v1, s[48:51], s3 offen offset:2048 sc1
    buffer_load_dwordx4 v[156:159], v1, s[48:51], s3 offen offset:3072 sc1
    ds_read_b64_tr_b16 v[64:65], v2 offset:0
    ds_read_b64_tr_b16 v[66:67], v2 offset:512
    ds_read_b64_tr_b16 v[68:69], v2 offset:1024
    ds_read_b64_tr_b16 v[70:71], v2 offset:1536
    ds_read_b64_tr_b16 v[72:73], v2 offset:2048
    ds_read_b64_tr_b16 v[74:75], v2 offset:2560
    v_lshlrev_b32 v16, 16, v8
    v_and_b32 v17, 0xffff0000, v8
    v_lshlrev_b32 v18, 16, v9
    v_and_b32 v19, 0xffff0000, v9
    v_lshlrev_b32 v20, 16, v10
    v_and_b32 v21, 0xffff0000, v10
    v_lshlrev_b32 v22, 16, v11
    v_and_b32 v23, 0xffff0000, v11
    v_lshlrev_b32 v24, 16, v12
    v_and_b32 v25, 0xffff0000, v12
    v_lshlrev_b32 v26, 16, v13
    v_and_b32 v27, 0xffff0000, v13
    v_lshlrev_b32 v28, 16, v14
    v_and_b32 v29, 0xffff0000, v14
    v_lshlrev_b32 v30, 16, v15
    v_and_b32 v31, 0xffff0000, v15
    s_lshl_b32 s11, s58, 13
    v_add_u32 v82, s11, v1
    v_add_u32 v83, 0x10000, v82
    ds_read_b64_tr_b16 v[76:77], v2 offset:3072
    ds_read_b64_tr_b16 v[78:79], v2 offset:3584
    s_waitcnt vmcnt(6)
    v_bitop3_b32 v95, v128, v132, 1 bitop3:0x80
    v_cmp_eq_u32 vcc, 0, v95
    s_cbranch_vccnz gst_158
gbk_159:
    s_waitcnt lgkmcnt(6)
    v_mfma_f32_32x32x16_bf16 v[16:31], v[64:67], v[128:131], v[16:31]
    s_add_u32 s3, s100, 8192
    buffer_load_dwordx4 v[160:163], v1, s[48:51], s3 offen offset:0 sc1
    ds_read_b64_tr_b16 v[64:65], v2 offset:4096
    ds_read_b64_tr_b16 v[66:67], v2 offset:4608
    s_waitcnt lgkmcnt(6)
    v_mfma_f32_32x32x16_bf16 v[16:31], v[68:71], v[132:135], v[16:31]
    buffer_load_dwordx4 v[164:167], v1, s[48:51], s3 offen offset:1024 sc1
    ds_write_b128 v82, a[64:67] offset:32768
    ds_read_b64_tr_b16 v[68:69], v2 offset:5120
    ds_read_b64_tr_b16 v[70:71], v2 offset:5632
    s_waitcnt vmcnt(6)
    v_bitop3_b32 v95, v136, v140, 1 bitop3:0x80
    v_cmp_eq_u32 vcc, 0, v95
    s_cbranch_vccnz gst_162
gbk_163:
    s_waitcnt lgkmcnt(7)
    v_mfma_f32_32x32x16_bf16 v[16:31], v[72:75], v[136:139], v[16:31]
    buffer_load_dwordx4 v[168:171], v1, s[48:51], s3 offen offset:2048 sc1
    ds_write_b128 v82, a[68:71] offset:33792
    ds_read_b64_tr_b16 v[72:73], v2 offset:6144
    ds_read_b64_tr_b16 v[74:75], v2 offset:6656
    s_waitcnt lgkmcnt(8)
    v_mfma_f32_32x32x16_bf16 v[16:31], v[76:79], v[140:143], v[16:31]
    buffer_load_dwordx4 v[172:175], v1, s[48:51], s3 offen offset:3072 sc1
    ds_read_b64_tr_b16 v[76:77], v2 offset:7168
    ds_read_b64_tr_b16 v[78:79], v2 offset:7680
    s_waitcnt vmcnt(6)
    v_bitop3_b32 v95, v144, v148, 1 bitop3:0x80
    v_cmp_eq_u32 vcc, 0, v95
    s_cbranch_vccnz gst_166
gbk_167:
    s_waitcnt lgkmcnt(8)
    v_mfma_f32_32x32x16_bf16 v[16:31], v[64:67], v[144:147], v[16:31]
    s_add_u32 s3, s100, 12288
    buffer_load_dwordx4 v[176:179], v1, s[48:51], s3 offen offset:0 sc1
    ds_write_b128 v82, a[72:75] offset:34816
    ds_read_b64_tr_b16 v[64:65], v2 offset:8192
    ds_read_b64_tr_b16 v[66:67], v2 offset:8704
    s_waitcnt lgkmcnt(8)
    v_mfma_f32_32x32x16_bf16 v[16:31], v[68:71], v[148:151], v[16:31]
    buffer_load_dwordx4 v[180:183], v1, s[48:51], s3 offen offset:1024 sc1
    ds_read_b64_tr_b16 v[68:69], v2 offset:9216
    ds_read_b64_tr_b16 v[70:71], v2 offset:9728
    s_waitcnt vmcnt(6)
    v_bitop3_b32 v95, v152, v156, 1 bitop3:0x80
    v_cmp_eq_u32 vcc, 0, v95
    s_cbranch_vccnz gst_170
gbk_171:
    s_waitcnt lgkmcnt(7)
    v_mfma_f32_32x32x16_bf16 v[16:31], v[72:75], v[152:155], v[16:31]
    buffer_load_dwordx4 v[184:187], v1, s[48:51], s3 offen offset:2048 sc1
    ds_write_b128 v82, a[76:79] offset:35840
    ds_read_b64_tr_b16 v[72:73], v2 offset:10240
    ds_read_b64_tr_b16 v[74:75], v2 offset:10752
    s_waitcnt lgkmcnt(8)
    v_mfma_f32_32x32x16_bf16 v[16:31], v[76:79], v[156:159], v[16:31]
    buffer_load_dwordx4 v[188:191], v1, s[48:51], s3 offen offset:3072 sc1
    ds_read_b64_tr_b16 v[76:77], v2 offset:11264
    ds_read_b64_tr_b16 v[78:79], v2 offset:11776
    s_waitcnt vmcnt(6)
    v_bitop3_b32 v95, v160, v164, 1 bitop3:0x80
    v_cmp_eq_u32 vcc, 0, v95
    s_cbranch_vccnz gst_174
gbk_175:
    s_waitcnt lgkmcnt(7)
    v_mfma_f32_32x32x16_bf16 v[16:31], v[64:67], v[160:163], v[16:31]
    s_add_u32 s3, s100, 16384
    buffer_load_dwordx4 v[192:195], v1, s[48:51], s3 offen offset:0 sc1
    ds_write_b128 v82, a[80:83] offset:36864
    ds_read_b64_tr_b16 v[64:65], v2 offset:12288
    ds_read_b64_tr_b16 v[66:67], v2 offset:12800
    s_waitcnt lgkmcnt(8)
    v_mfma_f32_32x32x16_bf16 v[16:31], v[68:71], v[164:167], v[16:31]
    buffer_load_dwordx4 v[196:199], v1, s[48:51], s3 offen offset:1024 sc1
    ds_read_b64_tr_b16 v[68:69], v2 offset:13312
    ds_read_b64_tr_b16 v[70:71], v2 offset:13824
    s_waitcnt vmcnt(6)
    v_bitop3_b32 v95, v168, v172, 1 bitop3:0x80
    v_cmp_eq_u32 vcc, 0, v95
    s_cbranch_vccnz gst_178
gbk_179:
    s_waitcnt lgkmcnt(7)
    v_mfma_f32_32x32x16_bf16 v[16:31], v[72:75], v[168:171], v[16:31]
    buffer_load_dwordx4 v[200:203], v1, s[48:51], s3 offen offset:2048 sc1
    ds_write_b128 v82, a[84:87] offset:37888
    ds_read_b64_tr_b16 v[72:73], v2 offset:14336
    ds_read_b64_tr_b16 v[74:75], v2 offset:14848
    s_waitcnt lgkmcnt(8)
    v_mfma_f32_32x32x16_bf16 v[16:31], v[76:79], v[172:175], v[16:31]
    buffer_load_dwordx4 v[204:207], v1, s[48:51], s3 offen offset:3072 sc1
    ds_write_b128 v82, a[88:91] offset:38912
    ds_read_b64_tr_b16 v[76:77], v2 offset:15360
    ds_read_b64_tr_b16 v[78:79], v2 offset:15872
    s_waitcnt vmcnt(6)
    v_bitop3_b32 v95, v176, v180, 1 bitop3:0x80
    v_cmp_eq_u32 vcc, 0, v95
    s_cbranch_vccnz gst_182
gbk_183:
    s_waitcnt lgkmcnt(8)
    v_mfma_f32_32x32x16_bf16 v[16:31], v[64:67], v[176:179], v[16:31]
    s_add_u32 s3, s100, 20480
    buffer_load_dwordx4 v[208:211], v1, s[48:51], s3 offen offset:0 sc1
    ds_read_b64_tr_b16 v[64:65], v2 offset:16384
    ds_read_b64_tr_b16 v[66:67], v2 offset:16896
    s_waitcnt lgkmcnt(8)
    v_mfma_f32_32x32x16_bf16 v[16:31], v[68:71], v[180:183], v[16:31]
    buffer_load_dwordx4 v[212:215], v1, s[48:51], s3 offen offset:1024 sc1
    ds_write_b128 v82, a[92:95] offset:39936
    ds_read_b64_tr_b16 v[68:69], v2 offset:17408
    ds_read_b64_tr_b16 v[70:71], v2 offset:17920
    s_waitcnt vmcnt(6)
    v_bitop3_b32 v95, v184, v188, 1 bitop3:0x80
    v_cmp_eq_u32 vcc, 0, v95
    s_cbranch_vccnz gst_186
gbk_187:
    s_waitcnt lgkmcnt(8)
    v_mfma_f32_32x32x16_bf16 v[16:31], v[72:75], v[184:187], v[16:31]
    buffer_load_dwordx4 v[216:219], v1, s[48:51], s3 offen offset:2048 sc1
    ds_read_b64_tr_b16 v[72:73], v2 offset:18432
    ds_read_b64_tr_b16 v[74:75], v2 offset:18944
    s_waitcnt lgkmcnt(7)
    v_mfma_f32_32x32x16_bf16 v[16:31], v[76:79], v[188:191], v[16:31]
    buffer_load_dwordx4 v[220:223], v1, s[48:51], s3 offen offset:3072 sc1
    ds_write_b128 v83, a[0:3] offset:32768
    ds_read_b64_tr_b16 v[76:77], v2 offset:19456
    ds_read_b64_tr_b16 v[78:79], v2 offset:19968
    s_waitcnt vmcnt(6)
    v_bitop3_b32 v95, v192, v196, 1 bitop3:0x80
    v_cmp_eq_u32 vcc, 0, v95
    s_cbranch_vccnz gst_190
gbk_191:
    s_waitcnt lgkmcnt(8)
    v_mfma_f32_32x32x16_bf16 v[16:31], v[64:67], v[192:195], v[16:31]
    s_add_u32 s3, s100, 24576
    buffer_load_dwordx4 v[224:227], v1, s[48:51], s3 offen offset:0 sc1
    ds_read_b64_tr_b16 v[64:65], v2 offset:20480
    ds_read_b64_tr_b16 v[66:67], v2 offset:20992
    s_waitcnt lgkmcnt(7)
    v_mfma_f32_32x32x16_bf16 v[16:31], v[68:71], v[196:199], v[16:31]
    buffer_load_dwordx4 v[228:231], v1, s[48:51], s3 offen offset:1024 sc1
    ds_write_b128 v83, a[4:7] offset:33792
    ds_read_b64_tr_b16 v[68:69], v2 offset:21504
    ds_read_b64_tr_b16 v[70:71], v2 offset:22016
    s_waitcnt vmcnt(6)
    v_bitop3_b32 v95, v200, v204, 1 bitop3:0x80
    v_cmp_eq_u32 vcc, 0, v95
    s_cbranch_vccnz gst_194
gbk_195:
    s_waitcnt lgkmcnt(8)
    v_mfma_f32_32x32x16_bf16 v[16:31], v[72:75], v[200:203], v[16:31]
    buffer_load_dwordx4 v[232:235], v1, s[48:51], s3 offen offset:2048 sc1
    ds_read_b64_tr_b16 v[72:73], v2 offset:22528
    ds_read_b64_tr_b16 v[74:75], v2 offset:23040
    s_waitcnt lgkmcnt(7)
    v_mfma_f32_32x32x16_bf16 v[16:31], v[76:79], v[204:207], v[16:31]
    buffer_load_dwordx4 v[236:239], v1, s[48:51], s3 offen offset:3072 sc1
    ds_write_b128 v83, a[8:11] offset:34816
    ds_read_b64_tr_b16 v[76:77], v2 offset:23552
    ds_read_b64_tr_b16 v[78:79], v2 offset:24064
    s_waitcnt vmcnt(6)
    v_bitop3_b32 v95, v208, v212, 1 bitop3:0x80
    v_cmp_eq_u32 vcc, 0, v95
    s_cbranch_vccnz gst_198
gbk_199:
    s_waitcnt lgkmcnt(8)
    v_mfma_f32_32x32x16_bf16 v[16:31], v[64:67], v[208:211], v[16:31]
    s_add_u32 s3, s100, 28672
    buffer_load_dwordx4 v[240:243], v1, s[48:51], s3 offen offset:0 sc1
    ds_write_b128 v83, a[12:15] offset:35840
    ds_read_b64_tr_b16 v[64:65], v2 offset:24576
    ds_read_b64_tr_b16 v[66:67], v2 offset:25088
    s_waitcnt lgkmcnt(8)
    v_mfma_f32_32x32x16_bf16 v[16:31], v[68:71], v[212:215], v[16:31]
    buffer_load_dwordx4 v[244:247], v1, s[48:51], s3 offen offset:1024 sc1
    ds_read_b64_tr_b16 v[68:69], v2 offset:25600
    ds_read_b64_tr_b16 v[70:71], v2 offset:26112
    s_waitcnt vmcnt(6)
    v_bitop3_b32 v95, v216, v220, 1 bitop3:0x80
    v_cmp_eq_u32 vcc, 0, v95
    s_cbranch_vccnz gst_202
gbk_203:
    s_waitcnt lgkmcnt(8)
    v_mfma_f32_32x32x16_bf16 v[16:31], v[72:75], v[216:219], v[16:31]
    buffer_load_dwordx4 v[248:251], v1, s[48:51], s3 offen offset:2048 sc1
    ds_write_b128 v83, a[16:19] offset:36864
    ds_read_b64_tr_b16 v[72:73], v2 offset:26624
    ds_read_b64_tr_b16 v[74:75], v2 offset:27136
    s_waitcnt lgkmcnt(8)
    v_mfma_f32_32x32x16_bf16 v[16:31], v[76:79], v[220:223], v[16:31]
    buffer_load_dwordx4 v[252:255], v1, s[48:51], s3 offen offset:3072 sc1
    ds_read_b64_tr_b16 v[76:77], v2 offset:27648
    ds_read_b64_tr_b16 v[78:79], v2 offset:28160
    s_waitcnt vmcnt(6)
    v_bitop3_b32 v95, v224, v228, 1 bitop3:0x80
    v_cmp_eq_u32 vcc, 0, v95
    s_cbranch_vccnz gst_206
gbk_207:
    s_waitcnt lgkmcnt(7)
    v_mfma_f32_32x32x16_bf16 v[16:31], v[64:67], v[224:227], v[16:31]
    ds_write_b128 v83, a[20:23] offset:37888
    ds_read_b64_tr_b16 v[64:65], v2 offset:28672
    ds_read_b64_tr_b16 v[66:67], v2 offset:29184
    s_waitcnt lgkmcnt(8)
    v_mfma_f32_32x32x16_bf16 v[16:31], v[68:71], v[228:231], v[16:31]
    ds_read_b64_tr_b16 v[68:69], v2 offset:29696
    ds_read_b64_tr_b16 v[70:71], v2 offset:30208
    s_waitcnt vmcnt(4)
    v_bitop3_b32 v95, v232, v236, 1 bitop3:0x80
    v_cmp_eq_u32 vcc, 0, v95
    s_cbranch_vccnz gst_210
gbk_211:
    s_waitcnt lgkmcnt(7)
    v_mfma_f32_32x32x16_bf16 v[16:31], v[72:75], v[232:235], v[16:31]
    ds_write_b128 v83, a[24:27] offset:38912
    ds_read_b64_tr_b16 v[72:73], v2 offset:30720
    ds_read_b64_tr_b16 v[74:75], v2 offset:31232
    s_waitcnt lgkmcnt(8)
    v_mfma_f32_32x32x16_bf16 v[16:31], v[76:79], v[236:239], v[16:31]
    ds_read_b64_tr_b16 v[76:77], v2 offset:31744
    ds_read_b64_tr_b16 v[78:79], v2 offset:32256
    s_waitcnt vmcnt(2)
    v_bitop3_b32 v95, v240, v244, 1 bitop3:0x80
    v_cmp_eq_u32 vcc, 0, v95
    s_cbranch_vccnz gst_214
gbk_215:
    s_waitcnt lgkmcnt(7)
    v_mfma_f32_32x32x16_bf16 v[16:31], v[64:67], v[240:243], v[16:31]
    ds_write_b128 v83, a[28:31] offset:39936
    s_waitcnt lgkmcnt(6)
    v_mfma_f32_32x32x16_bf16 v[16:31], v[68:71], v[244:247], v[16:31]
    s_waitcnt vmcnt(0)
    v_bitop3_b32 v95, v248, v252, 1 bitop3:0x80
    v_cmp_eq_u32 vcc, 0, v95
    s_cbranch_vccnz gst_218
gbk_219:
    s_waitcnt lgkmcnt(3)
    v_mfma_f32_32x32x16_bf16 v[16:31], v[72:75], v[248:251], v[16:31]
    s_waitcnt lgkmcnt(1)
    v_mfma_f32_32x32x16_bf16 v[16:31], v[76:79], v[252:255], v[16:31]
    s_nop 10
    s_nop 0
    v_cvt_pk_bf16_f32 v8, v16, v17
    v_cvt_pk_bf16_f32 v12, v24, v25
    v_add_u32 v16, 0x8000, v16
    v_add_u32 v24, 0x8000, v24
    v_cvt_pk_bf16_f32 v16, v16, v17
    v_cvt_pk_bf16_f32 v17, v18, v19
    v_cvt_pk_bf16_f32 v18, v20, v21
    v_cvt_pk_bf16_f32 v19, v22, v23
    v_cvt_pk_bf16_f32 v20, v24, v25
    v_cvt_pk_bf16_f32 v21, v26, v27
    v_cvt_pk_bf16_f32 v22, v28, v29
    v_cvt_pk_bf16_f32 v23, v30, v31
    v_and_b32 v16, -2, v16
    v_and_b32 v20, -2, v20
    s_cmp_lg_u32 s63, 0
    s_nop 0
    s_cbranch_scc0 fast_222
    buffer_store_dwordx4 v[16:19], v1, s[48:51], s61 offen
    buffer_store_dwordx4 v[20:23], v1, s[48:51], s61 offen offset:1024
    v_mov_b32 v94, 0
    v_mov_b32 v95, 0
    v_dot2c_f32_bf16 v94, s22, v16
    v_dot2c_f32_bf16 v95, v16, v16
    v_dot2c_f32_bf16 v94, s22, v17
    v_dot2c_f32_bf16 v95, v17, v17
    v_dot2c_f32_bf16 v94, s22, v18
    v_dot2c_f32_bf16 v95, v18, v18
    v_dot2c_f32_bf16 v94, s22, v19
    v_dot2c_f32_bf16 v95, v19, v19
    v_dot2c_f32_bf16 v94, s22, v20
    v_dot2c_f32_bf16 v95, v20, v20
    v_dot2c_f32_bf16 v94, s22, v21
    v_dot2c_f32_bf16 v95, v21, v21
    v_dot2c_f32_bf16 v94, s22, v22
    v_dot2c_f32_bf16 v95, v22, v22
    v_dot2c_f32_bf16 v94, s22, v23
    v_dot2c_f32_bf16 v95, v23, v23
    s_nop 1
    v_mov_b32 v92, v94
    v_mov_b32 v93, v95
    s_nop 0
    v_permlane32_swap_b32 v92, v94
    v_permlane32_swap_b32 v93, v95
    v_pk_add_f32 v[94:95], v[94:95], v[92:93]
    v_and_b32 v94, -2, v94
    buffer_store_dwordx2 v[94:95], v6, s[48:51], s101 offen
    s_nop 0
dend_223:
    v_mov_b32 v9, v17
    v_mov_b32 v10, v18
    v_mov_b32 v11, v19
    v_mov_b32 v13, v21
    v_mov_b32 v14, v22
    v_mov_b32_e64 v15, v23
    s_xor_b32 s62, s62, 0
    s_waitcnt lgkmcnt(0)
    s_barrier
    s_add_u32 s3, s60, 0
    buffer_load_dwordx4 v[128:131], v1, s[48:51], s3 offen offset:0 sc1
    buffer_load_dwordx4 v[132:135], v1, s[48:51], s3 offen offset:1024 sc1
    buffer_load_dwordx4 v[136:139], v1, s[48:51], s3 offen offset:2048 sc1
    buffer_load_dwordx4 v[140:143], v1, s[48:51], s3 offen offset:3072 sc1
    s_add_u32 s3, s60, 4096
    buffer_load_dwordx4 v[144:147], v1, s[48:51], s3 offen offset:0 sc1
    buffer_load_dwordx4 v[148:151], v1, s[48:51], s3 offen offset:1024 sc1
    buffer_load_dwordx4 v[152:155], v1, s[48:51], s3 offen offset:2048 sc1
    buffer_load_dwordx4 v[156:159], v1, s[48:51], s3 offen offset:3072 sc1
    ds_read_b128 v[64:67], v4 offset:0
    ds_read_b128 v[68:71], v1 offset:32768
    ds_read_b128 v[72:75], v4 offset:1024
    ds_read_b128 v[76:79], v1 offset:33792
    ds_read_b128 v[112:115], v4 offset:32768
    ds_read_b128 v[116:119], v4 offset:33792
    ds_read_b128 v[80:83], v4 offset:2048
    ds_read_b128 v[84:87], v1 offset:34816
    s_waitcnt vmcnt(6)
    v_bitop3_b32 v95, v128, v132, 1 bitop3:0x2
    v_cmp_eq_u32 vcc, 0, v95
    s_cbranch_vccnz gst_224
gbk_225:
    s_waitcnt lgkmcnt(6)
    v_mfma_f32_32x32x16_bf16 v[32:47], v[64:67], v[128:131], 0
    s_add_u32 s3, s60, 8192
    buffer_load_dwordx4 v[160:163], v1, s[48:51], s3 offen offset:0 sc1
    ds_read_b128 v[64:67], v4 offset:3072
    v_mfma_f32_32x32x16_bf16 v[48:63], v[128:131], v[68:71], 0
    ds_read_b128 v[68:71], v1 offset:35840
    s_waitcnt lgkmcnt(6)
    v_mfma_f32_32x32x16_bf16 v[32:47], v[72:75], v[132:135], v[32:47]
    buffer_load_dwordx4 v[164:167], v1, s[48:51], s3 offen offset:1024 sc1
    ds_read_b128 v[72:75], v4 offset:4096
    s_waitcnt vmcnt(6)
    v_bitop3_b32 v95, v136, v140, 1 bitop3:0x2
    v_cmp_eq_u32 vcc, 0, v95
    v_mfma_f32_32x32x16_bf16 v[48:63], v[132:135], v[76:79], v[48:63]
    ds_read_b128 v[76:79], v1 offset:36864
    s_cbranch_vccnz gst_228
gbk_229:
    s_waitcnt lgkmcnt(7)
    v_mfma_f32_32x32x16_bf16 v[16:31], v[112:115], v[128:131], 0
    ds_read_b128 v[120:123], v4 offset:34816
    s_waitcnt lgkmcnt(5)
    v_mfma_f32_32x32x16_bf16 v[32:47], v[80:83], v[136:139], v[32:47]
    buffer_load_dwordx4 v[168:171], v1, s[48:51], s3 offen offset:2048 sc1
    ds_read_b128 v[80:83], v4 offset:5120
    v_mfma_f32_32x32x16_bf16 v[48:63], v[136:139], v[84:87], v[48:63]
    ds_read_b128 v[84:87], v1 offset:37888
    s_waitcnt lgkmcnt(5)
    v_mfma_f32_32x32x16_bf16 v[32:47], v[64:67], v[140:143], v[32:47]
    buffer_load_dwordx4 v[172:175], v1, s[48:51], s3 offen offset:3072 sc1
    ds_read_b128 v[64:67], v4 offset:6144
    s_waitcnt vmcnt(6)
    v_bitop3_b32 v95, v144, v148, 1 bitop3:0x2
    v_cmp_eq_u32 vcc, 0, v95
    v_mfma_f32_32x32x16_bf16 v[48:63], v[140:143], v[68:71], v[48:63]
    ds_read_b128 v[68:71], v1 offset:38912
    s_cbranch_vccnz gst_232
gbk_233:
    v_mfma_f32_32x32x16_bf16 v[16:31], v[116:119], v[132:135], v[16:31]
    ds_read_b128 v[124:127], v4 offset:35840
    buffer_load_dwordx4 v[96:99], v1, s[48:51], s101 offen offset:0 sc1
    buffer_load_dwordx4 v[100:103], v1, s[48:51], s101 offen offset:1024 sc1
    buffer_load_dwordx4 v[104:107], v1, s[48:51], s101 offen offset:2048 sc1
    s_waitcnt lgkmcnt(6)
    v_mfma_f32_32x32x16_bf16 v[32:47], v[72:75], v[144:147], v[32:47]
    s_add_u32 s3, s60, 12288
    buffer_load_dwordx4 v[176:179], v1, s[48:51], s3 offen offset:0 sc1
    ds_read_b128 v[72:75], v4 offset:7168
    buffer_load_dwordx4 v[108:111], v1, s[48:51], s101 offen offset:3072 sc1
    v_mfma_f32_32x32x16_bf16 v[48:63], v[144:147], v[76:79], v[48:63]
    ds_read_b128 v[76:79], v1 offset:39936
    s_waitcnt lgkmcnt(5)
    v_mfma_f32_32x32x16_bf16 v[32:47], v[80:83], v[148:151], v[32:47]
    buffer_load_dwordx4 v[180:183], v1, s[48:51], s3 offen offset:1024 sc1
    ds_read_b128 v[80:83], v4 offset:8192
    s_waitcnt vmcnt(10)
    v_bitop3_b32 v95, v152, v156, 1 bitop3:0x2
    v_cmp_eq_u32 vcc, 0, v95
    v_mfma_f32_32x32x16_bf16 v[48:63], v[148:151], v[84:87], v[48:63]
    ds_read_b128 v[84:87], v1 offset:40960
    s_cbranch_vccnz gst_236
gbk_237:
    v_mfma_f32_32x32x16_bf16 v[16:31], v[120:123], v[136:139], v[16:31]
    ds_read_b128 v[112:115], v4 offset:36864
    s_waitcnt lgkmcnt(6)
    v_mfma_f32_32x32x16_bf16 v[32:47], v[64:67], v[152:155], v[32:47]
    buffer_load_dwordx4 v[184:187], v1, s[48:51], s3 offen offset:2048 sc1
    ds_read_b128 v[64:67], v4 offset:9216
    v_mfma_f32_32x32x16_bf16 v[48:63], v[152:155], v[68:71], v[48:63]
    ds_read_b128 v[68:71], v1 offset:41984
    s_waitcnt lgkmcnt(5)
    v_mfma_f32_32x32x16_bf16 v[32:47], v[72:75], v[156:159], v[32:47]
    buffer_load_dwordx4 v[188:191], v1, s[48:51], s3 offen offset:3072 sc1
    ds_read_b128 v[72:75], v4 offset:10240
    s_waitcnt vmcnt(10)
    v_bitop3_b32 v95, v160, v164, 1 bitop3:0x2
    v_cmp_eq_u32 vcc, 0, v95
    v_mfma_f32_32x32x16_bf16 v[48:63], v[156:159], v[76:79], v[48:63]
    ds_read_b128 v[76:79], v1 offset:43008
    s_cbranch_vccnz gst_240
gbk_241:
    v_mfma_f32_32x32x16_bf16 v[16:31], v[124:127], v[140:143], v[16:31]
    ds_read_b128 v[116:119], v4 offset:37888
    s_waitcnt lgkmcnt(6)
    v_mfma_f32_32x32x16_bf16 v[32:47], v[80:83], v[160:163], v[32:47]
    s_add_u32 s3, s60, 16384
    buffer_load_dwordx4 v[192:195], v1, s[48:51], s3 offen offset:0 sc1
    ds_read_b128 v[80:83], v4 offset:11264
    v_mfma_f32_32x32x16_bf16 v[48:63], v[160:163], v[84:87], v[48:63]
    ds_read_b128 v[84:87], v1 offset:44032
    s_waitcnt lgkmcnt(5)
    v_mfma_f32_32x32x16_bf16 v[32:47], v[64:67], v[164:167], v[32:47]
    buffer_load_dwordx4 v[196:199], v1, s[48:51], s3 offen offset:1024 sc1
    ds_read_b128 v[64:67], v4 offset:12288
    s_waitcnt vmcnt(10)
    v_bitop3_b32 v95, v168, v172, 1 bitop3:0x2
    v_cmp_eq_u32 vcc, 0, v95
    v_mfma_f32_32x32x16_bf16 v[48:63], v[164:167], v[68:71], v[48:63]
    ds_read_b128 v[68:71], v1 offset:45056
    s_cbranch_vccnz gst_244
gbk_245:
    v_mfma_f32_32x32x16_bf16 v[16:31], v[112:115], v[144:147], v[16:31]
    ds_read_b128 v[120:123], v4 offset:38912
    s_waitcnt lgkmcnt(6)
    v_mfma_f32_32x32x16_bf16 v[32:47], v[72:75], v[168:171], v[32:47]
    buffer_load_dwordx4 v[200:203], v1, s[48:51], s3 offen offset:2048 sc1
    ds_read_b128 v[72:75], v4 offset:13312
    v_mfma_f32_32x32x16_bf16 v[48:63], v[168:171], v[76:79], v[48:63]
    ds_read_b128 v[76:79], v1 offset:46080
    s_waitcnt lgkmcnt(5)
    v_mfma_f32_32x32x16_bf16 v[32:47], v[80:83], v[172:175], v[32:47]
    buffer_load_dwordx4 v[204:207], v1, s[48:51], s3 offen offset:3072 sc1
    ds_read_b128 v[80:83], v4 offset:14336
    s_waitcnt vmcnt(6)
    v_bitop3_b32 v95, v176, v180, 1 bitop3:0x2
    v_cmp_eq_u32_e64 vcc, 0, v95
    v_mfma_f32_32x32x16_bf16 v[48:63], v[172:175], v[84:87], v[48:63]
    ds_read_b128 v[84:87], v1 offset:47104
    s_cbranch_vccnz gst_248
gbk_249:
    v_mfma_f32_32x32x16_bf16 v[16:31], v[116:119], v[148:151], v[16:31]
    ds_read_b128 v[124:127], v4 offset:39936
    s_waitcnt lgkmcnt(6)
    v_mfma_f32_32x32x16_bf16 v[32:47], v[64:67], v[176:179], v[32:47]
    s_add_u32 s3, s60, 20480
    buffer_load_dwordx4 v[208:211], v1, s[48:51], s3 offen offset:0 sc1
    ds_read_b128 v[64:67], v4 offset:15360
    v_mfma_f32_32x32x16_bf16 v[48:63], v[176:179], v[68:71], v[48:63]
    ds_read_b128 v[68:71], v1 offset:48128
    v_bitop3_b32 v93, v96, v98, v100 bitop3:0xfe
    v_bitop3_b32 v93, v93, v102, v104 bitop3:0xfe
    v_bitop3_b32 v93, v93, v106, v108 bitop3:0xfe
    s_waitcnt lgkmcnt(5)
    v_mfma_f32_32x32x16_bf16 v[32:47], v[72:75], v[180:183], v[32:47]
    buffer_load_dwordx4 v[212:215], v1, s[48:51], s3 offen offset:1024 sc1
    ds_read_b128 v[72:75], v4 offset:16384
    s_waitcnt vmcnt(6)
    v_bitop3_b32 v95, v184, v188, 1 bitop3:0x2
    v_cmp_eq_u32 vcc, 0, v95
    v_mfma_f32_32x32x16_bf16 v[48:63], v[180:183], v[76:79], v[48:63]
    ds_read_b128 v[76:79], v1 offset:49152
    s_cbranch_vccnz gst_252
gbk_253:
    v_bitop3_b32 v93, v93, v110, 1 bitop3:0x2
    v_cmp_eq_u32 s[10:11], 0, v93
    v_mfma_f32_32x32x16_bf16 v[16:31], v[120:123], v[152:155], v[16:31]
    s_cmp_lg_u64 s[10:11], 0
    s_cbranch_scc1 sst_256
sbk_257:
    v_add_f32 v96, v96, v98
    s_waitcnt lgkmcnt(5)
    v_mfma_f32_32x32x16_bf16 v[32:47], v[80:83], v[184:187], v[32:47]
    buffer_load_dwordx4 v[216:219], v1, s[48:51], s3 offen offset:2048 sc1
    ds_read_b128 v[80:83], v4 offset:17408
    v_add_f32 v97, v97, v99
    v_add_f32 v100, v100, v102
    v_add_f32 v101, v101, v103
    v_mfma_f32_32x32x16_bf16 v[48:63], v[184:187], v[84:87], v[48:63]
    ds_read_b128 v[84:87], v1 offset:50176
    v_add_f32 v104, v104, v106
    v_add_f32 v105, v105, v107
    v_add_f32 v108, v108, v110
    s_waitcnt lgkmcnt(4)
    v_mfma_f32_32x32x16_bf16 v[32:47], v[64:67], v[188:191], v[32:47]
    buffer_load_dwordx4 v[220:223], v1, s[48:51], s3 offen offset:3072 sc1
    ds_read_b128 v[64:67], v4 offset:18432
    s_waitcnt vmcnt(6)
    v_bitop3_b32 v95, v192, v196, 1 bitop3:0x2
    v_cmp_eq_u32 vcc, 0, v95
    v_mfma_f32_32x32x16_bf16 v[48:63], v[188:191], v[68:71], v[48:63]
    ds_read_b128 v[68:71], v1 offset:51200
    s_cbranch_vccnz gst_260
gbk_261:
    v_add_f32 v109, v109, v111
    v_add_f32 v96, v96, v100
    v_mfma_f32_32x32x16_bf16 v[16:31], v[124:127], v[156:159], v[16:31]
    v_add_f32 v97, v97, v101
    v_add_f32 v104, v104, v108
    v_add_f32 v105, v105, v109
    v_add_f32 v96, v96, v104
    s_waitcnt lgkmcnt(4)
    v_mfma_f32_32x32x16_bf16 v[32:47], v[72:75], v[192:195], v[32:47]
    s_add_u32 s3, s60, 24576
    buffer_load_dwordx4 v[224:227], v1, s[48:51], s3 offen offset:0 sc1
    ds_read_b128 v[72:75], v4 offset:19456
    v_add_f32 v97, v97, v105
    v_mov_b32 v98, v96
    v_mfma_f32_32x32x16_bf16 v[48:63], v[192:195], v[76:79], v[48:63]
    ds_read_b128 v[76:79], v1 offset:52224
    v_mov_b32 v99, v97
    v_permlane32_swap_b32 v98, v96
    s_nop 0
    v_permlane32_swap_b32 v99, v97
    s_waitcnt lgkmcnt(4)
    v_mfma_f32_32x32x16_bf16 v[32:47], v[80:83], v[196:199], v[32:47]
    buffer_load_dwordx4 v[228:231], v1, s[48:51], s3 offen offset:1024 sc1
    ds_read_b128 v[80:83], v4 offset:20480
    s_waitcnt vmcnt(6)
    v_bitop3_b32 v95, v200, v204, 1 bitop3:0x2
    v_cmp_eq_u32 vcc, 0, v95
    v_mfma_f32_32x32x16_bf16 v[48:63], v[196:199], v[84:87], v[48:63]
    ds_read_b128 v[84:87], v1 offset:53248
    s_cbranch_vccnz gst_264
gbk_265:
    v_add_f32 v96, v96, v98
    v_add_f32 v97, v97, v99
    s_waitcnt lgkmcnt(4)
    v_mfma_f32_32x32x16_bf16 v[32:47], v[64:67], v[200:203], v[32:47]
    buffer_load_dwordx4 v[232:235], v1, s[48:51], s3 offen offset:2048 sc1
    ds_read_b128 v[64:67], v4 offset:21504
    v_mul_f32 v96, 0x3b000000, v96
    v_mul_f32 v97, 0x3b000000, v97
    v_fma_f32 v97, -v96, v96, v97
    v_mfma_f32_32x32x16_bf16 v[48:63], v[200:203], v[68:71], v[48:63]
    ds_read_b128 v[68:71], v1 offset:54272
    v_max_f32 v97, 0, v97
    v_add_f32 v97, 0x3727c5ac, v97
    v_rsq_f32 v88, v97
    s_waitcnt lgkmcnt(4)
    v_mfma_f32_32x32x16_bf16 v[32:47], v[72:75], v[204:207], v[32:47]
    buffer_load_dwordx4 v[236:239], v1, s[48:51], s3 offen offset:3072 sc1
    ds_read_b128 v[72:75], v4 offset:22528
    s_waitcnt vmcnt(6)
    v_bitop3_b32 v95, v208, v212, 1 bitop3:0x2
    v_cmp_eq_u32 vcc, 0, v95
    v_mfma_f32_32x32x16_bf16 v[48:63], v[204:207], v[76:79], v[48:63]
    ds_read_b128 v[76:79], v1 offset:55296
    s_cbranch_vccnz gst_268
gbk_269:
    v_mul_f32_e64 v90, v96, v88
    s_lshl_b32 s5, s58, 8
    s_waitcnt lgkmcnt(4)
    v_mfma_f32_32x32x16_bf16 v[32:47], v[80:83], v[208:211], v[32:47]
    s_add_u32 s3, s60, 28672
    buffer_load_dwordx4 v[240:243], v1, s[48:51], s3 offen offset:0 sc1
    ds_read_b128 v[80:83], v4 offset:23552
    s_add_u32 s5, s5, 147456
    v_lshl_add_u32 v98, v0, 2, s5
    v_mfma_f32_32x32x16_bf16 v[48:63], v[208:211], v[84:87], v[48:63]
    ds_read_b128 v[84:87], v1 offset:56320
    v_cndmask_b32 v99, v88, v90, s[12:13]
    ds_write_b32 v98, v99
    v_lshrrev_b32 v89, 5, v0
    s_waitcnt lgkmcnt(5)
    v_mfma_f32_32x32x16_bf16 v[32:47], v[64:67], v[212:215], v[32:47]
    buffer_load_dwordx4 v[244:247], v1, s[48:51], s3 offen offset:1024 sc1
    ds_read_b128 v[64:67], v4 offset:24576
    s_waitcnt vmcnt(6)
    v_bitop3_b32 v95, v216, v220, 1 bitop3:0x2
    v_cmp_eq_u32 vcc, 0, v95
    v_mfma_f32_32x32x16_bf16 v[48:63], v[212:215], v[68:71], v[48:63]
    ds_read_b128 v[68:71], v1 offset:57344
    s_cbranch_vccnz gst_272
gbk_273:
    v_lshlrev_b32 v91, 4, v89
    v_add_u32 v89, s5, v91
    s_waitcnt lgkmcnt(5)
    v_mfma_f32_32x32x16_bf16 v[32:47], v[72:75], v[216:219], v[32:47]
    buffer_load_dwordx4 v[248:251], v1, s[48:51], s3 offen offset:2048 sc1
    ds_read_b128 v[72:75], v4 offset:25600
    v_add_u32 v91, 0x24400, v91
    ds_read_b128 v[96:99], v89 offset:0
    ds_read_b128 v[128:131], v89 offset:128
    v_mfma_f32_32x32x16_bf16 v[48:63], v[216:219], v[76:79], v[48:63]
    ds_read_b128 v[76:79], v1 offset:58368
    ds_read_b128 v[100:103], v89 offset:32
    ds_read_b128 v[132:135], v89 offset:160
    ds_read_b128 v[104:107], v89 offset:64
    s_waitcnt lgkmcnt(10)
    v_mfma_f32_32x32x16_bf16 v[32:47], v[80:83], v[220:223], v[32:47]
    buffer_load_dwordx4 v[252:255], v1, s[48:51], s3 offen offset:3072 sc1
    ds_read_b128 v[80:83], v4 offset:26624
    s_waitcnt vmcnt(6)
    v_bitop3_b32 v95, v224, v228, 1 bitop3:0x2
    v_cmp_eq_u32 vcc, 0, v95
    v_mfma_f32_32x32x16_bf16 v[48:63], v[220:223], v[84:87], v[48:63]
    ds_read_b128 v[84:87], v1 offset:59392
    s_cbranch_vccnz gst_276
gbk_277:
    ds_read_b128 v[136:139], v89 offset:192
    ds_read_b128 v[108:111], v89 offset:96
    s_waitcnt lgkmcnt(11)
    v_mfma_f32_32x32x16_bf16 v[32:47], v[64:67], v[224:227], v[32:47]
    ds_read_b128 v[64:67], v4 offset:27648
    ds_read_b128 v[140:143], v89 offset:224
    v_and_b32 v93, 31, v0
    v_lshlrev_b32_e64 v93, 2, v93
    v_add_u32 v93, 0x24400, v93
    v_mfma_f32_32x32x16_bf16 v[48:63], v[224:227], v[68:71], v[48:63]
    ds_read_b128 v[68:71], v1 offset:60416
    ds_read_b32 v92, v93 offset:256
    ds_read_b128 v[144:147], v91 offset:128
    ds_read_b128 v[148:151], v91 offset:160
    s_waitcnt lgkmcnt(13)
    v_mfma_f32_32x32x16_bf16 v[32:47], v[72:75], v[228:231], v[32:47]
    ds_read_b128 v[72:75], v4 offset:28672
    ds_read_b128 v[152:155], v91 offset:192
    s_waitcnt vmcnt(4)
    v_bitop3_b32 v95, v232, v236, 1 bitop3:0x2
    v_cmp_eq_u32 vcc, 0, v95
    v_mfma_f32_32x32x16_bf16 v[48:63], v[228:231], v[76:79], v[48:63]
    ds_read_b128 v[76:79], v1 offset:61440
    s_cbranch_vccnz gst_280
gbk_281:
    ds_read_b128 v[156:159], v91 offset:224
    s_waitcnt lgkmcnt(12)
    v_mfma_f32_32x32x16_bf16 v[32:47], v[80:83], v[232:235], v[32:47]
    ds_read_b128 v[80:83], v4 offset:29696
    v_mfma_f32_32x32x16_bf16 v[48:63], v[232:235], v[84:87], v[48:63]
    ds_read_b128 v[84:87], v1 offset:62464
    s_waitcnt lgkmcnt(9)
    v_mfma_f32_32x32x16_bf16 v[32:47], v[64:67], v[236:239], v[32:47]
    ds_read_b128 v[64:67], v4 offset:30720
    s_waitcnt vmcnt(2)
    v_bitop3_b32 v95, v240, v244, 1 bitop3:0x2
    v_cmp_eq_u32 vcc, 0, v95
    v_mfma_f32_32x32x16_bf16 v[48:63], v[236:239], v[68:71], v[48:63]
    ds_read_b128 v[68:71], v1 offset:63488
    s_cbranch_vccnz gst_284
gbk_285:
    s_waitcnt lgkmcnt(5)
    v_mfma_f32_32x32x16_bf16 v[32:47], v[72:75], v[240:243], v[32:47]
    ds_read_b128 v[72:75], v4 offset:31744
    v_mfma_f32_32x32x16_bf16 v[48:63], v[240:243], v[76:79], v[48:63]
    ds_read_b128 v[76:79], v1 offset:64512
    s_waitcnt lgkmcnt(4)
    v_mfma_f32_32x32x16_bf16 v[32:47], v[80:83], v[244:247], v[32:47]
    s_waitcnt vmcnt(0)
    v_bitop3_b32 v95, v248, v252, 1 bitop3:0x2
    v_cmp_eq_u32 vcc, 0, v95
    v_mfma_f32_32x32x16_bf16 v[48:63], v[244:247], v[84:87], v[48:63]
    s_cbranch_vccnz gst_288
gbk_289:
    s_waitcnt lgkmcnt(2)
    v_mfma_f32_32x32x16_bf16 v[32:47], v[64:67], v[248:251], v[32:47]
    v_mfma_f32_32x32x16_bf16 v[48:63], v[248:251], v[68:71], v[48:63]
    s_waitcnt lgkmcnt(0)
    v_mfma_f32_32x32x16_bf16 v[32:47], v[72:75], v[252:255], v[32:47]
    v_mfma_f32_32x32x16_bf16 v[48:63], v[252:255], v[76:79], v[48:63]
    s_lshl_b32 s4, s59, 4
    s_add_u32 s4, s4, s57
    s_lshl_b32 s4, s4, 12
    s_add_u32 s4, s4, 0x800000
    s_nop 6
    v_pk_mul_f32 v[32:33], v[32:33], v[88:89] op_sel_hi:[1,0]
    v_pk_mul_f32 v[34:35], v[34:35], v[88:89] op_sel_hi:[1,0]
    v_pk_mul_f32 v[36:37], v[36:37], v[88:89] op_sel_hi:[1,0]
    v_pk_mul_f32 v[38:39], v[38:39], v[88:89] op_sel_hi:[1,0]
    v_pk_mul_f32 v[40:41], v[40:41], v[88:89] op_sel_hi:[1,0]
    v_pk_mul_f32 v[42:43], v[42:43], v[88:89] op_sel_hi:[1,0]
    v_pk_mul_f32 v[44:45], v[44:45], v[88:89] op_sel_hi:[1,0]
    v_pk_mul_f32 v[46:47], v[46:47], v[88:89] op_sel_hi:[1,0]
    v_pk_fma_f32 v[32:33], v[144:145], v[90:91], v[32:33] op_sel_hi:[1,0,1] neg_lo:[0,1,0] neg_hi:[0,1,0]
    v_pk_fma_f32 v[34:35], v[146:147], v[90:91], v[34:35] op_sel_hi:[1,0,1] neg_lo:[0,1,0] neg_hi:[0,1,0]
    v_pk_fma_f32 v[36:37], v[148:149], v[90:91], v[36:37] op_sel_hi:[1,0,1] neg_lo:[0,1,0] neg_hi:[0,1,0]
    v_pk_fma_f32 v[38:39], v[150:151], v[90:91], v[38:39] op_sel_hi:[1,0,1] neg_lo:[0,1,0] neg_hi:[0,1,0]
    v_pk_fma_f32 v[40:41], v[152:153], v[90:91], v[40:41] op_sel_hi:[1,0,1] neg_lo:[0,1,0] neg_hi:[0,1,0]
    v_pk_fma_f32 v[42:43], v[154:155], v[90:91], v[42:43] op_sel_hi:[1,0,1] neg_lo:[0,1,0] neg_hi:[0,1,0]
    v_pk_fma_f32 v[44:45], v[156:157], v[90:91], v[44:45] op_sel_hi:[1,0,1] neg_lo:[0,1,0] neg_hi:[0,1,0]
    v_pk_fma_f32 v[46:47], v[158:159], v[90:91], v[46:47] op_sel_hi:[1,0,1] neg_lo:[0,1,0] neg_hi:[0,1,0]
    v_and_b32 v32, 0xffff0000, v32
    v_and_b32 v40, 0xffff0000, v40
    v_cvt_pk_bf16_f32 v32, v32, v33
    v_cvt_pk_bf16_f32 v33, v34, v35
    v_cvt_pk_bf16_f32 v34, v36, v37
    v_cvt_pk_bf16_f32 v35, v38, v39
    v_cvt_pk_bf16_f32 v36, v40, v41
    v_cvt_pk_bf16_f32 v37, v42, v43
    v_cvt_pk_bf16_f32 v38, v44, v45
    v_cvt_pk_bf16_f32 v39, v46, v47
    v_or_b32 v32, 1, v32
    v_or_b32 v36, 1, v36
    buffer_store_dwordx4 v[32:35], v1, s[48:51], s4 offen offset:0 sc0 sc1
    buffer_store_dwordx4 v[36:39], v1, s[48:51], s4 offen offset:1024 sc0 sc1
    v_pk_mul_f32 v[48:49], v[48:49], v[96:97]
    v_pk_mul_f32 v[50:51], v[50:51], v[98:99]
    v_pk_mul_f32 v[52:53], v[52:53], v[100:101]
    v_pk_mul_f32 v[54:55], v[54:55], v[102:103]
    v_pk_mul_f32 v[56:57], v[56:57], v[104:105]
    v_pk_mul_f32 v[58:59], v[58:59], v[106:107]
    v_pk_mul_f32 v[60:61], v[60:61], v[108:109]
    v_pk_mul_f32 v[62:63], v[62:63], v[110:111]
    v_pk_fma_f32 v[48:49], v[128:129], v[92:93], v[48:49] op_sel_hi:[1,0,1] neg_lo:[0,1,0] neg_hi:[0,1,0]
    v_pk_fma_f32 v[50:51], v[130:131], v[92:93], v[50:51] op_sel_hi:[1,0,1] neg_lo:[0,1,0] neg_hi:[0,1,0]
    v_pk_fma_f32 v[52:53], v[132:133], v[92:93], v[52:53] op_sel_hi:[1,0,1] neg_lo:[0,1,0] neg_hi:[0,1,0]
    v_pk_fma_f32 v[54:55], v[134:135], v[92:93], v[54:55] op_sel_hi:[1,0,1] neg_lo:[0,1,0] neg_hi:[0,1,0]
    v_pk_fma_f32 v[56:57], v[136:137], v[92:93], v[56:57] op_sel_hi:[1,0,1] neg_lo:[0,1,0] neg_hi:[0,1,0]
    v_pk_fma_f32 v[58:59], v[138:139], v[92:93], v[58:59] op_sel_hi:[1,0,1] neg_lo:[0,1,0] neg_hi:[0,1,0]
    v_pk_fma_f32 v[60:61], v[140:141], v[92:93], v[60:61] op_sel_hi:[1,0,1] neg_lo:[0,1,0] neg_hi:[0,1,0]
    v_pk_fma_f32 v[62:63], v[142:143], v[92:93], v[62:63] op_sel_hi:[1,0,1] neg_lo:[0,1,0] neg_hi:[0,1,0]
    v_and_b32 v48, 0xffff0000, v48
    v_and_b32 v56, 0xffff0000, v56
    v_cvt_pk_bf16_f32 v48, v48, v49
    v_cvt_pk_bf16_f32 v49, v50, v51
    v_cvt_pk_bf16_f32 v50, v52, v53
    v_cvt_pk_bf16_f32 v51, v54, v55
    v_cvt_pk_bf16_f32 v52, v56, v57
    v_cvt_pk_bf16_f32 v53, v58, v59
    v_cvt_pk_bf16_f32 v54, v60, v61
    v_cvt_pk_bf16_f32 v55, v62, v63
    v_or_b32 v48, 1, v48
    v_or_b32 v52, 1, v52
    buffer_store_dwordx4 v[48:51], v1, s[48:51], s4 offen offset:2048 sc0 sc1
    buffer_store_dwordx4 v[52:55], v1, s[48:51], s4 offen offset:3072 sc0 sc1
    v_mul_f32 v88, 0x3eb8aa3b, v88
    v_mul_f32 v90, 0x3eb8aa3b, v90
    ds_read_b128 v[64:67], v4 offset:40960
    ds_read_b128 v[68:71], v4 offset:41984
    ds_read_b128 v[72:75], v4 offset:43008
    s_waitcnt lgkmcnt(2)
    v_mfma_f32_32x32x16_bf16 v[16:31], v[64:67], v[160:163], v[16:31]
    ds_read_b128 v[76:79], v4 offset:44032
    ds_read_b128 v[112:115], v91 offset:0
    ds_read_b128 v[116:119], v91 offset:32
    ds_read_b128 v[120:123], v91 offset:64
    ds_read_b128 v[124:127], v91 offset:96
    s_waitcnt lgkmcnt(6)
    v_mfma_f32_32x32x16_bf16 v[16:31], v[68:71], v[164:167], v[16:31]
    ds_read_b128 v[64:67], v4 offset:45056
    ds_write_b128 v7, v[32:35] offset:32768
    s_lshr_b32 s4, s58, 1
    s_add_u32 s4, s4, s56
    s_sub_u32 s7, s4, 2
    s_and_b32 s10, s58, 1
    s_lshl_b32 s5, s7, 1
    s_add_u32 s5, s5, s10
    s_waitcnt lgkmcnt(7)
    v_mfma_f32_32x32x16_bf16 v[16:31], v[72:75], v[168:171], v[16:31]
    ds_read_b128 v[68:71], v4 offset:46080
    s_lshl_b32 s5, s5, 5
    s_add_u32 s5, s5, s57
    s_lshl_b32 s5, s5, 12
    s_add_u32 s20, s5, 0x800000
    s_cmp_lt_u32 s7, 16
    s_cselect_b32 s20, s20, 0x7f000000
    s_add_u32 s21, s20, 65536
    s_waitcnt lgkmcnt(7)
    v_mfma_f32_32x32x16_bf16 v[16:31], v[76:79], v[172:175], v[16:31]
    ds_read_b128 v[72:75], v4 offset:47104
    s_waitcnt lgkmcnt(3)
    v_mfma_f32_32x32x16_bf16 v[16:31], v[64:67], v[176:179], v[16:31]
    ds_read_b128 v[76:79], v4 offset:48128
    ds_write_b128 v7, v[36:39] offset:33792
    s_waitcnt lgkmcnt(3)
    v_mfma_f32_32x32x16_bf16 v[16:31], v[68:71], v[180:183], v[16:31]
    ds_read_b128 v[64:67], v4 offset:49152
    s_waitcnt lgkmcnt(3)
    v_mfma_f32_32x32x16_bf16 v[16:31], v[72:75], v[184:187], v[16:31]
    ds_read_b128 v[68:71], v4 offset:50176
    s_waitcnt lgkmcnt(3)
    v_mfma_f32_32x32x16_bf16 v[16:31], v[76:79], v[188:191], v[16:31]
    ds_read_b128 v[72:75], v4 offset:51200
    ds_write_b128 v7, v[48:51] offset:34816
    s_waitcnt lgkmcnt(3)
    v_mfma_f32_32x32x16_bf16 v[16:31], v[64:67], v[192:195], v[16:31]
    ds_read_b128 v[76:79], v4 offset:52224
    s_waitcnt lgkmcnt(3)
    v_mfma_f32_32x32x16_bf16 v[16:31], v[68:71], v[196:199], v[16:31]
    ds_read_b128 v[64:67], v4 offset:53248
    s_waitcnt lgkmcnt(3)
    v_mfma_f32_32x32x16_bf16 v[16:31], v[72:75], v[200:203], v[16:31]
    ds_read_b128 v[68:71], v4 offset:54272
    ds_write_b128 v7, v[52:55] offset:35840
    s_waitcnt lgkmcnt(3)
    v_mfma_f32_32x32x16_bf16 v[16:31], v[76:79], v[204:207], v[16:31]
    ds_read_b128 v[72:75], v4 offset:55296
    s_waitcnt lgkmcnt(3)
    v_mfma_f32_32x32x16_bf16 v[16:31], v[64:67], v[208:211], v[16:31]
    ds_read_b128 v[76:79], v4 offset:56320
    v_mov_b32 v32, s22
    v_mov_b32 v33, s22
    v_mov_b32 v34, s22
    v_mov_b32 v35, s22
    s_waitcnt lgkmcnt(3)
    v_mfma_f32_32x32x16_bf16 v[16:31], v[68:71], v[212:215], v[16:31]
    ds_read_b128 v[64:67], v4 offset:57344
    v_mov_b32 v36, s22
    v_mov_b32 v37, s22
    v_mov_b32 v38, s22
    v_mov_b32 v39, s22
    s_waitcnt lgkmcnt(2)
    v_mfma_f32_32x32x16_bf16 v[16:31], v[72:75], v[216:219], v[16:31]
    ds_read_b128 v[68:71], v4 offset:58368
    v_mov_b32 v40, s22
    v_mov_b32 v41, s22
    v_mov_b32 v42, s22
    v_mov_b32 v43, s22
    s_waitcnt lgkmcnt(2)
    v_mfma_f32_32x32x16_bf16 v[16:31], v[76:79], v[220:223], v[16:31]
    ds_read_b128 v[72:75], v4 offset:59392
    v_mov_b32 v44, s22
    v_mov_b32 v45, s22
    v_mov_b32 v46, s22
    v_mov_b32 v47, s22
    s_waitcnt lgkmcnt(2)
    v_mfma_f32_32x32x16_bf16 v[16:31], v[64:67], v[224:227], v[16:31]
    ds_read_b128 v[76:79], v4 offset:60416
    s_waitcnt lgkmcnt(2)
    v_mfma_f32_32x32x16_bf16 v[16:31], v[68:71], v[228:231], v[16:31]
    ds_read_b128 v[64:67], v4 offset:61440
    s_waitcnt lgkmcnt(2)
    v_mfma_f32_32x32x16_bf16 v[16:31], v[72:75], v[232:235], v[16:31]
    ds_read_b128 v[68:71], v4 offset:62464
    s_waitcnt lgkmcnt(2)
    v_mfma_f32_32x32x16_bf16 v[16:31], v[76:79], v[236:239], v[16:31]
    ds_read_b128 v[72:75], v4 offset:63488
    s_waitcnt lgkmcnt(2)
    v_mfma_f32_32x32x16_bf16 v[16:31], v[64:67], v[240:243], v[16:31]
    ds_read_b128 v[76:79], v4 offset:64512
    s_waitcnt lgkmcnt(2)
    v_mfma_f32_32x32x16_bf16 v[16:31], v[68:71], v[244:247], v[16:31]
    s_waitcnt lgkmcnt(1)
    v_mfma_f32_32x32x16_bf16 v[16:31], v[72:75], v[248:251], v[16:31]
    s_waitcnt lgkmcnt(0)
    v_mfma_f32_32x32x16_bf16 v[16:31], v[76:79], v[252:255], v[16:31]
    s_barrier
    s_lshl_b32 s4, s58, 13
    s_add_u32 m0, s4, 98304
    s_nop 0
    buffer_load_dwordx4 v1, s[48:51], s20 offen offset:0 sc1 lds
    buffer_load_dwordx4 v1, s[48:51], s20 offen offset:1024 sc1 lds
    buffer_load_dwordx4 v1, s[48:51], s20 offen offset:2048 sc1 lds
    buffer_load_dwordx4 v1, s[48:51], s20 offen offset:3072 sc1 lds
    s_add_u32 m0, s4, 102400
    s_nop 0
    buffer_load_dwordx4 v1, s[48:51], s21 offen offset:0 sc1 lds
    buffer_load_dwordx4 v1, s[48:51], s21 offen offset:1024 sc1 lds
    buffer_load_dwordx4 v1, s[48:51], s21 offen offset:2048 sc1 lds
    buffer_load_dwordx4 v1, s[48:51], s21 offen offset:3072 sc1 lds
    v_pk_mul_f32 v[16:17], v[16:17], v[88:89] op_sel_hi:[1,0]
    v_pk_mul_f32 v[18:19], v[18:19], v[88:89] op_sel_hi:[1,0]
    v_pk_mul_f32 v[20:21], v[20:21], v[88:89] op_sel_hi:[1,0]
    v_pk_mul_f32 v[22:23], v[22:23], v[88:89] op_sel_hi:[1,0]
    v_pk_mul_f32 v[24:25], v[24:25], v[88:89] op_sel_hi:[1,0]
    v_pk_mul_f32 v[26:27], v[26:27], v[88:89] op_sel_hi:[1,0]
    v_pk_mul_f32 v[28:29], v[28:29], v[88:89] op_sel_hi:[1,0]
    v_pk_mul_f32 v[30:31], v[30:31], v[88:89] op_sel_hi:[1,0]
    v_pk_fma_f32 v[16:17], v[112:113], v[90:91], v[16:17] op_sel_hi:[1,0,1] neg_lo:[0,1,0] neg_hi:[0,1,0]
    v_pk_fma_f32 v[18:19], v[114:115], v[90:91], v[18:19] op_sel_hi:[1,0,1] neg_lo:[0,1,0] neg_hi:[0,1,0]
    v_pk_fma_f32 v[20:21], v[116:117], v[90:91], v[20:21] op_sel_hi:[1,0,1] neg_lo:[0,1,0] neg_hi:[0,1,0]
    v_pk_fma_f32 v[22:23], v[118:119], v[90:91], v[22:23] op_sel_hi:[1,0,1] neg_lo:[0,1,0] neg_hi:[0,1,0]
    v_pk_fma_f32 v[24:25], v[120:121], v[90:91], v[24:25] op_sel_hi:[1,0,1] neg_lo:[0,1,0] neg_hi:[0,1,0]
    v_pk_fma_f32 v[26:27], v[122:123], v[90:91], v[26:27] op_sel_hi:[1,0,1] neg_lo:[0,1,0] neg_hi:[0,1,0]
    v_pk_fma_f32 v[28:29], v[124:125], v[90:91], v[28:29] op_sel_hi:[1,0,1] neg_lo:[0,1,0] neg_hi:[0,1,0]
    v_pk_fma_f32 v[30:31], v[126:127], v[90:91], v[30:31] op_sel_hi:[1,0,1] neg_lo:[0,1,0] neg_hi:[0,1,0]
    v_cvt_pk_bf16_f32 v16, v16, v17
    v_cvt_pk_bf16_f32 v17, v18, v19
    v_cvt_pk_bf16_f32 v18, v20, v21
    v_cvt_pk_bf16_f32 v19, v22, v23
    v_cvt_pk_bf16_f32 v20, v24, v25
    v_cvt_pk_bf16_f32 v21, v26, v27
    v_cvt_pk_bf16_f32 v22, v28, v29
    v_cvt_pk_bf16_f32 v23, v30, v31
    s_lshl_b32 s11, s58, 13
    v_add_u32 v82, s11, v1
    v_add_u32 v83, 0x10000, v82
    s_lshl_b32 s11, s58, 13
    v_add_u32 v84, s11, v2
    v_add_u32 v85, 0x10000, v84
    ds_read_b64_tr_b16 a[224:225], v84 offset:0
    ds_read_b64_tr_b16 a[226:227], v84 offset:512
    ds_read_b64_tr_b16 a[228:229], v84 offset:1024
    ds_read_b64_tr_b16 a[230:231], v84 offset:1536
    ds_read_b64_tr_b16 a[232:233], v84 offset:2048
    ds_read_b64_tr_b16 a[234:235], v84 offset:2560
    ds_read_b64_tr_b16 a[236:237], v84 offset:3072
    ds_read_b64_tr_b16 a[238:239], v84 offset:3584
    ds_read_b64_tr_b16 a[240:241], v84 offset:4096
    ds_read_b64_tr_b16 a[242:243], v84 offset:4608
    ds_read_b64_tr_b16 a[244:245], v84 offset:5120
    ds_read_b64_tr_b16 a[246:247], v84 offset:5632
    ds_read_b64_tr_b16 a[248:249], v84 offset:6144
    ds_read_b64_tr_b16 a[250:251], v84 offset:6656
    ds_read_b64_tr_b16 a[252:253], v84 offset:7168
    ds_read_b64_tr_b16 a[254:255], v84 offset:7680
    ds_write_b128 v82, a[192:195] offset:0
    ds_write_b128 v82, a[196:199] offset:1024
    ds_write_b128 v82, a[200:203] offset:2048
    ds_write_b128 v82, a[204:207] offset:3072
    ds_write_b128 v82, a[208:211] offset:4096
    ds_write_b128 v82, a[212:215] offset:5120
    ds_write_b128 v82, a[216:219] offset:6144
    ds_write_b128 v82, a[220:223] offset:7168
    ds_write_b128 v83, a[128:131] offset:0
    ds_write_b128 v83, a[132:135] offset:1024
    ds_write_b128 v83, a[136:139] offset:2048
    ds_write_b128 v83, a[140:143] offset:3072
    v_mov_b32 v108, 0xffff
    v_mov_b32 v109, 0xffff0000
    v_cndmask_b32 v24, 0, v108, s[64:65]
    v_cndmask_b32 v110, 0, v109, s[66:67]
    v_or_b32 v24, v24, v110
    v_cndmask_b32 v25, 0, v108, s[68:69]
    v_cndmask_b32 v110, 0, v109, s[70:71]
    v_or_b32 v25, v25, v110
    v_cndmask_b32 v26, 0, v108, s[72:73]
    v_cndmask_b32 v110, 0, v109, s[74:75]
    v_or_b32 v26, v26, v110
    v_cndmask_b32 v27, 0, v108, s[76:77]
    v_cndmask_b32 v110, 0, v109, s[78:79]
    v_or_b32 v27, v27, v110
    v_cndmask_b32 v28, 0, v108, s[80:81]
    v_cndmask_b32 v110, 0, v109, s[82:83]
    v_or_b32 v28, v28, v110
    v_cndmask_b32 v29, 0, v108, s[84:85]
    v_cndmask_b32 v110, 0, v109, s[86:87]
    v_or_b32 v29, v29, v110
    v_cndmask_b32 v30, 0, v108, s[88:89]
    v_cndmask_b32 v110, 0, v109, s[90:91]
    v_or_b32 v30, v30, v110
    v_cndmask_b32 v31, 0, v108, s[92:93]
    v_cndmask_b32 v110, 0, v109, s[94:95]
    v_or_b32 v31, v31, v110
    ds_read_b128 v[76:79], v7 offset:32768
    ds_read_b128 v[80:83], v7 offset:33792
    s_mov_b64 exec, s[96:97]
    ds_read_b128 v[32:35], v7 offset:34816
    ds_read_b128 v[36:39], v7 offset:35840
    s_mov_b64 exec, -1
    s_mov_b64 exec, s[96:97]
    ds_read_b128 v[40:43], v7 offset:35072
    ds_read_b128 v[44:47], v7 offset:36096
    s_mov_b64 exec, -1
    v_mov_b32 v84, 0xff800000
    s_waitcnt lgkmcnt(5)
    v_mfma_f32_32x32x16_bf16 v[240:255], v[76:79], v[16:19], 0
    s_waitcnt lgkmcnt(4)
    v_mfma_f32_32x32x16_bf16 v[176:191], v[80:83], v[20:23], 0
    s_nop 8
    s_nop 0
    v_cndmask_b32 v240, v84, v240, s[64:65]
    v_cndmask_b32 v241, v84, v241, s[66:67]
    v_cndmask_b32 v242, v84, v242, s[68:69]
    v_cndmask_b32 v243, v84, v243, s[70:71]
    v_cndmask_b32 v244, v84, v244, s[72:73]
    v_cndmask_b32 v245, v84, v245, s[74:75]
    v_cndmask_b32 v246, v84, v246, s[76:77]
    v_cndmask_b32 v247, v84, v247, s[78:79]
    v_cndmask_b32 v248, v84, v248, s[80:81]
    v_cndmask_b32 v249, v84, v249, s[82:83]
    v_cndmask_b32 v250, v84, v250, s[84:85]
    v_cndmask_b32 v251, v84, v251, s[86:87]
    v_cndmask_b32 v252, v84, v252, s[88:89]
    v_cndmask_b32 v253, v84, v253, s[90:91]
    v_cndmask_b32 v254, v84, v254, s[92:93]
    v_cndmask_b32 v255, v84, v255, s[94:95]
    v_max_f32 v86, v240, v241
    v_max_f32 v85, v242, v243
    v_max3_f32 v86, v86, v244, v245
    v_max3_f32 v85, v85, v246, v247
    v_max3_f32 v86, v86, v248, v249
    v_max3_f32 v85, v85, v250, v251
    v_max3_f32 v86, v86, v252, v253
    v_max3_f32 v85, v85, v254, v255
    v_max_f32 v86, v86, v85
    v_mov_b32 v85, v86
    s_nop 1
    v_permlane32_swap_b32 v85, v86
    v_max_f32 v86, v86, v85
    v_sub_f32 v86, 0, v86
    v_pk_add_f32 v[240:241], v[240:241], v[86:87] op_sel_hi:[1,0]
    v_pk_add_f32 v[242:243], v[242:243], v[86:87] op_sel_hi:[1,0]
    v_pk_add_f32 v[244:245], v[244:245], v[86:87] op_sel_hi:[1,0]
    v_pk_add_f32 v[246:247], v[246:247], v[86:87] op_sel_hi:[1,0]
    v_pk_add_f32 v[248:249], v[248:249], v[86:87] op_sel_hi:[1,0]
    v_pk_add_f32 v[250:251], v[250:251], v[86:87] op_sel_hi:[1,0]
    v_pk_add_f32 v[252:253], v[252:253], v[86:87] op_sel_hi:[1,0]
    v_pk_add_f32 v[254:255], v[254:255], v[86:87] op_sel_hi:[1,0]
    v_pk_mov_b32 v[192:193], v[86:87], v[86:87] op_sel:[0,0]
    v_pk_mov_b32 v[194:195], v[86:87], v[86:87] op_sel:[0,0]
    v_pk_mov_b32 v[196:197], v[86:87], v[86:87] op_sel:[0,0]
    v_pk_mov_b32 v[198:199], v[86:87], v[86:87] op_sel:[0,0]
    v_pk_mov_b32 v[200:201], v[86:87], v[86:87] op_sel:[0,0]
    v_pk_mov_b32 v[202:203], v[86:87], v[86:87] op_sel:[0,0]
    v_pk_mov_b32 v[204:205], v[86:87], v[86:87] op_sel:[0,0]
    v_pk_mov_b32 v[206:207], v[86:87], v[86:87] op_sel:[0,0]
    v_cndmask_b32 v176, v84, v176, s[64:65]
    v_cndmask_b32 v177, v84, v177, s[66:67]
    v_cndmask_b32 v178, v84, v178, s[68:69]
    v_cndmask_b32 v179, v84, v179, s[70:71]
    v_cndmask_b32 v180, v84, v180, s[72:73]
    v_cndmask_b32 v181, v84, v181, s[74:75]
    v_cndmask_b32 v182, v84, v182, s[76:77]
    v_cndmask_b32 v183, v84, v183, s[78:79]
    v_cndmask_b32 v184, v84, v184, s[80:81]
    v_cndmask_b32 v185, v84, v185, s[82:83]
    v_cndmask_b32 v186, v84, v186, s[84:85]
    v_cndmask_b32 v187, v84, v187, s[86:87]
    v_cndmask_b32 v188, v84, v188, s[88:89]
    v_cndmask_b32 v189, v84, v189, s[90:91]
    v_cndmask_b32 v190, v84, v190, s[92:93]
    v_cndmask_b32 v191, v84, v191, s[94:95]
    v_max_f32 v88, v176, v177
    v_max_f32 v85, v178, v179
    v_max3_f32 v88, v88, v180, v181
    v_max3_f32 v85, v85, v182, v183
    v_max3_f32 v88, v88, v184, v185
    v_max3_f32 v85, v85, v186, v187
    v_max3_f32 v88, v88, v188, v189
    v_max3_f32 v85, v85, v190, v191
    v_max_f32 v88, v88, v85
    v_mov_b32 v85, v88
    s_nop 1
    v_permlane32_swap_b32 v85, v88
    v_max_f32 v88, v88, v85
    v_sub_f32 v88, 0, v88
    v_pk_add_f32 v[176:177], v[176:177], v[88:89] op_sel_hi:[1,0]
    v_pk_add_f32 v[178:179], v[178:179], v[88:89] op_sel_hi:[1,0]
    v_pk_add_f32 v[180:181], v[180:181], v[88:89] op_sel_hi:[1,0]
    v_pk_add_f32 v[182:183], v[182:183], v[88:89] op_sel_hi:[1,0]
    v_pk_add_f32 v[184:185], v[184:185], v[88:89] op_sel_hi:[1,0]
    v_pk_add_f32 v[186:187], v[186:187], v[88:89] op_sel_hi:[1,0]
    v_pk_add_f32 v[188:189], v[188:189], v[88:89] op_sel_hi:[1,0]
    v_pk_add_f32 v[190:191], v[190:191], v[88:89] op_sel_hi:[1,0]
    v_pk_mov_b32 v[208:209], v[88:89], v[88:89] op_sel:[0,0]
    v_pk_mov_b32 v[210:211], v[88:89], v[88:89] op_sel:[0,0]
    v_pk_mov_b32 v[212:213], v[88:89], v[88:89] op_sel:[0,0]
    v_pk_mov_b32 v[214:215], v[88:89], v[88:89] op_sel:[0,0]
    v_pk_mov_b32 v[216:217], v[88:89], v[88:89] op_sel:[0,0]
    v_pk_mov_b32 v[218:219], v[88:89], v[88:89] op_sel:[0,0]
    v_pk_mov_b32 v[220:221], v[88:89], v[88:89] op_sel:[0,0]
    v_pk_mov_b32 v[222:223], v[88:89], v[88:89] op_sel:[0,0]
    v_exp_f32 v240, v240
    v_exp_f32 v241, v241
    v_exp_f32 v242, v242
    v_exp_f32 v243, v243
    v_exp_f32 v244, v244
    v_exp_f32 v245, v245
    v_exp_f32 v246, v246
    v_exp_f32 v247, v247
    v_exp_f32 v248, v248
    v_exp_f32 v249, v249
    v_exp_f32 v250, v250
    v_exp_f32 v251, v251
    v_exp_f32 v252, v252
    v_exp_f32 v253, v253
    v_exp_f32 v254, v254
    v_exp_f32 v255, v255
    v_cvt_pk_bf16_f32 v240, v240, v241
    v_cvt_pk_bf16_f32 v241, v242, v243
    v_cvt_pk_bf16_f32 v242, v244, v245
    v_cvt_pk_bf16_f32 v243, v246, v247
    v_cvt_pk_bf16_f32 v244, v248, v249
    v_cvt_pk_bf16_f32 v245, v250, v251
    v_cvt_pk_bf16_f32 v246, v252, v253
    v_cvt_pk_bf16_f32 v247, v254, v255
    s_waitcnt lgkmcnt(0)
    v_mfma_f32_32x32x16_bf16 v[48:63], v[32:35], v[240:243], 0
    v_mfma_f32_32x32x16_bf16 v[48:63], v[36:39], v[244:247], v[48:63]
    s_mov_b64 s[16:17], 0
    s_lshl_b32 s4, s58, 12
    v_add_u32 v96, s4, v7
    s_mov_b32 s99, 200000
    s_nop 7
hlp_292:
    s_waitcnt vmcnt(0) lgkmcnt(0)
    s_cmp_ge_u32 s7, 16
    s_cbranch_scc1 hd_293
    ds_read_b32 v64, v96 offset:0
    ds_read_b32 v65, v96 offset:1024
    ds_read_b32 v66, v96 offset:2048
    ds_read_b32 v67, v96 offset:3072
    ds_read_b32 v68, v96 offset:4096
    ds_read_b32 v69, v96 offset:5120
    ds_read_b32 v70, v96 offset:6144
    ds_read_b32 v71, v96 offset:7168
    s_waitcnt lgkmcnt(0)
    v_bitop3_b32 v72, v64, v65, v66 bitop3:0x80
    v_bitop3_b32 v72, v72, v67, v68 bitop3:0x80
    v_bitop3_b32 v72, v72, v69, v70 bitop3:0x80
    v_bitop3_b32 v72, v72, v71, 1 bitop3:0x80
    v_cmp_eq_u32 vcc, 0, v72
    s_nop 4
    s_cbranch_vccnz hr_294
hd_293:
    s_barrier
    s_getpc_b64 s[10:11]
pc_295:
    s_lshr_b32 s4, s2, 3
    s_lshl_b32 s4, s4, 2
    s_add_u32 s4, s4, s58
    v_lshlrev_b32 v64, 7, v0
    v_add_u32 v64, s4, v64
    v_lshlrev_b32 v64, 7, v64
    v_cmp_gt_u32 vcc, L_codeend-pc_295-4, v64
    s_nop 4
    s_and_b64 exec, exec, vcc
    global_load_dword v111, v64, s[10:11]
    s_mov_b64 exec, -1
    s_cmp_lt_u32 s59, 8
    s_cbranch_scc1 achk_296
    ds_read_b128 v[64:67], v7 offset:28672
    ds_read_b128 v[68:71], v7 offset:24576
    v_exp_f32 v176, v176
    ds_read_b128 v[72:75], v7 offset:20480
    ds_read_b128 v[76:79], v7 offset:16384
    v_exp_f32 v177, v177
    s_mov_b64 exec, s[96:97]
    ds_read_b128 v[32:35], v7 offset:30720
    ds_read_b128 v[36:39], v7 offset:31744
    s_mov_b64 exec, -1
    s_waitcnt lgkmcnt(5)
    v_mfma_f32_32x32x16_bf16 v[112:127], v[64:67], v[16:19], v[192:207]
    v_exp_f32 v178, v178
    v_exp_f32 v179, v179
    v_exp_f32 v180, v180
    v_exp_f32 v181, v181
    s_waitcnt lgkmcnt(4)
    v_mfma_f32_32x32x16_bf16 v[128:143], v[68:71], v[16:19], v[192:207]
    v_exp_f32 v182, v182
    v_exp_f32 v183, v183
    v_exp_f32 v184, v184
    v_exp_f32 v185, v185
    s_waitcnt lgkmcnt(3)
    v_mfma_f32_32x32x16_bf16 v[144:159], v[72:75], v[16:19], v[192:207]
    ds_read_b128 v[80:83], v7 offset:12288
    v_exp_f32 v186, v186
    ds_read_b128 v[84:87], v7 offset:8192
    ds_read_b128 v[88:91], v7 offset:4096
    v_exp_f32 v187, v187
    v_exp_f32 v188, v188
    v_exp_f32 v189, v189
    v_exp_f32 v190, v190
    v_exp_f32 v191, v191
    v_cvt_pk_bf16_f32 v176, v176, v177
    v_cvt_pk_bf16_f32 v177, v178, v179
    v_cvt_pk_bf16_f32 v178, v180, v181
    v_cvt_pk_bf16_f32 v179, v182, v183
    v_cvt_pk_bf16_f32 v180, v184, v185
    v_cvt_pk_bf16_f32 v181, v186, v187
    v_cvt_pk_bf16_f32 v182, v188, v189
    v_cvt_pk_bf16_f32 v183, v190, v191
    v_mfma_f32_32x32x16_bf16 v[224:239], v[40:43], v[176:179], 0
    v_exp_f32 v112, v112
    v_exp_f32 v113, v113
    v_exp_f32 v114, v114
    v_exp_f32 v115, v115
    v_mfma_f32_32x32x16_bf16 v[224:239], v[44:47], v[180:183], v[224:239]
    s_mov_b64 exec, s[96:97]
    ds_read_b128 v[40:43], v7 offset:26624
    ds_read_b128 v[44:47], v7 offset:27648
    s_mov_b64 exec, -1
    v_exp_f32 v116, v116
    v_exp_f32 v117, v117
    v_exp_f32 v118, v118
    s_waitcnt lgkmcnt(7)
    v_mfma_f32_32x32x16_bf16 v[160:175], v[76:79], v[16:19], v[192:207]
    v_exp_f32 v119, v119
    v_exp_f32 v120, v120
    v_exp_f32 v121, v121
    v_exp_f32 v122, v122
    v_exp_f32 v123, v123
    v_exp_f32 v124, v124
    v_exp_f32 v125, v125
    v_exp_f32 v126, v126
    v_exp_f32_e64 v127, v127
    v_cvt_pk_bf16_f32 v112, v112, v113
    v_cvt_pk_bf16_f32 v113, v114, v115
    v_cvt_pk_bf16_f32 v114, v116, v117
    v_cvt_pk_bf16_f32 v115, v118, v119
    v_cvt_pk_bf16_f32 v116, v120, v121
    v_cvt_pk_bf16_f32 v117, v122, v123
    v_cvt_pk_bf16_f32 v118, v124, v125
    v_cvt_pk_bf16_f32 v119, v126, v127
    s_waitcnt lgkmcnt(5)
    v_mfma_f32_32x32x16_bf16 v[48:63], v[32:35], v[112:115], v[48:63]
    v_exp_f32 v128, v128
    v_exp_f32 v129, v129
    v_exp_f32 v130, v130
    v_exp_f32 v131, v131
    v_mfma_f32_32x32x16_bf16 v[48:63], v[36:39], v[116:119], v[48:63]
    s_mov_b64 exec, s[96:97]
    ds_read_b128 v[32:35], v7 offset:22528
    ds_read_b128 v[36:39], v7 offset:23552
    s_mov_b64 exec, -1
    v_exp_f32 v132, v132
    v_exp_f32 v133, v133
    v_exp_f32 v134, v134
    s_waitcnt lgkmcnt(6)
    v_mfma_f32_32x32x16_bf16 v[176:191], v[80:83], v[16:19], v[192:207]
    ds_read_b128 v[92:95], v7 offset:0
    v_exp_f32 v135, v135
    v_exp_f32 v136, v136
    v_exp_f32 v137, v137
    v_exp_f32 v138, v138
    v_exp_f32 v139, v139
    v_exp_f32 v140, v140
    v_exp_f32 v141, v141
    v_exp_f32 v142, v142
    v_exp_f32 v143, v143
    v_cvt_pk_bf16_f32 v128, v128, v129
    v_cvt_pk_bf16_f32 v129, v130, v131
    v_cvt_pk_bf16_f32 v130, v132, v133
    v_cvt_pk_bf16_f32 v131, v134, v135
    v_cvt_pk_bf16_f32 v132, v136, v137
    v_cvt_pk_bf16_f32 v133, v138, v139
    v_cvt_pk_bf16_f32 v134, v140, v141
    v_cvt_pk_bf16_f32 v135, v142, v143
    s_waitcnt lgkmcnt(3)
    v_mfma_f32_32x32x16_bf16 v[48:63], v[40:43], v[128:131], v[48:63]
    v_exp_f32 v144, v144
    v_exp_f32 v145, v145
    v_exp_f32 v146, v146
    v_exp_f32 v147, v147
    v_mfma_f32_32x32x16_bf16 v[48:63], v[44:47], v[132:135], v[48:63]
    s_mov_b64 exec, s[96:97]
    ds_read_b128 v[40:43], v7 offset:18432
    ds_read_b128 v[44:47], v7 offset:19456
    s_mov_b64 exec, -1
    v_exp_f32 v148, v148
    v_exp_f32 v149, v149
    v_exp_f32 v150, v150
    v_mfma_f32_32x32x16_bf16 v[112:127], v[84:87], v[16:19], v[192:207]
    ds_read_b128 v[96:99], v7 offset:29696
    v_exp_f32 v151, v151
    v_exp_f32 v152, v152
    v_exp_f32 v153, v153
    v_exp_f32 v154, v154
    v_exp_f32 v155, v155
    v_exp_f32 v156, v156
    v_exp_f32 v157, v157
    v_exp_f32 v158, v158
    v_exp_f32_e64 v159, v159
    v_cvt_pk_bf16_f32 v144, v144, v145
    v_cvt_pk_bf16_f32 v145, v146, v147
    v_cvt_pk_bf16_f32 v146, v148, v149
    v_cvt_pk_bf16_f32 v147, v150, v151
    v_cvt_pk_bf16_f32 v148, v152, v153
    v_cvt_pk_bf16_f32 v149, v154, v155
    v_cvt_pk_bf16_f32 v150, v156, v157
    v_cvt_pk_bf16_f32 v151, v158, v159
    s_waitcnt lgkmcnt(4)
    v_mfma_f32_32x32x16_bf16 v[48:63], v[32:35], v[144:147], v[48:63]
    v_exp_f32 v160, v160
    v_exp_f32 v161, v161
    v_exp_f32 v162, v162
    v_exp_f32 v163, v163
    v_mfma_f32_32x32x16_bf16 v[48:63], v[36:39], v[148:151], v[48:63]
    s_mov_b64 exec, s[96:97]
    ds_read_b128 v[32:35], v7 offset:14336
    ds_read_b128 v[36:39], v7 offset:15360
    s_mov_b64 exec, -1
    v_exp_f32 v164, v164
    v_exp_f32 v165, v165
    v_exp_f32 v166, v166
    v_mfma_f32_32x32x16_bf16 v[128:143], v[88:91], v[16:19], v[192:207]
    ds_read_b128 v[64:67], v7 offset:25600
    v_exp_f32 v167, v167
    v_exp_f32 v168, v168
    v_exp_f32 v169, v169
    v_exp_f32 v170, v170
    v_exp_f32 v171, v171
    v_exp_f32 v172, v172
    v_exp_f32 v173, v173
    v_exp_f32 v174, v174
    v_exp_f32_e64 v175, v175
    v_cvt_pk_bf16_f32 v160, v160, v161
    v_cvt_pk_bf16_f32 v161, v162, v163
    v_cvt_pk_bf16_f32 v162, v164, v165
    v_cvt_pk_bf16_f32 v163, v166, v167
    v_cvt_pk_bf16_f32 v164, v168, v169
    v_cvt_pk_bf16_f32 v165, v170, v171
    v_cvt_pk_bf16_f32 v166, v172, v173
    v_cvt_pk_bf16_f32 v167, v174, v175
    s_waitcnt lgkmcnt(4)
    v_mfma_f32_32x32x16_bf16 v[48:63], v[40:43], v[160:163], v[48:63]
    v_exp_f32 v176, v176
    v_exp_f32 v177, v177
    v_exp_f32 v178, v178
    v_exp_f32 v179, v179
    v_mfma_f32_32x32x16_bf16 v[48:63], v[44:47], v[164:167], v[48:63]
    s_mov_b64 exec, s[96:97]
    ds_read_b128 v[40:43], v7 offset:10240
    ds_read_b128 v[44:47], v7 offset:11264
    s_mov_b64 exec, -1
    v_exp_f32 v180, v180
    v_exp_f32 v181, v181
    v_exp_f32 v182, v182
    v_mfma_f32_32x32x16_bf16 v[144:159], v[92:95], v[16:19], v[192:207]
    ds_read_b128 v[68:71], v7 offset:21504
    v_exp_f32 v183, v183
    v_exp_f32 v184, v184
    v_exp_f32 v185, v185
    v_exp_f32 v186, v186
    v_exp_f32 v187, v187
    v_exp_f32 v188, v188
    v_exp_f32 v189, v189
    v_exp_f32 v190, v190
    v_exp_f32_e64 v191, v191
    v_cvt_pk_bf16_f32 v176, v176, v177
    v_cvt_pk_bf16_f32 v177, v178, v179
    v_cvt_pk_bf16_f32 v178, v180, v181
    v_cvt_pk_bf16_f32 v179, v182, v183
    v_cvt_pk_bf16_f32 v180, v184, v185
    v_cvt_pk_bf16_f32 v181, v186, v187
    v_cvt_pk_bf16_f32 v182, v188, v189
    v_cvt_pk_bf16_f32 v183, v190, v191
    s_waitcnt lgkmcnt(4)
    v_mfma_f32_32x32x16_bf16 v[48:63], v[32:35], v[176:179], v[48:63]
    v_exp_f32 v112, v112
    v_exp_f32 v113, v113
    v_exp_f32 v114, v114
    v_exp_f32 v115, v115
    v_mfma_f32_32x32x16_bf16 v[48:63], v[36:39], v[180:183], v[48:63]
    s_mov_b64 exec, s[96:97]
    ds_read_b128 v[32:35], v7 offset:6144
    ds_read_b128 v[36:39], v7 offset:7168
    s_mov_b64 exec, -1
    v_exp_f32 v116, v116
    v_exp_f32 v117, v117
    v_exp_f32 v118, v118
    v_mfma_f32_32x32x16_bf16 v[160:175], v[96:99], v[20:23], v[208:223]
    ds_read_b128 v[72:75], v7 offset:17408
    v_exp_f32 v119, v119
    v_exp_f32 v120, v120
    v_exp_f32 v121, v121
    v_exp_f32 v122, v122
    v_exp_f32 v123, v123
    v_exp_f32 v124, v124
    v_exp_f32 v125, v125
    v_exp_f32 v126, v126
    v_exp_f32_e64 v127, v127
    v_cvt_pk_bf16_f32 v112, v112, v113
    v_cvt_pk_bf16_f32 v113, v114, v115
    v_cvt_pk_bf16_f32 v114, v116, v117
    v_cvt_pk_bf16_f32 v115, v118, v119
    v_cvt_pk_bf16_f32 v116, v120, v121
    v_cvt_pk_bf16_f32 v117, v122, v123
    v_cvt_pk_bf16_f32 v118, v124, v125
    v_cvt_pk_bf16_f32 v119, v126, v127
    s_waitcnt lgkmcnt(4)
    v_mfma_f32_32x32x16_bf16 v[48:63], v[40:43], v[112:115], v[48:63]
    v_exp_f32 v128, v128
    v_exp_f32 v129, v129
    v_exp_f32 v130, v130
    v_exp_f32 v131, v131
    v_mfma_f32_32x32x16_bf16 v[48:63], v[44:47], v[116:119], v[48:63]
    s_mov_b64 exec, s[96:97]
    ds_read_b128 v[40:43], v7 offset:2048
    ds_read_b128 v[44:47], v7 offset:3072
    s_mov_b64 exec, -1
    v_exp_f32 v132, v132
    v_exp_f32 v133, v133
    v_exp_f32 v134, v134
    v_mfma_f32_32x32x16_bf16 v[176:191], v[64:67], v[20:23], v[208:223]
    ds_read_b128 v[76:79], v7 offset:13312
    v_exp_f32 v135, v135
    v_exp_f32 v136, v136
    v_exp_f32 v137, v137
    v_exp_f32 v138, v138
    v_exp_f32 v139, v139
    v_exp_f32 v140, v140
    v_exp_f32 v141, v141
    v_exp_f32 v142, v142
    v_exp_f32_e64 v143, v143
    v_cvt_pk_bf16_f32 v128, v128, v129
    v_cvt_pk_bf16_f32 v129, v130, v131
    v_cvt_pk_bf16_f32 v130, v132, v133
    v_cvt_pk_bf16_f32 v131, v134, v135
    v_cvt_pk_bf16_f32 v132, v136, v137
    v_cvt_pk_bf16_f32 v133, v138, v139
    v_cvt_pk_bf16_f32 v134, v140, v141
    v_cvt_pk_bf16_f32 v135, v142, v143
    s_waitcnt lgkmcnt(4)
    v_mfma_f32_32x32x16_bf16 v[48:63], v[32:35], v[128:131], v[48:63]
    v_exp_f32 v144, v144
    v_exp_f32 v145, v145
    v_exp_f32 v146, v146
    v_exp_f32 v147, v147
    v_mfma_f32_32x32x16_bf16 v[48:63], v[36:39], v[132:135], v[48:63]
    s_mov_b64 exec, s[96:97]
    ds_read_b128 v[32:35], v7 offset:30976
    ds_read_b128 v[36:39], v7 offset:32000
    s_mov_b64 exec, -1
    v_exp_f32 v148, v148
    v_exp_f32 v149, v149
    v_exp_f32 v150, v150
    v_mfma_f32_32x32x16_bf16 v[112:127], v[68:71], v[20:23], v[208:223]
    ds_read_b128 v[80:83], v7 offset:9216
    v_exp_f32 v151, v151
    v_exp_f32 v152, v152
    v_exp_f32 v153, v153
    v_exp_f32 v154, v154
    v_exp_f32 v155, v155
    v_exp_f32 v156, v156
    v_exp_f32 v157, v157
    v_exp_f32 v158, v158
    v_exp_f32_e64 v159, v159
    v_cvt_pk_bf16_f32 v144, v144, v145
    v_cvt_pk_bf16_f32 v145, v146, v147
    v_cvt_pk_bf16_f32 v146, v148, v149
    v_cvt_pk_bf16_f32 v147, v150, v151
    v_cvt_pk_bf16_f32 v148, v152, v153
    v_cvt_pk_bf16_f32 v149, v154, v155
    v_cvt_pk_bf16_f32 v150, v156, v157
    v_cvt_pk_bf16_f32 v151, v158, v159
    v_bfi_b32 v144, v24, 0, v144
    v_bfi_b32 v145, v25, 0, v145
    v_bfi_b32 v146, v26, 0, v146
    v_bfi_b32 v147, v27, 0, v147
    v_bfi_b32 v148, v28, 0, v148
    v_bfi_b32 v149, v29, 0, v149
    v_bfi_b32 v150, v30, 0, v150
    v_bfi_b32 v151, v31, 0, v151
    s_waitcnt lgkmcnt(4)
    v_mfma_f32_32x32x16_bf16 v[48:63], v[40:43], v[144:147], v[48:63]
    v_exp_f32 v160, v160
    v_exp_f32 v161, v161
    v_exp_f32 v162, v162
    v_exp_f32 v163, v163
    v_mfma_f32_32x32x16_bf16 v[48:63], v[44:47], v[148:151], v[48:63]
    s_mov_b64 exec, s[96:97]
    ds_read_b128 v[40:43], v7 offset:26880
    ds_read_b128 v[44:47], v7 offset:27904
    s_mov_b64 exec, -1
    v_exp_f32 v164, v164
    v_exp_f32 v165, v165
    v_exp_f32 v166, v166
    v_mfma_f32_32x32x16_bf16 v[128:143], v[72:75], v[20:23], v[208:223]
    ds_read_b128 v[84:87], v7 offset:5120
    v_exp_f32 v167, v167
    v_exp_f32 v168, v168
    v_exp_f32 v169, v169
    v_exp_f32 v170, v170
    v_exp_f32 v171, v171
    v_exp_f32 v172, v172
    v_exp_f32 v173, v173
    v_exp_f32 v174, v174
    v_exp_f32_e64 v175, v175
    v_cvt_pk_bf16_f32 v160, v160, v161
    v_cvt_pk_bf16_f32 v161, v162, v163
    v_cvt_pk_bf16_f32 v162, v164, v165
    v_cvt_pk_bf16_f32 v163, v166, v167
    v_cvt_pk_bf16_f32 v164, v168, v169
    v_cvt_pk_bf16_f32 v165, v170, v171
    v_cvt_pk_bf16_f32 v166, v172, v173
    v_cvt_pk_bf16_f32 v167, v174, v175
    s_waitcnt lgkmcnt(4)
    v_mfma_f32_32x32x16_bf16 v[224:239], v[32:35], v[160:163], v[224:239]
    v_rcp_f32 v57, v56
    v_cmp_ngt_f32 vcc, 0x71800000, v56
    s_nop 0
    s_or_b64 s[16:17], s[16:17], vcc
    v_mul_f32 v48, v48, v57
    v_mul_f32 v49, v49, v57
    v_mul_f32 v50, v50, v57
    v_mfma_f32_32x32x16_bf16 v[224:239], v[36:39], v[164:167], v[224:239]
    s_mov_b64 exec, s[96:97]
    ds_read_b128 v[32:35], v7 offset:22784
    ds_read_b128 v[36:39], v7 offset:23808
    s_mov_b64 exec, -1
    v_mul_f32 v51, v51, v57
    v_mul_f32 v52, v52, v57
    v_mul_f32 v53, v53, v57
    v_mul_f32 v54, v54, v57
    v_mul_f32 v55, v55, v57
    v_add_u32 v48, 0x8000, v48
    v_mfma_f32_32x32x16_bf16 v[144:159], v[76:79], v[20:23], v[208:223]
    ds_read_b128 v[88:91], v7 offset:1024
    v_cvt_pk_bf16_f32 v60, v48, v49
    v_cvt_pk_bf16_f32 v61, v50, v51
    v_cvt_pk_bf16_f32 v62, v52, v53
    v_cvt_pk_bf16_f32 v63, v54, v55
    v_and_b32 v60, -2, v60
    s_cmp_eq_u64 s[16:17], 0
    s_cselect_b32 s7, s62, 0x7f000000
    s_cselect_b32 s54, 0x7f000000, s62
    s_cmp_lg_u32 s63, 0
    s_nop 1
    s_cbranch_scc0 fast_336
    buffer_store_dwordx4 v[60:63], v1, s[48:51], s7 offen offset:0
    s_nop 1
dend_337:
    v_exp_f32 v176, v176
    v_exp_f32 v177, v177
    v_exp_f32 v178, v178
    v_exp_f32 v179, v179
    v_exp_f32 v180, v180
    v_exp_f32 v181, v181
    v_exp_f32 v182, v182
    v_exp_f32 v183, v183
    v_exp_f32 v184, v184
    v_exp_f32 v185, v185
    v_exp_f32 v186, v186
    v_exp_f32 v187, v187
    v_exp_f32 v188, v188
    v_exp_f32 v189, v189
    v_exp_f32 v190, v190
    v_exp_f32 v191, v191
    v_cvt_pk_bf16_f32 v176, v176, v177
    v_cvt_pk_bf16_f32 v177, v178, v179
    v_cvt_pk_bf16_f32 v178, v180, v181
    v_cvt_pk_bf16_f32 v179, v182, v183
    v_cvt_pk_bf16_f32 v180, v184, v185
    v_cvt_pk_bf16_f32 v181, v186, v187
    v_cvt_pk_bf16_f32 v182, v188, v189
    v_cvt_pk_bf16_f32 v183, v190, v191
    s_waitcnt lgkmcnt(4)
    v_mfma_f32_32x32x16_bf16 v[224:239], v[40:43], v[176:179], v[224:239]
    v_exp_f32 v112, v112
    v_exp_f32 v113, v113
    v_exp_f32 v114, v114
    v_exp_f32 v115, v115
    v_mfma_f32_32x32x16_bf16 v[224:239], v[44:47], v[180:183], v[224:239]
    s_mov_b64 exec, s[96:97]
    ds_read_b128 v[40:43], v7 offset:18688
    ds_read_b128 v[44:47], v7 offset:19712
    s_mov_b64 exec, -1
    v_exp_f32 v116, v116
    v_exp_f32 v117, v117
    v_exp_f32 v118, v118
    v_mfma_f32_32x32x16_bf16 v[160:175], v[80:83], v[20:23], v[208:223]
    v_exp_f32 v119, v119
    v_exp_f32 v120, v120
    v_exp_f32 v121, v121
    v_exp_f32 v122, v122
    v_exp_f32 v123, v123
    v_exp_f32 v124, v124
    v_exp_f32 v125, v125
    v_exp_f32 v126, v126
    v_exp_f32_e64 v127, v127
    v_cvt_pk_bf16_f32 v112, v112, v113
    v_cvt_pk_bf16_f32 v113, v114, v115
    v_cvt_pk_bf16_f32 v114, v116, v117
    v_cvt_pk_bf16_f32 v115, v118, v119
    v_cvt_pk_bf16_f32 v116, v120, v121
    v_cvt_pk_bf16_f32 v117, v122, v123
    v_cvt_pk_bf16_f32 v118, v124, v125
    v_cvt_pk_bf16_f32 v119, v126, v127
    s_waitcnt lgkmcnt(3)
    v_mfma_f32_32x32x16_bf16 v[224:239], v[32:35], v[112:115], v[224:239]
    v_exp_f32 v128, v128
    v_exp_f32 v129, v129
    v_exp_f32 v130, v130
    v_exp_f32 v131, v131
    v_mfma_f32_32x32x16_bf16 v[224:239], v[36:39], v[116:119], v[224:239]
    s_mov_b64 exec, s[96:97]
    ds_read_b128 v[32:35], v7 offset:14592
    ds_read_b128 v[36:39], v7 offset:15616
    s_mov_b64 exec, -1
    v_exp_f32 v132, v132
    v_exp_f32 v133, v133
    v_exp_f32 v134, v134
    v_mfma_f32_32x32x16_bf16 v[176:191], v[84:87], v[20:23], v[208:223]
    v_exp_f32 v135, v135
    v_exp_f32 v136, v136
    v_exp_f32 v137, v137
    v_exp_f32 v138, v138
    v_exp_f32 v139, v139
    v_exp_f32 v140, v140
    v_exp_f32 v141, v141
    v_exp_f32 v142, v142
    v_exp_f32_e64 v143, v143
    v_cvt_pk_bf16_f32 v128, v128, v129
    v_cvt_pk_bf16_f32 v129, v130, v131
    v_cvt_pk_bf16_f32 v130, v132, v133
    v_cvt_pk_bf16_f32 v131, v134, v135
    v_cvt_pk_bf16_f32 v132, v136, v137
    v_cvt_pk_bf16_f32 v133, v138, v139
    v_cvt_pk_bf16_f32 v134, v140, v141
    v_cvt_pk_bf16_f32 v135, v142, v143
    s_waitcnt lgkmcnt(2)
    v_mfma_f32_32x32x16_bf16 v[224:239], v[40:43], v[128:131], v[224:239]
    v_exp_f32 v144, v144
    v_exp_f32 v145, v145
    v_exp_f32 v146, v146
    v_exp_f32 v147, v147
    v_mfma_f32_32x32x16_bf16 v[224:239], v[44:47], v[132:135], v[224:239]
    s_mov_b64 exec, s[96:97]
    ds_read_b128 v[40:43], v7 offset:10496
    ds_read_b128 v[44:47], v7 offset:11520
    s_mov_b64 exec, -1
    v_exp_f32 v148, v148
    v_exp_f32 v149, v149
    v_exp_f32 v150, v150
    v_mfma_f32_32x32x16_bf16 v[112:127], v[88:91], v[20:23], v[208:223]
    v_exp_f32 v151, v151
    v_exp_f32 v152, v152
    v_exp_f32 v153, v153
    v_exp_f32 v154, v154
    v_exp_f32 v155, v155
    v_exp_f32 v156, v156
    v_exp_f32 v157, v157
    v_exp_f32 v158, v158
    v_exp_f32_e64 v159, v159
    v_cvt_pk_bf16_f32 v144, v144, v145
    v_cvt_pk_bf16_f32 v145, v146, v147
    v_cvt_pk_bf16_f32 v146, v148, v149
    v_cvt_pk_bf16_f32 v147, v150, v151
    v_cvt_pk_bf16_f32 v148, v152, v153
    v_cvt_pk_bf16_f32 v149, v154, v155
    v_cvt_pk_bf16_f32 v150, v156, v157
    v_cvt_pk_bf16_f32 v151, v158, v159
    s_waitcnt lgkmcnt(2)
    v_mfma_f32_32x32x16_bf16 v[224:239], v[32:35], v[144:147], v[224:239]
    v_exp_f32 v160, v160
    v_exp_f32 v161, v161
    v_exp_f32 v162, v162
    v_exp_f32 v163, v163
    v_mfma_f32_32x32x16_bf16 v[224:239], v[36:39], v[148:151], v[224:239]
    s_mov_b64 exec, s[96:97]
    ds_read_b128 v[32:35], v7 offset:6400
    ds_read_b128 v[36:39], v7 offset:7424
    s_mov_b64 exec, -1
    v_exp_f32 v164, v164
    v_exp_f32 v165, v165
    v_exp_f32 v166, v166
    v_exp_f32 v167, v167
    v_exp_f32 v168, v168
    v_exp_f32 v169, v169
    v_exp_f32 v170, v170
    v_exp_f32 v171, v171
    v_exp_f32 v172, v172
    v_exp_f32 v173, v173
    v_exp_f32 v174, v174
    v_exp_f32_e64 v175, v175
    v_cvt_pk_bf16_f32 v160, v160, v161
    v_cvt_pk_bf16_f32 v161, v162, v163
    v_cvt_pk_bf16_f32 v162, v164, v165
    v_cvt_pk_bf16_f32 v163, v166, v167
    v_cvt_pk_bf16_f32 v164, v168, v169
    v_cvt_pk_bf16_f32 v165, v170, v171
    v_cvt_pk_bf16_f32 v166, v172, v173
    v_cvt_pk_bf16_f32 v167, v174, v175
    s_waitcnt lgkmcnt(2)
    v_mfma_f32_32x32x16_bf16 v[224:239], v[40:43], v[160:163], v[224:239]
    v_exp_f32 v176, v176
    v_exp_f32 v177, v177
    v_exp_f32 v178, v178
    v_exp_f32 v179, v179
    v_mfma_f32_32x32x16_bf16 v[224:239], v[44:47], v[164:167], v[224:239]
    s_mov_b64 exec, s[96:97]
    ds_read_b128 v[40:43], v7 offset:2304
    ds_read_b128 v[44:47], v7 offset:3328
    s_mov_b64 exec, -1
    v_exp_f32 v180, v180
    v_exp_f32 v181, v181
    v_exp_f32 v182, v182
    v_exp_f32 v183, v183
    v_exp_f32 v184, v184
    v_exp_f32 v185, v185
    v_exp_f32 v186, v186
    v_exp_f32 v187, v187
    v_exp_f32 v188, v188
    v_exp_f32 v189, v189
    v_exp_f32 v190, v190
    v_exp_f32_e64 v191, v191
    v_cvt_pk_bf16_f32 v176, v176, v177
    v_cvt_pk_bf16_f32 v177, v178, v179
    v_cvt_pk_bf16_f32 v178, v180, v181
    v_cvt_pk_bf16_f32 v179, v182, v183
    v_cvt_pk_bf16_f32 v180, v184, v185
    v_cvt_pk_bf16_f32 v181, v186, v187
    v_cvt_pk_bf16_f32 v182, v188, v189
    v_cvt_pk_bf16_f32 v183, v190, v191
    s_waitcnt lgkmcnt(2)
    v_mfma_f32_32x32x16_bf16 v[224:239], v[32:35], v[176:179], v[224:239]
    v_exp_f32 v112, v112
    v_exp_f32 v113, v113
    v_exp_f32 v114, v114
    v_exp_f32 v115, v115
    v_mfma_f32_32x32x16_bf16 v[224:239], v[36:39], v[180:183], v[224:239]
    v_exp_f32 v116, v116
    v_exp_f32 v117, v117
    v_exp_f32 v118, v118
    v_exp_f32 v119, v119
    v_exp_f32 v120, v120
    v_exp_f32 v121, v121
    v_exp_f32 v122, v122
    v_exp_f32 v123, v123
    v_exp_f32 v124, v124
    v_exp_f32 v125, v125
    v_exp_f32 v126, v126
    v_exp_f32_e64 v127, v127
    v_cvt_pk_bf16_f32 v112, v112, v113
    v_cvt_pk_bf16_f32 v113, v114, v115
    v_cvt_pk_bf16_f32 v114, v116, v117
    v_cvt_pk_bf16_f32 v115, v118, v119
    v_cvt_pk_bf16_f32 v116, v120, v121
    v_cvt_pk_bf16_f32 v117, v122, v123
    v_cvt_pk_bf16_f32 v118, v124, v125
    v_cvt_pk_bf16_f32 v119, v126, v127
    v_bfi_b32 v112, v24, 0, v112
    v_bfi_b32 v113, v25, 0, v113
    v_bfi_b32 v114, v26, 0, v114
    v_bfi_b32 v115, v27, 0, v115
    v_bfi_b32 v116, v28, 0, v116
    v_bfi_b32 v117, v29, 0, v117
    v_bfi_b32 v118, v30, 0, v118
    v_bfi_b32 v119, v31, 0, v119
    s_waitcnt lgkmcnt(0)
    v_mfma_f32_32x32x16_bf16 v[224:239], v[40:43], v[112:115], v[224:239]
    v_mfma_f32_32x32x16_bf16 v[224:239], v[44:47], v[116:119], v[224:239]
    s_nop 11
    v_rcp_f32 v233, v232
    v_cmp_ngt_f32 vcc, 0x71800000, v232
    s_nop 0
    s_or_b64 s[16:17], s[16:17], vcc
    v_mul_f32 v224, v224, v233
    v_mul_f32 v225, v225, v233
    v_mul_f32 v226, v226, v233
    v_mul_f32 v227, v227, v233
    v_mul_f32 v228, v228, v233
    v_mul_f32 v229, v229, v233
    v_mul_f32 v230, v230, v233
    v_mul_f32_e64 v231, v231, v233
    v_add_u32 v224, 0x8000, v224
    v_cvt_pk_bf16_f32 v236, v224, v225
    v_cvt_pk_bf16_f32 v237, v226, v227
    v_cvt_pk_bf16_f32 v238, v228, v229
    v_cvt_pk_bf16_f32 v239, v230, v231
    v_and_b32 v236, -2, v236
    s_cmp_eq_u64 s[16:17], 0
    s_cselect_b32 s7, s62, 0x7f000000
    s_cmp_lg_u32 s63, 0
    s_cbranch_scc0 fast_338
    buffer_store_dwordx4 v[236:239], v1, s[48:51], s7 offen offset:1024
    s_nop 1
dend_339:
ajoin_297:
    s_cmp_lg_u64 s[16:17], 0
    s_cbranch_scc1 aslow_298
adone_299:
    s_add_u32 s3, s100, 0
    buffer_load_dwordx4 v[128:131], v1, s[48:51], s3 offen offset:0 sc1
    buffer_load_dwordx4 v[132:135], v1, s[48:51], s3 offen offset:1024 sc1
    buffer_load_dwordx4 v[136:139], v1, s[48:51], s3 offen offset:2048 sc1
    buffer_load_dwordx4 v[140:143], v1, s[48:51], s3 offen offset:3072 sc1
    s_add_u32 s3, s100, 4096
    buffer_load_dwordx4 v[144:147], v1, s[48:51], s3 offen offset:0 sc1
    buffer_load_dwordx4 v[148:151], v1, s[48:51], s3 offen offset:1024 sc1
    buffer_load_dwordx4 v[152:155], v1, s[48:51], s3 offen offset:2048 sc1
    buffer_load_dwordx4 v[156:159], v1, s[48:51], s3 offen offset:3072 sc1
    ds_read_b128 v[64:67], v1 offset:0
    ds_read_b128 v[68:71], v1 offset:1024
    ds_read_b128 v[72:75], v1 offset:2048
    v_lshlrev_b32 v16, 16, v8
    v_and_b32 v17, 0xffff0000, v8
    v_lshlrev_b32 v18, 16, v9
    v_and_b32 v19, 0xffff0000, v9
    v_lshlrev_b32 v20, 16, v10
    v_and_b32 v21, 0xffff0000, v10
    v_lshlrev_b32 v22, 16, v11
    v_and_b32 v23, 0xffff0000, v11
    v_lshlrev_b32 v24, 16, v12
    v_and_b32 v25, 0xffff0000, v12
    v_lshlrev_b32 v26, 16, v13
    v_and_b32 v27, 0xffff0000, v13
    v_lshlrev_b32 v28, 16, v14
    v_and_b32 v29, 0xffff0000, v14
    v_lshlrev_b32 v30, 16, v15
    v_and_b32 v31, 0xffff0000, v15
    s_lshl_b32 s11, s58, 13
    v_add_u32 v82, s11, v1
    v_add_u32 v83, 0x10000, v82
    ds_read_b128 v[76:79], v1 offset:3072
    s_waitcnt vmcnt(6)
    v_bitop3_b32 v95, v128, v132, 1 bitop3:0x2
    v_cmp_eq_u32 vcc, 0, v95
    s_cbranch_vccnz gst_346
gbk_347:
    s_waitcnt lgkmcnt(3)
    v_mfma_f32_32x32x16_bf16 v[16:31], v[64:67], v[128:131], v[16:31]
    s_add_u32 s3, s100, 8192
    buffer_load_dwordx4 v[160:163], v1, s[48:51], s3 offen offset:0 sc1
    ds_read_b128 v[64:67], v1 offset:4096
    s_waitcnt lgkmcnt(3)
    v_mfma_f32_32x32x16_bf16 v[16:31], v[68:71], v[132:135], v[16:31]
    buffer_load_dwordx4 v[164:167], v1, s[48:51], s3 offen offset:1024 sc1
    ds_write_b128 v83, a[144:147] offset:4096
    ds_read_b128 v[68:71], v1 offset:5120
    s_waitcnt vmcnt(6)
    v_bitop3_b32 v95, v136, v140, 1 bitop3:0x2
    v_cmp_eq_u32 vcc, 0, v95
    s_cbranch_vccnz gst_350
gbk_351:
    s_waitcnt lgkmcnt(4)
    v_mfma_f32_32x32x16_bf16 v[16:31], v[72:75], v[136:139], v[16:31]
    buffer_load_dwordx4 v[168:171], v1, s[48:51], s3 offen offset:2048 sc1
    ds_write_b128 v83, a[148:151] offset:5120
    ds_read_b128 v[72:75], v1 offset:6144
    s_waitcnt lgkmcnt(5)
    v_mfma_f32_32x32x16_bf16 v[16:31], v[76:79], v[140:143], v[16:31]
    buffer_load_dwordx4 v[172:175], v1, s[48:51], s3 offen offset:3072 sc1
    ds_write_b128 v83, a[152:155] offset:6144
    ds_read_b128 v[76:79], v1 offset:7168
    s_waitcnt vmcnt(6)
    v_bitop3_b32 v95, v144, v148, 1 bitop3:0x2
    v_cmp_eq_u32 vcc, 0, v95
    s_cbranch_vccnz gst_354
gbk_355:
    s_waitcnt lgkmcnt(6)
    v_mfma_f32_32x32x16_bf16 v[16:31], v[64:67], v[144:147], v[16:31]
    s_add_u32 s3, s100, 12288
    buffer_load_dwordx4 v[176:179], v1, s[48:51], s3 offen offset:0 sc1
    ds_read_b128 v[64:67], v1 offset:8192
    s_waitcnt lgkmcnt(5)
    v_mfma_f32_32x32x16_bf16 v[16:31], v[68:71], v[148:151], v[16:31]
    buffer_load_dwordx4 v[180:183], v1, s[48:51], s3 offen offset:1024 sc1
    ds_write_b128 v83, a[156:159] offset:7168
    ds_read_b128 v[68:71], v1 offset:9216
    s_waitcnt vmcnt(6)
    v_bitop3_b32 v95, v152, v156, 1 bitop3:0x2
    v_cmp_eq_u32 vcc, 0, v95
    s_cbranch_vccnz gst_358
gbk_359:
    s_waitcnt lgkmcnt(5)
    v_mfma_f32_32x32x16_bf16 v[16:31], v[72:75], v[152:155], v[16:31]
    buffer_load_dwordx4 v[184:187], v1, s[48:51], s3 offen offset:2048 sc1
    ds_write_b128 v82, a[160:163] offset:32768
    ds_read_b128 v[72:75], v1 offset:10240
    s_waitcnt lgkmcnt(5)
    v_mfma_f32_32x32x16_bf16 v[16:31], v[76:79], v[156:159], v[16:31]
    buffer_load_dwordx4 v[188:191], v1, s[48:51], s3 offen offset:3072 sc1
    ds_read_b128 v[76:79], v1 offset:11264
    s_waitcnt vmcnt(6)
    v_bitop3_b32 v95, v160, v164, 1 bitop3:0x2
    v_cmp_eq_u32 vcc, 0, v95
    s_cbranch_vccnz gst_362
gbk_363:
    s_waitcnt lgkmcnt(5)
    v_mfma_f32_32x32x16_bf16 v[16:31], v[64:67], v[160:163], v[16:31]
    s_add_u32 s3, s100, 16384
    buffer_load_dwordx4 v[192:195], v1, s[48:51], s3 offen offset:0 sc1
    ds_write_b128 v82, a[164:167] offset:33792
    s_barrier
    ds_read_b128 v[64:67], v1 offset:12288
    s_waitcnt lgkmcnt(5)
    v_mfma_f32_32x32x16_bf16 v[16:31], v[68:71], v[164:167], v[16:31]
    buffer_load_dwordx4 v[196:199], v1, s[48:51], s3 offen offset:1024 sc1
    ds_write_b128 v82, a[168:171] offset:34816
    ds_read_b128 v[68:71], v1 offset:13312
    s_waitcnt vmcnt(6)
    v_bitop3_b32 v95, v168, v172, 1 bitop3:0x2
    v_cmp_eq_u32 vcc, 0, v95
    s_cbranch_vccnz gst_366
gbk_367:
    s_waitcnt lgkmcnt(5)
    v_mfma_f32_32x32x16_bf16 v[16:31], v[72:75], v[168:171], v[16:31]
    buffer_load_dwordx4 v[200:203], v1, s[48:51], s3 offen offset:2048 sc1
    ds_read_b128 v[72:75], v1 offset:14336
    s_waitcnt lgkmcnt(5)
    v_mfma_f32_32x32x16_bf16 v[16:31], v[76:79], v[172:175], v[16:31]
    buffer_load_dwordx4 v[204:207], v1, s[48:51], s3 offen offset:3072 sc1
    ds_write_b128 v82, a[172:175] offset:35840
    ds_read_b128 v[76:79], v1 offset:15360
    s_waitcnt vmcnt(6)
    v_bitop3_b32 v95, v176, v180, 1 bitop3:0x2
    v_cmp_eq_u32 vcc, 0, v95
    s_cbranch_vccnz gst_370
gbk_371:
    s_waitcnt lgkmcnt(5)
    v_mfma_f32_32x32x16_bf16 v[16:31], v[64:67], v[176:179], v[16:31]
    s_add_u32 s3, s100, 20480
    buffer_load_dwordx4 v[208:211], v1, s[48:51], s3 offen offset:0 sc1
    ds_write_b128 v82, a[176:179] offset:36864
    ds_read_b128 v[64:67], v1 offset:16384
    s_waitcnt lgkmcnt(5)
    v_mfma_f32_32x32x16_bf16 v[16:31], v[68:71], v[180:183], v[16:31]
    buffer_load_dwordx4 v[212:215], v1, s[48:51], s3 offen offset:1024 sc1
    ds_read_b128 v[68:71], v1 offset:17408
    s_waitcnt vmcnt(6)
    v_bitop3_b32 v95, v184, v188, 1 bitop3:0x2
    v_cmp_eq_u32 vcc, 0, v95
    s_cbranch_vccnz gst_374
gbk_375:
    s_waitcnt lgkmcnt(5)
    v_mfma_f32_32x32x16_bf16 v[16:31], v[72:75], v[184:187], v[16:31]
    buffer_load_dwordx4 v[216:219], v1, s[48:51], s3 offen offset:2048 sc1
    ds_write_b128 v82, a[180:183] offset:37888
    ds_read_b128 v[72:75], v1 offset:18432
    s_waitcnt lgkmcnt(5)
    v_mfma_f32_32x32x16_bf16 v[16:31], v[76:79], v[188:191], v[16:31]
    buffer_load_dwordx4 v[220:223], v1, s[48:51], s3 offen offset:3072 sc1
    ds_write_b128 v82, a[184:187] offset:38912
    ds_read_b128 v[76:79], v1 offset:19456
    s_waitcnt vmcnt(6)
    v_bitop3_b32 v95, v192, v196, 1 bitop3:0x2
    v_cmp_eq_u32 vcc, 0, v95
    s_cbranch_vccnz gst_378
gbk_379:
    s_waitcnt lgkmcnt(5)
    v_mfma_f32_32x32x16_bf16 v[16:31], v[64:67], v[192:195], v[16:31]
    s_add_u32 s3, s100, 24576
    buffer_load_dwordx4 v[224:227], v1, s[48:51], s3 offen offset:0 sc1
    ds_write_b128 v82, a[188:191] offset:39936
    ds_read_b128 v[64:67], v1 offset:20480
    s_waitcnt lgkmcnt(6)
    v_mfma_f32_32x32x16_bf16 v[16:31], v[68:71], v[196:199], v[16:31]
    buffer_load_dwordx4 v[228:231], v1, s[48:51], s3 offen offset:1024 sc1
    ds_read_b128 v[68:71], v1 offset:21504
    s_waitcnt vmcnt(6)
    v_bitop3_b32 v95, v200, v204, 1 bitop3:0x2
    v_cmp_eq_u32 vcc, 0, v95
    s_cbranch_vccnz gst_382
gbk_383:
    s_waitcnt lgkmcnt(5)
    v_mfma_f32_32x32x16_bf16 v[16:31], v[72:75], v[200:203], v[16:31]
    buffer_load_dwordx4 v[232:235], v1, s[48:51], s3 offen offset:2048 sc1
    ds_write_b128 v83, a[96:99] offset:32768
    ds_read_b128 v[72:75], v1 offset:22528
    s_waitcnt lgkmcnt(5)
    v_mfma_f32_32x32x16_bf16 v[16:31], v[76:79], v[204:207], v[16:31]
    buffer_load_dwordx4 v[236:239], v1, s[48:51], s3 offen offset:3072 sc1
    ds_write_b128 v83, a[100:103] offset:33792
    ds_read_b128 v[76:79], v1 offset:23552
    s_waitcnt vmcnt(6)
    v_bitop3_b32 v95, v208, v212, 1 bitop3:0x2
    v_cmp_eq_u32 vcc, 0, v95
    s_cbranch_vccnz gst_386
gbk_387:
    s_waitcnt lgkmcnt(5)
    v_mfma_f32_32x32x16_bf16 v[16:31], v[64:67], v[208:211], v[16:31]
    s_add_u32 s3, s100, 28672
    buffer_load_dwordx4 v[240:243], v1, s[48:51], s3 offen offset:0 sc1
    ds_read_b128 v[64:67], v1 offset:24576
    s_waitcnt lgkmcnt(5)
    v_mfma_f32_32x32x16_bf16 v[16:31], v[68:71], v[212:215], v[16:31]
    buffer_load_dwordx4 v[244:247], v1, s[48:51], s3 offen offset:1024 sc1
    ds_write_b128 v83, a[104:107] offset:34816
    ds_read_b128 v[68:71], v1 offset:25600
    s_waitcnt vmcnt(6)
    v_bitop3_b32 v95, v216, v220, 1 bitop3:0x2
    v_cmp_eq_u32 vcc, 0, v95
    s_cbranch_vccnz gst_390
gbk_391:
    s_waitcnt lgkmcnt(5)
    v_mfma_f32_32x32x16_bf16 v[16:31], v[72:75], v[216:219], v[16:31]
    buffer_load_dwordx4 v[248:251], v1, s[48:51], s3 offen offset:2048 sc1
    ds_write_b128 v83, a[108:111] offset:35840
    ds_read_b128 v[72:75], v1 offset:26624
    s_waitcnt lgkmcnt(5)
    v_mfma_f32_32x32x16_bf16 v[16:31], v[76:79], v[220:223], v[16:31]
    buffer_load_dwordx4 v[252:255], v1, s[48:51], s3 offen offset:3072 sc1
    ds_read_b128 v[76:79], v1 offset:27648
    s_waitcnt vmcnt(6)
    v_bitop3_b32 v95, v224, v228, 1 bitop3:0x2
    v_cmp_eq_u32 vcc, 0, v95
    s_cbranch_vccnz gst_394
gbk_395:
    s_waitcnt lgkmcnt(5)
    v_mfma_f32_32x32x16_bf16 v[16:31], v[64:67], v[224:227], v[16:31]
    ds_write_b128 v83, a[112:115] offset:36864
    ds_read_b128 v[64:67], v1 offset:28672
    s_waitcnt lgkmcnt(5)
    v_mfma_f32_32x32x16_bf16 v[16:31], v[68:71], v[228:231], v[16:31]
    ds_write_b128 v83, a[116:119] offset:37888
    ds_read_b128 v[68:71], v1 offset:29696
    s_waitcnt vmcnt(4)
    v_bitop3_b32 v95, v232, v236, 1 bitop3:0x2
    v_cmp_eq_u32 vcc, 0, v95
    s_cbranch_vccnz gst_398
gbk_399:
    s_waitcnt lgkmcnt(5)
    v_mfma_f32_32x32x16_bf16 v[16:31], v[72:75], v[232:235], v[16:31]
    ds_read_b128 v[72:75], v1 offset:30720
    s_waitcnt lgkmcnt(5)
    v_mfma_f32_32x32x16_bf16 v[16:31], v[76:79], v[236:239], v[16:31]
    ds_write_b128 v83, a[120:123] offset:38912
    ds_read_b128 v[76:79], v1 offset:31744
    s_waitcnt vmcnt(2)
    v_bitop3_b32 v95, v240, v244, 1 bitop3:0x2
    v_cmp_eq_u32 vcc, 0, v95
    s_cbranch_vccnz gst_402
gbk_403:
    s_waitcnt lgkmcnt(5)
    v_mfma_f32_32x32x16_bf16 v[16:31], v[64:67], v[240:243], v[16:31]
    ds_write_b128 v83, a[124:127] offset:39936
    s_waitcnt lgkmcnt(4)
    v_mfma_f32_32x32x16_bf16 v[16:31], v[68:71], v[244:247], v[16:31]
    s_waitcnt vmcnt(0)
    v_bitop3_b32 v95, v248, v252, 1 bitop3:0x2
    v_cmp_eq_u32 vcc, 0, v95
    s_cbranch_vccnz gst_406
gbk_407:
    s_waitcnt lgkmcnt(3)
    v_mfma_f32_32x32x16_bf16 v[16:31], v[72:75], v[248:251], v[16:31]
    s_waitcnt lgkmcnt(1)
    v_mfma_f32_32x32x16_bf16 v[16:31], v[76:79], v[252:255], v[16:31]
    s_nop 11
    v_cvt_pk_bf16_f32 v8, v16, v17
    v_cvt_pk_bf16_f32 v12, v24, v25
    v_and_b32 v16, 0xffff0000, v16
    v_and_b32 v24, 0xffff0000, v24
    v_cvt_pk_bf16_f32 v16, v16, v17
    v_cvt_pk_bf16_f32 v17, v18, v19
    v_cvt_pk_bf16_f32 v18, v20, v21
    v_cvt_pk_bf16_f32 v19, v22, v23
    v_cvt_pk_bf16_f32 v20, v24, v25
    v_cvt_pk_bf16_f32 v21, v26, v27
    v_cvt_pk_bf16_f32 v22, v28, v29
    v_cvt_pk_bf16_f32 v23, v30, v31
    v_or_b32 v16, 1, v16
    v_or_b32 v20, 1, v20
    s_cmp_lg_u32 s63, 0
    s_nop 0
    s_cbranch_scc0 fast_410
    buffer_store_dwordx4 v[16:19], v1, s[48:51], s61 offen
    buffer_store_dwordx4 v[20:23], v1, s[48:51], s61 offen offset:1024
    v_mov_b32 v94, 0
    v_mov_b32 v95, 0
    v_dot2c_f32_bf16 v94, s22, v16
    v_dot2c_f32_bf16 v95, v16, v16
    v_dot2c_f32_bf16 v94, s22, v17
    v_dot2c_f32_bf16 v95, v17, v17
    v_dot2c_f32_bf16 v94, s22, v18
    v_dot2c_f32_bf16 v95, v18, v18
    v_dot2c_f32_bf16 v94, s22, v19
    v_dot2c_f32_bf16 v95, v19, v19
    v_dot2c_f32_bf16 v94, s22, v20
    v_dot2c_f32_bf16 v95, v20, v20
    v_dot2c_f32_bf16 v94, s22, v21
    v_dot2c_f32_bf16 v95, v21, v21
    v_dot2c_f32_bf16 v94, s22, v22
    v_dot2c_f32_bf16 v95, v22, v22
    v_dot2c_f32_bf16 v94, s22, v23
    v_dot2c_f32_bf16 v95, v23, v23
    s_nop 1
    v_mov_b32 v92, v94
    v_mov_b32 v93, v95
    s_nop 0
    v_permlane32_swap_b32 v92, v94
    v_permlane32_swap_b32 v93, v95
    v_pk_add_f32 v[94:95], v[94:95], v[92:93]
    v_or_b32 v94, 1, v94
    buffer_store_dwordx2 v[94:95], v6, s[48:51], s101 offen
    s_nop 0
dend_411:
    v_mov_b32 v9, v17
    v_mov_b32 v10, v18
    v_mov_b32 v11, v19
    v_mov_b32 v13, v21
    v_mov_b32 v14, v22
    v_mov_b32_e64 v15, v23
    s_xor_b32 s62, s62, 0
    s_waitcnt lgkmcnt(0)
    s_barrier
    s_add_u32 s3, s60, 0
    buffer_load_dwordx4 v[128:131], v1, s[48:51], s3 offen offset:0 sc1
    buffer_load_dwordx4 v[132:135], v1, s[48:51], s3 offen offset:1024 sc1
    buffer_load_dwordx4 v[136:139], v1, s[48:51], s3 offen offset:2048 sc1
    buffer_load_dwordx4 v[140:143], v1, s[48:51], s3 offen offset:3072 sc1
    s_add_u32 s3, s60, 4096
    buffer_load_dwordx4 v[144:147], v1, s[48:51], s3 offen offset:0 sc1
    buffer_load_dwordx4 v[148:151], v1, s[48:51], s3 offen offset:1024 sc1
    buffer_load_dwordx4 v[152:155], v1, s[48:51], s3 offen offset:2048 sc1
    buffer_load_dwordx4 v[156:159], v1, s[48:51], s3 offen offset:3072 sc1
    ds_read_b128 v[64:67], v4 offset:0
    ds_read_b128 v[68:71], v1 offset:32768
    ds_read_b128 v[72:75], v4 offset:1024
    ds_read_b128 v[76:79], v1 offset:33792
    ds_read_b128 v[80:83], v4 offset:2048
    ds_read_b128 v[84:87], v1 offset:34816
    s_waitcnt vmcnt(6)
    v_bitop3_b32 v95, v128, v132, 1 bitop3:0x80
    v_cmp_eq_u32 vcc, 0, v95
    s_cbranch_vccnz gst_412
gbk_413:
    s_waitcnt lgkmcnt(4)
    v_mfma_f32_32x32x16_bf16 v[32:47], v[128:131], v[64:67], 0
    s_add_u32 s3, s60, 8192
    buffer_load_dwordx4 v[160:163], v1, s[48:51], s3 offen offset:0 sc1
    ds_read_b128 v[64:67], v4 offset:3072
    v_mfma_f32_32x32x16_bf16 v[48:63], v[128:131], v[68:71], 0
    ds_read_b128 v[68:71], v1 offset:35840
    s_waitcnt lgkmcnt(4)
    v_mfma_f32_32x32x16_bf16 v[32:47], v[132:135], v[72:75], v[32:47]
    buffer_load_dwordx4 v[164:167], v1, s[48:51], s3 offen offset:1024 sc1
    ds_read_b128 v[72:75], v4 offset:4096
    s_waitcnt vmcnt(6)
    v_bitop3_b32 v95, v136, v140, 1 bitop3:0x80
    v_cmp_eq_u32 vcc, 0, v95
    v_mfma_f32_32x32x16_bf16 v[48:63], v[132:135], v[76:79], v[48:63]
    ds_read_b128 v[76:79], v1 offset:36864
    s_cbranch_vccnz gst_416
gbk_417:
    s_waitcnt lgkmcnt(4)
    v_mfma_f32_32x32x16_bf16 v[32:47], v[136:139], v[80:83], v[32:47]
    buffer_load_dwordx4 v[168:171], v1, s[48:51], s3 offen offset:2048 sc1
    ds_read_b128 v[80:83], v4 offset:5120
    v_mfma_f32_32x32x16_bf16 v[48:63], v[136:139], v[84:87], v[48:63]
    ds_read_b128 v[84:87], v1 offset:37888
    s_waitcnt lgkmcnt(4)
    v_mfma_f32_32x32x16_bf16 v[32:47], v[140:143], v[64:67], v[32:47]
    buffer_load_dwordx4 v[172:175], v1, s[48:51], s3 offen offset:3072 sc1
    ds_read_b128 v[64:67], v4 offset:6144
    s_waitcnt vmcnt(6)
    v_bitop3_b32 v95, v144, v148, 1 bitop3:0x80
    v_cmp_eq_u32 vcc, 0, v95
    v_mfma_f32_32x32x16_bf16 v[48:63], v[140:143], v[68:71], v[48:63]
    ds_read_b128 v[68:71], v1 offset:38912
    s_cbranch_vccnz gst_420
gbk_421:
    s_waitcnt lgkmcnt(4)
    v_mfma_f32_32x32x16_bf16 v[32:47], v[144:147], v[72:75], v[32:47]
    s_add_u32 s3, s60, 12288
    buffer_load_dwordx4 v[176:179], v1, s[48:51], s3 offen offset:0 sc1
    ds_read_b128 v[72:75], v4 offset:7168
    v_mfma_f32_32x32x16_bf16 v[48:63], v[144:147], v[76:79], v[48:63]
    ds_read_b128 v[76:79], v1 offset:39936
    buffer_load_dwordx4 v[96:99], v1, s[48:51], s101 offen offset:0 sc1
    buffer_load_dwordx4 v[100:103], v1, s[48:51], s101 offen offset:1024 sc1
    buffer_load_dwordx4 v[104:107], v1, s[48:51], s101 offen offset:2048 sc1
    s_waitcnt lgkmcnt(4)
    v_mfma_f32_32x32x16_bf16 v[32:47], v[148:151], v[80:83], v[32:47]
    buffer_load_dwordx4 v[180:183], v1, s[48:51], s3 offen offset:1024 sc1
    ds_read_b128 v[80:83], v4 offset:8192
    s_waitcnt vmcnt(9)
    v_bitop3_b32 v95, v152, v156, 1 bitop3:0x80
    v_cmp_eq_u32 vcc, 0, v95
    v_mfma_f32_32x32x16_bf16 v[48:63], v[148:151], v[84:87], v[48:63]
    ds_read_b128 v[84:87], v1 offset:40960
    s_cbranch_vccnz gst_424
gbk_425:
    buffer_load_dwordx4 v[108:111], v1, s[48:51], s101 offen offset:3072 sc1
    s_waitcnt lgkmcnt(4)
    v_mfma_f32_32x32x16_bf16 v[32:47], v[152:155], v[64:67], v[32:47]
    buffer_load_dwordx4 v[184:187], v1, s[48:51], s3 offen offset:2048 sc1
    ds_read_b128 v[64:67], v4 offset:9216
    v_mfma_f32_32x32x16_bf16 v[48:63], v[152:155], v[68:71], v[48:63]
    ds_read_b128 v[68:71], v1 offset:41984
    s_waitcnt lgkmcnt(4)
    v_mfma_f32_32x32x16_bf16 v[32:47], v[156:159], v[72:75], v[32:47]
    buffer_load_dwordx4 v[188:191], v1, s[48:51], s3 offen offset:3072 sc1
    ds_read_b128 v[72:75], v4 offset:10240
    s_waitcnt vmcnt(10)
    v_bitop3_b32 v95, v160, v164, 1 bitop3:0x80
    v_cmp_eq_u32 vcc, 0, v95
    v_mfma_f32_32x32x16_bf16 v[48:63], v[156:159], v[76:79], v[48:63]
    ds_read_b128 v[76:79], v1 offset:43008
    s_cbranch_vccnz gst_428
gbk_429:
    s_waitcnt lgkmcnt(4)
    v_mfma_f32_32x32x16_bf16 v[32:47], v[160:163], v[80:83], v[32:47]
    s_add_u32 s3, s60, 16384
    buffer_load_dwordx4 v[192:195], v1, s[48:51], s3 offen offset:0 sc1
    ds_read_b128 v[80:83], v4 offset:11264
    v_mfma_f32_32x32x16_bf16 v[48:63], v[160:163], v[84:87], v[48:63]
    ds_read_b128 v[84:87], v1 offset:44032
    s_waitcnt lgkmcnt(4)
    v_mfma_f32_32x32x16_bf16 v[32:47], v[164:167], v[64:67], v[32:47]
    buffer_load_dwordx4 v[196:199], v1, s[48:51], s3 offen offset:1024 sc1
    ds_read_b128 v[64:67], v4 offset:12288
    s_waitcnt vmcnt(10)
    v_bitop3_b32 v95, v168, v172, 1 bitop3:0x80
    v_cmp_eq_u32 vcc, 0, v95
    v_mfma_f32_32x32x16_bf16 v[48:63], v[164:167], v[68:71], v[48:63]
    ds_read_b128 v[68:71], v1 offset:45056
    s_cbranch_vccnz gst_432
gbk_433:
    s_waitcnt lgkmcnt(4)
    v_mfma_f32_32x32x16_bf16 v[32:47], v[168:171], v[72:75], v[32:47]
    buffer_load_dwordx4 v[200:203], v1, s[48:51], s3 offen offset:2048 sc1
    ds_read_b128 v[72:75], v4 offset:13312
    v_mfma_f32_32x32x16_bf16 v[48:63], v[168:171], v[76:79], v[48:63]
    ds_read_b128 v[76:79], v1 offset:46080
    s_waitcnt lgkmcnt(4)
    v_mfma_f32_32x32x16_bf16 v[32:47], v[172:175], v[80:83], v[32:47]
    buffer_load_dwordx4 v[204:207], v1, s[48:51], s3 offen offset:3072 sc1
    ds_read_b128 v[80:83], v4 offset:14336
    s_waitcnt vmcnt(7)
    v_bitop3_b32 v95, v176, v180, 1 bitop3:0x80
    v_cmp_eq_u32 vcc, 0, v95
    v_mfma_f32_32x32x16_bf16 v[48:63], v[172:175], v[84:87], v[48:63]
    ds_read_b128 v[84:87], v1 offset:47104
    s_cbranch_vccnz gst_436
gbk_437:
    s_waitcnt lgkmcnt(4)
    v_mfma_f32_32x32x16_bf16 v[32:47], v[176:179], v[64:67], v[32:47]
    s_add_u32 s3, s60, 20480
    buffer_load_dwordx4 v[208:211], v1, s[48:51], s3 offen offset:0 sc1
    ds_read_b128 v[64:67], v4 offset:15360
    v_mfma_f32_32x32x16_bf16 v[48:63], v[176:179], v[68:71], v[48:63]
    ds_read_b128 v[68:71], v1 offset:48128
    s_waitcnt lgkmcnt(4)
    v_mfma_f32_32x32x16_bf16 v[32:47], v[180:183], v[72:75], v[32:47]
    buffer_load_dwordx4 v[212:215], v1, s[48:51], s3 offen offset:1024 sc1
    ds_read_b128 v[72:75], v4 offset:16384
    s_waitcnt vmcnt(6)
    v_bitop3_b32 v95, v184, v188, 1 bitop3:0x80
    v_cmp_eq_u32 vcc, 0, v95
    v_mfma_f32_32x32x16_bf16 v[48:63], v[180:183], v[76:79], v[48:63]
    ds_read_b128 v[76:79], v1 offset:49152
    s_cbranch_vccnz gst_440
gbk_441:
    s_waitcnt lgkmcnt(4)
    v_mfma_f32_32x32x16_bf16 v[32:47], v[184:187], v[80:83], v[32:47]
    buffer_load_dwordx4 v[216:219], v1, s[48:51], s3 offen offset:2048 sc1
    ds_read_b128 v[80:83], v4 offset:17408
    v_mfma_f32_32x32x16_bf16 v[48:63], v[184:187], v[84:87], v[48:63]
    ds_read_b128 v[84:87], v1 offset:50176
    s_waitcnt lgkmcnt(4)
    v_mfma_f32_32x32x16_bf16 v[32:47], v[188:191], v[64:67], v[32:47]
    buffer_load_dwordx4 v[220:223], v1, s[48:51], s3 offen offset:3072 sc1
    ds_read_b128 v[64:67], v4 offset:18432
    s_waitcnt vmcnt(6)
    v_bitop3_b32 v95, v192, v196, 1 bitop3:0x80
    v_cmp_eq_u32 vcc, 0, v95
    v_mfma_f32_32x32x16_bf16 v[48:63], v[188:191], v[68:71], v[48:63]
    ds_read_b128 v[68:71], v1 offset:51200
    s_cbranch_vccnz gst_444
gbk_445:
    v_bitop3_b32 v93, v96, v98, v100 bitop3:0x80
    v_bitop3_b32 v93, v93, v102, v104 bitop3:0x80
    s_waitcnt lgkmcnt(4)
    v_mfma_f32_32x32x16_bf16 v[32:47], v[192:195], v[72:75], v[32:47]
    s_add_u32 s3, s60, 24576
    buffer_load_dwordx4 v[224:227], v1, s[48:51], s3 offen offset:0 sc1
    ds_read_b128 v[72:75], v4 offset:19456
    v_bitop3_b32 v93, v93, v106, v108 bitop3:0x80
    v_bitop3_b32 v93, v93, v110, 1 bitop3:0x80
    v_mfma_f32_32x32x16_bf16 v[48:63], v[192:195], v[76:79], v[48:63]
    ds_read_b128 v[76:79], v1 offset:52224
    v_cmp_eq_u32 s[10:11], 0, v93
    s_nop 0
    s_cmp_lg_u64 s[10:11], 0
    s_cbranch_scc1 sst_448
sbk_449:
    s_waitcnt lgkmcnt(4)
    v_mfma_f32_32x32x16_bf16 v[32:47], v[196:199], v[80:83], v[32:47]
    buffer_load_dwordx4 v[228:231], v1, s[48:51], s3 offen offset:1024 sc1
    ds_read_b128 v[80:83], v4 offset:20480
    s_waitcnt vmcnt(6)
    v_bitop3_b32 v95, v200, v204, 1 bitop3:0x80
    v_cmp_eq_u32 vcc, 0, v95
    v_mfma_f32_32x32x16_bf16 v[48:63], v[196:199], v[84:87], v[48:63]
    ds_read_b128 v[84:87], v1 offset:53248
    s_cbranch_vccnz gst_452
gbk_453:
    v_add_f32 v96, v96, v98
    v_add_f32 v97, v97, v99
    s_waitcnt lgkmcnt(4)
    v_mfma_f32_32x32x16_bf16 v[32:47], v[200:203], v[64:67], v[32:47]
    buffer_load_dwordx4 v[232:235], v1, s[48:51], s3 offen offset:2048 sc1
    ds_read_b128 v[64:67], v4 offset:21504
    v_add_f32 v100, v100, v102
    v_add_f32 v101, v101, v103
    v_add_f32 v104, v104, v106
    v_mfma_f32_32x32x16_bf16 v[48:63], v[200:203], v[68:71], v[48:63]
    ds_read_b128 v[68:71], v1 offset:54272
    v_add_f32 v105, v105, v107
    v_add_f32 v108, v108, v110
    v_add_f32 v109, v109, v111
    s_waitcnt lgkmcnt(4)
    v_mfma_f32_32x32x16_bf16 v[32:47], v[204:207], v[72:75], v[32:47]
    buffer_load_dwordx4 v[236:239], v1, s[48:51], s3 offen offset:3072 sc1
    ds_read_b128 v[72:75], v4 offset:22528
    s_waitcnt vmcnt(6)
    v_bitop3_b32 v95, v208, v212, 1 bitop3:0x80
    v_cmp_eq_u32 vcc, 0, v95
    v_mfma_f32_32x32x16_bf16 v[48:63], v[204:207], v[76:79], v[48:63]
    ds_read_b128 v[76:79], v1 offset:55296
    s_cbranch_vccnz gst_456
gbk_457:
    v_add_f32 v96, v96, v100
    v_add_f32 v97, v97, v101
    s_waitcnt lgkmcnt(4)
    v_mfma_f32_32x32x16_bf16 v[32:47], v[208:211], v[80:83], v[32:47]
    s_add_u32 s3, s60, 28672
    buffer_load_dwordx4 v[240:243], v1, s[48:51], s3 offen offset:0 sc1
    ds_read_b128 v[80:83], v4 offset:23552
    v_add_f32 v104, v104, v108
    v_add_f32 v105, v105, v109
    v_mfma_f32_32x32x16_bf16 v[48:63], v[208:211], v[84:87], v[48:63]
    ds_read_b128 v[84:87], v1 offset:56320
    v_add_f32 v96, v96, v104
    v_add_f32 v97, v97, v105
    v_mov_b32 v98, v96
    s_waitcnt lgkmcnt(4)
    v_mfma_f32_32x32x16_bf16 v[32:47], v[212:215], v[64:67], v[32:47]
    buffer_load_dwordx4 v[244:247], v1, s[48:51], s3 offen offset:1024 sc1
    ds_read_b128 v[64:67], v4 offset:24576
    s_waitcnt vmcnt(6)
    v_bitop3_b32 v95, v216, v220, 1 bitop3:0x80
    v_cmp_eq_u32 vcc, 0, v95
    v_mfma_f32_32x32x16_bf16 v[48:63], v[212:215], v[68:71], v[48:63]
    ds_read_b128 v[68:71], v1 offset:57344
    s_cbranch_vccnz gst_460
gbk_461:
    v_mov_b32 v99, v97
    v_permlane32_swap_b32 v98, v96
    s_waitcnt lgkmcnt(4)
    v_mfma_f32_32x32x16_bf16 v[32:47], v[216:219], v[72:75], v[32:47]
    buffer_load_dwordx4 v[248:251], v1, s[48:51], s3 offen offset:2048 sc1
    ds_read_b128 v[72:75], v4 offset:25600
    v_permlane32_swap_b32 v99, v97
    v_add_f32 v96, v96, v98
    v_add_f32 v97, v97, v99
    v_mfma_f32_32x32x16_bf16 v[48:63], v[216:219], v[76:79], v[48:63]
    ds_read_b128 v[76:79], v1 offset:58368
    v_mul_f32 v96, 0x3b000000, v96
    v_mul_f32 v97, 0x3b000000, v97
    v_fma_f32 v97, -v96, v96, v97
    s_waitcnt lgkmcnt(4)
    v_mfma_f32_32x32x16_bf16 v[32:47], v[220:223], v[80:83], v[32:47]
    buffer_load_dwordx4 v[252:255], v1, s[48:51], s3 offen offset:3072 sc1
    ds_read_b128 v[80:83], v4 offset:26624
    s_waitcnt vmcnt(6)
    v_bitop3_b32 v95, v224, v228, 1 bitop3:0x80
    v_cmp_eq_u32 vcc, 0, v95
    v_mfma_f32_32x32x16_bf16 v[48:63], v[220:223], v[84:87], v[48:63]
    ds_read_b128 v[84:87], v1 offset:59392
    s_cbranch_vccnz gst_464
gbk_465:
    v_max_f32 v97, 0, v97
    v_add_f32 v97, 0x3727c5ac, v97
    s_waitcnt lgkmcnt(4)
    v_mfma_f32_32x32x16_bf16 v[32:47], v[224:227], v[64:67], v[32:47]
    ds_read_b128 v[64:67], v4 offset:27648
    v_rsq_f32 v88, v97
    s_nop 0
    v_mul_f32 v90, v96, v88
    s_lshl_b32 s5, s58, 8
    v_mfma_f32_32x32x16_bf16 v[48:63], v[224:227], v[68:71], v[48:63]
    ds_read_b128 v[68:71], v1 offset:60416
    s_add_u32 s5, s5, 147456
    v_lshl_add_u32 v98, v0, 2, s5
    v_cndmask_b32 v99, v88, v90, s[12:13]
    s_waitcnt lgkmcnt(4)
    v_mfma_f32_32x32x16_bf16 v[32:47], v[228:231], v[72:75], v[32:47]
    ds_read_b128 v[72:75], v4 offset:28672
    ds_write_b32 v98, v99
    s_waitcnt vmcnt(4)
    v_bitop3_b32 v95, v232, v236, 1 bitop3:0x80
    v_cmp_eq_u32 vcc, 0, v95
    v_mfma_f32_32x32x16_bf16 v[48:63], v[228:231], v[76:79], v[48:63]
    ds_read_b128 v[76:79], v1 offset:61440
    s_cbranch_vccnz gst_468
gbk_469:
    v_lshrrev_b32 v89, 5, v0
    v_lshlrev_b32 v91, 4, v89
    s_waitcnt lgkmcnt(5)
    v_mfma_f32_32x32x16_bf16 v[32:47], v[232:235], v[80:83], v[32:47]
    ds_read_b128 v[80:83], v4 offset:29696
    v_add_u32 v89, s5, v91
    v_add_u32 v91, 0x24580, v91
    ds_read_b128 v[96:99], v89 offset:0
    ds_read_b128 v[16:19], v89 offset:128
    v_mfma_f32_32x32x16_bf16 v[48:63], v[232:235], v[84:87], v[48:63]
    ds_read_b128 v[84:87], v1 offset:62464
    ds_read_b128 v[100:103], v89 offset:32
    ds_read_b128 v[20:23], v89 offset:160
    ds_read_b128 v[104:107], v89 offset:64
    s_waitcnt lgkmcnt(10)
    v_mfma_f32_32x32x16_bf16 v[32:47], v[236:239], v[64:67], v[32:47]
    ds_read_b128 v[64:67], v4 offset:30720
    ds_read_b128 v[24:27], v89 offset:192
    s_waitcnt vmcnt(2)
    v_bitop3_b32 v95, v240, v244, 1 bitop3:0x80
    v_cmp_eq_u32 vcc, 0, v95
    v_mfma_f32_32x32x16_bf16 v[48:63], v[236:239], v[68:71], v[48:63]
    ds_read_b128 v[68:71], v1 offset:63488
    s_cbranch_vccnz gst_472
gbk_473:
    ds_read_b128 v[108:111], v89 offset:96
    ds_read_b128 v[28:31], v89 offset:224
    s_waitcnt lgkmcnt(12)
    v_mfma_f32_32x32x16_bf16 v[32:47], v[240:243], v[72:75], v[32:47]
    ds_read_b128 v[72:75], v4 offset:31744
    v_and_b32 v93, 31, v0
    v_lshlrev_b32 v93, 2, v93
    v_add_u32 v93, 0x24580, v93
    ds_read_b32 v92, v93 offset:256
    v_mfma_f32_32x32x16_bf16 v[48:63], v[240:243], v[76:79], v[48:63]
    ds_read_b128 v[76:79], v1 offset:64512
    ds_read_b32 v94, v93 offset:128
    s_waitcnt lgkmcnt(12)
    v_mfma_f32_32x32x16_bf16 v[32:47], v[244:247], v[80:83], v[32:47]
    s_waitcnt vmcnt(0)
    v_bitop3_b32 v95, v248, v252, 1 bitop3:0x80
    v_cmp_eq_u32 vcc, 0, v95
    v_mfma_f32_32x32x16_bf16 v[48:63], v[244:247], v[84:87], v[48:63]
    s_cbranch_vccnz gst_476
gbk_477:
    s_waitcnt lgkmcnt(6)
    v_mfma_f32_32x32x16_bf16 v[32:47], v[248:251], v[64:67], v[32:47]
    v_mfma_f32_32x32x16_bf16 v[48:63], v[248:251], v[68:71], v[48:63]
    s_waitcnt lgkmcnt(1)
    v_mfma_f32_32x32x16_bf16 v[32:47], v[252:255], v[72:75], v[32:47]
    v_mfma_f32_32x32x16_bf16 v[48:63], v[252:255], v[76:79], v[48:63]
    s_waitcnt lgkmcnt(0)
    v_mov_b32 v64, s22
    v_mov_b32 v65, s22
    v_mov_b32 v66, s22
    v_mov_b32 v67, s22
    s_add_u32 s4, s9, 131072
    v_add_u32 v68, s4, v1
    s_mov_b32 s16, 0x100000
    s_lshl_b32 s4, s56, 12
    s_add_u32 s4, s4, s16
    s_nop 0
    v_pk_fma_f32 v[32:33], v[32:33], v[96:97], s[30:31]
    v_pk_fma_f32 v[34:35], v[34:35], v[98:99], s[30:31]
    v_pk_fma_f32 v[36:37], v[36:37], v[100:101], s[30:31]
    v_pk_fma_f32 v[38:39], v[38:39], v[102:103], s[30:31]
    v_pk_fma_f32 v[40:41], v[40:41], v[104:105], s[30:31]
    v_pk_fma_f32 v[42:43], v[42:43], v[106:107], s[30:31]
    v_pk_fma_f32 v[44:45], v[44:45], v[108:109], s[30:31]
    v_pk_fma_f32 v[46:47], v[46:47], v[110:111], s[30:31]
    v_pk_fma_f32 v[32:33], v[16:17], v[94:95], v[32:33] op_sel_hi:[1,0,1] neg_lo:[0,1,0] neg_hi:[0,1,0]
    v_pk_fma_f32 v[34:35], v[18:19], v[94:95], v[34:35] op_sel_hi:[1,0,1] neg_lo:[0,1,0] neg_hi:[0,1,0]
    v_pk_fma_f32 v[36:37], v[20:21], v[94:95], v[36:37] op_sel_hi:[1,0,1] neg_lo:[0,1,0] neg_hi:[0,1,0]
    v_pk_fma_f32 v[38:39], v[22:23], v[94:95], v[38:39] op_sel_hi:[1,0,1] neg_lo:[0,1,0] neg_hi:[0,1,0]
    v_pk_fma_f32 v[40:41], v[24:25], v[94:95], v[40:41] op_sel_hi:[1,0,1] neg_lo:[0,1,0] neg_hi:[0,1,0]
    v_pk_fma_f32 v[42:43], v[26:27], v[94:95], v[42:43] op_sel_hi:[1,0,1] neg_lo:[0,1,0] neg_hi:[0,1,0]
    v_pk_fma_f32 v[44:45], v[28:29], v[94:95], v[44:45] op_sel_hi:[1,0,1] neg_lo:[0,1,0] neg_hi:[0,1,0]
    v_pk_fma_f32 v[46:47], v[30:31], v[94:95], v[46:47] op_sel_hi:[1,0,1] neg_lo:[0,1,0] neg_hi:[0,1,0]
    v_pk_mul_f32 v[48:49], v[48:49], v[96:97]
    v_pk_mul_f32 v[50:51], v[50:51], v[98:99]
    v_pk_mul_f32 v[52:53], v[52:53], v[100:101]
    v_pk_mul_f32 v[54:55], v[54:55], v[102:103]
    v_pk_mul_f32 v[56:57], v[56:57], v[104:105]
    v_pk_mul_f32 v[58:59], v[58:59], v[106:107]
    v_pk_mul_f32 v[60:61], v[60:61], v[108:109]
    v_pk_mul_f32 v[62:63], v[62:63], v[110:111]
    v_pk_fma_f32 v[48:49], v[16:17], v[92:93], v[48:49] op_sel_hi:[1,0,1] neg_lo:[0,1,0] neg_hi:[0,1,0]
    v_pk_fma_f32 v[50:51], v[18:19], v[92:93], v[50:51] op_sel_hi:[1,0,1] neg_lo:[0,1,0] neg_hi:[0,1,0]
    v_pk_fma_f32 v[52:53], v[20:21], v[92:93], v[52:53] op_sel_hi:[1,0,1] neg_lo:[0,1,0] neg_hi:[0,1,0]
    v_pk_fma_f32 v[54:55], v[22:23], v[92:93], v[54:55] op_sel_hi:[1,0,1] neg_lo:[0,1,0] neg_hi:[0,1,0]
    v_pk_fma_f32 v[56:57], v[24:25], v[92:93], v[56:57] op_sel_hi:[1,0,1] neg_lo:[0,1,0] neg_hi:[0,1,0]
    v_pk_fma_f32 v[58:59], v[26:27], v[92:93], v[58:59] op_sel_hi:[1,0,1] neg_lo:[0,1,0] neg_hi:[0,1,0]
    v_pk_fma_f32 v[60:61], v[28:29], v[92:93], v[60:61] op_sel_hi:[1,0,1] neg_lo:[0,1,0] neg_hi:[0,1,0]
    v_pk_fma_f32 v[62:63], v[30:31], v[92:93], v[62:63] op_sel_hi:[1,0,1] neg_lo:[0,1,0] neg_hi:[0,1,0]
    v_cvt_pk_bf16_f32 v48, v48, v49
    v_cvt_pk_bf16_f32 v49, v50, v51
    v_cvt_pk_bf16_f32 v50, v52, v53
    v_cvt_pk_bf16_f32 v51, v54, v55
    v_cvt_pk_bf16_f32 v52, v56, v57
    v_cvt_pk_bf16_f32 v53, v58, v59
    v_cvt_pk_bf16_f32 v54, v60, v61
    v_cvt_pk_bf16_f32 v55, v62, v63
    v_pk_mul_f32 v[96:97], v[32:33], s[28:29]
    v_pk_mul_f32 v[98:99], v[34:35], s[28:29]
    v_pk_mul_f32 v[100:101], v[36:37], s[28:29]
    v_pk_mul_f32 v[102:103], v[38:39], s[28:29]
    v_pk_mul_f32 v[104:105], v[40:41], s[28:29]
    v_pk_mul_f32 v[106:107], v[42:43], s[28:29]
    v_pk_mul_f32 v[108:109], v[44:45], s[28:29]
    v_pk_mul_f32 v[110:111], v[46:47], s[28:29]
    v_exp_f32_e64 v96, v96 clamp
    v_max_f32 v32, s30, v32
    v_exp_f32_e64 v97, v97 clamp
    v_max_f32 v33, s30, v33
    v_exp_f32_e64 v98, v98 clamp
    v_max_f32 v34, s30, v34
    v_exp_f32_e64 v99, v99 clamp
    v_max_f32 v35, s30, v35
    v_exp_f32_e64 v100, v100 clamp
    v_max_f32 v36, s30, v36
    v_exp_f32_e64 v101, v101 clamp
    v_max_f32 v37, s30, v37
    v_exp_f32_e64 v102, v102 clamp
    v_max_f32 v38, s30, v38
    v_exp_f32_e64 v103, v103 clamp
    v_max_f32 v39, s30, v39
    v_exp_f32_e64 v104, v104 clamp
    v_max_f32 v40, s30, v40
    v_exp_f32_e64 v105, v105 clamp
    v_max_f32 v41, s30, v41
    v_exp_f32_e64 v106, v106 clamp
    v_max_f32 v42, s30, v42
    v_exp_f32_e64 v107, v107 clamp
    v_max_f32 v43, s30, v43
    v_exp_f32_e64 v108, v108 clamp
    v_max_f32 v44, s30, v44
    v_exp_f32_e64 v109, v109 clamp
    v_max_f32 v45, s30, v45
    v_exp_f32_e64 v110, v110 clamp
    v_max_f32 v46, s30, v46
    v_exp_f32_e64 v111, v111 clamp
    v_max_f32 v47, s30, v47
    v_pk_add_f32 v[32:33], v[32:33], v[96:97]
    v_pk_add_f32 v[34:35], v[34:35], v[98:99]
    v_pk_add_f32 v[36:37], v[36:37], v[100:101]
    v_pk_add_f32 v[38:39], v[38:39], v[102:103]
    v_pk_add_f32 v[40:41], v[40:41], v[104:105]
    v_pk_add_f32 v[42:43], v[42:43], v[106:107]
    v_pk_add_f32 v[44:45], v[44:45], v[108:109]
    v_pk_add_f32 v[46:47], v[46:47], v[110:111]
    v_cvt_pk_bf16_f32 v32, v32, v33
    v_cvt_pk_bf16_f32 v33, v34, v35
    v_cvt_pk_bf16_f32 v34, v36, v37
    v_cvt_pk_bf16_f32 v35, v38, v39
    v_cvt_pk_bf16_f32 v36, v40, v41
    v_cvt_pk_bf16_f32 v37, v42, v43
    v_mfma_f32_32x32x16_bf16 v[96:111], v[32:35], v[48:51], 0
    v_cvt_pk_bf16_f32 v38, v44, v45
    v_cvt_pk_bf16_f32 v39, v46, v47
    s_nop 1
    v_mfma_f32_32x32x16_bf16 v[96:111], v[36:39], v[52:55], v[96:111]
    v_mfma_f32_32x32x16_bf16 v[112:127], v[32:35], v[64:67], 0
    v_mfma_f32_32x32x16_bf16 v[112:127], v[36:39], v[64:67], v[112:127]
    s_nop 9
    v_cndmask_b32 v32, v104, v96, s[96:97]
    v_cndmask_b32 v33, v105, v97, s[96:97]
    v_cndmask_b32 v34, v106, v98, s[96:97]
    v_cndmask_b32 v35, v107, v99, s[96:97]
    v_cndmask_b32 v36, v108, v100, s[96:97]
    v_cndmask_b32 v37, v109, v101, s[96:97]
    v_cndmask_b32 v38, v110, v102, s[96:97]
    v_cndmask_b32 v39, v111, v103, s[96:97]
    ds_write_b128 v7, v[32:35] offset:32768
    ds_write_b128 v7, v[36:39] offset:33792
    v_cndmask_b32 v40, v112, v120, s[96:97]
    v_cndmask_b32 v41, v113, v121, s[96:97]
    v_cndmask_b32 v42, v114, v122, s[96:97]
    v_cndmask_b32 v43, v115, v123, s[96:97]
    v_cndmask_b32 v44, v116, v124, s[96:97]
    v_cndmask_b32 v45, v117, v125, s[96:97]
    v_cndmask_b32 v46, v118, v126, s[96:97]
    v_cndmask_b32 v47, v119, v127, s[96:97]
    ds_write_b128 v7, v[40:43] offset:34816
    ds_write_b128 v7, v[44:47] offset:35840
    s_waitcnt lgkmcnt(0)
    s_barrier
    ds_read_b128 v[32:35], v68 offset:0
    ds_read_b128 v[36:39], v68 offset:4096
    ds_read_b128 v[40:43], v68 offset:8192
    ds_read_b128 v[44:47], v68 offset:12288
    s_waitcnt lgkmcnt(0)
    v_pk_add_f32 v[32:33], v[32:33], v[36:37]
    v_pk_add_f32 v[34:35], v[34:35], v[38:39]
    v_pk_add_f32 v[40:41], v[40:41], v[44:45]
    v_pk_add_f32 v[42:43], v[42:43], v[46:47]
    v_pk_add_f32 v[32:33], v[32:33], v[40:41]
    v_pk_add_f32 v[34:35], v[34:35], v[42:43]
    v_or_b32_e64 v32, 1, v32
    buffer_store_dwordx4 v[32:35], v5, s[48:51], s4 offen sc0 sc1
    ds_read_b128 v[64:67], v4 offset:32768
    ds_read_b128 v[68:71], v4 offset:33792
    ds_read_b128 v[72:75], v4 offset:34816
    s_waitcnt lgkmcnt(2)
    v_mfma_f32_32x32x16_bf16 v[16:31], v[64:67], v[128:131], 0
    ds_read_b128 v[76:79], v4 offset:35840
    ds_read_b128 v[112:115], v91 offset:0
    ds_read_b128 v[116:119], v91 offset:32
    ds_read_b128 v[120:123], v91 offset:64
    ds_read_b128 v[124:127], v91 offset:96
    s_waitcnt lgkmcnt(6)
    v_mfma_f32_32x32x16_bf16 v[16:31], v[68:71], v[132:135], v[16:31]
    ds_read_b128 v[64:67], v4 offset:36864
    s_waitcnt lgkmcnt(6)
    v_mfma_f32_32x32x16_bf16 v[16:31], v[72:75], v[136:139], v[16:31]
    ds_read_b128 v[68:71], v4 offset:37888
    s_waitcnt lgkmcnt(6)
    v_mfma_f32_32x32x16_bf16 v[16:31], v[76:79], v[140:143], v[16:31]
    ds_read_b128 v[72:75], v4 offset:38912
    s_waitcnt lgkmcnt(2)
    v_mfma_f32_32x32x16_bf16 v[16:31], v[64:67], v[144:147], v[16:31]
    ds_read_b128 v[76:79], v4 offset:39936
    s_waitcnt lgkmcnt(2)
    v_mfma_f32_32x32x16_bf16 v[16:31], v[68:71], v[148:151], v[16:31]
    ds_read_b128 v[64:67], v4 offset:40960
    s_waitcnt lgkmcnt(2)
    v_mfma_f32_32x32x16_bf16 v[16:31], v[72:75], v[152:155], v[16:31]
    ds_read_b128 v[68:71], v4 offset:41984
    s_waitcnt lgkmcnt(2)
    v_mfma_f32_32x32x16_bf16 v[16:31], v[76:79], v[156:159], v[16:31]
    ds_read_b128 v[72:75], v4 offset:43008
    s_waitcnt lgkmcnt(2)
    v_mfma_f32_32x32x16_bf16 v[16:31], v[64:67], v[160:163], v[16:31]
    ds_read_b128 v[76:79], v4 offset:44032
    s_waitcnt lgkmcnt(2)
    v_mfma_f32_32x32x16_bf16 v[16:31], v[68:71], v[164:167], v[16:31]
    ds_read_b128 v[64:67], v4 offset:45056
    s_waitcnt lgkmcnt(2)
    v_mfma_f32_32x32x16_bf16 v[16:31], v[72:75], v[168:171], v[16:31]
    ds_read_b128 v[68:71], v4 offset:46080
    s_waitcnt lgkmcnt(2)
    v_mfma_f32_32x32x16_bf16 v[16:31], v[76:79], v[172:175], v[16:31]
    ds_read_b128 v[72:75], v4 offset:47104
    s_waitcnt lgkmcnt(2)
    v_mfma_f32_32x32x16_bf16 v[16:31], v[64:67], v[176:179], v[16:31]
    ds_read_b128 v[76:79], v4 offset:48128
    s_waitcnt lgkmcnt(2)
    v_mfma_f32_32x32x16_bf16 v[16:31], v[68:71], v[180:183], v[16:31]
    ds_read_b128 v[64:67], v4 offset:49152
    s_lshl_b32 s4, s57, 16
    s_add_u32 s4, s4, s16
    s_add_u32 s4, s4, 0x500000
    s_lshr_b32 s5, s58, 1
    s_lshl_b32 s5, s5, 15
    s_add_u32 s20, s4, s5
    s_and_b32 s5, s58, 1
    s_lshl_b32 s10, s5, 15
    s_add_u32 s21, s4, s10
    s_waitcnt lgkmcnt(2)
    v_mfma_f32_32x32x16_bf16 v[16:31], v[72:75], v[184:187], v[16:31]
    ds_read_b128 v[68:71], v4 offset:50176
    s_lshl_b32 s5, s5, 10
    s_add_u32 s20, s20, s5
    v_lshrrev_b32 v57, 4, v0
    v_lshlrev_b32 v57, 5, v57
    v_and_b32 v58, 1, v0
    v_lshl_add_u32 v57, v58, 4, v57
    s_waitcnt lgkmcnt(2)
    v_mfma_f32_32x32x16_bf16 v[16:31], v[76:79], v[188:191], v[16:31]
    ds_read_b128 v[72:75], v4 offset:51200
    v_add_u32 v59, 157696, v57
    v_bfe_u32 v58, v0, 1, 3
    v_lshl_add_u32 v57, v58, 12, v57
    s_lshl_b32 s5, s58, 7
    v_add_u32 v59, s5, v59
    s_waitcnt lgkmcnt(2)
    v_mfma_f32_32x32x16_bf16 v[16:31], v[64:67], v[192:195], v[16:31]
    ds_read_b128 v[76:79], v4 offset:52224
    s_waitcnt lgkmcnt(2)
    v_mfma_f32_32x32x16_bf16 v[16:31], v[68:71], v[196:199], v[16:31]
    ds_read_b128 v[64:67], v4 offset:53248
    s_waitcnt lgkmcnt(2)
    v_mfma_f32_32x32x16_bf16 v[16:31], v[72:75], v[200:203], v[16:31]
    ds_read_b128 v[68:71], v4 offset:54272
    s_waitcnt lgkmcnt(2)
    v_mfma_f32_32x32x16_bf16 v[16:31], v[76:79], v[204:207], v[16:31]
    ds_read_b128 v[72:75], v4 offset:55296
    s_waitcnt lgkmcnt(2)
    v_mfma_f32_32x32x16_bf16 v[16:31], v[64:67], v[208:211], v[16:31]
    ds_read_b128 v[76:79], v4 offset:56320
    s_waitcnt lgkmcnt(2)
    v_mfma_f32_32x32x16_bf16 v[16:31], v[68:71], v[212:215], v[16:31]
    ds_read_b128 v[64:67], v4 offset:57344
    s_waitcnt lgkmcnt(2)
    v_mfma_f32_32x32x16_bf16 v[16:31], v[72:75], v[216:219], v[16:31]
    ds_read_b128 v[68:71], v4 offset:58368
    s_waitcnt lgkmcnt(2)
    v_mfma_f32_32x32x16_bf16 v[16:31], v[76:79], v[220:223], v[16:31]
    ds_read_b128 v[72:75], v4 offset:59392
    s_waitcnt lgkmcnt(2)
    v_mfma_f32_32x32x16_bf16 v[16:31], v[64:67], v[224:227], v[16:31]
    ds_read_b128 v[76:79], v4 offset:60416
    s_waitcnt lgkmcnt(2)
    v_mfma_f32_32x32x16_bf16 v[16:31], v[68:71], v[228:231], v[16:31]
    ds_read_b128 v[64:67], v4 offset:61440
    s_waitcnt lgkmcnt(2)
    v_mfma_f32_32x32x16_bf16 v[16:31], v[72:75], v[232:235], v[16:31]
    ds_read_b128 v[68:71], v4 offset:62464
    s_add_u32 s7, s20, 0
    buffer_load_dwordx4 v[128:131], v1, s[48:51], s7 offen sc1
    s_waitcnt lgkmcnt(2)
    v_mfma_f32_32x32x16_bf16 v[16:31], v[76:79], v[236:239], v[16:31]
    ds_read_b128 v[72:75], v4 offset:63488
    s_add_u32 s7, s20, 4096
    buffer_load_dwordx4 v[132:135], v1, s[48:51], s7 offen sc1
    s_waitcnt lgkmcnt(2)
    v_mfma_f32_32x32x16_bf16 v[16:31], v[64:67], v[240:243], v[16:31]
    ds_read_b128 v[76:79], v4 offset:64512
    s_add_u32 s7, s20, 8192
    buffer_load_dwordx4 v[136:139], v1, s[48:51], s7 offen sc1
    s_waitcnt lgkmcnt(2)
    v_mfma_f32_32x32x16_bf16 v[16:31], v[68:71], v[244:247], v[16:31]
    s_add_u32 s7, s20, 12288
    buffer_load_dwordx4 v[140:143], v1, s[48:51], s7 offen sc1
    s_waitcnt lgkmcnt(1)
    v_mfma_f32_32x32x16_bf16 v[16:31], v[72:75], v[248:251], v[16:31]
    s_add_u32 s7, s20, 16384
    buffer_load_dwordx4 v[144:147], v1, s[48:51], s7 offen sc1
    s_waitcnt lgkmcnt(0)
    v_mfma_f32_32x32x16_bf16 v[16:31], v[76:79], v[252:255], v[16:31]
    s_add_u32 s7, s20, 20480
    buffer_load_dwordx4 v[148:151], v1, s[48:51], s7 offen sc1
    s_add_u32 s7, s20, 24576
    buffer_load_dwordx4 v[152:155], v1, s[48:51], s7 offen sc1
    s_nop 9
    v_pk_fma_f32 v[16:17], v[16:17], v[88:89], s[30:31] op_sel_hi:[1,0,1]
    v_pk_fma_f32 v[18:19], v[18:19], v[88:89], s[30:31] op_sel_hi:[1,0,1]
    v_pk_fma_f32 v[20:21], v[20:21], v[88:89], s[30:31] op_sel_hi:[1,0,1]
    s_add_u32 s7, s20, 28672
    buffer_load_dwordx4 v[156:159], v1, s[48:51], s7 offen sc1
    v_pk_fma_f32 v[22:23], v[22:23], v[88:89], s[30:31] op_sel_hi:[1,0,1]
    v_pk_fma_f32 v[24:25], v[24:25], v[88:89], s[30:31] op_sel_hi:[1,0,1]
    v_pk_fma_f32 v[26:27], v[26:27], v[88:89], s[30:31] op_sel_hi:[1,0,1]
    v_pk_fma_f32 v[28:29], v[28:29], v[88:89], s[30:31] op_sel_hi:[1,0,1]
    buffer_load_dwordx4 v[60:63], v57, s[48:51], s21 offen offset:2048 sc1
    v_pk_fma_f32 v[30:31], v[30:31], v[88:89], s[30:31] op_sel_hi:[1,0,1]
    v_pk_fma_f32 v[16:17], v[112:113], v[90:91], v[16:17] op_sel_hi:[1,0,1] neg_lo:[0,1,0] neg_hi:[0,1,0]
    v_pk_fma_f32 v[18:19], v[114:115], v[90:91], v[18:19] op_sel_hi:[1,0,1] neg_lo:[0,1,0] neg_hi:[0,1,0]
    v_pk_fma_f32 v[20:21], v[116:117], v[90:91], v[20:21] op_sel_hi:[1,0,1] neg_lo:[0,1,0] neg_hi:[0,1,0]
    v_pk_fma_f32 v[22:23], v[118:119], v[90:91], v[22:23] op_sel_hi:[1,0,1] neg_lo:[0,1,0] neg_hi:[0,1,0]
    v_pk_fma_f32 v[24:25], v[120:121], v[90:91], v[24:25] op_sel_hi:[1,0,1] neg_lo:[0,1,0] neg_hi:[0,1,0]
    v_pk_fma_f32 v[26:27], v[122:123], v[90:91], v[26:27] op_sel_hi:[1,0,1] neg_lo:[0,1,0] neg_hi:[0,1,0]
    v_pk_fma_f32 v[28:29], v[124:125], v[90:91], v[28:29] op_sel_hi:[1,0,1] neg_lo:[0,1,0] neg_hi:[0,1,0]
    v_pk_fma_f32 v[30:31], v[126:127], v[90:91], v[30:31] op_sel_hi:[1,0,1] neg_lo:[0,1,0] neg_hi:[0,1,0]
    v_pk_mul_f32 v[96:97], v[16:17], s[28:29]
    v_pk_mul_f32 v[98:99], v[18:19], s[28:29]
    v_pk_mul_f32 v[100:101], v[20:21], s[28:29]
    v_pk_mul_f32 v[102:103], v[22:23], s[28:29]
    v_pk_mul_f32 v[104:105], v[24:25], s[28:29]
    v_pk_mul_f32 v[106:107], v[26:27], s[28:29]
    v_pk_mul_f32 v[108:109], v[28:29], s[28:29]
    v_pk_mul_f32 v[110:111], v[30:31], s[28:29]
    v_exp_f32_e64 v96, v96 clamp
    v_max_f32 v16, s30, v16
    v_exp_f32_e64 v97, v97 clamp
    v_max_f32 v17, s30, v17
    v_exp_f32_e64 v98, v98 clamp
    v_max_f32 v18, s30, v18
    v_exp_f32_e64 v99, v99 clamp
    v_max_f32 v19, s30, v19
    v_exp_f32_e64 v100, v100 clamp
    v_max_f32 v20, s30, v20
    v_exp_f32_e64 v101, v101 clamp
    v_max_f32 v21, s30, v21
    v_exp_f32_e64 v102, v102 clamp
    v_max_f32 v22, s30, v22
    v_exp_f32_e64 v103, v103 clamp
    v_max_f32 v23, s30, v23
    v_exp_f32_e64 v104, v104 clamp
    v_max_f32 v24, s30, v24
    v_exp_f32_e64 v105, v105 clamp
    v_max_f32 v25, s30, v25
    v_exp_f32_e64 v106, v106 clamp
    v_max_f32 v26, s30, v26
    v_exp_f32_e64 v107, v107 clamp
    v_max_f32 v27, s30, v27
    v_exp_f32_e64 v108, v108 clamp
    v_max_f32 v28, s30, v28
    v_exp_f32_e64 v109, v109 clamp
    v_max_f32 v29, s30, v29
    v_exp_f32_e64 v110, v110 clamp
    v_max_f32 v30, s30, v30
    v_exp_f32_e64 v111, v111 clamp
    v_max_f32 v31, s30, v31
    v_pk_add_f32 v[16:17], v[16:17], v[96:97]
    v_pk_add_f32 v[18:19], v[18:19], v[98:99]
    v_pk_add_f32 v[20:21], v[20:21], v[100:101]
    v_pk_add_f32 v[22:23], v[22:23], v[102:103]
    v_pk_add_f32 v[24:25], v[24:25], v[104:105]
    v_pk_add_f32 v[26:27], v[26:27], v[106:107]
    v_pk_add_f32 v[28:29], v[28:29], v[108:109]
    v_pk_add_f32 v[30:31], v[30:31], v[110:111]
    v_cvt_pk_bf16_f32 v16, v16, v17
    v_cvt_pk_bf16_f32 v17, v18, v19
    v_cvt_pk_bf16_f32 v18, v20, v21
    v_cvt_pk_bf16_f32 v19, v22, v23
    v_cvt_pk_bf16_f32 v20, v24, v25
    v_cvt_pk_bf16_f32 v21, v26, v27
    v_cvt_pk_bf16_f32 v22, v28, v29
    v_cvt_pk_bf16_f32 v23, v30, v31
    s_lshl_b32 s11, s58, 13
    v_add_u32 v84, s11, v1
    v_add_u32 v85, 0x10000, v84
    ds_write_b128 v84, a[224:227] offset:0
    ds_write_b128 v84, a[228:231] offset:1024
    ds_write_b128 v84, a[232:235] offset:2048
    ds_write_b128 v84, a[236:239] offset:3072
    ds_write_b128 v84, a[240:243] offset:4096
    ds_write_b128 v84, a[244:247] offset:5120
    ds_write_b128 v84, a[248:251] offset:6144
    ds_write_b128 v84, a[252:255] offset:7168
    s_add_u32 s4, s9, 153600
    v_add_u32 v56, s4, v1
    v_add_u32 v58, 153600, v1
    v_lshrrev_b32 v48, 4, v0
    v_lshlrev_b32_e64 v48, 5, v48
    v_add_u32 v48, 157696, v48
    s_mov_b32 s99, 200000
    s_nop 0
klp_480:
    s_waitcnt vmcnt(0)
    v_bitop3_b32 v49, v128, v132, v136 bitop3:0x80
    v_bitop3_b32 v49, v49, v140, v144 bitop3:0x80
    v_bitop3_b32 v49, v49, v148, v152 bitop3:0x80
    v_bitop3_b32 v49, v49, v156, v60 bitop3:0x80
    v_bitop3_b32 v49, v49, v49, 1 bitop3:0x80
    v_cmp_eq_u32 vcc, 0, v49
    s_nop 3
    s_nop 0
    s_cbranch_vccnz kr_482
kd_481:
    v_pk_add_f32 v[128:129], v[128:129], v[144:145]
    v_pk_add_f32 v[130:131], v[130:131], v[146:147]
    v_pk_add_f32 v[132:133], v[132:133], v[148:149]
    v_pk_add_f32 v[134:135], v[134:135], v[150:151]
    v_pk_add_f32 v[136:137], v[136:137], v[152:153]
    v_pk_add_f32 v[138:139], v[138:139], v[154:155]
    v_pk_add_f32 v[140:141], v[140:141], v[156:157]
    v_pk_add_f32 v[142:143], v[142:143], v[158:159]
    v_pk_add_f32 v[128:129], v[128:129], v[136:137]
    v_pk_add_f32 v[130:131], v[130:131], v[138:139]
    v_pk_add_f32 v[132:133], v[132:133], v[140:141]
    v_pk_add_f32 v[134:135], v[134:135], v[142:143]
    v_pk_add_f32 v[128:129], v[128:129], v[132:133]
    v_pk_add_f32 v[130:131], v[130:131], v[134:135]
    ds_write_b128 v56, v[128:131]
    v_add_f32_dpp v60, v60, v60 quad_perm:[2,3,0,1] row_mask:0xf bank_mask:0xf
    v_add_f32_dpp v61, v61, v61 quad_perm:[2,3,0,1] row_mask:0xf bank_mask:0xf
    v_add_f32_dpp v62, v62, v62 quad_perm:[2,3,0,1] row_mask:0xf bank_mask:0xf
    v_add_f32_dpp v63, v63, v63 quad_perm:[2,3,0,1] row_mask:0xf bank_mask:0xf
    v_add_f32_dpp v60, v60, v60 row_ror:4 row_mask:0xf bank_mask:0xf
    v_add_f32_dpp v61, v61, v61 row_ror:4 row_mask:0xf bank_mask:0xf
    v_add_f32_dpp v62, v62, v62 row_ror:4 row_mask:0xf bank_mask:0xf
    v_add_f32_dpp v63, v63, v63 row_ror:4 row_mask:0xf bank_mask:0xf
    v_add_f32_dpp v60, v60, v60 row_ror:8 row_mask:0xf bank_mask:0xf
    v_add_f32_dpp v61, v61, v61 row_ror:8 row_mask:0xf bank_mask:0xf
    v_add_f32_dpp v62, v62, v62 row_ror:8 row_mask:0xf bank_mask:0xf
    v_add_f32_dpp v63, v63, v63 row_ror:8 row_mask:0xf bank_mask:0xf
    ds_write_b128 v59, v[60:63]
    s_waitcnt lgkmcnt(0)
    s_barrier
    ds_read_b128 v[32:35], v58
    ds_read_b128 v[64:67], v58 offset:2048
    ds_read_b128 v[40:43], v48
    ds_read_b128 v[72:75], v48 offset:128
    ds_read_b128 v[36:39], v58 offset:1024
    ds_read_b128 v[68:71], v58 offset:3072
    ds_read_b128 v[44:47], v48 offset:16
    ds_read_b128 v[76:79], v48 offset:144
    s_waitcnt lgkmcnt(4)
    v_pk_add_f32 v[32:33], v[32:33], v[64:65]
    v_pk_add_f32 v[34:35], v[34:35], v[66:67]
    v_pk_add_f32 v[40:41], v[40:41], v[72:73]
    v_pk_add_f32 v[42:43], v[42:43], v[74:75]
    v_cvt_pk_bf16_f32 v80, v32, v33
    v_cvt_pk_bf16_f32 v84, v40, v41
    v_cvt_pk_bf16_f32 v81, v34, v35
    v_cvt_pk_bf16_f32 v85, v42, v43
    s_waitcnt lgkmcnt(0)
    v_pk_add_f32 v[36:37], v[36:37], v[68:69]
    v_pk_add_f32 v[38:39], v[38:39], v[70:71]
    v_pk_add_f32 v[44:45], v[44:45], v[76:77]
    v_pk_add_f32 v[46:47], v[46:47], v[78:79]
    v_cvt_pk_bf16_f32 v82, v36, v37
    v_cvt_pk_bf16_f32 v86, v44, v45
    v_cvt_pk_bf16_f32 v83, v38, v39
    v_cvt_pk_bf16_f32 v87, v46, v47
    v_cndmask_b32 v96, v84, v80, s[96:97]
    v_cndmask_b32 v97, v85, v81, s[96:97]
    v_cndmask_b32 v98, v86, v82, s[96:97]
    v_cndmask_b32 v99, v87, v83, s[96:97]
    v_cndmask_b32 v100, v80, v84, s[96:97]
    v_cndmask_b32 v101, v81, v85, s[96:97]
    v_mfma_f32_32x32x16_bf16 v[64:79], v[96:99], v[16:19], 0
    v_cndmask_b32 v102, v82, v86, s[96:97]
    v_cndmask_b32 v103, v83, v87, s[96:97]
    s_nop 1
    v_mfma_f32_32x32x16_bf16 v[48:63], v[100:103], v[20:23], 0
    s_nop 6
    v_add_f32 v72, 0x358637bd, v72
    v_rcp_f32 v72, v72
    s_nop 0
    v_mul_f32 v64, v64, v72
    v_mul_f32 v65, v65, v72
    v_mul_f32 v66, v66, v72
    v_mul_f32 v67, v67, v72
    v_mul_f32 v68, v68, v72
    v_mul_f32 v69, v69, v72
    v_mul_f32 v70, v70, v72
    v_mul_f32 v71, v71, v72
    v_and_b32 v64, 0xffff0000, v64
    v_cvt_pk_bf16_f32 v104, v64, v65
    v_cvt_pk_bf16_f32 v105, v66, v67
    v_cvt_pk_bf16_f32 v106, v68, v69
    v_cvt_pk_bf16_f32 v107, v70, v71
    v_or_b32 v104, 1, v104
    s_cmp_lg_u32 s63, 0
    s_nop 0
    s_cbranch_scc0 fast_492
    buffer_store_dwordx4 v[104:107], v1, s[48:51], s62 offen offset:0
    s_nop 1
dend_493:
    v_add_f32 v48, 0x358637bd, v48
    v_rcp_f32 v48, v48
    s_nop 0
    v_mul_f32 v56, v56, v48
    v_mul_f32 v57, v57, v48
    v_mul_f32 v58, v58, v48
    v_mul_f32 v59, v59, v48
    v_mul_f32 v60, v60, v48
    v_mul_f32 v61, v61, v48
    v_mul_f32 v62, v62, v48
    v_mul_f32_e64 v63, v63, v48
    v_and_b32 v56, 0xffff0000, v56
    v_cvt_pk_bf16_f32 v108, v56, v57
    v_cvt_pk_bf16_f32 v109, v58, v59
    v_cvt_pk_bf16_f32 v110, v60, v61
    v_cvt_pk_bf16_f32 v111, v62, v63
    v_or_b32 v108, 1, v108
    s_cmp_lg_u32 s63, 0
    s_nop 0
    s_cbranch_scc0 fast_494
    buffer_store_dwordx4 v[108:111], v1, s[48:51], s62 offen offset:1024
    s_nop 1
dend_495:
    s_add_u32 s3, s100, 0
    buffer_load_dwordx4 v[128:131], v1, s[48:51], s3 offen offset:0 sc1
    buffer_load_dwordx4 v[132:135], v1, s[48:51], s3 offen offset:1024 sc1
    buffer_load_dwordx4 v[136:139], v1, s[48:51], s3 offen offset:2048 sc1
    buffer_load_dwordx4 v[140:143], v1, s[48:51], s3 offen offset:3072 sc1
    s_add_u32 s3, s100, 4096
    buffer_load_dwordx4 v[144:147], v1, s[48:51], s3 offen offset:0 sc1
    buffer_load_dwordx4 v[148:151], v1, s[48:51], s3 offen offset:1024 sc1
    buffer_load_dwordx4 v[152:155], v1, s[48:51], s3 offen offset:2048 sc1
    buffer_load_dwordx4 v[156:159], v1, s[48:51], s3 offen offset:3072 sc1
    ds_read_b128 v[64:67], v1 offset:0
    ds_read_b128 v[68:71], v1 offset:1024
    ds_read_b128 v[72:75], v1 offset:2048
    v_lshlrev_b32 v16, 16, v8
    v_and_b32 v17, 0xffff0000, v8
    v_lshlrev_b32 v18, 16, v9
    v_and_b32 v19, 0xffff0000, v9
    v_lshlrev_b32 v20, 16, v10
    v_and_b32 v21, 0xffff0000, v10
    v_lshlrev_b32 v22, 16, v11
    v_and_b32 v23, 0xffff0000, v11
    v_lshlrev_b32 v24, 16, v12
    v_and_b32 v25, 0xffff0000, v12
    v_lshlrev_b32 v26, 16, v13
    v_and_b32 v27, 0xffff0000, v13
    v_lshlrev_b32 v28, 16, v14
    v_and_b32 v29, 0xffff0000, v14
    v_lshlrev_b32 v30, 16, v15
    v_and_b32 v31, 0xffff0000, v15
    ds_read_b128 v[76:79], v1 offset:3072
    s_waitcnt vmcnt(6)
    v_bitop3_b32 v95, v128, v132, 1 bitop3:0x80
    v_cmp_eq_u32 vcc, 0, v95
    s_cbranch_vccnz gst_496
gbk_497:
    s_waitcnt lgkmcnt(3)
    v_mfma_f32_32x32x16_bf16 v[16:31], v[64:67], v[128:131], v[16:31]
    s_add_u32 s3, s100, 8192
    buffer_load_dwordx4 v[160:163], v1, s[48:51], s3 offen offset:0 sc1
    ds_read_b128 v[64:67], v1 offset:4096
    s_waitcnt lgkmcnt(3)
    v_mfma_f32_32x32x16_bf16 v[16:31], v[68:71], v[132:135], v[16:31]
    buffer_load_dwordx4 v[164:167], v1, s[48:51], s3 offen offset:1024 sc1
    ds_read_b128 v[68:71], v1 offset:5120
    s_waitcnt vmcnt(6)
    v_bitop3_b32 v95, v136, v140, 1 bitop3:0x80
    v_cmp_eq_u32 vcc, 0, v95
    s_cbranch_vccnz gst_500
gbk_501:
    s_waitcnt lgkmcnt(3)
    v_mfma_f32_32x32x16_bf16 v[16:31], v[72:75], v[136:139], v[16:31]
    buffer_load_dwordx4 v[168:171], v1, s[48:51], s3 offen offset:2048 sc1
    ds_read_b128 v[72:75], v1 offset:6144
    s_waitcnt lgkmcnt(3)
    v_mfma_f32_32x32x16_bf16 v[16:31], v[76:79], v[140:143], v[16:31]
    buffer_load_dwordx4 v[172:175], v1, s[48:51], s3 offen offset:3072 sc1
    ds_read_b128 v[76:79], v1 offset:7168
    s_waitcnt vmcnt(6)
    v_bitop3_b32 v95, v144, v148, 1 bitop3:0x80
    v_cmp_eq_u32 vcc, 0, v95
    s_cbranch_vccnz gst_504
gbk_505:
    s_waitcnt lgkmcnt(3)
    v_mfma_f32_32x32x16_bf16 v[16:31], v[64:67], v[144:147], v[16:31]
    s_add_u32 s3, s100, 12288
    buffer_load_dwordx4 v[176:179], v1, s[48:51], s3 offen offset:0 sc1
    ds_read_b128 v[64:67], v1 offset:8192
    s_waitcnt lgkmcnt(3)
    v_mfma_f32_32x32x16_bf16 v[16:31], v[68:71], v[148:151], v[16:31]
    buffer_load_dwordx4 v[180:183], v1, s[48:51], s3 offen offset:1024 sc1
    ds_read_b128 v[68:71], v1 offset:9216
    s_waitcnt vmcnt(6)
    v_bitop3_b32 v95, v152, v156, 1 bitop3:0x80
    v_cmp_eq_u32 vcc, 0, v95
    s_cbranch_vccnz gst_508
gbk_509:
    s_waitcnt lgkmcnt(3)
    v_mfma_f32_32x32x16_bf16 v[16:31], v[72:75], v[152:155], v[16:31]
    buffer_load_dwordx4 v[184:187], v1, s[48:51], s3 offen offset:2048 sc1
    ds_read_b128 v[72:75], v1 offset:10240
    s_waitcnt lgkmcnt(3)
    v_mfma_f32_32x32x16_bf16 v[16:31], v[76:79], v[156:159], v[16:31]
    buffer_load_dwordx4 v[188:191], v1, s[48:51], s3 offen offset:3072 sc1
    ds_read_b128 v[76:79], v1 offset:11264
    s_waitcnt vmcnt(6)
    v_bitop3_b32 v95, v160, v164, 1 bitop3:0x80
    v_cmp_eq_u32 vcc, 0, v95
    s_cbranch_vccnz gst_512
gbk_513:
    s_waitcnt lgkmcnt(3)
    v_mfma_f32_32x32x16_bf16 v[16:31], v[64:67], v[160:163], v[16:31]
    s_add_u32 s3, s100, 16384
    buffer_load_dwordx4 v[192:195], v1, s[48:51], s3 offen offset:0 sc1
    ds_read_b128 v[64:67], v1 offset:12288
    s_waitcnt lgkmcnt(3)
    v_mfma_f32_32x32x16_bf16 v[16:31], v[68:71], v[164:167], v[16:31]
    buffer_load_dwordx4 v[196:199], v1, s[48:51], s3 offen offset:1024 sc1
    ds_read_b128 v[68:71], v1 offset:13312
    s_waitcnt vmcnt(6)
    v_bitop3_b32 v95, v168, v172, 1 bitop3:0x80
    v_cmp_eq_u32 vcc, 0, v95
    s_cbranch_vccnz gst_516
gbk_517:
    s_waitcnt lgkmcnt(3)
    v_mfma_f32_32x32x16_bf16 v[16:31], v[72:75], v[168:171], v[16:31]
    buffer_load_dwordx4 v[200:203], v1, s[48:51], s3 offen offset:2048 sc1
    ds_read_b128 v[72:75], v1 offset:14336
    s_waitcnt lgkmcnt(3)
    v_mfma_f32_32x32x16_bf16 v[16:31], v[76:79], v[172:175], v[16:31]
    buffer_load_dwordx4 v[204:207], v1, s[48:51], s3 offen offset:3072 sc1
    ds_read_b128 v[76:79], v1 offset:15360
    s_waitcnt vmcnt(6)
    v_bitop3_b32 v95, v176, v180, 1 bitop3:0x80
    v_cmp_eq_u32 vcc, 0, v95
    s_cbranch_vccnz gst_520
gbk_521:
    s_waitcnt lgkmcnt(3)
    v_mfma_f32_32x32x16_bf16 v[16:31], v[64:67], v[176:179], v[16:31]
    s_add_u32 s3, s100, 20480
    buffer_load_dwordx4 v[208:211], v1, s[48:51], s3 offen offset:0 sc1
    ds_read_b128 v[64:67], v1 offset:16384
    s_waitcnt lgkmcnt(3)
    v_mfma_f32_32x32x16_bf16 v[16:31], v[68:71], v[180:183], v[16:31]
    buffer_load_dwordx4 v[212:215], v1, s[48:51], s3 offen offset:1024 sc1
    ds_read_b128 v[68:71], v1 offset:17408
    s_waitcnt vmcnt(6)
    v_bitop3_b32 v95, v184, v188, 1 bitop3:0x80
    v_cmp_eq_u32 vcc, 0, v95
    s_cbranch_vccnz gst_524
gbk_525:
    s_waitcnt lgkmcnt(3)
    v_mfma_f32_32x32x16_bf16 v[16:31], v[72:75], v[184:187], v[16:31]
    buffer_load_dwordx4 v[216:219], v1, s[48:51], s3 offen offset:2048 sc1
    ds_read_b128 v[72:75], v1 offset:18432
    s_waitcnt lgkmcnt(3)
    v_mfma_f32_32x32x16_bf16 v[16:31], v[76:79], v[188:191], v[16:31]
    buffer_load_dwordx4 v[220:223], v1, s[48:51], s3 offen offset:3072 sc1
    ds_read_b128 v[76:79], v1 offset:19456
    s_waitcnt vmcnt(6)
    v_bitop3_b32 v95, v192, v196, 1 bitop3:0x80
    v_cmp_eq_u32 vcc, 0, v95
    s_cbranch_vccnz gst_528
gbk_529:
    s_waitcnt lgkmcnt(3)
    v_mfma_f32_32x32x16_bf16 v[16:31], v[64:67], v[192:195], v[16:31]
    s_add_u32 s3, s100, 24576
    buffer_load_dwordx4 v[224:227], v1, s[48:51], s3 offen offset:0 sc1
    ds_read_b128 v[64:67], v1 offset:20480
    s_waitcnt lgkmcnt(3)
    v_mfma_f32_32x32x16_bf16 v[16:31], v[68:71], v[196:199], v[16:31]
    buffer_load_dwordx4 v[228:231], v1, s[48:51], s3 offen offset:1024 sc1
    ds_read_b128 v[68:71], v1 offset:21504
    s_waitcnt vmcnt(6)
    v_bitop3_b32 v95, v200, v204, 1 bitop3:0x80
    v_cmp_eq_u32 vcc, 0, v95
    s_cbranch_vccnz gst_532
gbk_533:
    s_waitcnt lgkmcnt(3)
    v_mfma_f32_32x32x16_bf16 v[16:31], v[72:75], v[200:203], v[16:31]
    buffer_load_dwordx4 v[232:235], v1, s[48:51], s3 offen offset:2048 sc1
    ds_read_b128 v[72:75], v1 offset:22528
    s_waitcnt lgkmcnt(3)
    v_mfma_f32_32x32x16_bf16 v[16:31], v[76:79], v[204:207], v[16:31]
    buffer_load_dwordx4 v[236:239], v1, s[48:51], s3 offen offset:3072 sc1
    ds_read_b128 v[76:79], v1 offset:23552
    s_waitcnt vmcnt(6)
    v_bitop3_b32 v95, v208, v212, 1 bitop3:0x80
    v_cmp_eq_u32 vcc, 0, v95
    s_cbranch_vccnz gst_536
gbk_537:
    s_waitcnt lgkmcnt(3)
    v_mfma_f32_32x32x16_bf16 v[16:31], v[64:67], v[208:211], v[16:31]
    s_add_u32 s3, s100, 28672
    buffer_load_dwordx4 v[240:243], v1, s[48:51], s3 offen offset:0 sc1
    ds_read_b128 v[64:67], v1 offset:24576
    s_waitcnt lgkmcnt(3)
    v_mfma_f32_32x32x16_bf16 v[16:31], v[68:71], v[212:215], v[16:31]
    buffer_load_dwordx4 v[244:247], v1, s[48:51], s3 offen offset:1024 sc1
    ds_read_b128 v[68:71], v1 offset:25600
    s_waitcnt vmcnt(6)
    v_bitop3_b32 v95, v216, v220, 1 bitop3:0x80
    v_cmp_eq_u32 vcc, 0, v95
    s_cbranch_vccnz gst_540
gbk_541:
    s_waitcnt lgkmcnt(3)
    v_mfma_f32_32x32x16_bf16 v[16:31], v[72:75], v[216:219], v[16:31]
    buffer_load_dwordx4 v[248:251], v1, s[48:51], s3 offen offset:2048 sc1
    ds_read_b128 v[72:75], v1 offset:26624
    s_waitcnt lgkmcnt(3)
    v_mfma_f32_32x32x16_bf16 v[16:31], v[76:79], v[220:223], v[16:31]
    buffer_load_dwordx4 v[252:255], v1, s[48:51], s3 offen offset:3072 sc1
    ds_read_b128 v[76:79], v1 offset:27648
    s_waitcnt vmcnt(6)
    v_bitop3_b32 v95, v224, v228, 1 bitop3:0x80
    v_cmp_eq_u32 vcc, 0, v95
    s_cbranch_vccnz gst_544
gbk_545:
    s_waitcnt lgkmcnt(3)
    v_mfma_f32_32x32x16_bf16 v[16:31], v[64:67], v[224:227], v[16:31]
    ds_read_b128 v[64:67], v1 offset:28672
    s_waitcnt lgkmcnt(3)
    v_mfma_f32_32x32x16_bf16 v[16:31], v[68:71], v[228:231], v[16:31]
    ds_read_b128 v[68:71], v1 offset:29696
    s_waitcnt vmcnt(4)
    v_bitop3_b32 v95, v232, v236, 1 bitop3:0x80
    v_cmp_eq_u32 vcc, 0, v95
    s_cbranch_vccnz gst_548
gbk_549:
    s_waitcnt lgkmcnt(3)
    v_mfma_f32_32x32x16_bf16 v[16:31], v[72:75], v[232:235], v[16:31]
    ds_read_b128 v[72:75], v1 offset:30720
    s_waitcnt lgkmcnt(3)
    v_mfma_f32_32x32x16_bf16 v[16:31], v[76:79], v[236:239], v[16:31]
    ds_read_b128 v[76:79], v1 offset:31744
    s_waitcnt vmcnt(2)
    v_bitop3_b32 v95, v240, v244, 1 bitop3:0x80
    v_cmp_eq_u32 vcc, 0, v95
    s_cbranch_vccnz gst_552
gbk_553:
    s_waitcnt lgkmcnt(3)
    v_mfma_f32_32x32x16_bf16 v[16:31], v[64:67], v[240:243], v[16:31]
    s_waitcnt lgkmcnt(2)
    v_mfma_f32_32x32x16_bf16 v[16:31], v[68:71], v[244:247], v[16:31]
    s_waitcnt vmcnt(0)
    v_bitop3_b32 v95, v248, v252, 1 bitop3:0x80
    v_cmp_eq_u32 vcc, 0, v95
    s_cbranch_vccnz gst_556
gbk_557:
    s_waitcnt lgkmcnt(1)
    v_mfma_f32_32x32x16_bf16 v[16:31], v[72:75], v[248:251], v[16:31]
    s_waitcnt lgkmcnt(0)
    v_mfma_f32_32x32x16_bf16 v[16:31], v[76:79], v[252:255], v[16:31]
    s_nop 10
    s_nop 0
    v_cvt_pk_bf16_f32 v16, v16, v17
    v_cvt_pk_bf16_f32 v17, v18, v19
    v_cvt_pk_bf16_f32 v18, v20, v21
    v_cvt_pk_bf16_f32 v19, v22, v23
    v_cvt_pk_bf16_f32 v20, v24, v25
    v_cvt_pk_bf16_f32 v21, v26, v27
    v_cvt_pk_bf16_f32 v22, v28, v29
    v_cvt_pk_bf16_f32 v23, v30, v31
    v_and_b32 v64, 31, v0
    v_lshlrev_b32 v64, 10, v64
    v_lshrrev_b32 v65, 5, v0
    v_lshl_add_u32 v64, v65, 4, v64
    s_lshl_b32 s4, s57, 6
    s_add_u32 s4, s4, s60
    v_permlane32_swap_b32 v16, v18
    v_permlane32_swap_b32 v17, v19
    v_permlane32_swap_b32 v20, v22
    v_permlane32_swap_b32 v21, v23
    buffer_store_dwordx4 v[16:19], v64, s[44:47], s4 offen
    buffer_store_dwordx4 v[20:23], v64, s[44:47], s4 offen offset:32
    s_nop 1
L_end:
    s_endpgm
zw_9:
    v_min_u32 v14, 47, v0
    v_lshlrev_b32 v14, 2, v14
    s_mov_b32 s99, 200000
    s_nop 0
poll_10:
    buffer_load_dword v15, v14, s[52:55], 0 offen sc1
    s_waitcnt vmcnt(0)
    v_cmp_le_u32 vcc, 1, v15
    s_nop 0
    s_cmp_eq_u64 vcc, exec
    s_nop 2
    s_cbranch_scc1 polld_11
    s_sub_u32 s99, s99, 1
    s_cmp_lg_u32 s99, 0
    s_cbranch_scc1 poll_10
polld_11:
    s_branch zok_8
hpb_13:
    s_mov_b32 s99, 200000
poll_15:
    buffer_load_dword v58, v56, s[48:51], 0 offen sc1
    s_waitcnt vmcnt(0)
    v_cmp_le_u32 vcc, v57, v58
    s_nop 0
    s_cmp_eq_u64 vcc, exec
    s_nop 2
    s_cbranch_scc1 polld_16
    s_sleep 4
    s_sub_u32 s99, s99, 1
    s_cmp_lg_u32 s99, 0
    s_cbranch_scc1 poll_15
polld_16:
    s_branch hpo_14
gb_36:
    s_mov_b32 s99, 200000
poll_38:
    buffer_load_dword v105, v106, s[48:51], s98 offen sc1
    s_waitcnt vmcnt(0)
    v_cmp_le_u32 vcc, s4, v105
    s_nop 0
    s_cmp_eq_u64 vcc, exec
    s_nop 2
    s_cbranch_scc1 polld_39
    s_sub_u32 s99, s99, 1
    s_cmp_lg_u32 s99, 0
    s_cbranch_scc1 poll_38
polld_39:
    s_branch go_37
achk_18:
    ds_read_b128 v[64:67], v7 offset:28672
    ds_read_b128 v[68:71], v7 offset:24576
    v_exp_f32 v176, v176
    ds_read_b128 v[72:75], v7 offset:20480
    ds_read_b128 v[76:79], v7 offset:16384
    v_exp_f32 v177, v177
    s_mov_b64 exec, s[96:97]
    ds_read_b128 v[32:35], v7 offset:30720
    ds_read_b128 v[36:39], v7 offset:31744
    s_mov_b64 exec, -1
    s_waitcnt lgkmcnt(5)
    v_mfma_f32_32x32x16_bf16 v[112:127], v[64:67], v[16:19], v[192:207]
    v_exp_f32 v178, v178
    v_exp_f32 v179, v179
    v_exp_f32 v180, v180
    s_lshl_b32 s11, s58, 13
    s_add_u32 m0, s11, 65536
    s_mov_b32 s10, 1024
    buffer_load_dwordx4 v111, s[32:35], s10 offen offset:0 lds
    v_exp_f32 v181, v181
    s_waitcnt lgkmcnt(4)
    v_mfma_f32_32x32x16_bf16 v[128:143], v[68:71], v[16:19], v[192:207]
    v_exp_f32 v182, v182
    v_exp_f32 v183, v183
    v_exp_f32 v184, v184
    v_exp_f32 v185, v185
    s_waitcnt lgkmcnt(3)
    v_mfma_f32_32x32x16_bf16 v[144:159], v[72:75], v[16:19], v[192:207]
    ds_read_b128 v[80:83], v7 offset:12288
    v_exp_f32 v186, v186
    ds_read_b128 v[84:87], v7 offset:8192
    ds_read_b128 v[88:91], v7 offset:4096
    v_exp_f32 v187, v187
    v_exp_f32 v188, v188
    v_exp_f32 v189, v189
    v_exp_f32 v190, v190
    v_exp_f32_e64 v191, v191
    v_cvt_pk_bf16_f32 v176, v176, v177
    v_cvt_pk_bf16_f32 v177, v178, v179
    v_cvt_pk_bf16_f32 v178, v180, v181
    v_cvt_pk_bf16_f32 v179, v182, v183
    v_cvt_pk_bf16_f32 v180, v184, v185
    s_mov_b32 s10, 49152
    buffer_load_dwordx4 v111, s[32:35], s10 offen offset:1024 lds
    v_cvt_pk_bf16_f32 v181, v186, v187
    v_cvt_pk_bf16_f32 v182, v188, v189
    v_cvt_pk_bf16_f32 v183, v190, v191
    v_mfma_f32_32x32x16_bf16 v[224:239], v[40:43], v[176:179], 0
    v_exp_f32 v112, v112
    v_exp_f32 v113, v113
    v_exp_f32 v114, v114
    v_exp_f32 v115, v115
    v_mfma_f32_32x32x16_bf16 v[224:239], v[44:47], v[180:183], v[224:239]
    s_mov_b64 exec, s[96:97]
    ds_read_b128 v[40:43], v7 offset:26624
    ds_read_b128 v[44:47], v7 offset:27648
    s_mov_b64 exec, -1
    v_exp_f32 v116, v116
    v_exp_f32 v117, v117
    v_exp_f32 v118, v118
    s_waitcnt lgkmcnt(7)
    v_mfma_f32_32x32x16_bf16 v[160:175], v[76:79], v[16:19], v[192:207]
    v_exp_f32 v119, v119
    v_exp_f32 v120, v120
    v_exp_f32 v121, v121
    v_exp_f32 v122, v122
    v_exp_f32 v123, v123
    buffer_store_dwordx4 a[112:115], v1, s[48:51], s61 offen offset:0 sc0 sc1
    buffer_store_dwordx4 a[112:115], v1, s[48:51], s61 offen offset:1024 sc0 sc1
    s_lshl_b32 s4, s57, 8
    s_add_u32 s4, s4, s101
    s_mov_b64 exec, 0xffff
    buffer_store_dwordx4 a[112:115], v1, s[48:51], s4 offen offset:0 sc0 sc1
    s_mov_b64 exec, -1
    s_mov_b32 s10, 97280
    buffer_load_dwordx4 v111, s[32:35], s10 offen offset:2048 lds
    v_exp_f32 v124, v124
    v_exp_f32 v125, v125
    v_exp_f32 v126, v126
    v_exp_f32 v127, v127
    v_cvt_pk_bf16_f32 v112, v112, v113
    v_cvt_pk_bf16_f32 v113, v114, v115
    v_cvt_pk_bf16_f32 v114, v116, v117
    v_cvt_pk_bf16_f32 v115, v118, v119
    v_cvt_pk_bf16_f32 v116, v120, v121
    v_cvt_pk_bf16_f32 v117, v122, v123
    v_cvt_pk_bf16_f32 v118, v124, v125
    v_cvt_pk_bf16_f32 v119, v126, v127
    s_waitcnt lgkmcnt(5)
    s_cmp_lt_u32 s59, 1
    s_cbranch_scc1 sk_22
    v_mfma_f32_32x32x16_bf16 v[48:63], v[32:35], v[112:115], v[48:63]
sk_22:
    v_exp_f32 v128, v128
    v_exp_f32 v129, v129
    v_exp_f32 v130, v130
    v_exp_f32 v131, v131
    s_cmp_lt_u32 s59, 1
    s_cbranch_scc1 sk_23
    v_mfma_f32_32x32x16_bf16 v[48:63], v[36:39], v[116:119], v[48:63]
sk_23:
    s_mov_b64 exec, s[96:97]
    ds_read_b128 v[32:35], v7 offset:22528
    ds_read_b128 v[36:39], v7 offset:23552
    s_mov_b64 exec, -1
    v_exp_f32 v132, v132
    s_mov_b32 s10, 145408
    buffer_load_dwordx4 v111, s[32:35], s10 offen offset:3072 lds
    v_exp_f32 v133, v133
    v_exp_f32 v134, v134
    s_waitcnt lgkmcnt(6)
    v_mfma_f32_32x32x16_bf16 v[176:191], v[80:83], v[16:19], v[192:207]
    ds_read_b128 v[92:95], v7 offset:0
    v_exp_f32 v135, v135
    v_exp_f32 v136, v136
    v_exp_f32 v137, v137
    v_exp_f32 v138, v138
    v_exp_f32 v139, v139
    v_exp_f32 v140, v140
    v_exp_f32 v141, v141
    v_exp_f32 v142, v142
    v_exp_f32 v143, v143
    v_cvt_pk_bf16_f32 v128, v128, v129
    v_cvt_pk_bf16_f32 v129, v130, v131
    v_cvt_pk_bf16_f32 v130, v132, v133
    v_cvt_pk_bf16_f32 v131, v134, v135
    v_cvt_pk_bf16_f32 v132, v136, v137
    s_lshl_b32 s11, s58, 13
    s_add_u32 m0, s11, 69632
    s_mov_b32 s10, 197632
    buffer_load_dwordx4 v111, s[32:35], s10 offen offset:0 lds
    v_cvt_pk_bf16_f32 v133, v138, v139
    v_cvt_pk_bf16_f32 v134, v140, v141
    v_cvt_pk_bf16_f32 v135, v142, v143
    s_waitcnt lgkmcnt(3)
    s_cmp_lt_u32 s59, 2
    s_cbranch_scc1 sk_24
    v_mfma_f32_32x32x16_bf16 v[48:63], v[40:43], v[128:131], v[48:63]
sk_24:
    v_exp_f32 v144, v144
    v_exp_f32 v145, v145
    v_exp_f32 v146, v146
    v_exp_f32 v147, v147
    s_cmp_lt_u32 s59, 2
    s_cbranch_scc1 sk_25
    v_mfma_f32_32x32x16_bf16 v[48:63], v[44:47], v[132:135], v[48:63]
sk_25:
    s_mov_b64 exec, s[96:97]
    ds_read_b128 v[40:43], v7 offset:18432
    ds_read_b128 v[44:47], v7 offset:19456
    s_mov_b64 exec, -1
    v_exp_f32 v148, v148
    v_exp_f32 v149, v149
    v_exp_f32 v150, v150
    v_mfma_f32_32x32x16_bf16 v[112:127], v[84:87], v[16:19], v[192:207]
    ds_read_b128 v[96:99], v7 offset:29696
    v_exp_f32 v151, v151
    v_exp_f32 v152, v152
    v_exp_f32 v153, v153
    v_exp_f32 v154, v154
    s_mov_b32 s10, 245760
    buffer_load_dwordx4 v111, s[32:35], s10 offen offset:1024 lds
    v_exp_f32 v155, v155
    v_exp_f32 v156, v156
    v_exp_f32 v157, v157
    v_exp_f32 v158, v158
    v_exp_f32 v159, v159
    v_cvt_pk_bf16_f32 v144, v144, v145
    v_cvt_pk_bf16_f32 v145, v146, v147
    v_cvt_pk_bf16_f32 v146, v148, v149
    v_cvt_pk_bf16_f32 v147, v150, v151
    v_cvt_pk_bf16_f32 v148, v152, v153
    v_cvt_pk_bf16_f32 v149, v154, v155
    v_cvt_pk_bf16_f32 v150, v156, v157
    v_cvt_pk_bf16_f32 v151, v158, v159
    s_waitcnt lgkmcnt(4)
    s_cmp_lt_u32 s59, 3
    s_cbranch_scc1 sk_26
    v_mfma_f32_32x32x16_bf16 v[48:63], v[32:35], v[144:147], v[48:63]
sk_26:
    v_exp_f32 v160, v160
    v_exp_f32 v161, v161
    v_exp_f32 v162, v162
    v_exp_f32 v163, v163
    s_cmp_lt_u32 s59, 3
    s_cbranch_scc1 sk_27
    v_mfma_f32_32x32x16_bf16 v[48:63], v[36:39], v[148:151], v[48:63]
sk_27:
    s_mov_b64 exec, s[96:97]
    ds_read_b128 v[32:35], v7 offset:14336
    ds_read_b128 v[36:39], v7 offset:15360
    s_mov_b64 exec, -1
    v_exp_f32 v164, v164
    s_mov_b32 s10, 293888
    buffer_load_dwordx4 v111, s[32:35], s10 offen offset:2048 lds
    v_exp_f32 v165, v165
    v_exp_f32 v166, v166
    v_mfma_f32_32x32x16_bf16 v[128:143], v[88:91], v[16:19], v[192:207]
    ds_read_b128 v[64:67], v7 offset:25600
    v_exp_f32 v167, v167
    v_exp_f32 v168, v168
    v_exp_f32 v169, v169
    v_exp_f32 v170, v170
    v_exp_f32 v171, v171
    v_exp_f32 v172, v172
    v_exp_f32 v173, v173
    v_exp_f32 v174, v174
    v_exp_f32 v175, v175
    v_cvt_pk_bf16_f32 v160, v160, v161
    v_cvt_pk_bf16_f32 v161, v162, v163
    v_cvt_pk_bf16_f32 v162, v164, v165
    v_cvt_pk_bf16_f32 v163, v166, v167
    v_and_b32 v106, 15, v0
    v_lshlrev_b32_e64 v106, 2, v106
    buffer_load_dword v105, v106, s[48:51], s98 offen sc1
    s_mov_b32 s10, 342016
    buffer_load_dwordx4 v111, s[32:35], s10 offen offset:3072 lds
    v_cvt_pk_bf16_f32 v164, v168, v169
    v_cvt_pk_bf16_f32 v165, v170, v171
    v_cvt_pk_bf16_f32 v166, v172, v173
    v_cvt_pk_bf16_f32 v167, v174, v175
    s_waitcnt lgkmcnt(4)
    s_cmp_lt_u32 s59, 4
    s_cbranch_scc1 sk_28
    v_mfma_f32_32x32x16_bf16 v[48:63], v[40:43], v[160:163], v[48:63]
sk_28:
    v_exp_f32 v176, v176
    v_exp_f32 v177, v177
    v_exp_f32 v178, v178
    v_exp_f32 v179, v179
    s_cmp_lt_u32 s59, 4
    s_cbranch_scc1 sk_29
    v_mfma_f32_32x32x16_bf16 v[48:63], v[44:47], v[164:167], v[48:63]
sk_29:
    s_mov_b64 exec, s[96:97]
    ds_read_b128 v[40:43], v7 offset:10240
    ds_read_b128 v[44:47], v7 offset:11264
    s_mov_b64 exec, -1
    v_exp_f32 v180, v180
    v_exp_f32 v181, v181
    v_exp_f32 v182, v182
    v_mfma_f32_32x32x16_bf16 v[144:159], v[92:95], v[16:19], v[192:207]
    ds_read_b128 v[68:71], v7 offset:21504
    v_exp_f32 v183, v183
    v_exp_f32 v184, v184
    v_exp_f32 v185, v185
    v_exp_f32 v186, v186
    s_lshl_b32 s11, s58, 13
    s_add_u32 m0, s11, 32768
    s_mov_b32 s10, 2048
    buffer_load_dwordx4 v111, s[32:35], s10 offen offset:0 lds
    v_exp_f32 v187, v187
    v_exp_f32 v188, v188
    v_exp_f32 v189, v189
    v_exp_f32 v190, v190
    v_exp_f32 v191, v191
    v_cvt_pk_bf16_f32 v176, v176, v177
    v_cvt_pk_bf16_f32 v177, v178, v179
    v_cvt_pk_bf16_f32 v178, v180, v181
    v_cvt_pk_bf16_f32 v179, v182, v183
    v_cvt_pk_bf16_f32 v180, v184, v185
    v_cvt_pk_bf16_f32 v181, v186, v187
    v_cvt_pk_bf16_f32 v182, v188, v189
    v_cvt_pk_bf16_f32 v183, v190, v191
    s_waitcnt lgkmcnt(4)
    s_cmp_lt_u32 s59, 5
    s_cbranch_scc1 sk_30
    v_mfma_f32_32x32x16_bf16 v[48:63], v[32:35], v[176:179], v[48:63]
sk_30:
    v_exp_f32 v112, v112
    v_exp_f32 v113, v113
    v_exp_f32 v114, v114
    v_exp_f32 v115, v115
    s_cmp_lt_u32 s59, 5
    s_cbranch_scc1 sk_31
    v_mfma_f32_32x32x16_bf16 v[48:63], v[36:39], v[180:183], v[48:63]
sk_31:
    s_mov_b64 exec, s[96:97]
    ds_read_b128 v[32:35], v7 offset:6144
    ds_read_b128 v[36:39], v7 offset:7168
    s_mov_b64 exec, -1
    v_exp_f32 v116, v116
    s_mov_b32 s10, 50176
    buffer_load_dwordx4 v111, s[32:35], s10 offen offset:1024 lds
    v_exp_f32 v117, v117
    v_exp_f32 v118, v118
    v_mfma_f32_32x32x16_bf16 v[160:175], v[96:99], v[20:23], v[208:223]
    ds_read_b128 v[72:75], v7 offset:17408
    v_exp_f32 v119, v119
    v_exp_f32 v120, v120
    v_exp_f32 v121, v121
    v_exp_f32 v122, v122
    v_exp_f32 v123, v123
    v_exp_f32 v124, v124
    v_exp_f32 v125, v125
    v_exp_f32 v126, v126
    v_exp_f32_e64 v127, v127
    v_cvt_pk_bf16_f32 v112, v112, v113
    v_cvt_pk_bf16_f32 v113, v114, v115
    v_cvt_pk_bf16_f32 v114, v116, v117
    v_cvt_pk_bf16_f32 v115, v118, v119
    s_mov_b32 s10, 98304
    buffer_load_dwordx4 v111, s[32:35], s10 offen offset:2048 lds
    v_cvt_pk_bf16_f32 v116, v120, v121
    v_cvt_pk_bf16_f32 v117, v122, v123
    v_cvt_pk_bf16_f32 v118, v124, v125
    v_cvt_pk_bf16_f32 v119, v126, v127
    s_waitcnt lgkmcnt(4)
    s_cmp_lt_u32 s59, 6
    s_cbranch_scc1 sk_32
    v_mfma_f32_32x32x16_bf16 v[48:63], v[40:43], v[112:115], v[48:63]
sk_32:
    v_exp_f32 v128, v128
    v_exp_f32 v129, v129
    v_exp_f32 v130, v130
    v_exp_f32 v131, v131
    s_cmp_lt_u32 s59, 6
    s_cbranch_scc1 sk_33
    v_mfma_f32_32x32x16_bf16 v[48:63], v[44:47], v[116:119], v[48:63]
sk_33:
    s_mov_b64 exec, s[96:97]
    ds_read_b128 v[40:43], v7 offset:2048
    ds_read_b128 v[44:47], v7 offset:3072
    s_mov_b64 exec, -1
    v_exp_f32 v132, v132
    v_exp_f32 v133, v133
    v_exp_f32 v134, v134
    v_mfma_f32_32x32x16_bf16 v[176:191], v[64:67], v[20:23], v[208:223]
    ds_read_b128 v[76:79], v7 offset:13312
    v_exp_f32 v135, v135
    v_exp_f32 v136, v136
    v_exp_f32 v137, v137
    v_exp_f32 v138, v138
    s_mov_b32 s10, 146432
    buffer_load_dwordx4 v111, s[32:35], s10 offen offset:3072 lds
    v_exp_f32 v139, v139
    v_exp_f32 v140, v140
    v_exp_f32 v141, v141
    v_exp_f32 v142, v142
    v_exp_f32_e64 v143, v143
    v_cvt_pk_bf16_f32 v128, v128, v129
    v_cvt_pk_bf16_f32 v129, v130, v131
    v_cvt_pk_bf16_f32 v130, v132, v133
    v_cvt_pk_bf16_f32 v131, v134, v135
    v_cvt_pk_bf16_f32 v132, v136, v137
    v_cvt_pk_bf16_f32 v133, v138, v139
    v_cvt_pk_bf16_f32 v134, v140, v141
    v_cvt_pk_bf16_f32 v135, v142, v143
    s_waitcnt lgkmcnt(4)
    s_cmp_lt_u32 s59, 7
    s_cbranch_scc1 sk_34
    v_mfma_f32_32x32x16_bf16 v[48:63], v[32:35], v[128:131], v[48:63]
sk_34:
    v_exp_f32 v144, v144
    v_exp_f32 v145, v145
    v_exp_f32 v146, v146
    v_exp_f32 v147, v147
    s_waitcnt vmcnt(11)
    v_and_b32 v108, 15, v0
    v_lshlrev_b32 v108, 7, v108
    v_add_u32 v108, s61, v108
    v_add_u32 v104, 0x200000, v108
    v_xor_b32 v104, 16384, v104
    v_cndmask_b32 v108, v108, v104, s[96:97]
    s_lshl_b32 s4, s57, 8
    s_add_u32 s4, s4, s101
    v_and_b32 v104, 1, v0
    v_lshl_add_u32 v104, v104, 7, s4
    v_cndmask_b32 v108, v108, v104, s[12:13]
    s_mov_b32 exec_hi, 3
    s_mov_b32 exec_lo, 0xffff0000
    buffer_load_dword a255, v108, s[48:51], 0 offen sc1
    s_mov_b64 exec, -1
    s_lshl_b32 s11, s58, 13
    s_add_u32 m0, s11, 36864
    s_mov_b32 s10, 198656
    buffer_load_dwordx4 v111, s[32:35], s10 offen offset:0 lds
    s_cmp_lt_u32 s59, 7
    s_cbranch_scc1 sk_35
    v_mfma_f32_32x32x16_bf16 v[48:63], v[36:39], v[132:135], v[48:63]
sk_35:
    s_mov_b64 exec, s[96:97]
    ds_read_b128 v[32:35], v7 offset:30976
    ds_read_b128 v[36:39], v7 offset:32000
    s_mov_b64 exec, -1
    v_exp_f32 v148, v148
    v_exp_f32 v149, v149
    v_exp_f32 v150, v150
    v_mfma_f32_32x32x16_bf16 v[112:127], v[68:71], v[20:23], v[208:223]
    ds_read_b128 v[80:83], v7 offset:9216
    v_exp_f32 v151, v151
    v_exp_f32 v152, v152
    v_exp_f32 v153, v153
    v_exp_f32 v154, v154
    v_exp_f32 v155, v155
    v_exp_f32 v156, v156
    v_exp_f32 v157, v157
    v_exp_f32 v158, v158
    v_exp_f32 v159, v159
    v_cvt_pk_bf16_f32 v144, v144, v145
    v_cvt_pk_bf16_f32 v145, v146, v147
    v_cvt_pk_bf16_f32 v146, v148, v149
    v_cvt_pk_bf16_f32 v147, v150, v151
    s_waitcnt vmcnt(7)
    s_movk_i32 s4, 0x100
    v_cmp_gt_u32 vcc, s4, v105
    s_cbranch_vccnz gb_36
go_37:
    v_and_b32 v105, 0xff, v105
    v_cmp_eq_u32 vcc, s6, v105
    s_nop 0
    s_cmp_eq_u64 vcc, exec
    s_cselect_b32 s63, 1, 0
    s_lshl_b32 s4, s57, 2
    s_add_u32 s4, s4, s58
    s_lshl_b32 s4, s4, 5
    s_add_u32 s4, s4, s56
    s_lshl_b32 s4, s4, 2
    s_add_u32 s4, s4, 0x442000
    v_mov_b32_e64 v108, 1
    s_mov_b64 exec, 1
    buffer_store_dword v108, off, s[48:51], s4 sc0 sc1
    s_mov_b64 exec, -1
    s_mov_b32 s10, 246784
    buffer_load_dwordx4 v111, s[32:35], s10 offen offset:1024 lds
    v_cvt_pk_bf16_f32 v148, v152, v153
    v_cvt_pk_bf16_f32 v149, v154, v155
    v_cvt_pk_bf16_f32 v150, v156, v157
    v_cvt_pk_bf16_f32 v151, v158, v159
    v_bfi_b32 v144, v24, 0, v144
    v_bfi_b32 v145, v25, 0, v145
    v_bfi_b32 v146, v26, 0, v146
    v_bfi_b32 v147, v27, 0, v147
    v_bfi_b32 v148, v28, 0, v148
    v_bfi_b32 v149, v29, 0, v149
    v_bfi_b32 v150, v30, 0, v150
    v_bfi_b32 v151, v31, 0, v151
    s_waitcnt lgkmcnt(4)
    s_cmp_lt_u32 s59, 8
    s_cbranch_scc1 sk_40
    v_mfma_f32_32x32x16_bf16 v[48:63], v[40:43], v[144:147], v[48:63]
sk_40:
    v_exp_f32 v160, v160
    v_exp_f32 v161, v161
    v_exp_f32 v162, v162
    v_exp_f32 v163, v163
    s_cmp_lt_u32 s59, 8
    s_cbranch_scc1 sk_41
    v_mfma_f32_32x32x16_bf16 v[48:63], v[44:47], v[148:151], v[48:63]
sk_41:
    s_mov_b64 exec, s[96:97]
    ds_read_b128 v[40:43], v7 offset:26880
    ds_read_b128 v[44:47], v7 offset:27904
    s_mov_b64 exec, -1
    v_exp_f32 v164, v164
    v_exp_f32 v165, v165
    v_exp_f32 v166, v166
    s_mov_b32 s10, 294912
    buffer_load_dwordx4 v111, s[32:35], s10 offen offset:2048 lds
    v_mfma_f32_32x32x16_bf16 v[128:143], v[72:75], v[20:23], v[208:223]
    ds_read_b128 v[84:87], v7 offset:5120
    v_exp_f32 v167, v167
    v_exp_f32 v168, v168
    v_exp_f32 v169, v169
    v_exp_f32 v170, v170
    v_exp_f32 v171, v171
    v_exp_f32 v172, v172
    v_exp_f32 v173, v173
    v_exp_f32 v174, v174
    v_exp_f32_e64 v175, v175
    v_cvt_pk_bf16_f32 v160, v160, v161
    v_cvt_pk_bf16_f32 v161, v162, v163
    v_cvt_pk_bf16_f32 v162, v164, v165
    v_cvt_pk_bf16_f32 v163, v166, v167
    v_cvt_pk_bf16_f32 v164, v168, v169
    v_cvt_pk_bf16_f32 v165, v170, v171
    v_cvt_pk_bf16_f32 v166, v172, v173
    v_cvt_pk_bf16_f32 v167, v174, v175
    s_mov_b32 s10, 343040
    buffer_load_dwordx4 v111, s[32:35], s10 offen offset:3072 lds
    s_waitcnt lgkmcnt(4)
    s_cmp_lt_u32 s59, 1
    s_cbranch_scc1 sk_42
    v_mfma_f32_32x32x16_bf16 v[224:239], v[32:35], v[160:163], v[224:239]
sk_42:
    v_rcp_f32 v57, v56
    v_cmp_ngt_f32 vcc, 0x71800000, v56
    s_nop 0
    s_or_b64 s[16:17], s[16:17], vcc
    v_mul_f32 v48, v48, v57
    v_mul_f32 v49, v49, v57
    v_mul_f32 v50, v50, v57
    s_cmp_lt_u32 s59, 1
    s_cbranch_scc1 sk_43
    v_mfma_f32_32x32x16_bf16 v[224:239], v[36:39], v[164:167], v[224:239]
sk_43:
    s_mov_b64 exec, s[96:97]
    ds_read_b128 v[32:35], v7 offset:22784
    ds_read_b128 v[36:39], v7 offset:23808
    s_mov_b64 exec, -1
    v_mul_f32 v51, v51, v57
    v_mul_f32 v52, v52, v57
    v_mul_f32 v53, v53, v57
    v_mul_f32 v54, v54, v57
    v_mul_f32 v55, v55, v57
    v_add_u32 v48, 0x8000, v48
    v_mfma_f32_32x32x16_bf16 v[144:159], v[76:79], v[20:23], v[208:223]
    ds_read_b128 v[88:91], v7 offset:1024
    v_cvt_pk_bf16_f32 v60, v48, v49
    v_cvt_pk_bf16_f32 v61, v50, v51
    v_cvt_pk_bf16_f32 v62, v52, v53
    v_cvt_pk_bf16_f32 v63, v54, v55
    v_and_b32 v60, -2, v60
    s_cmp_eq_u64 s[16:17], 0
    s_cselect_b32 s7, s62, 0x7f000000
    s_cselect_b32 s54, 0x7f000000, s62
    buffer_store_dwordx4 v[60:63], v1, s[48:51], s7 offen offset:0 sc0 sc1
    v_exp_f32 v176, v176
    v_exp_f32 v177, v177
    v_exp_f32 v178, v178
    v_lshrrev_b32 v108, 2, v0
    s_lshl_b32 s11, s58, 7
    v_add_u32 v108, s11, v108
    v_lshlrev_b32 v108, 11, v108
    v_sub_u32 v111, v111, v108
    v_xor_b32 v111, 512, v111
    s_lshl_b32 s11, s58, 13
    s_add_u32 m0, s11, 0
    s_mov_b32 s10, 0
    buffer_load_dwordx4 v111, s[36:39], s10 offen offset:0 lds
    v_exp_f32 v179, v179
    v_exp_f32 v180, v180
    v_exp_f32 v181, v181
    v_exp_f32 v182, v182
    v_exp_f32 v183, v183
    v_exp_f32 v184, v184
    v_exp_f32 v185, v185
    v_exp_f32 v186, v186
    v_exp_f32 v187, v187
    v_exp_f32 v188, v188
    v_exp_f32 v189, v189
    v_exp_f32 v190, v190
    v_exp_f32 v191, v191
    v_cvt_pk_bf16_f32 v176, v176, v177
    v_cvt_pk_bf16_f32 v177, v178, v179
    s_mov_b32 s10, 15360
    buffer_load_dwordx4 v111, s[36:39], s10 offen offset:1024 lds
    v_cvt_pk_bf16_f32 v178, v180, v181
    v_cvt_pk_bf16_f32 v179, v182, v183
    v_cvt_pk_bf16_f32 v180, v184, v185
    v_cvt_pk_bf16_f32 v181, v186, v187
    v_cvt_pk_bf16_f32 v182, v188, v189
    v_cvt_pk_bf16_f32 v183, v190, v191
    s_waitcnt lgkmcnt(4)
    s_cmp_lt_u32 s59, 2
    s_cbranch_scc1 sk_44
    v_mfma_f32_32x32x16_bf16 v[224:239], v[40:43], v[176:179], v[224:239]
sk_44:
    v_exp_f32 v112, v112
    v_exp_f32 v113, v113
    v_exp_f32 v114, v114
    v_exp_f32 v115, v115
    s_cmp_lt_u32 s59, 2
    s_cbranch_scc1 sk_45
    v_mfma_f32_32x32x16_bf16 v[224:239], v[44:47], v[180:183], v[224:239]
sk_45:
    s_mov_b64 exec, s[96:97]
    ds_read_b128 v[40:43], v7 offset:18688
    ds_read_b128 v[44:47], v7 offset:19712
    s_mov_b64 exec, -1
    v_exp_f32 v116, v116
    v_exp_f32 v117, v117
    v_exp_f32 v118, v118
    v_mfma_f32_32x32x16_bf16 v[160:175], v[80:83], v[20:23], v[208:223]
    v_exp_f32 v119, v119
    v_exp_f32 v120, v120
    v_exp_f32 v121, v121
    s_mov_b32 s10, 30720
    buffer_load_dwordx4 v111, s[36:39], s10 offen offset:2048 lds
    v_exp_f32 v122, v122
    v_exp_f32 v123, v123
    v_exp_f32 v124, v124
    v_exp_f32 v125, v125
    v_exp_f32 v126, v126
    v_exp_f32_e64 v127, v127
    v_cvt_pk_bf16_f32 v112, v112, v113
    v_cvt_pk_bf16_f32 v113, v114, v115
    v_cvt_pk_bf16_f32 v114, v116, v117
    v_cvt_pk_bf16_f32 v115, v118, v119
    v_cvt_pk_bf16_f32 v116, v120, v121
    v_cvt_pk_bf16_f32 v117, v122, v123
    v_cvt_pk_bf16_f32 v118, v124, v125
    v_cvt_pk_bf16_f32 v119, v126, v127
    s_waitcnt lgkmcnt(3)
    s_cmp_lt_u32 s59, 3
    s_cbranch_scc1 sk_46
    v_mfma_f32_32x32x16_bf16 v[224:239], v[32:35], v[112:115], v[224:239]
sk_46:
    v_exp_f32 v128, v128
    v_exp_f32 v129, v129
    v_exp_f32 v130, v130
    s_mov_b32 s10, 46080
    buffer_load_dwordx4 v111, s[36:39], s10 offen offset:3072 lds
    v_exp_f32 v131, v131
    s_cmp_lt_u32 s59, 3
    s_cbranch_scc1 sk_47
    v_mfma_f32_32x32x16_bf16 v[224:239], v[36:39], v[116:119], v[224:239]
sk_47:
    s_mov_b64 exec, s[96:97]
    ds_read_b128 v[32:35], v7 offset:14592
    ds_read_b128 v[36:39], v7 offset:15616
    s_mov_b64 exec, -1
    v_exp_f32 v132, v132
    v_exp_f32 v133, v133
    v_exp_f32 v134, v134
    v_mfma_f32_32x32x16_bf16 v[176:191], v[84:87], v[20:23], v[208:223]
    v_exp_f32 v135, v135
    v_exp_f32 v136, v136
    v_exp_f32 v137, v137
    v_exp_f32 v138, v138
    v_exp_f32 v139, v139
    v_exp_f32 v140, v140
    v_exp_f32 v141, v141
    v_exp_f32 v142, v142
    v_exp_f32 v143, v143
    v_cvt_pk_bf16_f32 v128, v128, v129
    s_lshl_b32 s11, s58, 13
    s_add_u32 m0, s11, 4096
    s_mov_b32 s10, 65536
    buffer_load_dwordx4 v111, s[36:39], s10 offen offset:0 lds
    v_cvt_pk_bf16_f32 v129, v130, v131
    v_cvt_pk_bf16_f32 v130, v132, v133
    v_cvt_pk_bf16_f32 v131, v134, v135
    v_cvt_pk_bf16_f32 v132, v136, v137
    v_cvt_pk_bf16_f32 v133, v138, v139
    v_cvt_pk_bf16_f32 v134, v140, v141
    v_cvt_pk_bf16_f32 v135, v142, v143
    s_waitcnt lgkmcnt(2)
    s_cmp_lt_u32 s59, 4
    s_cbranch_scc1 sk_48
    v_mfma_f32_32x32x16_bf16 v[224:239], v[40:43], v[128:131], v[224:239]
sk_48:
    v_exp_f32 v144, v144
    v_exp_f32 v145, v145
    v_exp_f32 v146, v146
    v_exp_f32 v147, v147
    s_cmp_lt_u32 s59, 4
    s_cbranch_scc1 sk_49
    v_mfma_f32_32x32x16_bf16 v[224:239], v[44:47], v[132:135], v[224:239]
sk_49:
    s_mov_b64 exec, s[96:97]
    ds_read_b128 v[40:43], v7 offset:10496
    ds_read_b128 v[44:47], v7 offset:11520
    s_mov_b64 exec, -1
    v_exp_f32 v148, v148
    v_exp_f32 v149, v149
    v_exp_f32 v150, v150
    v_mfma_f32_32x32x16_bf16 v[112:127], v[88:91], v[20:23], v[208:223]
    v_exp_f32 v151, v151
    v_exp_f32 v152, v152
    v_exp_f32 v153, v153
    s_mov_b32 s10, 80896
    buffer_load_dwordx4 v111, s[36:39], s10 offen offset:1024 lds
    v_exp_f32 v154, v154
    v_exp_f32 v155, v155
    v_exp_f32 v156, v156
    v_exp_f32 v157, v157
    v_exp_f32 v158, v158
    v_exp_f32_e64 v159, v159
    v_cvt_pk_bf16_f32 v144, v144, v145
    v_cvt_pk_bf16_f32 v145, v146, v147
    v_cvt_pk_bf16_f32 v146, v148, v149
    v_cvt_pk_bf16_f32 v147, v150, v151
    v_cvt_pk_bf16_f32 v148, v152, v153
    v_cvt_pk_bf16_f32 v149, v154, v155
    v_cvt_pk_bf16_f32 v150, v156, v157
    v_cvt_pk_bf16_f32 v151, v158, v159
    s_waitcnt lgkmcnt(2)
    s_cmp_lt_u32 s59, 5
    s_cbranch_scc1 sk_50
    v_mfma_f32_32x32x16_bf16 v[224:239], v[32:35], v[144:147], v[224:239]
sk_50:
    v_exp_f32 v160, v160
    v_exp_f32 v161, v161
    v_exp_f32 v162, v162
    s_mov_b32 s10, 96256
    buffer_load_dwordx4 v111, s[36:39], s10 offen offset:2048 lds
    v_exp_f32 v163, v163
    s_cmp_lt_u32 s59, 5
    s_cbranch_scc1 sk_51
    v_mfma_f32_32x32x16_bf16 v[224:239], v[36:39], v[148:151], v[224:239]
sk_51:
    s_mov_b64 exec, s[96:97]
    ds_read_b128 v[32:35], v7 offset:6400
    ds_read_b128 v[36:39], v7 offset:7424
    s_mov_b64 exec, -1
    v_exp_f32 v164, v164
    v_exp_f32 v165, v165
    v_exp_f32 v166, v166
    v_exp_f32 v167, v167
    v_exp_f32 v168, v168
    v_exp_f32 v169, v169
    v_exp_f32 v170, v170
    v_exp_f32 v171, v171
    v_exp_f32 v172, v172
    v_exp_f32 v173, v173
    v_exp_f32 v174, v174
    v_exp_f32_e64 v175, v175
    v_cvt_pk_bf16_f32 v160, v160, v161
    s_mov_b32 s10, 111616
    buffer_load_dwordx4 v111, s[36:39], s10 offen offset:3072 lds
    v_cvt_pk_bf16_f32 v161, v162, v163
    v_cvt_pk_bf16_f32 v162, v164, v165
    v_cvt_pk_bf16_f32 v163, v166, v167
    v_cvt_pk_bf16_f32 v164, v168, v169
    v_cvt_pk_bf16_f32 v165, v170, v171
    v_cvt_pk_bf16_f32 v166, v172, v173
    v_cvt_pk_bf16_f32 v167, v174, v175
    s_waitcnt lgkmcnt(2)
    s_cmp_lt_u32 s59, 6
    s_cbranch_scc1 sk_52
    v_mfma_f32_32x32x16_bf16 v[224:239], v[40:43], v[160:163], v[224:239]
sk_52:
    v_exp_f32 v176, v176
    v_exp_f32 v177, v177
    v_exp_f32 v178, v178
    v_exp_f32 v179, v179
    s_cmp_lt_u32 s59, 6
    s_cbranch_scc1 sk_53
    v_mfma_f32_32x32x16_bf16 v[224:239], v[44:47], v[164:167], v[224:239]
sk_53:
    s_mov_b64 exec, s[96:97]
    ds_read_b128 v[40:43], v7 offset:2304
    ds_read_b128 v[44:47], v7 offset:3328
    s_mov_b64 exec, -1
    v_exp_f32 v180, v180
    v_exp_f32 v181, v181
    v_exp_f32 v182, v182
    v_exp_f32 v183, v183
    v_exp_f32 v184, v184
    v_exp_f32 v185, v185
    v_exp_f32 v186, v186
    v_exp_f32 v187, v187
    v_exp_f32 v188, v188
    v_exp_f32 v189, v189
    v_exp_f32 v190, v190
    v_exp_f32_e64 v191, v191
    v_cvt_pk_bf16_f32 v176, v176, v177
    v_cvt_pk_bf16_f32 v177, v178, v179
    v_cvt_pk_bf16_f32 v178, v180, v181
    v_cvt_pk_bf16_f32 v179, v182, v183
    v_cvt_pk_bf16_f32 v180, v184, v185
    v_cvt_pk_bf16_f32 v181, v186, v187
    v_cvt_pk_bf16_f32 v182, v188, v189
    v_cvt_pk_bf16_f32 v183, v190, v191
    s_waitcnt lgkmcnt(2)
    s_cmp_lt_u32 s59, 7
    s_cbranch_scc1 sk_54
    v_mfma_f32_32x32x16_bf16 v[224:239], v[32:35], v[176:179], v[224:239]
sk_54:
    v_exp_f32 v112, v112
    v_exp_f32 v113, v113
    v_exp_f32 v114, v114
    v_exp_f32 v115, v115
    s_cmp_lt_u32 s59, 7
    s_cbranch_scc1 sk_55
    v_mfma_f32_32x32x16_bf16 v[224:239], v[36:39], v[180:183], v[224:239]
sk_55:
    v_exp_f32 v116, v116
    v_exp_f32 v117, v117
    v_exp_f32 v118, v118
    v_exp_f32 v119, v119
    v_exp_f32 v120, v120
    v_exp_f32 v121, v121
    v_exp_f32 v122, v122
    v_exp_f32 v123, v123
    v_exp_f32 v124, v124
    v_exp_f32 v125, v125
    v_exp_f32 v126, v126
    v_exp_f32_e64 v127, v127
    v_cvt_pk_bf16_f32 v112, v112, v113
    v_cvt_pk_bf16_f32 v113, v114, v115
    v_cvt_pk_bf16_f32 v114, v116, v117
    v_cvt_pk_bf16_f32 v115, v118, v119
    v_cvt_pk_bf16_f32 v116, v120, v121
    v_cvt_pk_bf16_f32 v117, v122, v123
    v_cvt_pk_bf16_f32 v118, v124, v125
    v_cvt_pk_bf16_f32 v119, v126, v127
    v_bfi_b32 v112, v24, 0, v112
    v_bfi_b32 v113, v25, 0, v113
    v_bfi_b32 v114, v26, 0, v114
    v_bfi_b32 v115, v27, 0, v115
    v_bfi_b32 v116, v28, 0, v116
    v_bfi_b32 v117, v29, 0, v117
    v_bfi_b32 v118, v30, 0, v118
    v_bfi_b32 v119, v31, 0, v119
    s_waitcnt lgkmcnt(0)
    s_cmp_lt_u32 s59, 8
    s_cbranch_scc1 sk_56
    v_mfma_f32_32x32x16_bf16 v[224:239], v[40:43], v[112:115], v[224:239]
sk_56:
    s_cmp_lt_u32 s59, 8
    s_cbranch_scc1 sk_57
    v_mfma_f32_32x32x16_bf16 v[224:239], v[44:47], v[116:119], v[224:239]
sk_57:
    s_nop 11
    v_rcp_f32 v233, v232
    v_cmp_ngt_f32 vcc, 0x71800000, v232
    s_nop 0
    s_or_b64 s[16:17], s[16:17], vcc
    v_mul_f32 v224, v224, v233
    v_mul_f32 v225, v225, v233
    v_mul_f32 v226, v226, v233
    v_mul_f32 v227, v227, v233
    v_mul_f32 v228, v228, v233
    v_mul_f32 v229, v229, v233
    v_mul_f32 v230, v230, v233
    v_mul_f32_e64 v231, v231, v233
    v_add_u32 v224, 0x8000, v224
    v_cvt_pk_bf16_f32 v236, v224, v225
    v_cvt_pk_bf16_f32 v237, v226, v227
    v_cvt_pk_bf16_f32 v238, v228, v229
    v_cvt_pk_bf16_f32 v239, v230, v231
    v_and_b32 v236, -2, v236
    s_cmp_eq_u64 s[16:17], 0
    s_cselect_b32 s7, s62, 0x7f000000
    buffer_store_dwordx4 v[236:239], v1, s[48:51], s7 offen offset:1024 sc0 sc1
    s_nop 1
    s_branch ajoin_19
gb_58:
    s_mov_b32 s99, 200000
poll_60:
    buffer_load_dword v105, v106, s[48:51], s98 offen sc1
    s_waitcnt vmcnt(0)
    v_cmp_le_u32 vcc, s4, v105
    s_nop 0
    s_cmp_eq_u64 vcc, exec
    s_nop 1
    s_nop 0
    s_cbranch_scc1 polld_61
    s_sub_u32 s99, s99, 1
    s_cmp_lg_u32 s99, 0
    s_cbranch_scc1 poll_60
polld_61:
    s_branch go_59
aslow_20:
    s_waitcnt vmcnt(0) lgkmcnt(0)
    ds_read_b128 v[64:67], v7 offset:0
    ds_read_b128 v[68:71], v7 offset:4096
    ds_read_b128 v[72:75], v7 offset:8192
    ds_read_b128 v[76:79], v7 offset:12288
    ds_read_b128 v[80:83], v7 offset:16384
    ds_read_b128 v[84:87], v7 offset:20480
    ds_read_b128 v[88:91], v7 offset:24576
    ds_read_b128 v[92:95], v7 offset:28672
    ds_read_b128 v[96:99], v7 offset:32768
    s_mov_b64 exec, s[96:97]
    ds_read_b128 v[32:35], v7 offset:34816
    ds_read_b128 v[36:39], v7 offset:35840
    s_mov_b64 exec, -1
    s_mov_b64 exec, s[96:97]
    ds_read_b128 v[40:43], v7 offset:2048
    ds_read_b128 v[44:47], v7 offset:3072
    s_mov_b64 exec, -1
    s_waitcnt lgkmcnt(0)
    v_mfma_f32_32x32x16_bf16 v[112:127], v[64:67], v[16:19], 0
    v_mfma_f32_32x32x16_bf16 v[128:143], v[68:71], v[16:19], 0
    v_mfma_f32_32x32x16_bf16 v[144:159], v[72:75], v[16:19], 0
    v_mfma_f32_32x32x16_bf16 v[160:175], v[76:79], v[16:19], 0
    v_mfma_f32_32x32x16_bf16 v[176:191], v[80:83], v[16:19], 0
    v_mfma_f32_32x32x16_bf16 v[192:207], v[84:87], v[16:19], 0
    v_mfma_f32_32x32x16_bf16 v[208:223], v[88:91], v[16:19], 0
    v_mfma_f32_32x32x16_bf16 v[224:239], v[92:95], v[16:19], 0
    v_mfma_f32_32x32x16_bf16 v[240:255], v[96:99], v[16:19], 0
    s_cmp_ge_u32 s59, 8
    s_nop 10
    s_cbranch_scc1 valid_62
    v_mov_b32 v112, 0xff800000
    v_mov_b32 v113, 0xff800000
    v_mov_b32 v114, 0xff800000
    v_mov_b32 v115, 0xff800000
    v_mov_b32 v116, 0xff800000
    v_mov_b32 v117, 0xff800000
    v_mov_b32 v118, 0xff800000
    v_mov_b32 v119, 0xff800000
    v_mov_b32 v120, 0xff800000
    v_mov_b32 v121, 0xff800000
    v_mov_b32 v122, 0xff800000
    v_mov_b32 v123, 0xff800000
    v_mov_b32 v124, 0xff800000
    v_mov_b32 v125, 0xff800000
    v_mov_b32 v126, 0xff800000
    v_mov_b32 v127, 0xff800000
    s_cmp_ge_u32 s59, 7
    s_nop 0
    s_cbranch_scc1 valid_62
    v_mov_b32 v128, 0xff800000
    v_mov_b32 v129, 0xff800000
    v_mov_b32 v130, 0xff800000
    v_mov_b32 v131, 0xff800000
    v_mov_b32 v132, 0xff800000
    v_mov_b32 v133, 0xff800000
    v_mov_b32 v134, 0xff800000
    v_mov_b32 v135, 0xff800000
    v_mov_b32 v136, 0xff800000
    v_mov_b32 v137, 0xff800000
    v_mov_b32 v138, 0xff800000
    v_mov_b32 v139, 0xff800000
    v_mov_b32 v140, 0xff800000
    v_mov_b32 v141, 0xff800000
    v_mov_b32 v142, 0xff800000
    v_mov_b32 v143, 0xff800000
    s_cmp_ge_u32 s59, 6
    s_nop 0
    s_cbranch_scc1 valid_62
    v_mov_b32 v144, 0xff800000
    v_mov_b32 v145, 0xff800000
    v_mov_b32 v146, 0xff800000
    v_mov_b32 v147, 0xff800000
    v_mov_b32 v148, 0xff800000
    v_mov_b32 v149, 0xff800000
    v_mov_b32 v150, 0xff800000
    v_mov_b32 v151, 0xff800000
    v_mov_b32 v152, 0xff800000
    v_mov_b32 v153, 0xff800000
    v_mov_b32 v154, 0xff800000
    v_mov_b32 v155, 0xff800000
    v_mov_b32 v156, 0xff800000
    v_mov_b32 v157, 0xff800000
    v_mov_b32 v158, 0xff800000
    v_mov_b32 v159, 0xff800000
    s_cmp_ge_u32 s59, 5
    s_nop 0
    s_cbranch_scc1 valid_62
    v_mov_b32 v160, 0xff800000
    v_mov_b32 v161, 0xff800000
    v_mov_b32 v162, 0xff800000
    v_mov_b32 v163, 0xff800000
    v_mov_b32 v164, 0xff800000
    v_mov_b32 v165, 0xff800000
    v_mov_b32 v166, 0xff800000
    v_mov_b32 v167, 0xff800000
    v_mov_b32 v168, 0xff800000
    v_mov_b32 v169, 0xff800000
    v_mov_b32 v170, 0xff800000
    v_mov_b32 v171, 0xff800000
    v_mov_b32 v172, 0xff800000
    v_mov_b32 v173, 0xff800000
    v_mov_b32 v174, 0xff800000
    v_mov_b32 v175, 0xff800000
    s_cmp_ge_u32 s59, 4
    s_nop 0
    s_cbranch_scc1 valid_62
    v_mov_b32 v176, 0xff800000
    v_mov_b32 v177, 0xff800000
    v_mov_b32 v178, 0xff800000
    v_mov_b32 v179, 0xff800000
    v_mov_b32 v180, 0xff800000
    v_mov_b32 v181, 0xff800000
    v_mov_b32 v182, 0xff800000
    v_mov_b32 v183, 0xff800000
    v_mov_b32 v184, 0xff800000
    v_mov_b32 v185, 0xff800000
    v_mov_b32 v186, 0xff800000
    v_mov_b32 v187, 0xff800000
    v_mov_b32 v188, 0xff800000
    v_mov_b32 v189, 0xff800000
    v_mov_b32 v190, 0xff800000
    v_mov_b32 v191, 0xff800000
    s_cmp_ge_u32 s59, 3
    s_nop 0
    s_cbranch_scc1 valid_62
    v_mov_b32 v192, 0xff800000
    v_mov_b32 v193, 0xff800000
    v_mov_b32 v194, 0xff800000
    v_mov_b32 v195, 0xff800000
    v_mov_b32 v196, 0xff800000
    v_mov_b32 v197, 0xff800000
    v_mov_b32 v198, 0xff800000
    v_mov_b32 v199, 0xff800000
    v_mov_b32 v200, 0xff800000
    v_mov_b32 v201, 0xff800000
    v_mov_b32 v202, 0xff800000
    v_mov_b32 v203, 0xff800000
    v_mov_b32 v204, 0xff800000
    v_mov_b32 v205, 0xff800000
    v_mov_b32 v206, 0xff800000
    v_mov_b32 v207, 0xff800000
    s_cmp_ge_u32 s59, 2
    s_nop 0
    s_cbranch_scc1 valid_62
    v_mov_b32 v208, 0xff800000
    v_mov_b32 v209, 0xff800000
    v_mov_b32 v210, 0xff800000
    v_mov_b32 v211, 0xff800000
    v_mov_b32 v212, 0xff800000
    v_mov_b32 v213, 0xff800000
    v_mov_b32 v214, 0xff800000
    v_mov_b32 v215, 0xff800000
    v_mov_b32 v216, 0xff800000
    v_mov_b32 v217, 0xff800000
    v_mov_b32 v218, 0xff800000
    v_mov_b32 v219, 0xff800000
    v_mov_b32 v220, 0xff800000
    v_mov_b32 v221, 0xff800000
    v_mov_b32 v222, 0xff800000
    v_mov_b32 v223, 0xff800000
    s_cmp_ge_u32 s59, 1
    s_nop 0
    s_cbranch_scc1 valid_62
    v_mov_b32 v224, 0xff800000
    v_mov_b32 v225, 0xff800000
    v_mov_b32 v226, 0xff800000
    v_mov_b32 v227, 0xff800000
    v_mov_b32 v228, 0xff800000
    v_mov_b32 v229, 0xff800000
    v_mov_b32 v230, 0xff800000
    v_mov_b32 v231, 0xff800000
    v_mov_b32 v232, 0xff800000
    v_mov_b32 v233, 0xff800000
    v_mov_b32 v234, 0xff800000
    v_mov_b32 v235, 0xff800000
    v_mov_b32 v236, 0xff800000
    v_mov_b32 v237, 0xff800000
    v_mov_b32 v238, 0xff800000
    v_mov_b32 v239, 0xff800000
    s_nop 1
valid_62:
    v_cndmask_b32 v240, v112, v240, s[64:65]
    v_cndmask_b32 v241, v113, v241, s[66:67]
    v_cndmask_b32 v242, v114, v242, s[68:69]
    v_cndmask_b32 v243, v115, v243, s[70:71]
    v_cndmask_b32 v244, v116, v244, s[72:73]
    v_cndmask_b32 v245, v117, v245, s[74:75]
    v_cndmask_b32 v246, v118, v246, s[76:77]
    v_cndmask_b32 v247, v119, v247, s[78:79]
    v_cndmask_b32 v248, v120, v248, s[80:81]
    v_cndmask_b32 v249, v121, v249, s[82:83]
    v_cndmask_b32 v250, v122, v250, s[84:85]
    v_cndmask_b32 v251, v123, v251, s[86:87]
    v_cndmask_b32 v252, v124, v252, s[88:89]
    v_cndmask_b32 v253, v125, v253, s[90:91]
    v_cndmask_b32 v254, v126, v254, s[92:93]
    v_cndmask_b32 v255, v127, v255, s[94:95]
    v_max_f32 v108, v240, v241
    v_max_f32 v109, v242, v243
    v_max3_f32 v108, v108, v244, v245
    v_max3_f32 v109, v109, v246, v247
    v_max3_f32 v108, v108, v248, v249
    v_max3_f32 v109, v109, v250, v251
    v_max3_f32 v108, v108, v252, v253
    v_max3_f32 v109, v109, v254, v255
    v_max3_f32 v108, v108, v128, v129
    v_max3_f32 v109, v109, v130, v131
    v_max3_f32 v108, v108, v132, v133
    v_max3_f32 v109, v109, v134, v135
    v_max3_f32 v108, v108, v136, v137
    v_max3_f32 v109, v109, v138, v139
    v_max3_f32 v108, v108, v140, v141
    v_max3_f32 v109, v109, v142, v143
    v_max3_f32 v108, v108, v144, v145
    v_max3_f32 v109, v109, v146, v147
    v_max3_f32 v108, v108, v148, v149
    v_max3_f32 v109, v109, v150, v151
    v_max3_f32 v108, v108, v152, v153
    v_max3_f32 v109, v109, v154, v155
    v_max3_f32 v108, v108, v156, v157
    v_max3_f32 v109, v109, v158, v159
    v_max3_f32 v108, v108, v160, v161
    v_max3_f32 v109, v109, v162, v163
    v_max3_f32 v108, v108, v164, v165
    v_max3_f32 v109, v109, v166, v167
    v_max3_f32 v108, v108, v168, v169
    v_max3_f32 v109, v109, v170, v171
    v_max3_f32 v108, v108, v172, v173
    v_max3_f32 v109, v109, v174, v175
    v_max3_f32 v108, v108, v176, v177
    v_max3_f32 v109, v109, v178, v179
    v_max3_f32 v108, v108, v180, v181
    v_max3_f32 v109, v109, v182, v183
    v_max3_f32 v108, v108, v184, v185
    v_max3_f32 v109, v109, v186, v187
    v_max3_f32 v108, v108, v188, v189
    v_max3_f32 v109, v109, v190, v191
    v_max3_f32 v108, v108, v192, v193
    v_max3_f32 v109, v109, v194, v195
    v_max3_f32 v108, v108, v196, v197
    v_max3_f32 v109, v109, v198, v199
    v_max3_f32 v108, v108, v200, v201
    v_max3_f32 v109, v109, v202, v203
    v_max3_f32 v108, v108, v204, v205
    v_max3_f32 v109, v109, v206, v207
    v_max3_f32 v108, v108, v208, v209
    v_max3_f32 v109, v109, v210, v211
    v_max3_f32 v108, v108, v212, v213
    v_max3_f32 v109, v109, v214, v215
    v_max3_f32 v108, v108, v216, v217
    v_max3_f32 v109, v109, v218, v219
    v_max3_f32 v108, v108, v220, v221
    v_max3_f32 v109, v109, v222, v223
    v_max3_f32 v108, v108, v224, v225
    v_max3_f32 v109, v109, v226, v227
    v_max3_f32 v108, v108, v228, v229
    v_max3_f32 v109, v109, v230, v231
    v_max3_f32 v108, v108, v232, v233
    v_max3_f32 v109, v109, v234, v235
    v_max3_f32 v108, v108, v236, v237
    v_max3_f32 v109, v109, v238, v239
    v_max_f32 v108, v108, v109
    v_mov_b32 v109, v108
    s_nop 1
    v_permlane32_swap_b32 v109, v108
    v_max_f32 v108, v108, v109
    v_sub_f32 v108, 0, v108
    v_pk_add_f32 v[128:129], v[128:129], v[108:109] op_sel_hi:[1,0]
    v_pk_add_f32 v[130:131], v[130:131], v[108:109] op_sel_hi:[1,0]
    v_pk_add_f32 v[132:133], v[132:133], v[108:109] op_sel_hi:[1,0]
    v_pk_add_f32 v[134:135], v[134:135], v[108:109] op_sel_hi:[1,0]
    v_pk_add_f32 v[136:137], v[136:137], v[108:109] op_sel_hi:[1,0]
    v_pk_add_f32 v[138:139], v[138:139], v[108:109] op_sel_hi:[1,0]
    v_pk_add_f32 v[140:141], v[140:141], v[108:109] op_sel_hi:[1,0]
    v_pk_add_f32 v[142:143], v[142:143], v[108:109] op_sel_hi:[1,0]
    v_exp_f32 v128, v128
    v_exp_f32 v129, v129
    v_exp_f32 v130, v130
    v_exp_f32 v131, v131
    v_exp_f32 v132, v132
    v_exp_f32 v133, v133
    v_exp_f32 v134, v134
    v_exp_f32 v135, v135
    v_exp_f32 v136, v136
    v_exp_f32 v137, v137
    v_exp_f32 v138, v138
    v_exp_f32 v139, v139
    v_exp_f32 v140, v140
    v_exp_f32 v141, v141
    v_exp_f32 v142, v142
    v_exp_f32 v143, v143
    v_cvt_pk_bf16_f32 v128, v128, v129
    v_cvt_pk_bf16_f32 v129, v130, v131
    v_cvt_pk_bf16_f32 v130, v132, v133
    v_cvt_pk_bf16_f32 v131, v134, v135
    v_cvt_pk_bf16_f32 v132, v136, v137
    v_cvt_pk_bf16_f32 v133, v138, v139
    v_cvt_pk_bf16_f32 v134, v140, v141
    v_cvt_pk_bf16_f32 v135, v142, v143
    v_pk_add_f32 v[144:145], v[144:145], v[108:109] op_sel_hi:[1,0]
    v_pk_add_f32 v[146:147], v[146:147], v[108:109] op_sel_hi:[1,0]
    v_pk_add_f32 v[148:149], v[148:149], v[108:109] op_sel_hi:[1,0]
    v_pk_add_f32 v[150:151], v[150:151], v[108:109] op_sel_hi:[1,0]
    v_pk_add_f32 v[152:153], v[152:153], v[108:109] op_sel_hi:[1,0]
    v_pk_add_f32 v[154:155], v[154:155], v[108:109] op_sel_hi:[1,0]
    v_pk_add_f32 v[156:157], v[156:157], v[108:109] op_sel_hi:[1,0]
    v_pk_add_f32 v[158:159], v[158:159], v[108:109] op_sel_hi:[1,0]
    v_exp_f32 v144, v144
    v_exp_f32 v145, v145
    v_exp_f32 v146, v146
    v_exp_f32 v147, v147
    v_exp_f32 v148, v148
    v_exp_f32 v149, v149
    v_exp_f32 v150, v150
    v_exp_f32 v151, v151
    v_exp_f32 v152, v152
    v_exp_f32 v153, v153
    v_exp_f32 v154, v154
    v_exp_f32 v155, v155
    v_exp_f32 v156, v156
    v_exp_f32 v157, v157
    v_exp_f32 v158, v158
    v_exp_f32 v159, v159
    v_cvt_pk_bf16_f32 v144, v144, v145
    v_cvt_pk_bf16_f32 v145, v146, v147
    v_cvt_pk_bf16_f32 v146, v148, v149
    v_cvt_pk_bf16_f32 v147, v150, v151
    v_cvt_pk_bf16_f32 v148, v152, v153
    v_cvt_pk_bf16_f32 v149, v154, v155
    v_cvt_pk_bf16_f32 v150, v156, v157
    v_cvt_pk_bf16_f32 v151, v158, v159
    v_pk_add_f32 v[160:161], v[160:161], v[108:109] op_sel_hi:[1,0]
    v_pk_add_f32 v[162:163], v[162:163], v[108:109] op_sel_hi:[1,0]
    v_pk_add_f32 v[164:165], v[164:165], v[108:109] op_sel_hi:[1,0]
    v_pk_add_f32 v[166:167], v[166:167], v[108:109] op_sel_hi:[1,0]
    v_pk_add_f32 v[168:169], v[168:169], v[108:109] op_sel_hi:[1,0]
    v_pk_add_f32 v[170:171], v[170:171], v[108:109] op_sel_hi:[1,0]
    v_pk_add_f32 v[172:173], v[172:173], v[108:109] op_sel_hi:[1,0]
    v_pk_add_f32 v[174:175], v[174:175], v[108:109] op_sel_hi:[1,0]
    v_exp_f32 v160, v160
    v_exp_f32 v161, v161
    v_exp_f32 v162, v162
    v_exp_f32 v163, v163
    v_exp_f32 v164, v164
    v_exp_f32 v165, v165
    v_exp_f32 v166, v166
    v_exp_f32 v167, v167
    v_exp_f32 v168, v168
    v_exp_f32 v169, v169
    v_exp_f32 v170, v170
    v_exp_f32 v171, v171
    v_exp_f32 v172, v172
    v_exp_f32 v173, v173
    v_exp_f32 v174, v174
    v_exp_f32 v175, v175
    v_cvt_pk_bf16_f32 v160, v160, v161
    v_cvt_pk_bf16_f32 v161, v162, v163
    v_cvt_pk_bf16_f32 v162, v164, v165
    v_cvt_pk_bf16_f32 v163, v166, v167
    v_cvt_pk_bf16_f32 v164, v168, v169
    v_cvt_pk_bf16_f32 v165, v170, v171
    v_cvt_pk_bf16_f32 v166, v172, v173
    v_cvt_pk_bf16_f32 v167, v174, v175
    v_pk_add_f32 v[176:177], v[176:177], v[108:109] op_sel_hi:[1,0]
    v_pk_add_f32 v[178:179], v[178:179], v[108:109] op_sel_hi:[1,0]
    v_pk_add_f32 v[180:181], v[180:181], v[108:109] op_sel_hi:[1,0]
    v_pk_add_f32 v[182:183], v[182:183], v[108:109] op_sel_hi:[1,0]
    v_pk_add_f32 v[184:185], v[184:185], v[108:109] op_sel_hi:[1,0]
    v_pk_add_f32 v[186:187], v[186:187], v[108:109] op_sel_hi:[1,0]
    v_pk_add_f32 v[188:189], v[188:189], v[108:109] op_sel_hi:[1,0]
    v_pk_add_f32 v[190:191], v[190:191], v[108:109] op_sel_hi:[1,0]
    v_exp_f32 v176, v176
    v_exp_f32 v177, v177
    v_exp_f32 v178, v178
    v_exp_f32 v179, v179
    v_exp_f32 v180, v180
    v_exp_f32 v181, v181
    v_exp_f32 v182, v182
    v_exp_f32 v183, v183
    v_exp_f32 v184, v184
    v_exp_f32 v185, v185
    v_exp_f32 v186, v186
    v_exp_f32 v187, v187
    v_exp_f32 v188, v188
    v_exp_f32 v189, v189
    v_exp_f32 v190, v190
    v_exp_f32 v191, v191
    v_cvt_pk_bf16_f32 v176, v176, v177
    v_cvt_pk_bf16_f32 v177, v178, v179
    v_cvt_pk_bf16_f32 v178, v180, v181
    v_cvt_pk_bf16_f32 v179, v182, v183
    v_cvt_pk_bf16_f32 v180, v184, v185
    v_cvt_pk_bf16_f32 v181, v186, v187
    v_cvt_pk_bf16_f32 v182, v188, v189
    v_cvt_pk_bf16_f32 v183, v190, v191
    v_pk_add_f32 v[192:193], v[192:193], v[108:109] op_sel_hi:[1,0]
    v_pk_add_f32 v[194:195], v[194:195], v[108:109] op_sel_hi:[1,0]
    v_pk_add_f32 v[196:197], v[196:197], v[108:109] op_sel_hi:[1,0]
    v_pk_add_f32 v[198:199], v[198:199], v[108:109] op_sel_hi:[1,0]
    v_pk_add_f32 v[200:201], v[200:201], v[108:109] op_sel_hi:[1,0]
    v_pk_add_f32 v[202:203], v[202:203], v[108:109] op_sel_hi:[1,0]
    v_pk_add_f32 v[204:205], v[204:205], v[108:109] op_sel_hi:[1,0]
    v_pk_add_f32 v[206:207], v[206:207], v[108:109] op_sel_hi:[1,0]
    v_exp_f32 v192, v192
    v_exp_f32 v193, v193
    v_exp_f32 v194, v194
    v_exp_f32 v195, v195
    v_exp_f32 v196, v196
    v_exp_f32 v197, v197
    v_exp_f32 v198, v198
    v_exp_f32 v199, v199
    v_exp_f32 v200, v200
    v_exp_f32 v201, v201
    v_exp_f32 v202, v202
    v_exp_f32 v203, v203
    v_exp_f32 v204, v204
    v_exp_f32 v205, v205
    v_exp_f32 v206, v206
    v_exp_f32 v207, v207
    v_cvt_pk_bf16_f32 v192, v192, v193
    v_cvt_pk_bf16_f32 v193, v194, v195
    v_cvt_pk_bf16_f32 v194, v196, v197
    v_cvt_pk_bf16_f32 v195, v198, v199
    v_cvt_pk_bf16_f32 v196, v200, v201
    v_cvt_pk_bf16_f32 v197, v202, v203
    v_cvt_pk_bf16_f32 v198, v204, v205
    v_cvt_pk_bf16_f32 v199, v206, v207
    v_pk_add_f32 v[208:209], v[208:209], v[108:109] op_sel_hi:[1,0]
    v_pk_add_f32 v[210:211], v[210:211], v[108:109] op_sel_hi:[1,0]
    v_pk_add_f32 v[212:213], v[212:213], v[108:109] op_sel_hi:[1,0]
    v_pk_add_f32 v[214:215], v[214:215], v[108:109] op_sel_hi:[1,0]
    v_pk_add_f32 v[216:217], v[216:217], v[108:109] op_sel_hi:[1,0]
    v_pk_add_f32 v[218:219], v[218:219], v[108:109] op_sel_hi:[1,0]
    v_pk_add_f32 v[220:221], v[220:221], v[108:109] op_sel_hi:[1,0]
    v_pk_add_f32 v[222:223], v[222:223], v[108:109] op_sel_hi:[1,0]
    v_exp_f32 v208, v208
    v_exp_f32 v209, v209
    v_exp_f32 v210, v210
    v_exp_f32 v211, v211
    v_exp_f32 v212, v212
    v_exp_f32 v213, v213
    v_exp_f32 v214, v214
    v_exp_f32 v215, v215
    v_exp_f32 v216, v216
    v_exp_f32 v217, v217
    v_exp_f32 v218, v218
    v_exp_f32 v219, v219
    v_exp_f32 v220, v220
    v_exp_f32 v221, v221
    v_exp_f32 v222, v222
    v_exp_f32 v223, v223
    v_cvt_pk_bf16_f32 v208, v208, v209
    v_cvt_pk_bf16_f32 v209, v210, v211
    v_cvt_pk_bf16_f32 v210, v212, v213
    v_cvt_pk_bf16_f32 v211, v214, v215
    v_cvt_pk_bf16_f32 v212, v216, v217
    v_cvt_pk_bf16_f32 v213, v218, v219
    v_cvt_pk_bf16_f32 v214, v220, v221
    v_cvt_pk_bf16_f32 v215, v222, v223
    v_pk_add_f32 v[224:225], v[224:225], v[108:109] op_sel_hi:[1,0]
    v_pk_add_f32 v[226:227], v[226:227], v[108:109] op_sel_hi:[1,0]
    v_pk_add_f32 v[228:229], v[228:229], v[108:109] op_sel_hi:[1,0]
    v_pk_add_f32 v[230:231], v[230:231], v[108:109] op_sel_hi:[1,0]
    v_pk_add_f32 v[232:233], v[232:233], v[108:109] op_sel_hi:[1,0]
    v_pk_add_f32 v[234:235], v[234:235], v[108:109] op_sel_hi:[1,0]
    v_pk_add_f32 v[236:237], v[236:237], v[108:109] op_sel_hi:[1,0]
    v_pk_add_f32 v[238:239], v[238:239], v[108:109] op_sel_hi:[1,0]
    v_exp_f32 v224, v224
    v_exp_f32 v225, v225
    v_exp_f32 v226, v226
    v_exp_f32 v227, v227
    v_exp_f32 v228, v228
    v_exp_f32 v229, v229
    v_exp_f32 v230, v230
    v_exp_f32 v231, v231
    v_exp_f32 v232, v232
    v_exp_f32 v233, v233
    v_exp_f32 v234, v234
    v_exp_f32 v235, v235
    v_exp_f32 v236, v236
    v_exp_f32 v237, v237
    v_exp_f32 v238, v238
    v_exp_f32 v239, v239
    v_cvt_pk_bf16_f32 v224, v224, v225
    v_cvt_pk_bf16_f32 v225, v226, v227
    v_cvt_pk_bf16_f32 v226, v228, v229
    v_cvt_pk_bf16_f32 v227, v230, v231
    v_cvt_pk_bf16_f32 v228, v232, v233
    v_cvt_pk_bf16_f32 v229, v234, v235
    v_cvt_pk_bf16_f32 v230, v236, v237
    v_cvt_pk_bf16_f32 v231, v238, v239
    v_pk_add_f32 v[240:241], v[240:241], v[108:109] op_sel_hi:[1,0]
    v_pk_add_f32 v[242:243], v[242:243], v[108:109] op_sel_hi:[1,0]
    v_pk_add_f32 v[244:245], v[244:245], v[108:109] op_sel_hi:[1,0]
    v_pk_add_f32 v[246:247], v[246:247], v[108:109] op_sel_hi:[1,0]
    v_pk_add_f32 v[248:249], v[248:249], v[108:109] op_sel_hi:[1,0]
    v_pk_add_f32 v[250:251], v[250:251], v[108:109] op_sel_hi:[1,0]
    v_pk_add_f32 v[252:253], v[252:253], v[108:109] op_sel_hi:[1,0]
    v_pk_add_f32 v[254:255], v[254:255], v[108:109] op_sel_hi:[1,0]
    v_exp_f32 v240, v240
    v_exp_f32 v241, v241
    v_exp_f32 v242, v242
    v_exp_f32 v243, v243
    v_exp_f32 v244, v244
    v_exp_f32 v245, v245
    v_exp_f32 v246, v246
    v_exp_f32 v247, v247
    v_exp_f32 v248, v248
    v_exp_f32 v249, v249
    v_exp_f32 v250, v250
    v_exp_f32 v251, v251
    v_exp_f32 v252, v252
    v_exp_f32 v253, v253
    v_exp_f32 v254, v254
    v_exp_f32 v255, v255
    v_cvt_pk_bf16_f32 v240, v240, v241
    v_cvt_pk_bf16_f32 v241, v242, v243
    v_cvt_pk_bf16_f32 v242, v244, v245
    v_cvt_pk_bf16_f32 v243, v246, v247
    v_cvt_pk_bf16_f32 v244, v248, v249
    v_cvt_pk_bf16_f32 v245, v250, v251
    v_cvt_pk_bf16_f32 v246, v252, v253
    v_cvt_pk_bf16_f32 v247, v254, v255
    v_bfi_b32 v100, v24, 0, v240
    v_and_b32 v240, v24, v240
    v_bfi_b32 v101, v25, 0, v241
    v_and_b32 v241, v25, v241
    v_bfi_b32 v102, v26, 0, v242
    v_and_b32 v242, v26, v242
    v_bfi_b32 v103, v27, 0, v243
    v_and_b32 v243, v27, v243
    v_bfi_b32 v104, v28, 0, v244
    v_and_b32 v244, v28, v244
    v_bfi_b32 v105, v29, 0, v245
    v_and_b32 v245, v29, v245
    v_bfi_b32 v106, v30, 0, v246
    v_and_b32 v246, v30, v246
    v_bfi_b32 v107, v31, 0, v247
    v_and_b32 v247, v31, v247
    v_mfma_f32_32x32x16_bf16 v[48:63], v[32:35], v[240:243], 0
    s_nop 0
    v_mfma_f32_32x32x16_bf16 v[48:63], v[36:39], v[244:247], v[48:63]
    v_mfma_f32_32x32x16_bf16 v[48:63], v[40:43], v[100:103], v[48:63]
    v_mfma_f32_32x32x16_bf16 v[48:63], v[44:47], v[104:107], v[48:63]
    s_nop 7
    s_mov_b64 exec, s[96:97]
    ds_read_b128 v[32:35], v7 offset:6144
    ds_read_b128 v[36:39], v7 offset:7168
    s_mov_b64 exec, -1
    s_waitcnt lgkmcnt(0)
    v_mfma_f32_32x32x16_bf16 v[48:63], v[32:35], v[128:131], v[48:63]
    v_mfma_f32_32x32x16_bf16 v[48:63], v[36:39], v[132:135], v[48:63]
    s_nop 7
    s_mov_b64 exec, s[96:97]
    ds_read_b128 v[32:35], v7 offset:10240
    ds_read_b128 v[36:39], v7 offset:11264
    s_mov_b64 exec, -1
    s_waitcnt lgkmcnt(0)
    v_mfma_f32_32x32x16_bf16 v[48:63], v[32:35], v[144:147], v[48:63]
    v_mfma_f32_32x32x16_bf16 v[48:63], v[36:39], v[148:151], v[48:63]
    s_nop 7
    s_mov_b64 exec, s[96:97]
    ds_read_b128 v[32:35], v7 offset:14336
    ds_read_b128 v[36:39], v7 offset:15360
    s_mov_b64 exec, -1
    s_waitcnt lgkmcnt(0)
    v_mfma_f32_32x32x16_bf16 v[48:63], v[32:35], v[160:163], v[48:63]
    v_mfma_f32_32x32x16_bf16 v[48:63], v[36:39], v[164:167], v[48:63]
    s_nop 7
    s_mov_b64 exec, s[96:97]
    ds_read_b128 v[32:35], v7 offset:18432
    ds_read_b128 v[36:39], v7 offset:19456
    s_mov_b64 exec, -1
    s_waitcnt lgkmcnt(0)
    v_mfma_f32_32x32x16_bf16 v[48:63], v[32:35], v[176:179], v[48:63]
    v_mfma_f32_32x32x16_bf16 v[48:63], v[36:39], v[180:183], v[48:63]
    s_nop 7
    s_mov_b64 exec, s[96:97]
    ds_read_b128 v[32:35], v7 offset:22528
    ds_read_b128 v[36:39], v7 offset:23552
    s_mov_b64 exec, -1
    s_waitcnt lgkmcnt(0)
    v_mfma_f32_32x32x16_bf16 v[48:63], v[32:35], v[192:195], v[48:63]
    v_mfma_f32_32x32x16_bf16 v[48:63], v[36:39], v[196:199], v[48:63]
    s_nop 7
    s_mov_b64 exec, s[96:97]
    ds_read_b128 v[32:35], v7 offset:26624
    ds_read_b128 v[36:39], v7 offset:27648
    s_mov_b64 exec, -1
    s_waitcnt lgkmcnt(0)
    v_mfma_f32_32x32x16_bf16 v[48:63], v[32:35], v[208:211], v[48:63]
    v_mfma_f32_32x32x16_bf16 v[48:63], v[36:39], v[212:215], v[48:63]
    s_nop 7
    s_mov_b64 exec, s[96:97]
    ds_read_b128 v[32:35], v7 offset:30720
    ds_read_b128 v[36:39], v7 offset:31744
    s_mov_b64 exec, -1
    s_waitcnt lgkmcnt(0)
    v_mfma_f32_32x32x16_bf16 v[48:63], v[32:35], v[224:227], v[48:63]
    v_mfma_f32_32x32x16_bf16 v[48:63], v[36:39], v[228:231], v[48:63]
    s_nop 11
    v_rcp_f32 v57, v56
    s_nop 0
    v_mul_f32 v48, v48, v57
    v_mul_f32 v49, v49, v57
    v_mul_f32 v50, v50, v57
    v_mul_f32 v51, v51, v57
    v_mul_f32 v52, v52, v57
    v_mul_f32 v53, v53, v57
    v_mul_f32 v54, v54, v57
    v_mul_f32 v55, v55, v57
    v_add_u32 v48, 0x8000, v48
    v_cvt_pk_bf16_f32 v60, v48, v49
    v_cvt_pk_bf16_f32 v61, v50, v51
    v_cvt_pk_bf16_f32 v62, v52, v53
    v_cvt_pk_bf16_f32 v63, v54, v55
    v_and_b32 v60, -2, v60
    s_mov_b32 s7, s54
    buffer_store_dwordx4 v[60:63], v1, s[48:51], s7 offen offset:0 sc0 sc1
    ds_read_b128 v[64:67], v7 offset:1024
    ds_read_b128 v[68:71], v7 offset:5120
    ds_read_b128 v[72:75], v7 offset:9216
    ds_read_b128 v[76:79], v7 offset:13312
    ds_read_b128 v[80:83], v7 offset:17408
    ds_read_b128 v[84:87], v7 offset:21504
    ds_read_b128 v[88:91], v7 offset:25600
    ds_read_b128 v[92:95], v7 offset:29696
    ds_read_b128 v[96:99], v7 offset:33792
    s_mov_b64 exec, s[96:97]
    ds_read_b128 v[32:35], v7 offset:35072
    ds_read_b128 v[36:39], v7 offset:36096
    s_mov_b64 exec, -1
    s_mov_b64 exec, s[96:97]
    ds_read_b128 v[40:43], v7 offset:2304
    ds_read_b128 v[44:47], v7 offset:3328
    s_mov_b64 exec, -1
    s_waitcnt lgkmcnt(0)
    v_mfma_f32_32x32x16_bf16 v[112:127], v[64:67], v[20:23], 0
    v_mfma_f32_32x32x16_bf16 v[128:143], v[68:71], v[20:23], 0
    v_mfma_f32_32x32x16_bf16 v[144:159], v[72:75], v[20:23], 0
    v_mfma_f32_32x32x16_bf16 v[160:175], v[76:79], v[20:23], 0
    v_mfma_f32_32x32x16_bf16 v[176:191], v[80:83], v[20:23], 0
    v_mfma_f32_32x32x16_bf16 v[192:207], v[84:87], v[20:23], 0
    v_mfma_f32_32x32x16_bf16 v[208:223], v[88:91], v[20:23], 0
    v_mfma_f32_32x32x16_bf16 v[224:239], v[92:95], v[20:23], 0
    v_mfma_f32_32x32x16_bf16 v[240:255], v[96:99], v[20:23], 0
    s_cmp_ge_u32 s59, 8
    s_nop 10
    s_cbranch_scc1 valid_63
    v_mov_b32 v112, 0xff800000
    v_mov_b32 v113, 0xff800000
    v_mov_b32 v114, 0xff800000
    v_mov_b32 v115, 0xff800000
    v_mov_b32 v116, 0xff800000
    v_mov_b32 v117, 0xff800000
    v_mov_b32 v118, 0xff800000
    v_mov_b32 v119, 0xff800000
    v_mov_b32 v120, 0xff800000
    v_mov_b32 v121, 0xff800000
    v_mov_b32 v122, 0xff800000
    v_mov_b32 v123, 0xff800000
    v_mov_b32 v124, 0xff800000
    v_mov_b32 v125, 0xff800000
    v_mov_b32 v126, 0xff800000
    v_mov_b32 v127, 0xff800000
    s_cmp_ge_u32 s59, 7
    s_nop 0
    s_cbranch_scc1 valid_63
    v_mov_b32 v128, 0xff800000
    v_mov_b32 v129, 0xff800000
    v_mov_b32 v130, 0xff800000
    v_mov_b32 v131, 0xff800000
    v_mov_b32 v132, 0xff800000
    v_mov_b32 v133, 0xff800000
    v_mov_b32 v134, 0xff800000
    v_mov_b32 v135, 0xff800000
    v_mov_b32 v136, 0xff800000
    v_mov_b32 v137, 0xff800000
    v_mov_b32 v138, 0xff800000
    v_mov_b32 v139, 0xff800000
    v_mov_b32 v140, 0xff800000
    v_mov_b32 v141, 0xff800000
    v_mov_b32 v142, 0xff800000
    v_mov_b32 v143, 0xff800000
    s_cmp_ge_u32 s59, 6
    s_nop 0
    s_cbranch_scc1 valid_63
    v_mov_b32 v144, 0xff800000
    v_mov_b32 v145, 0xff800000
    v_mov_b32 v146, 0xff800000
    v_mov_b32 v147, 0xff800000
    v_mov_b32 v148, 0xff800000
    v_mov_b32 v149, 0xff800000
    v_mov_b32 v150, 0xff800000
    v_mov_b32 v151, 0xff800000
    v_mov_b32 v152, 0xff800000
    v_mov_b32 v153, 0xff800000
    v_mov_b32 v154, 0xff800000
    v_mov_b32 v155, 0xff800000
    v_mov_b32 v156, 0xff800000
    v_mov_b32 v157, 0xff800000
    v_mov_b32 v158, 0xff800000
    v_mov_b32 v159, 0xff800000
    s_cmp_ge_u32 s59, 5
    s_nop 0
    s_cbranch_scc1 valid_63
    v_mov_b32 v160, 0xff800000
    v_mov_b32 v161, 0xff800000
    v_mov_b32 v162, 0xff800000
    v_mov_b32 v163, 0xff800000
    v_mov_b32 v164, 0xff800000
    v_mov_b32 v165, 0xff800000
    v_mov_b32 v166, 0xff800000
    v_mov_b32 v167, 0xff800000
    v_mov_b32 v168, 0xff800000
    v_mov_b32 v169, 0xff800000
    v_mov_b32 v170, 0xff800000
    v_mov_b32 v171, 0xff800000
    v_mov_b32 v172, 0xff800000
    v_mov_b32 v173, 0xff800000
    v_mov_b32 v174, 0xff800000
    v_mov_b32 v175, 0xff800000
    s_cmp_ge_u32 s59, 4
    s_nop 0
    s_cbranch_scc1 valid_63
    v_mov_b32 v176, 0xff800000
    v_mov_b32 v177, 0xff800000
    v_mov_b32 v178, 0xff800000
    v_mov_b32 v179, 0xff800000
    v_mov_b32 v180, 0xff800000
    v_mov_b32 v181, 0xff800000
    v_mov_b32 v182, 0xff800000
    v_mov_b32 v183, 0xff800000
    v_mov_b32 v184, 0xff800000
    v_mov_b32 v185, 0xff800000
    v_mov_b32 v186, 0xff800000
    v_mov_b32 v187, 0xff800000
    v_mov_b32 v188, 0xff800000
    v_mov_b32 v189, 0xff800000
    v_mov_b32 v190, 0xff800000
    v_mov_b32 v191, 0xff800000
    s_cmp_ge_u32 s59, 3
    s_nop 0
    s_cbranch_scc1 valid_63
    v_mov_b32 v192, 0xff800000
    v_mov_b32 v193, 0xff800000
    v_mov_b32 v194, 0xff800000
    v_mov_b32 v195, 0xff800000
    v_mov_b32 v196, 0xff800000
    v_mov_b32 v197, 0xff800000
    v_mov_b32 v198, 0xff800000
    v_mov_b32 v199, 0xff800000
    v_mov_b32 v200, 0xff800000
    v_mov_b32 v201, 0xff800000
    v_mov_b32 v202, 0xff800000
    v_mov_b32 v203, 0xff800000
    v_mov_b32 v204, 0xff800000
    v_mov_b32 v205, 0xff800000
    v_mov_b32 v206, 0xff800000
    v_mov_b32 v207, 0xff800000
    s_cmp_ge_u32 s59, 2
    s_nop 0
    s_cbranch_scc1 valid_63
    v_mov_b32 v208, 0xff800000
    v_mov_b32 v209, 0xff800000
    v_mov_b32 v210, 0xff800000
    v_mov_b32 v211, 0xff800000
    v_mov_b32 v212, 0xff800000
    v_mov_b32 v213, 0xff800000
    v_mov_b32 v214, 0xff800000
    v_mov_b32 v215, 0xff800000
    v_mov_b32 v216, 0xff800000
    v_mov_b32 v217, 0xff800000
    v_mov_b32 v218, 0xff800000
    v_mov_b32 v219, 0xff800000
    v_mov_b32 v220, 0xff800000
    v_mov_b32 v221, 0xff800000
    v_mov_b32 v222, 0xff800000
    v_mov_b32 v223, 0xff800000
    s_cmp_ge_u32 s59, 1
    s_nop 0
    s_cbranch_scc1 valid_63
    v_mov_b32 v224, 0xff800000
    v_mov_b32 v225, 0xff800000
    v_mov_b32 v226, 0xff800000
    v_mov_b32 v227, 0xff800000
    v_mov_b32 v228, 0xff800000
    v_mov_b32 v229, 0xff800000
    v_mov_b32 v230, 0xff800000
    v_mov_b32 v231, 0xff800000
    v_mov_b32 v232, 0xff800000
    v_mov_b32 v233, 0xff800000
    v_mov_b32 v234, 0xff800000
    v_mov_b32 v235, 0xff800000
    v_mov_b32 v236, 0xff800000
    v_mov_b32 v237, 0xff800000
    v_mov_b32 v238, 0xff800000
    v_mov_b32 v239, 0xff800000
    s_nop 1
valid_63:
    v_cndmask_b32 v240, v112, v240, s[64:65]
    v_cndmask_b32 v241, v113, v241, s[66:67]
    v_cndmask_b32 v242, v114, v242, s[68:69]
    v_cndmask_b32 v243, v115, v243, s[70:71]
    v_cndmask_b32 v244, v116, v244, s[72:73]
    v_cndmask_b32 v245, v117, v245, s[74:75]
    v_cndmask_b32 v246, v118, v246, s[76:77]
    v_cndmask_b32 v247, v119, v247, s[78:79]
    v_cndmask_b32 v248, v120, v248, s[80:81]
    v_cndmask_b32 v249, v121, v249, s[82:83]
    v_cndmask_b32 v250, v122, v250, s[84:85]
    v_cndmask_b32 v251, v123, v251, s[86:87]
    v_cndmask_b32 v252, v124, v252, s[88:89]
    v_cndmask_b32 v253, v125, v253, s[90:91]
    v_cndmask_b32 v254, v126, v254, s[92:93]
    v_cndmask_b32 v255, v127, v255, s[94:95]
    v_max_f32 v108, v240, v241
    v_max_f32 v109, v242, v243
    v_max3_f32 v108, v108, v244, v245
    v_max3_f32 v109, v109, v246, v247
    v_max3_f32 v108, v108, v248, v249
    v_max3_f32 v109, v109, v250, v251
    v_max3_f32 v108, v108, v252, v253
    v_max3_f32 v109, v109, v254, v255
    v_max3_f32 v108, v108, v128, v129
    v_max3_f32 v109, v109, v130, v131
    v_max3_f32 v108, v108, v132, v133
    v_max3_f32 v109, v109, v134, v135
    v_max3_f32 v108, v108, v136, v137
    v_max3_f32 v109, v109, v138, v139
    v_max3_f32 v108, v108, v140, v141
    v_max3_f32 v109, v109, v142, v143
    v_max3_f32 v108, v108, v144, v145
    v_max3_f32 v109, v109, v146, v147
    v_max3_f32 v108, v108, v148, v149
    v_max3_f32 v109, v109, v150, v151
    v_max3_f32 v108, v108, v152, v153
    v_max3_f32 v109, v109, v154, v155
    v_max3_f32 v108, v108, v156, v157
    v_max3_f32 v109, v109, v158, v159
    v_max3_f32 v108, v108, v160, v161
    v_max3_f32 v109, v109, v162, v163
    v_max3_f32 v108, v108, v164, v165
    v_max3_f32 v109, v109, v166, v167
    v_max3_f32 v108, v108, v168, v169
    v_max3_f32 v109, v109, v170, v171
    v_max3_f32 v108, v108, v172, v173
    v_max3_f32 v109, v109, v174, v175
    v_max3_f32 v108, v108, v176, v177
    v_max3_f32 v109, v109, v178, v179
    v_max3_f32 v108, v108, v180, v181
    v_max3_f32 v109, v109, v182, v183
    v_max3_f32 v108, v108, v184, v185
    v_max3_f32 v109, v109, v186, v187
    v_max3_f32 v108, v108, v188, v189
    v_max3_f32 v109, v109, v190, v191
    v_max3_f32 v108, v108, v192, v193
    v_max3_f32 v109, v109, v194, v195
    v_max3_f32 v108, v108, v196, v197
    v_max3_f32 v109, v109, v198, v199
    v_max3_f32 v108, v108, v200, v201
    v_max3_f32 v109, v109, v202, v203
    v_max3_f32 v108, v108, v204, v205
    v_max3_f32 v109, v109, v206, v207
    v_max3_f32 v108, v108, v208, v209
    v_max3_f32 v109, v109, v210, v211
    v_max3_f32 v108, v108, v212, v213
    v_max3_f32 v109, v109, v214, v215
    v_max3_f32 v108, v108, v216, v217
    v_max3_f32 v109, v109, v218, v219
    v_max3_f32 v108, v108, v220, v221
    v_max3_f32 v109, v109, v222, v223
    v_max3_f32 v108, v108, v224, v225
    v_max3_f32 v109, v109, v226, v227
    v_max3_f32 v108, v108, v228, v229
    v_max3_f32 v109, v109, v230, v231
    v_max3_f32 v108, v108, v232, v233
    v_max3_f32 v109, v109, v234, v235
    v_max3_f32 v108, v108, v236, v237
    v_max3_f32 v109, v109, v238, v239
    v_max_f32 v108, v108, v109
    v_mov_b32 v109, v108
    s_nop 1
    v_permlane32_swap_b32 v109, v108
    v_max_f32 v108, v108, v109
    v_sub_f32 v108, 0, v108
    v_pk_add_f32 v[128:129], v[128:129], v[108:109] op_sel_hi:[1,0]
    v_pk_add_f32 v[130:131], v[130:131], v[108:109] op_sel_hi:[1,0]
    v_pk_add_f32 v[132:133], v[132:133], v[108:109] op_sel_hi:[1,0]
    v_pk_add_f32 v[134:135], v[134:135], v[108:109] op_sel_hi:[1,0]
    v_pk_add_f32 v[136:137], v[136:137], v[108:109] op_sel_hi:[1,0]
    v_pk_add_f32 v[138:139], v[138:139], v[108:109] op_sel_hi:[1,0]
    v_pk_add_f32 v[140:141], v[140:141], v[108:109] op_sel_hi:[1,0]
    v_pk_add_f32 v[142:143], v[142:143], v[108:109] op_sel_hi:[1,0]
    v_exp_f32 v128, v128
    v_exp_f32 v129, v129
    v_exp_f32 v130, v130
    v_exp_f32 v131, v131
    v_exp_f32 v132, v132
    v_exp_f32 v133, v133
    v_exp_f32 v134, v134
    v_exp_f32 v135, v135
    v_exp_f32 v136, v136
    v_exp_f32 v137, v137
    v_exp_f32 v138, v138
    v_exp_f32 v139, v139
    v_exp_f32 v140, v140
    v_exp_f32 v141, v141
    v_exp_f32 v142, v142
    v_exp_f32 v143, v143
    v_cvt_pk_bf16_f32 v128, v128, v129
    v_cvt_pk_bf16_f32 v129, v130, v131
    v_cvt_pk_bf16_f32 v130, v132, v133
    v_cvt_pk_bf16_f32 v131, v134, v135
    v_cvt_pk_bf16_f32 v132, v136, v137
    v_cvt_pk_bf16_f32 v133, v138, v139
    v_cvt_pk_bf16_f32 v134, v140, v141
    v_cvt_pk_bf16_f32 v135, v142, v143
    v_pk_add_f32 v[144:145], v[144:145], v[108:109] op_sel_hi:[1,0]
    v_pk_add_f32 v[146:147], v[146:147], v[108:109] op_sel_hi:[1,0]
    v_pk_add_f32 v[148:149], v[148:149], v[108:109] op_sel_hi:[1,0]
    v_pk_add_f32 v[150:151], v[150:151], v[108:109] op_sel_hi:[1,0]
    v_pk_add_f32 v[152:153], v[152:153], v[108:109] op_sel_hi:[1,0]
    v_pk_add_f32 v[154:155], v[154:155], v[108:109] op_sel_hi:[1,0]
    v_pk_add_f32 v[156:157], v[156:157], v[108:109] op_sel_hi:[1,0]
    v_pk_add_f32 v[158:159], v[158:159], v[108:109] op_sel_hi:[1,0]
    v_exp_f32 v144, v144
    v_exp_f32 v145, v145
    v_exp_f32 v146, v146
    v_exp_f32 v147, v147
    v_exp_f32 v148, v148
    v_exp_f32 v149, v149
    v_exp_f32 v150, v150
    v_exp_f32 v151, v151
    v_exp_f32 v152, v152
    v_exp_f32 v153, v153
    v_exp_f32 v154, v154
    v_exp_f32 v155, v155
    v_exp_f32 v156, v156
    v_exp_f32 v157, v157
    v_exp_f32 v158, v158
    v_exp_f32 v159, v159
    v_cvt_pk_bf16_f32 v144, v144, v145
    v_cvt_pk_bf16_f32 v145, v146, v147
    v_cvt_pk_bf16_f32 v146, v148, v149
    v_cvt_pk_bf16_f32 v147, v150, v151
    v_cvt_pk_bf16_f32 v148, v152, v153
    v_cvt_pk_bf16_f32 v149, v154, v155
    v_cvt_pk_bf16_f32 v150, v156, v157
    v_cvt_pk_bf16_f32 v151, v158, v159
    v_pk_add_f32 v[160:161], v[160:161], v[108:109] op_sel_hi:[1,0]
    v_pk_add_f32 v[162:163], v[162:163], v[108:109] op_sel_hi:[1,0]
    v_pk_add_f32 v[164:165], v[164:165], v[108:109] op_sel_hi:[1,0]
    v_pk_add_f32 v[166:167], v[166:167], v[108:109] op_sel_hi:[1,0]
    v_pk_add_f32 v[168:169], v[168:169], v[108:109] op_sel_hi:[1,0]
    v_pk_add_f32 v[170:171], v[170:171], v[108:109] op_sel_hi:[1,0]
    v_pk_add_f32 v[172:173], v[172:173], v[108:109] op_sel_hi:[1,0]
    v_pk_add_f32 v[174:175], v[174:175], v[108:109] op_sel_hi:[1,0]
    v_exp_f32 v160, v160
    v_exp_f32 v161, v161
    v_exp_f32 v162, v162
    v_exp_f32 v163, v163
    v_exp_f32 v164, v164
    v_exp_f32 v165, v165
    v_exp_f32 v166, v166
    v_exp_f32 v167, v167
    v_exp_f32 v168, v168
    v_exp_f32 v169, v169
    v_exp_f32 v170, v170
    v_exp_f32 v171, v171
    v_exp_f32 v172, v172
    v_exp_f32 v173, v173
    v_exp_f32 v174, v174
    v_exp_f32 v175, v175
    v_cvt_pk_bf16_f32 v160, v160, v161
    v_cvt_pk_bf16_f32 v161, v162, v163
    v_cvt_pk_bf16_f32 v162, v164, v165
    v_cvt_pk_bf16_f32 v163, v166, v167
    v_cvt_pk_bf16_f32 v164, v168, v169
    v_cvt_pk_bf16_f32 v165, v170, v171
    v_cvt_pk_bf16_f32 v166, v172, v173
    v_cvt_pk_bf16_f32 v167, v174, v175
    v_pk_add_f32 v[176:177], v[176:177], v[108:109] op_sel_hi:[1,0]
    v_pk_add_f32 v[178:179], v[178:179], v[108:109] op_sel_hi:[1,0]
    v_pk_add_f32 v[180:181], v[180:181], v[108:109] op_sel_hi:[1,0]
    v_pk_add_f32 v[182:183], v[182:183], v[108:109] op_sel_hi:[1,0]
    v_pk_add_f32 v[184:185], v[184:185], v[108:109] op_sel_hi:[1,0]
    v_pk_add_f32 v[186:187], v[186:187], v[108:109] op_sel_hi:[1,0]
    v_pk_add_f32 v[188:189], v[188:189], v[108:109] op_sel_hi:[1,0]
    v_pk_add_f32 v[190:191], v[190:191], v[108:109] op_sel_hi:[1,0]
    v_exp_f32 v176, v176
    v_exp_f32 v177, v177
    v_exp_f32 v178, v178
    v_exp_f32 v179, v179
    v_exp_f32 v180, v180
    v_exp_f32 v181, v181
    v_exp_f32 v182, v182
    v_exp_f32 v183, v183
    v_exp_f32 v184, v184
    v_exp_f32 v185, v185
    v_exp_f32 v186, v186
    v_exp_f32 v187, v187
    v_exp_f32 v188, v188
    v_exp_f32 v189, v189
    v_exp_f32 v190, v190
    v_exp_f32 v191, v191
    v_cvt_pk_bf16_f32 v176, v176, v177
    v_cvt_pk_bf16_f32 v177, v178, v179
    v_cvt_pk_bf16_f32 v178, v180, v181
    v_cvt_pk_bf16_f32 v179, v182, v183
    v_cvt_pk_bf16_f32 v180, v184, v185
    v_cvt_pk_bf16_f32 v181, v186, v187
    v_cvt_pk_bf16_f32 v182, v188, v189
    v_cvt_pk_bf16_f32 v183, v190, v191
    v_pk_add_f32 v[192:193], v[192:193], v[108:109] op_sel_hi:[1,0]
    v_pk_add_f32 v[194:195], v[194:195], v[108:109] op_sel_hi:[1,0]
    v_pk_add_f32 v[196:197], v[196:197], v[108:109] op_sel_hi:[1,0]
    v_pk_add_f32 v[198:199], v[198:199], v[108:109] op_sel_hi:[1,0]
    v_pk_add_f32 v[200:201], v[200:201], v[108:109] op_sel_hi:[1,0]
    v_pk_add_f32 v[202:203], v[202:203], v[108:109] op_sel_hi:[1,0]
    v_pk_add_f32 v[204:205], v[204:205], v[108:109] op_sel_hi:[1,0]
    v_pk_add_f32 v[206:207], v[206:207], v[108:109] op_sel_hi:[1,0]
    v_exp_f32 v192, v192
    v_exp_f32 v193, v193
    v_exp_f32 v194, v194
    v_exp_f32 v195, v195
    v_exp_f32 v196, v196
    v_exp_f32 v197, v197
    v_exp_f32 v198, v198
    v_exp_f32 v199, v199
    v_exp_f32 v200, v200
    v_exp_f32 v201, v201
    v_exp_f32 v202, v202
    v_exp_f32 v203, v203
    v_exp_f32 v204, v204
    v_exp_f32 v205, v205
    v_exp_f32 v206, v206
    v_exp_f32 v207, v207
    v_cvt_pk_bf16_f32 v192, v192, v193
    v_cvt_pk_bf16_f32 v193, v194, v195
    v_cvt_pk_bf16_f32 v194, v196, v197
    v_cvt_pk_bf16_f32 v195, v198, v199
    v_cvt_pk_bf16_f32 v196, v200, v201
    v_cvt_pk_bf16_f32 v197, v202, v203
    v_cvt_pk_bf16_f32 v198, v204, v205
    v_cvt_pk_bf16_f32 v199, v206, v207
    v_pk_add_f32 v[208:209], v[208:209], v[108:109] op_sel_hi:[1,0]
    v_pk_add_f32 v[210:211], v[210:211], v[108:109] op_sel_hi:[1,0]
    v_pk_add_f32 v[212:213], v[212:213], v[108:109] op_sel_hi:[1,0]
    v_pk_add_f32 v[214:215], v[214:215], v[108:109] op_sel_hi:[1,0]
    v_pk_add_f32 v[216:217], v[216:217], v[108:109] op_sel_hi:[1,0]
    v_pk_add_f32 v[218:219], v[218:219], v[108:109] op_sel_hi:[1,0]
    v_pk_add_f32 v[220:221], v[220:221], v[108:109] op_sel_hi:[1,0]
    v_pk_add_f32 v[222:223], v[222:223], v[108:109] op_sel_hi:[1,0]
    v_exp_f32 v208, v208
    v_exp_f32 v209, v209
    v_exp_f32 v210, v210
    v_exp_f32 v211, v211
    v_exp_f32 v212, v212
    v_exp_f32 v213, v213
    v_exp_f32 v214, v214
    v_exp_f32 v215, v215
    v_exp_f32 v216, v216
    v_exp_f32 v217, v217
    v_exp_f32 v218, v218
    v_exp_f32 v219, v219
    v_exp_f32 v220, v220
    v_exp_f32 v221, v221
    v_exp_f32 v222, v222
    v_exp_f32 v223, v223
    v_cvt_pk_bf16_f32 v208, v208, v209
    v_cvt_pk_bf16_f32 v209, v210, v211
    v_cvt_pk_bf16_f32 v210, v212, v213
    v_cvt_pk_bf16_f32 v211, v214, v215
    v_cvt_pk_bf16_f32 v212, v216, v217
    v_cvt_pk_bf16_f32 v213, v218, v219
    v_cvt_pk_bf16_f32 v214, v220, v221
    v_cvt_pk_bf16_f32 v215, v222, v223
    v_pk_add_f32 v[224:225], v[224:225], v[108:109] op_sel_hi:[1,0]
    v_pk_add_f32 v[226:227], v[226:227], v[108:109] op_sel_hi:[1,0]
    v_pk_add_f32 v[228:229], v[228:229], v[108:109] op_sel_hi:[1,0]
    v_pk_add_f32 v[230:231], v[230:231], v[108:109] op_sel_hi:[1,0]
    v_pk_add_f32 v[232:233], v[232:233], v[108:109] op_sel_hi:[1,0]
    v_pk_add_f32 v[234:235], v[234:235], v[108:109] op_sel_hi:[1,0]
    v_pk_add_f32 v[236:237], v[236:237], v[108:109] op_sel_hi:[1,0]
    v_pk_add_f32 v[238:239], v[238:239], v[108:109] op_sel_hi:[1,0]
    v_exp_f32 v224, v224
    v_exp_f32 v225, v225
    v_exp_f32 v226, v226
    v_exp_f32 v227, v227
    v_exp_f32 v228, v228
    v_exp_f32 v229, v229
    v_exp_f32 v230, v230
    v_exp_f32 v231, v231
    v_exp_f32 v232, v232
    v_exp_f32 v233, v233
    v_exp_f32 v234, v234
    v_exp_f32 v235, v235
    v_exp_f32 v236, v236
    v_exp_f32 v237, v237
    v_exp_f32 v238, v238
    v_exp_f32 v239, v239
    v_cvt_pk_bf16_f32 v224, v224, v225
    v_cvt_pk_bf16_f32 v225, v226, v227
    v_cvt_pk_bf16_f32 v226, v228, v229
    v_cvt_pk_bf16_f32 v227, v230, v231
    v_cvt_pk_bf16_f32 v228, v232, v233
    v_cvt_pk_bf16_f32 v229, v234, v235
    v_cvt_pk_bf16_f32 v230, v236, v237
    v_cvt_pk_bf16_f32 v231, v238, v239
    v_pk_add_f32 v[240:241], v[240:241], v[108:109] op_sel_hi:[1,0]
    v_pk_add_f32 v[242:243], v[242:243], v[108:109] op_sel_hi:[1,0]
    v_pk_add_f32 v[244:245], v[244:245], v[108:109] op_sel_hi:[1,0]
    v_pk_add_f32 v[246:247], v[246:247], v[108:109] op_sel_hi:[1,0]
    v_pk_add_f32 v[248:249], v[248:249], v[108:109] op_sel_hi:[1,0]
    v_pk_add_f32 v[250:251], v[250:251], v[108:109] op_sel_hi:[1,0]
    v_pk_add_f32 v[252:253], v[252:253], v[108:109] op_sel_hi:[1,0]
    v_pk_add_f32 v[254:255], v[254:255], v[108:109] op_sel_hi:[1,0]
    v_exp_f32 v240, v240
    v_exp_f32 v241, v241
    v_exp_f32 v242, v242
    v_exp_f32 v243, v243
    v_exp_f32 v244, v244
    v_exp_f32 v245, v245
    v_exp_f32 v246, v246
    v_exp_f32 v247, v247
    v_exp_f32 v248, v248
    v_exp_f32 v249, v249
    v_exp_f32 v250, v250
    v_exp_f32 v251, v251
    v_exp_f32 v252, v252
    v_exp_f32 v253, v253
    v_exp_f32 v254, v254
    v_exp_f32 v255, v255
    v_cvt_pk_bf16_f32 v240, v240, v241
    v_cvt_pk_bf16_f32 v241, v242, v243
    v_cvt_pk_bf16_f32 v242, v244, v245
    v_cvt_pk_bf16_f32 v243, v246, v247
    v_cvt_pk_bf16_f32 v244, v248, v249
    v_cvt_pk_bf16_f32 v245, v250, v251
    v_cvt_pk_bf16_f32 v246, v252, v253
    v_cvt_pk_bf16_f32 v247, v254, v255
    v_bfi_b32 v100, v24, 0, v240
    v_and_b32 v240, v24, v240
    v_bfi_b32 v101, v25, 0, v241
    v_and_b32 v241, v25, v241
    v_bfi_b32 v102, v26, 0, v242
    v_and_b32 v242, v26, v242
    v_bfi_b32 v103, v27, 0, v243
    v_and_b32 v243, v27, v243
    v_bfi_b32 v104, v28, 0, v244
    v_and_b32 v244, v28, v244
    v_bfi_b32 v105, v29, 0, v245
    v_and_b32 v245, v29, v245
    v_bfi_b32 v106, v30, 0, v246
    v_and_b32 v246, v30, v246
    v_bfi_b32 v107, v31, 0, v247
    v_and_b32 v247, v31, v247
    v_mfma_f32_32x32x16_bf16 v[48:63], v[32:35], v[240:243], 0
    s_nop 0
    v_mfma_f32_32x32x16_bf16 v[48:63], v[36:39], v[244:247], v[48:63]
    v_mfma_f32_32x32x16_bf16 v[48:63], v[40:43], v[100:103], v[48:63]
    v_mfma_f32_32x32x16_bf16 v[48:63], v[44:47], v[104:107], v[48:63]
    s_nop 7
    s_mov_b64 exec, s[96:97]
    ds_read_b128 v[32:35], v7 offset:6400
    ds_read_b128 v[36:39], v7 offset:7424
    s_mov_b64 exec, -1
    s_waitcnt lgkmcnt(0)
    v_mfma_f32_32x32x16_bf16 v[48:63], v[32:35], v[128:131], v[48:63]
    v_mfma_f32_32x32x16_bf16 v[48:63], v[36:39], v[132:135], v[48:63]
    s_nop 7
    s_mov_b64 exec, s[96:97]
    ds_read_b128 v[32:35], v7 offset:10496
    ds_read_b128 v[36:39], v7 offset:11520
    s_mov_b64 exec, -1
    s_waitcnt lgkmcnt(0)
    v_mfma_f32_32x32x16_bf16 v[48:63], v[32:35], v[144:147], v[48:63]
    v_mfma_f32_32x32x16_bf16 v[48:63], v[36:39], v[148:151], v[48:63]
    s_nop 7
    s_mov_b64 exec, s[96:97]
    ds_read_b128 v[32:35], v7 offset:14592
    ds_read_b128 v[36:39], v7 offset:15616
    s_mov_b64 exec, -1
    s_waitcnt lgkmcnt(0)
    v_mfma_f32_32x32x16_bf16 v[48:63], v[32:35], v[160:163], v[48:63]
    v_mfma_f32_32x32x16_bf16 v[48:63], v[36:39], v[164:167], v[48:63]
    s_nop 7
    s_mov_b64 exec, s[96:97]
    ds_read_b128 v[32:35], v7 offset:18688
    ds_read_b128 v[36:39], v7 offset:19712
    s_mov_b64 exec, -1
    s_waitcnt lgkmcnt(0)
    v_mfma_f32_32x32x16_bf16 v[48:63], v[32:35], v[176:179], v[48:63]
    v_mfma_f32_32x32x16_bf16 v[48:63], v[36:39], v[180:183], v[48:63]
    s_nop 7
    s_mov_b64 exec, s[96:97]
    ds_read_b128 v[32:35], v7 offset:22784
    ds_read_b128 v[36:39], v7 offset:23808
    s_mov_b64 exec, -1
    s_waitcnt lgkmcnt(0)
    v_mfma_f32_32x32x16_bf16 v[48:63], v[32:35], v[192:195], v[48:63]
    v_mfma_f32_32x32x16_bf16 v[48:63], v[36:39], v[196:199], v[48:63]
    s_nop 7
    s_mov_b64 exec, s[96:97]
    ds_read_b128 v[32:35], v7 offset:26880
    ds_read_b128 v[36:39], v7 offset:27904
    s_mov_b64 exec, -1
    s_waitcnt lgkmcnt(0)
    v_mfma_f32_32x32x16_bf16 v[48:63], v[32:35], v[208:211], v[48:63]
    v_mfma_f32_32x32x16_bf16 v[48:63], v[36:39], v[212:215], v[48:63]
    s_nop 7
    s_mov_b64 exec, s[96:97]
    ds_read_b128 v[32:35], v7 offset:30976
    ds_read_b128 v[36:39], v7 offset:32000
    s_mov_b64 exec, -1
    s_waitcnt lgkmcnt(0)
    v_mfma_f32_32x32x16_bf16 v[48:63], v[32:35], v[224:227], v[48:63]
    v_mfma_f32_32x32x16_bf16 v[48:63], v[36:39], v[228:231], v[48:63]
    s_nop 11
    v_rcp_f32 v57, v56
    s_nop 0
    v_mul_f32 v48, v48, v57
    v_mul_f32 v49, v49, v57
    v_mul_f32 v50, v50, v57
    v_mul_f32 v51, v51, v57
    v_mul_f32 v52, v52, v57
    v_mul_f32 v53, v53, v57
    v_mul_f32 v54, v54, v57
    v_mul_f32 v55, v55, v57
    v_add_u32 v48, 0x8000, v48
    v_cvt_pk_bf16_f32 v60, v48, v49
    v_cvt_pk_bf16_f32 v61, v50, v51
    v_cvt_pk_bf16_f32 v62, v52, v53
    v_cvt_pk_bf16_f32 v63, v54, v55
    v_and_b32 v60, -2, v60
    s_mov_b32 s7, s62
    buffer_store_dwordx4 v[60:63], v1, s[48:51], s7 offen offset:1024 sc0 sc1
    s_waitcnt vmcnt(0)
    s_nop 0
    s_branch adone_21
fast_64:
    v_mov_b32 v93, s5
    s_mov_b64 exec, 1
    buffer_store_dword v93, off, s[48:51], s4 sc0 sc1
    s_mov_b64 exec, -1
    s_branch dend_65
fast_68:
    buffer_store_dwordx4 v[16:19], v1, s[48:51], s61 offen sc0 sc1
    buffer_store_dwordx4 v[20:23], v1, s[48:51], s61 offen offset:1024 sc0 sc1
    v_mov_b32 v94, 0
    v_mov_b32 v95, 0
    v_dot2c_f32_bf16 v94, s22, v16
    v_dot2c_f32_bf16 v95, v16, v16
    v_dot2c_f32_bf16 v94, s22, v17
    v_dot2c_f32_bf16 v95, v17, v17
    v_dot2c_f32_bf16 v94, s22, v18
    v_dot2c_f32_bf16 v95, v18, v18
    v_dot2c_f32_bf16 v94, s22, v19
    v_dot2c_f32_bf16 v95, v19, v19
    v_dot2c_f32_bf16 v94, s22, v20
    v_dot2c_f32_bf16 v95, v20, v20
    v_dot2c_f32_bf16 v94, s22, v21
    v_dot2c_f32_bf16 v95, v21, v21
    v_dot2c_f32_bf16 v94, s22, v22
    v_dot2c_f32_bf16 v95, v22, v22
    v_dot2c_f32_bf16 v94, s22, v23
    v_dot2c_f32_bf16 v95, v23, v23
    s_nop 1
    v_mov_b32 v92, v94
    v_mov_b32 v93, v95
    s_nop 0
    v_permlane32_swap_b32 v92, v94
    v_permlane32_swap_b32 v93, v95
    v_pk_add_f32 v[94:95], v[94:95], v[92:93]
    v_or_b32 v94, 1, v94
    buffer_store_dwordx2 v[94:95], v6, s[48:51], s101 offen sc0 sc1
    s_nop 0
    s_branch dend_69
gst_70:
    s_mov_b32 s99, 200000
glp_72:
    s_add_u32 s3, s60, 0
    buffer_load_dwordx4 v[128:131], v1, s[48:51], s3 offen offset:0 sc1
    buffer_load_dwordx4 v[132:135], v1, s[48:51], s3 offen offset:1024 sc1
    buffer_load_dwordx4 v[136:139], v1, s[48:51], s3 offen offset:2048 sc1
    buffer_load_dwordx4 v[140:143], v1, s[48:51], s3 offen offset:3072 sc1
    s_add_u32 s3, s60, 4096
    buffer_load_dwordx4 v[144:147], v1, s[48:51], s3 offen offset:0 sc1
    buffer_load_dwordx4 v[148:151], v1, s[48:51], s3 offen offset:1024 sc1
    buffer_load_dwordx4 v[152:155], v1, s[48:51], s3 offen offset:2048 sc1
    buffer_load_dwordx4 v[156:159], v1, s[48:51], s3 offen offset:3072 sc1
    s_waitcnt vmcnt(0)
    v_bitop3_b32 v95, v128, v132, 1 bitop3:0x80
    v_cmp_eq_u32 vcc, 0, v95
    s_nop 4
    s_cbranch_vccz gbk_71
    s_sub_u32 s99, s99, 1
    s_cmp_lg_u32 s99, 0
    s_cbranch_scc1 glp_72
    s_branch gbk_71
gst_74:
    s_mov_b32 s99, 200000
glp_76:
    s_add_u32 s3, s60, 0
    buffer_load_dwordx4 v[136:139], v1, s[48:51], s3 offen offset:2048 sc1
    buffer_load_dwordx4 v[140:143], v1, s[48:51], s3 offen offset:3072 sc1
    s_add_u32 s3, s60, 4096
    buffer_load_dwordx4 v[144:147], v1, s[48:51], s3 offen offset:0 sc1
    buffer_load_dwordx4 v[148:151], v1, s[48:51], s3 offen offset:1024 sc1
    buffer_load_dwordx4 v[152:155], v1, s[48:51], s3 offen offset:2048 sc1
    buffer_load_dwordx4 v[156:159], v1, s[48:51], s3 offen offset:3072 sc1
    s_add_u32 s3, s60, 8192
    buffer_load_dwordx4 v[160:163], v1, s[48:51], s3 offen offset:0 sc1
    buffer_load_dwordx4 v[164:167], v1, s[48:51], s3 offen offset:1024 sc1
    s_waitcnt vmcnt(0)
    v_bitop3_b32 v95, v136, v140, 1 bitop3:0x80
    v_cmp_eq_u32 vcc, 0, v95
    s_nop 4
    s_cbranch_vccz gbk_75
    s_sub_u32 s99, s99, 1
    s_cmp_lg_u32 s99, 0
    s_cbranch_scc1 glp_76
    s_branch gbk_75
gst_78:
    s_mov_b32 s99, 200000
glp_80:
    s_add_u32 s3, s60, 4096
    buffer_load_dwordx4 v[144:147], v1, s[48:51], s3 offen offset:0 sc1
    buffer_load_dwordx4 v[148:151], v1, s[48:51], s3 offen offset:1024 sc1
    buffer_load_dwordx4 v[152:155], v1, s[48:51], s3 offen offset:2048 sc1
    buffer_load_dwordx4 v[156:159], v1, s[48:51], s3 offen offset:3072 sc1
    s_add_u32 s3, s60, 8192
    buffer_load_dwordx4 v[160:163], v1, s[48:51], s3 offen offset:0 sc1
    buffer_load_dwordx4 v[164:167], v1, s[48:51], s3 offen offset:1024 sc1
    buffer_load_dwordx4 v[168:171], v1, s[48:51], s3 offen offset:2048 sc1
    buffer_load_dwordx4 v[172:175], v1, s[48:51], s3 offen offset:3072 sc1
    s_waitcnt vmcnt(0)
    v_bitop3_b32 v95, v144, v148, 1 bitop3:0x80
    v_cmp_eq_u32 vcc, 0, v95
    s_nop 4
    s_cbranch_vccz gbk_79
    s_sub_u32 s99, s99, 1
    s_cmp_lg_u32 s99, 0
    s_cbranch_scc1 glp_80
    s_branch gbk_79
gst_82:
    s_mov_b32 s99, 200000
glp_84:
    s_add_u32 s3, s60, 4096
    buffer_load_dwordx4 v[152:155], v1, s[48:51], s3 offen offset:2048 sc1
    buffer_load_dwordx4 v[156:159], v1, s[48:51], s3 offen offset:3072 sc1
    s_add_u32 s3, s60, 8192
    buffer_load_dwordx4 v[160:163], v1, s[48:51], s3 offen offset:0 sc1
    buffer_load_dwordx4 v[164:167], v1, s[48:51], s3 offen offset:1024 sc1
    buffer_load_dwordx4 v[168:171], v1, s[48:51], s3 offen offset:2048 sc1
    buffer_load_dwordx4 v[172:175], v1, s[48:51], s3 offen offset:3072 sc1
    s_add_u32 s3, s60, 12288
    buffer_load_dwordx4 v[176:179], v1, s[48:51], s3 offen offset:0 sc1
    buffer_load_dwordx4 v[180:183], v1, s[48:51], s3 offen offset:1024 sc1
    s_waitcnt vmcnt(0)
    v_bitop3_b32 v95, v152, v156, 1 bitop3:0x80
    v_cmp_eq_u32 vcc, 0, v95
    s_nop 4
    s_cbranch_vccz gbk_83
    s_sub_u32 s99, s99, 1
    s_cmp_lg_u32 s99, 0
    s_cbranch_scc1 glp_84
    s_branch gbk_83
gst_86:
    s_mov_b32 s99, 200000
glp_88:
    s_add_u32 s3, s60, 8192
    buffer_load_dwordx4 v[160:163], v1, s[48:51], s3 offen offset:0 sc1
    buffer_load_dwordx4 v[164:167], v1, s[48:51], s3 offen offset:1024 sc1
    buffer_load_dwordx4 v[168:171], v1, s[48:51], s3 offen offset:2048 sc1
    buffer_load_dwordx4 v[172:175], v1, s[48:51], s3 offen offset:3072 sc1
    s_add_u32 s3, s60, 12288
    buffer_load_dwordx4 v[176:179], v1, s[48:51], s3 offen offset:0 sc1
    buffer_load_dwordx4 v[180:183], v1, s[48:51], s3 offen offset:1024 sc1
    buffer_load_dwordx4 v[184:187], v1, s[48:51], s3 offen offset:2048 sc1
    buffer_load_dwordx4 v[188:191], v1, s[48:51], s3 offen offset:3072 sc1
    s_waitcnt vmcnt(0)
    v_bitop3_b32 v95, v160, v164, 1 bitop3:0x80
    v_cmp_eq_u32 vcc, 0, v95
    s_nop 4
    s_cbranch_vccz gbk_87
    s_sub_u32 s99, s99, 1
    s_cmp_lg_u32 s99, 0
    s_cbranch_scc1 glp_88
    s_branch gbk_87
gst_90:
    s_mov_b32 s99, 200000
glp_92:
    s_add_u32 s3, s60, 8192
    buffer_load_dwordx4 v[168:171], v1, s[48:51], s3 offen offset:2048 sc1
    buffer_load_dwordx4 v[172:175], v1, s[48:51], s3 offen offset:3072 sc1
    s_add_u32 s3, s60, 12288
    buffer_load_dwordx4 v[176:179], v1, s[48:51], s3 offen offset:0 sc1
    buffer_load_dwordx4 v[180:183], v1, s[48:51], s3 offen offset:1024 sc1
    buffer_load_dwordx4 v[184:187], v1, s[48:51], s3 offen offset:2048 sc1
    buffer_load_dwordx4 v[188:191], v1, s[48:51], s3 offen offset:3072 sc1
    s_add_u32 s3, s60, 16384
    buffer_load_dwordx4 v[192:195], v1, s[48:51], s3 offen offset:0 sc1
    buffer_load_dwordx4 v[196:199], v1, s[48:51], s3 offen offset:1024 sc1
    s_waitcnt vmcnt(0)
    v_bitop3_b32 v95, v168, v172, 1 bitop3:0x80
    v_cmp_eq_u32 vcc, 0, v95
    s_nop 4
    s_cbranch_vccz gbk_91
    s_sub_u32 s99, s99, 1
    s_cmp_lg_u32 s99, 0
    s_cbranch_scc1 glp_92
    s_branch gbk_91
gst_94:
    s_mov_b32 s99, 200000
glp_96:
    s_add_u32 s3, s60, 12288
    buffer_load_dwordx4 v[176:179], v1, s[48:51], s3 offen offset:0 sc1
    buffer_load_dwordx4 v[180:183], v1, s[48:51], s3 offen offset:1024 sc1
    buffer_load_dwordx4 v[184:187], v1, s[48:51], s3 offen offset:2048 sc1
    buffer_load_dwordx4 v[188:191], v1, s[48:51], s3 offen offset:3072 sc1
    s_add_u32 s3, s60, 16384
    buffer_load_dwordx4 v[192:195], v1, s[48:51], s3 offen offset:0 sc1
    buffer_load_dwordx4 v[196:199], v1, s[48:51], s3 offen offset:1024 sc1
    buffer_load_dwordx4 v[200:203], v1, s[48:51], s3 offen offset:2048 sc1
    buffer_load_dwordx4 v[204:207], v1, s[48:51], s3 offen offset:3072 sc1
    s_waitcnt vmcnt(0)
    v_bitop3_b32 v95, v176, v180, 1 bitop3:0x80
    v_cmp_eq_u32 vcc, 0, v95
    s_nop 4
    s_cbranch_vccz gbk_95
    s_sub_u32 s99, s99, 1
    s_cmp_lg_u32 s99, 0
    s_cbranch_scc1 glp_96
    s_branch gbk_95
gst_98:
    s_mov_b32 s99, 200000
glp_100:
    s_add_u32 s3, s60, 12288
    buffer_load_dwordx4 v[184:187], v1, s[48:51], s3 offen offset:2048 sc1
    buffer_load_dwordx4 v[188:191], v1, s[48:51], s3 offen offset:3072 sc1
    s_add_u32 s3, s60, 16384
    buffer_load_dwordx4 v[192:195], v1, s[48:51], s3 offen offset:0 sc1
    buffer_load_dwordx4 v[196:199], v1, s[48:51], s3 offen offset:1024 sc1
    buffer_load_dwordx4 v[200:203], v1, s[48:51], s3 offen offset:2048 sc1
    buffer_load_dwordx4 v[204:207], v1, s[48:51], s3 offen offset:3072 sc1
    s_add_u32 s3, s60, 20480
    buffer_load_dwordx4 v[208:211], v1, s[48:51], s3 offen offset:0 sc1
    buffer_load_dwordx4 v[212:215], v1, s[48:51], s3 offen offset:1024 sc1
    s_waitcnt vmcnt(0)
    v_bitop3_b32 v95, v184, v188, 1 bitop3:0x80
    v_cmp_eq_u32 vcc, 0, v95
    s_nop 4
    s_cbranch_vccz gbk_99
    s_sub_u32 s99, s99, 1
    s_cmp_lg_u32 s99, 0
    s_cbranch_scc1 glp_100
    s_branch gbk_99
gst_102:
    s_mov_b32 s99, 200000
glp_104:
    s_add_u32 s3, s60, 16384
    buffer_load_dwordx4 v[192:195], v1, s[48:51], s3 offen offset:0 sc1
    buffer_load_dwordx4 v[196:199], v1, s[48:51], s3 offen offset:1024 sc1
    buffer_load_dwordx4 v[200:203], v1, s[48:51], s3 offen offset:2048 sc1
    buffer_load_dwordx4 v[204:207], v1, s[48:51], s3 offen offset:3072 sc1
    s_add_u32 s3, s60, 20480
    buffer_load_dwordx4 v[208:211], v1, s[48:51], s3 offen offset:0 sc1
    buffer_load_dwordx4 v[212:215], v1, s[48:51], s3 offen offset:1024 sc1
    buffer_load_dwordx4 v[216:219], v1, s[48:51], s3 offen offset:2048 sc1
    buffer_load_dwordx4 v[220:223], v1, s[48:51], s3 offen offset:3072 sc1
    s_waitcnt vmcnt(0)
    v_bitop3_b32 v95, v192, v196, 1 bitop3:0x80
    v_cmp_eq_u32 vcc, 0, v95
    s_nop 4
    s_cbranch_vccz gbk_103
    s_sub_u32 s99, s99, 1
    s_cmp_lg_u32 s99, 0
    s_cbranch_scc1 glp_104
    s_branch gbk_103
sst_106:
    s_mov_b32 s99, 200000
    s_mov_b64 s[10:11], vcc
slp_108:
    buffer_load_dwordx4 v[96:99], v1, s[48:51], s101 offen offset:0 sc1
    buffer_load_dwordx4 v[100:103], v1, s[48:51], s101 offen offset:1024 sc1
    buffer_load_dwordx4 v[104:107], v1, s[48:51], s101 offen offset:2048 sc1
    buffer_load_dwordx4 v[108:111], v1, s[48:51], s101 offen offset:3072 sc1
    s_waitcnt vmcnt(0)
    v_bitop3_b32 v93, v96, v98, v100 bitop3:0x80
    v_bitop3_b32 v93, v93, v102, v104 bitop3:0x80
    v_bitop3_b32 v93, v93, v106, v108 bitop3:0x80
    v_bitop3_b32 v93, v93, v110, 1 bitop3:0x80
    v_cmp_eq_u32 vcc, 0, v93
    s_nop 4
    s_cbranch_vccz sle_109
    s_sub_u32 s99, s99, 1
    s_cmp_lg_u32 s99, 0
    s_cbranch_scc1 slp_108
sle_109:
    s_mov_b64 vcc, s[10:11]
    s_branch sbk_107
gst_110:
    s_mov_b32 s99, 200000
glp_112:
    s_add_u32 s3, s60, 16384
    buffer_load_dwordx4 v[200:203], v1, s[48:51], s3 offen offset:2048 sc1
    buffer_load_dwordx4 v[204:207], v1, s[48:51], s3 offen offset:3072 sc1
    s_add_u32 s3, s60, 20480
    buffer_load_dwordx4 v[208:211], v1, s[48:51], s3 offen offset:0 sc1
    buffer_load_dwordx4 v[212:215], v1, s[48:51], s3 offen offset:1024 sc1
    buffer_load_dwordx4 v[216:219], v1, s[48:51], s3 offen offset:2048 sc1
    buffer_load_dwordx4 v[220:223], v1, s[48:51], s3 offen offset:3072 sc1
    s_add_u32 s3, s60, 24576
    buffer_load_dwordx4 v[224:227], v1, s[48:51], s3 offen offset:0 sc1
    buffer_load_dwordx4 v[228:231], v1, s[48:51], s3 offen offset:1024 sc1
    s_waitcnt vmcnt(0)
    v_bitop3_b32 v95, v200, v204, 1 bitop3:0x80
    v_cmp_eq_u32 vcc, 0, v95
    s_nop 4
    s_cbranch_vccz gbk_111
    s_sub_u32 s99, s99, 1
    s_cmp_lg_u32 s99, 0
    s_cbranch_scc1 glp_112
    s_branch gbk_111
gst_114:
    s_mov_b32 s99, 200000
glp_116:
    s_add_u32 s3, s60, 20480
    buffer_load_dwordx4 v[208:211], v1, s[48:51], s3 offen offset:0 sc1
    buffer_load_dwordx4 v[212:215], v1, s[48:51], s3 offen offset:1024 sc1
    buffer_load_dwordx4 v[216:219], v1, s[48:51], s3 offen offset:2048 sc1
    buffer_load_dwordx4 v[220:223], v1, s[48:51], s3 offen offset:3072 sc1
    s_add_u32 s3, s60, 24576
    buffer_load_dwordx4 v[224:227], v1, s[48:51], s3 offen offset:0 sc1
    buffer_load_dwordx4 v[228:231], v1, s[48:51], s3 offen offset:1024 sc1
    buffer_load_dwordx4 v[232:235], v1, s[48:51], s3 offen offset:2048 sc1
    buffer_load_dwordx4 v[236:239], v1, s[48:51], s3 offen offset:3072 sc1
    s_waitcnt vmcnt(0)
    v_bitop3_b32 v95, v208, v212, 1 bitop3:0x80
    v_cmp_eq_u32 vcc, 0, v95
    s_nop 4
    s_cbranch_vccz gbk_115
    s_sub_u32 s99, s99, 1
    s_cmp_lg_u32 s99, 0
    s_cbranch_scc1 glp_116
    s_branch gbk_115
gst_118:
    s_mov_b32 s99, 200000
glp_120:
    s_add_u32 s3, s60, 20480
    buffer_load_dwordx4 v[216:219], v1, s[48:51], s3 offen offset:2048 sc1
    buffer_load_dwordx4 v[220:223], v1, s[48:51], s3 offen offset:3072 sc1
    s_add_u32 s3, s60, 24576
    buffer_load_dwordx4 v[224:227], v1, s[48:51], s3 offen offset:0 sc1
    buffer_load_dwordx4 v[228:231], v1, s[48:51], s3 offen offset:1024 sc1
    buffer_load_dwordx4 v[232:235], v1, s[48:51], s3 offen offset:2048 sc1
    buffer_load_dwordx4 v[236:239], v1, s[48:51], s3 offen offset:3072 sc1
    s_add_u32 s3, s60, 28672
    buffer_load_dwordx4 v[240:243], v1, s[48:51], s3 offen offset:0 sc1
    buffer_load_dwordx4 v[244:247], v1, s[48:51], s3 offen offset:1024 sc1
    s_waitcnt vmcnt(0)
    v_bitop3_b32 v95, v216, v220, 1 bitop3:0x80
    v_cmp_eq_u32 vcc, 0, v95
    s_nop 4
    s_cbranch_vccz gbk_119
    s_sub_u32 s99, s99, 1
    s_cmp_lg_u32 s99, 0
    s_cbranch_scc1 glp_120
    s_branch gbk_119
gst_122:
    s_mov_b32 s99, 200000
glp_124:
    s_add_u32 s3, s60, 24576
    buffer_load_dwordx4 v[224:227], v1, s[48:51], s3 offen offset:0 sc1
    buffer_load_dwordx4 v[228:231], v1, s[48:51], s3 offen offset:1024 sc1
    buffer_load_dwordx4 v[232:235], v1, s[48:51], s3 offen offset:2048 sc1
    buffer_load_dwordx4 v[236:239], v1, s[48:51], s3 offen offset:3072 sc1
    s_add_u32 s3, s60, 28672
    buffer_load_dwordx4 v[240:243], v1, s[48:51], s3 offen offset:0 sc1
    buffer_load_dwordx4 v[244:247], v1, s[48:51], s3 offen offset:1024 sc1
    buffer_load_dwordx4 v[248:251], v1, s[48:51], s3 offen offset:2048 sc1
    buffer_load_dwordx4 v[252:255], v1, s[48:51], s3 offen offset:3072 sc1
    s_waitcnt vmcnt(0)
    v_bitop3_b32 v95, v224, v228, 1 bitop3:0x80
    v_cmp_eq_u32 vcc, 0, v95
    s_nop 4
    s_cbranch_vccz gbk_123
    s_sub_u32 s99, s99, 1
    s_cmp_lg_u32 s99, 0
    s_cbranch_scc1 glp_124
    s_branch gbk_123
gst_126:
    s_mov_b32 s99, 200000
glp_128:
    s_add_u32 s3, s60, 24576
    buffer_load_dwordx4 v[232:235], v1, s[48:51], s3 offen offset:2048 sc1
    buffer_load_dwordx4 v[236:239], v1, s[48:51], s3 offen offset:3072 sc1
    s_add_u32 s3, s60, 28672
    buffer_load_dwordx4 v[240:243], v1, s[48:51], s3 offen offset:0 sc1
    buffer_load_dwordx4 v[244:247], v1, s[48:51], s3 offen offset:1024 sc1
    buffer_load_dwordx4 v[248:251], v1, s[48:51], s3 offen offset:2048 sc1
    buffer_load_dwordx4 v[252:255], v1, s[48:51], s3 offen offset:3072 sc1
    s_waitcnt vmcnt(0)
    v_bitop3_b32 v95, v232, v236, 1 bitop3:0x80
    v_cmp_eq_u32 vcc, 0, v95
    s_nop 4
    s_cbranch_vccz gbk_127
    s_sub_u32 s99, s99, 1
    s_cmp_lg_u32 s99, 0
    s_cbranch_scc1 glp_128
    s_branch gbk_127
gst_130:
    s_mov_b32 s99, 200000
glp_132:
    s_add_u32 s3, s60, 28672
    buffer_load_dwordx4 v[240:243], v1, s[48:51], s3 offen offset:0 sc1
    buffer_load_dwordx4 v[244:247], v1, s[48:51], s3 offen offset:1024 sc1
    buffer_load_dwordx4 v[248:251], v1, s[48:51], s3 offen offset:2048 sc1
    buffer_load_dwordx4 v[252:255], v1, s[48:51], s3 offen offset:3072 sc1
    s_waitcnt vmcnt(0)
    v_bitop3_b32 v95, v240, v244, 1 bitop3:0x80
    v_cmp_eq_u32 vcc, 0, v95
    s_nop 4
    s_cbranch_vccz gbk_131
    s_sub_u32 s99, s99, 1
    s_cmp_lg_u32 s99, 0
    s_cbranch_scc1 glp_132
    s_branch gbk_131
gst_134:
    s_mov_b32 s99, 200000
glp_136:
    s_add_u32 s3, s60, 28672
    buffer_load_dwordx4 v[248:251], v1, s[48:51], s3 offen offset:2048 sc1
    buffer_load_dwordx4 v[252:255], v1, s[48:51], s3 offen offset:3072 sc1
    s_waitcnt vmcnt(0)
    v_bitop3_b32 v95, v248, v252, 1 bitop3:0x80
    v_cmp_eq_u32 vcc, 0, v95
    s_nop 4
    s_cbranch_vccz gbk_135
    s_sub_u32 s99, s99, 1
    s_cmp_lg_u32 s99, 0
    s_cbranch_scc1 glp_136
    s_branch gbk_135
kfb_138:
    s_mov_b32 s99, 200000
poll_140:
    buffer_load_dword v61, v60, s[48:51], s7 offen sc1
    s_waitcnt vmcnt(0)
    v_cmp_le_u32 vcc, 1, v61
    s_nop 0
    s_cmp_eq_u64 vcc, exec
    s_nop 2
    s_cbranch_scc1 polld_141
    s_sub_u32 s99, s99, 1
    s_cmp_lg_u32 s99, 0
    s_cbranch_scc1 poll_140
polld_141:
    s_branch kfo_139
kr_144:
    v_and_b32 v192, 1, v128
    v_and_b32 v193, 1, v132
    v_and_b32 v194, 1, v136
    v_and_b32 v195, 1, v140
    v_and_b32 v196, 1, v144
    v_and_b32 v197, 1, v148
    v_and_b32 v198, 1, v152
    v_and_b32 v199, 1, v156
    v_and_b32 v200, 1, v60
    v_cmp_eq_u32 vcc, 0, v192
    s_cbranch_vccz ks_145
    s_add_u32 s7, s20, 0
    buffer_load_dwordx4 v[128:131], v1, s[48:51], s7 offen sc1
ks_145:
    v_cmp_eq_u32 vcc, 0, v193
    s_cbranch_vccz ks_146
    s_add_u32 s7, s20, 4096
    buffer_load_dwordx4 v[132:135], v1, s[48:51], s7 offen sc1
ks_146:
    v_cmp_eq_u32 vcc, 0, v194
    s_cbranch_vccz ks_147
    s_add_u32 s7, s20, 8192
    buffer_load_dwordx4 v[136:139], v1, s[48:51], s7 offen sc1
ks_147:
    v_cmp_eq_u32 vcc, 0, v195
    s_cbranch_vccz ks_148
    s_add_u32 s7, s20, 12288
    buffer_load_dwordx4 v[140:143], v1, s[48:51], s7 offen sc1
ks_148:
    v_cmp_eq_u32 vcc, 0, v196
    s_cbranch_vccz ks_149
    s_add_u32 s7, s20, 16384
    buffer_load_dwordx4 v[144:147], v1, s[48:51], s7 offen sc1
ks_149:
    v_cmp_eq_u32 vcc, 0, v197
    s_cbranch_vccz ks_150
    s_add_u32 s7, s20, 20480
    buffer_load_dwordx4 v[148:151], v1, s[48:51], s7 offen sc1
ks_150:
    v_cmp_eq_u32 vcc, 0, v198
    s_cbranch_vccz ks_151
    s_add_u32 s7, s20, 24576
    buffer_load_dwordx4 v[152:155], v1, s[48:51], s7 offen sc1
ks_151:
    v_cmp_eq_u32 vcc, 0, v199
    s_cbranch_vccz ks_152
    s_add_u32 s7, s20, 28672
    buffer_load_dwordx4 v[156:159], v1, s[48:51], s7 offen sc1
ks_152:
    v_cmp_eq_u32 vcc, 0, v200
    s_cbranch_vccz ks_153
    buffer_load_dwordx4 v[60:63], v57, s[48:51], s21 offen offset:2048 sc1
ks_153:
    s_sub_u32 s99, s99, 1
    s_cmp_lg_u32 s99, 0
    s_nop 1
    s_cbranch_scc1 klp_142
    s_waitcnt vmcnt(0)
    s_branch kd_143
fast_154:
    buffer_store_dwordx4 v[104:107], v1, s[48:51], s62 offen offset:0 sc0 sc1
    s_nop 1
    s_branch dend_155
fast_156:
    buffer_store_dwordx4 v[108:111], v1, s[48:51], s62 offen offset:1024 sc0 sc1
    s_nop 1
    s_branch dend_157
gst_158:
    s_mov_b32 s99, 200000
glp_160:
    s_add_u32 s3, s100, 0
    buffer_load_dwordx4 v[128:131], v1, s[48:51], s3 offen offset:0 sc1
    buffer_load_dwordx4 v[132:135], v1, s[48:51], s3 offen offset:1024 sc1
    buffer_load_dwordx4 v[136:139], v1, s[48:51], s3 offen offset:2048 sc1
    buffer_load_dwordx4 v[140:143], v1, s[48:51], s3 offen offset:3072 sc1
    s_add_u32 s3, s100, 4096
    buffer_load_dwordx4 v[144:147], v1, s[48:51], s3 offen offset:0 sc1
    buffer_load_dwordx4 v[148:151], v1, s[48:51], s3 offen offset:1024 sc1
    buffer_load_dwordx4 v[152:155], v1, s[48:51], s3 offen offset:2048 sc1
    buffer_load_dwordx4 v[156:159], v1, s[48:51], s3 offen offset:3072 sc1
    s_waitcnt vmcnt(0)
    v_bitop3_b32 v95, v128, v132, 1 bitop3:0x80
    v_cmp_eq_u32 vcc, 0, v95
    s_nop 4
    s_cbranch_vccz gbk_159
    s_sub_u32 s99, s99, 1
    s_cmp_lg_u32 s99, 0
    s_cbranch_scc1 glp_160
    s_branch gbk_159
gst_162:
    s_mov_b32 s99, 200000
glp_164:
    s_add_u32 s3, s100, 0
    buffer_load_dwordx4 v[136:139], v1, s[48:51], s3 offen offset:2048 sc1
    buffer_load_dwordx4 v[140:143], v1, s[48:51], s3 offen offset:3072 sc1
    s_add_u32 s3, s100, 4096
    buffer_load_dwordx4 v[144:147], v1, s[48:51], s3 offen offset:0 sc1
    buffer_load_dwordx4 v[148:151], v1, s[48:51], s3 offen offset:1024 sc1
    buffer_load_dwordx4 v[152:155], v1, s[48:51], s3 offen offset:2048 sc1
    buffer_load_dwordx4 v[156:159], v1, s[48:51], s3 offen offset:3072 sc1
    s_add_u32 s3, s100, 8192
    buffer_load_dwordx4 v[160:163], v1, s[48:51], s3 offen offset:0 sc1
    buffer_load_dwordx4 v[164:167], v1, s[48:51], s3 offen offset:1024 sc1
    s_waitcnt vmcnt(0)
    v_bitop3_b32 v95, v136, v140, 1 bitop3:0x80
    v_cmp_eq_u32 vcc, 0, v95
    s_nop 4
    s_cbranch_vccz gbk_163
    s_sub_u32 s99, s99, 1
    s_cmp_lg_u32 s99, 0
    s_cbranch_scc1 glp_164
    s_branch gbk_163
gst_166:
    s_mov_b32 s99, 200000
glp_168:
    s_add_u32 s3, s100, 4096
    buffer_load_dwordx4 v[144:147], v1, s[48:51], s3 offen offset:0 sc1
    buffer_load_dwordx4 v[148:151], v1, s[48:51], s3 offen offset:1024 sc1
    buffer_load_dwordx4 v[152:155], v1, s[48:51], s3 offen offset:2048 sc1
    buffer_load_dwordx4 v[156:159], v1, s[48:51], s3 offen offset:3072 sc1
    s_add_u32 s3, s100, 8192
    buffer_load_dwordx4 v[160:163], v1, s[48:51], s3 offen offset:0 sc1
    buffer_load_dwordx4 v[164:167], v1, s[48:51], s3 offen offset:1024 sc1
    buffer_load_dwordx4 v[168:171], v1, s[48:51], s3 offen offset:2048 sc1
    buffer_load_dwordx4 v[172:175], v1, s[48:51], s3 offen offset:3072 sc1
    s_waitcnt vmcnt(0)
    v_bitop3_b32 v95, v144, v148, 1 bitop3:0x80
    v_cmp_eq_u32 vcc, 0, v95
    s_nop 4
    s_cbranch_vccz gbk_167
    s_sub_u32 s99, s99, 1
    s_cmp_lg_u32 s99, 0
    s_cbranch_scc1 glp_168
    s_branch gbk_167
gst_170:
    s_mov_b32 s99, 200000
glp_172:
    s_add_u32 s3, s100, 4096
    buffer_load_dwordx4 v[152:155], v1, s[48:51], s3 offen offset:2048 sc1
    buffer_load_dwordx4 v[156:159], v1, s[48:51], s3 offen offset:3072 sc1
    s_add_u32 s3, s100, 8192
    buffer_load_dwordx4 v[160:163], v1, s[48:51], s3 offen offset:0 sc1
    buffer_load_dwordx4 v[164:167], v1, s[48:51], s3 offen offset:1024 sc1
    buffer_load_dwordx4 v[168:171], v1, s[48:51], s3 offen offset:2048 sc1
    buffer_load_dwordx4 v[172:175], v1, s[48:51], s3 offen offset:3072 sc1
    s_add_u32 s3, s100, 12288
    buffer_load_dwordx4 v[176:179], v1, s[48:51], s3 offen offset:0 sc1
    buffer_load_dwordx4 v[180:183], v1, s[48:51], s3 offen offset:1024 sc1
    s_waitcnt vmcnt(0)
    v_bitop3_b32 v95, v152, v156, 1 bitop3:0x80
    v_cmp_eq_u32 vcc, 0, v95
    s_nop 4
    s_cbranch_vccz gbk_171
    s_sub_u32 s99, s99, 1
    s_cmp_lg_u32 s99, 0
    s_cbranch_scc1 glp_172
    s_branch gbk_171
gst_174:
    s_mov_b32 s99, 200000
glp_176:
    s_add_u32 s3, s100, 8192
    buffer_load_dwordx4 v[160:163], v1, s[48:51], s3 offen offset:0 sc1
    buffer_load_dwordx4 v[164:167], v1, s[48:51], s3 offen offset:1024 sc1
    buffer_load_dwordx4 v[168:171], v1, s[48:51], s3 offen offset:2048 sc1
    buffer_load_dwordx4 v[172:175], v1, s[48:51], s3 offen offset:3072 sc1
    s_add_u32 s3, s100, 12288
    buffer_load_dwordx4 v[176:179], v1, s[48:51], s3 offen offset:0 sc1
    buffer_load_dwordx4 v[180:183], v1, s[48:51], s3 offen offset:1024 sc1
    buffer_load_dwordx4 v[184:187], v1, s[48:51], s3 offen offset:2048 sc1
    buffer_load_dwordx4 v[188:191], v1, s[48:51], s3 offen offset:3072 sc1
    s_waitcnt vmcnt(0)
    v_bitop3_b32 v95, v160, v164, 1 bitop3:0x80
    v_cmp_eq_u32 vcc, 0, v95
    s_nop 4
    s_cbranch_vccz gbk_175
    s_sub_u32 s99, s99, 1
    s_cmp_lg_u32 s99, 0
    s_cbranch_scc1 glp_176
    s_branch gbk_175
gst_178:
    s_mov_b32 s99, 200000
glp_180:
    s_add_u32 s3, s100, 8192
    buffer_load_dwordx4 v[168:171], v1, s[48:51], s3 offen offset:2048 sc1
    buffer_load_dwordx4 v[172:175], v1, s[48:51], s3 offen offset:3072 sc1
    s_add_u32 s3, s100, 12288
    buffer_load_dwordx4 v[176:179], v1, s[48:51], s3 offen offset:0 sc1
    buffer_load_dwordx4 v[180:183], v1, s[48:51], s3 offen offset:1024 sc1
    buffer_load_dwordx4 v[184:187], v1, s[48:51], s3 offen offset:2048 sc1
    buffer_load_dwordx4 v[188:191], v1, s[48:51], s3 offen offset:3072 sc1
    s_add_u32 s3, s100, 16384
    buffer_load_dwordx4 v[192:195], v1, s[48:51], s3 offen offset:0 sc1
    buffer_load_dwordx4 v[196:199], v1, s[48:51], s3 offen offset:1024 sc1
    s_waitcnt vmcnt(0)
    v_bitop3_b32 v95, v168, v172, 1 bitop3:0x80
    v_cmp_eq_u32 vcc, 0, v95
    s_nop 4
    s_cbranch_vccz gbk_179
    s_sub_u32 s99, s99, 1
    s_cmp_lg_u32 s99, 0
    s_cbranch_scc1 glp_180
    s_branch gbk_179
gst_182:
    s_mov_b32 s99, 200000
glp_184:
    s_add_u32 s3, s100, 12288
    buffer_load_dwordx4 v[176:179], v1, s[48:51], s3 offen offset:0 sc1
    buffer_load_dwordx4 v[180:183], v1, s[48:51], s3 offen offset:1024 sc1
    buffer_load_dwordx4 v[184:187], v1, s[48:51], s3 offen offset:2048 sc1
    buffer_load_dwordx4 v[188:191], v1, s[48:51], s3 offen offset:3072 sc1
    s_add_u32 s3, s100, 16384
    buffer_load_dwordx4 v[192:195], v1, s[48:51], s3 offen offset:0 sc1
    buffer_load_dwordx4 v[196:199], v1, s[48:51], s3 offen offset:1024 sc1
    buffer_load_dwordx4 v[200:203], v1, s[48:51], s3 offen offset:2048 sc1
    buffer_load_dwordx4 v[204:207], v1, s[48:51], s3 offen offset:3072 sc1
    s_waitcnt vmcnt(0)
    v_bitop3_b32 v95, v176, v180, 1 bitop3:0x80
    v_cmp_eq_u32 vcc, 0, v95
    s_nop 4
    s_cbranch_vccz gbk_183
    s_sub_u32 s99, s99, 1
    s_cmp_lg_u32 s99, 0
    s_cbranch_scc1 glp_184
    s_branch gbk_183
gst_186:
    s_mov_b32 s99, 200000
glp_188:
    s_add_u32 s3, s100, 12288
    buffer_load_dwordx4 v[184:187], v1, s[48:51], s3 offen offset:2048 sc1
    buffer_load_dwordx4 v[188:191], v1, s[48:51], s3 offen offset:3072 sc1
    s_add_u32 s3, s100, 16384
    buffer_load_dwordx4 v[192:195], v1, s[48:51], s3 offen offset:0 sc1
    buffer_load_dwordx4 v[196:199], v1, s[48:51], s3 offen offset:1024 sc1
    buffer_load_dwordx4 v[200:203], v1, s[48:51], s3 offen offset:2048 sc1
    buffer_load_dwordx4 v[204:207], v1, s[48:51], s3 offen offset:3072 sc1
    s_add_u32 s3, s100, 20480
    buffer_load_dwordx4 v[208:211], v1, s[48:51], s3 offen offset:0 sc1
    buffer_load_dwordx4 v[212:215], v1, s[48:51], s3 offen offset:1024 sc1
    s_waitcnt vmcnt(0)
    v_bitop3_b32 v95, v184, v188, 1 bitop3:0x80
    v_cmp_eq_u32 vcc, 0, v95
    s_nop 4
    s_cbranch_vccz gbk_187
    s_sub_u32 s99, s99, 1
    s_cmp_lg_u32 s99, 0
    s_cbranch_scc1 glp_188
    s_branch gbk_187
gst_190:
    s_mov_b32 s99, 200000
glp_192:
    s_add_u32 s3, s100, 16384
    buffer_load_dwordx4 v[192:195], v1, s[48:51], s3 offen offset:0 sc1
    buffer_load_dwordx4 v[196:199], v1, s[48:51], s3 offen offset:1024 sc1
    buffer_load_dwordx4 v[200:203], v1, s[48:51], s3 offen offset:2048 sc1
    buffer_load_dwordx4 v[204:207], v1, s[48:51], s3 offen offset:3072 sc1
    s_add_u32 s3, s100, 20480
    buffer_load_dwordx4 v[208:211], v1, s[48:51], s3 offen offset:0 sc1
    buffer_load_dwordx4 v[212:215], v1, s[48:51], s3 offen offset:1024 sc1
    buffer_load_dwordx4 v[216:219], v1, s[48:51], s3 offen offset:2048 sc1
    buffer_load_dwordx4 v[220:223], v1, s[48:51], s3 offen offset:3072 sc1
    s_waitcnt vmcnt(0)
    v_bitop3_b32 v95, v192, v196, 1 bitop3:0x80
    v_cmp_eq_u32 vcc, 0, v95
    s_nop 4
    s_cbranch_vccz gbk_191
    s_sub_u32 s99, s99, 1
    s_cmp_lg_u32 s99, 0
    s_cbranch_scc1 glp_192
    s_branch gbk_191
gst_194:
    s_mov_b32 s99, 200000
glp_196:
    s_add_u32 s3, s100, 16384
    buffer_load_dwordx4 v[200:203], v1, s[48:51], s3 offen offset:2048 sc1
    buffer_load_dwordx4 v[204:207], v1, s[48:51], s3 offen offset:3072 sc1
    s_add_u32 s3, s100, 20480
    buffer_load_dwordx4 v[208:211], v1, s[48:51], s3 offen offset:0 sc1
    buffer_load_dwordx4 v[212:215], v1, s[48:51], s3 offen offset:1024 sc1
    buffer_load_dwordx4 v[216:219], v1, s[48:51], s3 offen offset:2048 sc1
    buffer_load_dwordx4 v[220:223], v1, s[48:51], s3 offen offset:3072 sc1
    s_add_u32 s3, s100, 24576
    buffer_load_dwordx4 v[224:227], v1, s[48:51], s3 offen offset:0 sc1
    buffer_load_dwordx4 v[228:231], v1, s[48:51], s3 offen offset:1024 sc1
    s_waitcnt vmcnt(0)
    v_bitop3_b32 v95, v200, v204, 1 bitop3:0x80
    v_cmp_eq_u32 vcc, 0, v95
    s_nop 4
    s_cbranch_vccz gbk_195
    s_sub_u32 s99, s99, 1
    s_cmp_lg_u32 s99, 0
    s_cbranch_scc1 glp_196
    s_branch gbk_195
gst_198:
    s_mov_b32 s99, 200000
glp_200:
    s_add_u32 s3, s100, 20480
    buffer_load_dwordx4 v[208:211], v1, s[48:51], s3 offen offset:0 sc1
    buffer_load_dwordx4 v[212:215], v1, s[48:51], s3 offen offset:1024 sc1
    buffer_load_dwordx4 v[216:219], v1, s[48:51], s3 offen offset:2048 sc1
    buffer_load_dwordx4 v[220:223], v1, s[48:51], s3 offen offset:3072 sc1
    s_add_u32 s3, s100, 24576
    buffer_load_dwordx4 v[224:227], v1, s[48:51], s3 offen offset:0 sc1
    buffer_load_dwordx4 v[228:231], v1, s[48:51], s3 offen offset:1024 sc1
    buffer_load_dwordx4 v[232:235], v1, s[48:51], s3 offen offset:2048 sc1
    buffer_load_dwordx4 v[236:239], v1, s[48:51], s3 offen offset:3072 sc1
    s_waitcnt vmcnt(0)
    v_bitop3_b32 v95, v208, v212, 1 bitop3:0x80
    v_cmp_eq_u32 vcc, 0, v95
    s_nop 4
    s_cbranch_vccz gbk_199
    s_sub_u32 s99, s99, 1
    s_cmp_lg_u32 s99, 0
    s_cbranch_scc1 glp_200
    s_branch gbk_199
gst_202:
    s_mov_b32 s99, 200000
glp_204:
    s_add_u32 s3, s100, 20480
    buffer_load_dwordx4 v[216:219], v1, s[48:51], s3 offen offset:2048 sc1
    buffer_load_dwordx4 v[220:223], v1, s[48:51], s3 offen offset:3072 sc1
    s_add_u32 s3, s100, 24576
    buffer_load_dwordx4 v[224:227], v1, s[48:51], s3 offen offset:0 sc1
    buffer_load_dwordx4 v[228:231], v1, s[48:51], s3 offen offset:1024 sc1
    buffer_load_dwordx4 v[232:235], v1, s[48:51], s3 offen offset:2048 sc1
    buffer_load_dwordx4 v[236:239], v1, s[48:51], s3 offen offset:3072 sc1
    s_add_u32 s3, s100, 28672
    buffer_load_dwordx4 v[240:243], v1, s[48:51], s3 offen offset:0 sc1
    buffer_load_dwordx4 v[244:247], v1, s[48:51], s3 offen offset:1024 sc1
    s_waitcnt vmcnt(0)
    v_bitop3_b32 v95, v216, v220, 1 bitop3:0x80
    v_cmp_eq_u32 vcc, 0, v95
    s_nop 4
    s_cbranch_vccz gbk_203
    s_sub_u32 s99, s99, 1
    s_cmp_lg_u32 s99, 0
    s_cbranch_scc1 glp_204
    s_branch gbk_203
gst_206:
    s_mov_b32 s99, 200000
glp_208:
    s_add_u32 s3, s100, 24576
    buffer_load_dwordx4 v[224:227], v1, s[48:51], s3 offen offset:0 sc1
    buffer_load_dwordx4 v[228:231], v1, s[48:51], s3 offen offset:1024 sc1
    buffer_load_dwordx4 v[232:235], v1, s[48:51], s3 offen offset:2048 sc1
    buffer_load_dwordx4 v[236:239], v1, s[48:51], s3 offen offset:3072 sc1
    s_add_u32 s3, s100, 28672
    buffer_load_dwordx4 v[240:243], v1, s[48:51], s3 offen offset:0 sc1
    buffer_load_dwordx4 v[244:247], v1, s[48:51], s3 offen offset:1024 sc1
    buffer_load_dwordx4 v[248:251], v1, s[48:51], s3 offen offset:2048 sc1
    buffer_load_dwordx4 v[252:255], v1, s[48:51], s3 offen offset:3072 sc1
    s_waitcnt vmcnt(0)
    v_bitop3_b32 v95, v224, v228, 1 bitop3:0x80
    v_cmp_eq_u32 vcc, 0, v95
    s_nop 4
    s_cbranch_vccz gbk_207
    s_sub_u32 s99, s99, 1
    s_cmp_lg_u32 s99, 0
    s_cbranch_scc1 glp_208
    s_branch gbk_207
gst_210:
    s_mov_b32 s99, 200000
glp_212:
    s_add_u32 s3, s100, 24576
    buffer_load_dwordx4 v[232:235], v1, s[48:51], s3 offen offset:2048 sc1
    buffer_load_dwordx4 v[236:239], v1, s[48:51], s3 offen offset:3072 sc1
    s_add_u32 s3, s100, 28672
    buffer_load_dwordx4 v[240:243], v1, s[48:51], s3 offen offset:0 sc1
    buffer_load_dwordx4 v[244:247], v1, s[48:51], s3 offen offset:1024 sc1
    buffer_load_dwordx4 v[248:251], v1, s[48:51], s3 offen offset:2048 sc1
    buffer_load_dwordx4 v[252:255], v1, s[48:51], s3 offen offset:3072 sc1
    s_waitcnt vmcnt(0)
    v_bitop3_b32 v95, v232, v236, 1 bitop3:0x80
    v_cmp_eq_u32 vcc, 0, v95
    s_nop 4
    s_cbranch_vccz gbk_211
    s_sub_u32 s99, s99, 1
    s_cmp_lg_u32 s99, 0
    s_cbranch_scc1 glp_212
    s_branch gbk_211
gst_214:
    s_mov_b32 s99, 200000
glp_216:
    s_add_u32 s3, s100, 28672
    buffer_load_dwordx4 v[240:243], v1, s[48:51], s3 offen offset:0 sc1
    buffer_load_dwordx4 v[244:247], v1, s[48:51], s3 offen offset:1024 sc1
    buffer_load_dwordx4 v[248:251], v1, s[48:51], s3 offen offset:2048 sc1
    buffer_load_dwordx4 v[252:255], v1, s[48:51], s3 offen offset:3072 sc1
    s_waitcnt vmcnt(0)
    v_bitop3_b32 v95, v240, v244, 1 bitop3:0x80
    v_cmp_eq_u32 vcc, 0, v95
    s_nop 4
    s_cbranch_vccz gbk_215
    s_sub_u32 s99, s99, 1
    s_cmp_lg_u32 s99, 0
    s_cbranch_scc1 glp_216
    s_branch gbk_215
gst_218:
    s_mov_b32 s99, 200000
glp_220:
    s_add_u32 s3, s100, 28672
    buffer_load_dwordx4 v[248:251], v1, s[48:51], s3 offen offset:2048 sc1
    buffer_load_dwordx4 v[252:255], v1, s[48:51], s3 offen offset:3072 sc1
    s_waitcnt vmcnt(0)
    v_bitop3_b32 v95, v248, v252, 1 bitop3:0x80
    v_cmp_eq_u32 vcc, 0, v95
    s_nop 4
    s_cbranch_vccz gbk_219
    s_sub_u32 s99, s99, 1
    s_cmp_lg_u32 s99, 0
    s_cbranch_scc1 glp_220
    s_branch gbk_219
fast_222:
    buffer_store_dwordx4 v[16:19], v1, s[48:51], s61 offen sc0 sc1
    buffer_store_dwordx4 v[20:23], v1, s[48:51], s61 offen offset:1024 sc0 sc1
    v_mov_b32 v94, 0
    v_mov_b32 v95, 0
    v_dot2c_f32_bf16 v94, s22, v16
    v_dot2c_f32_bf16 v95, v16, v16
    v_dot2c_f32_bf16 v94, s22, v17
    v_dot2c_f32_bf16 v95, v17, v17
    v_dot2c_f32_bf16 v94, s22, v18
    v_dot2c_f32_bf16 v95, v18, v18
    v_dot2c_f32_bf16 v94, s22, v19
    v_dot2c_f32_bf16 v95, v19, v19
    v_dot2c_f32_bf16 v94, s22, v20
    v_dot2c_f32_bf16 v95, v20, v20
    v_dot2c_f32_bf16 v94, s22, v21
    v_dot2c_f32_bf16 v95, v21, v21
    v_dot2c_f32_bf16 v94, s22, v22
    v_dot2c_f32_bf16 v95, v22, v22
    v_dot2c_f32_bf16 v94, s22, v23
    v_dot2c_f32_bf16 v95, v23, v23
    s_nop 1
    v_mov_b32 v92, v94
    v_mov_b32 v93, v95
    s_nop 0
    v_permlane32_swap_b32 v92, v94
    v_permlane32_swap_b32 v93, v95
    v_pk_add_f32 v[94:95], v[94:95], v[92:93]
    v_and_b32 v94, -2, v94
    buffer_store_dwordx2 v[94:95], v6, s[48:51], s101 offen sc0 sc1
    s_nop 0
    s_branch dend_223
gst_224:
    s_mov_b32 s99, 200000
glp_226:
    s_add_u32 s3, s60, 0
    buffer_load_dwordx4 v[128:131], v1, s[48:51], s3 offen offset:0 sc1
    buffer_load_dwordx4 v[132:135], v1, s[48:51], s3 offen offset:1024 sc1
    buffer_load_dwordx4 v[136:139], v1, s[48:51], s3 offen offset:2048 sc1
    buffer_load_dwordx4 v[140:143], v1, s[48:51], s3 offen offset:3072 sc1
    s_add_u32 s3, s60, 4096
    buffer_load_dwordx4 v[144:147], v1, s[48:51], s3 offen offset:0 sc1
    buffer_load_dwordx4 v[148:151], v1, s[48:51], s3 offen offset:1024 sc1
    buffer_load_dwordx4 v[152:155], v1, s[48:51], s3 offen offset:2048 sc1
    buffer_load_dwordx4 v[156:159], v1, s[48:51], s3 offen offset:3072 sc1
    s_waitcnt vmcnt(0)
    v_bitop3_b32 v95, v128, v132, 1 bitop3:0x2
    v_cmp_eq_u32 vcc, 0, v95
    s_nop 4
    s_cbranch_vccz gbk_225
    s_sub_u32 s99, s99, 1
    s_cmp_lg_u32 s99, 0
    s_cbranch_scc1 glp_226
    s_branch gbk_225
gst_228:
    s_mov_b32 s99, 200000
glp_230:
    s_add_u32 s3, s60, 0
    buffer_load_dwordx4 v[136:139], v1, s[48:51], s3 offen offset:2048 sc1
    buffer_load_dwordx4 v[140:143], v1, s[48:51], s3 offen offset:3072 sc1
    s_add_u32 s3, s60, 4096
    buffer_load_dwordx4 v[144:147], v1, s[48:51], s3 offen offset:0 sc1
    buffer_load_dwordx4 v[148:151], v1, s[48:51], s3 offen offset:1024 sc1
    buffer_load_dwordx4 v[152:155], v1, s[48:51], s3 offen offset:2048 sc1
    buffer_load_dwordx4 v[156:159], v1, s[48:51], s3 offen offset:3072 sc1
    s_add_u32 s3, s60, 8192
    buffer_load_dwordx4 v[160:163], v1, s[48:51], s3 offen offset:0 sc1
    buffer_load_dwordx4 v[164:167], v1, s[48:51], s3 offen offset:1024 sc1
    s_waitcnt vmcnt(0)
    v_bitop3_b32 v95, v136, v140, 1 bitop3:0x2
    v_cmp_eq_u32 vcc, 0, v95
    s_nop 4
    s_cbranch_vccz gbk_229
    s_sub_u32 s99, s99, 1
    s_cmp_lg_u32 s99, 0
    s_cbranch_scc1 glp_230
    s_branch gbk_229
gst_232:
    s_mov_b32 s99, 200000
glp_234:
    s_add_u32 s3, s60, 4096
    buffer_load_dwordx4 v[144:147], v1, s[48:51], s3 offen offset:0 sc1
    buffer_load_dwordx4 v[148:151], v1, s[48:51], s3 offen offset:1024 sc1
    buffer_load_dwordx4 v[152:155], v1, s[48:51], s3 offen offset:2048 sc1
    buffer_load_dwordx4 v[156:159], v1, s[48:51], s3 offen offset:3072 sc1
    s_add_u32 s3, s60, 8192
    buffer_load_dwordx4 v[160:163], v1, s[48:51], s3 offen offset:0 sc1
    buffer_load_dwordx4 v[164:167], v1, s[48:51], s3 offen offset:1024 sc1
    buffer_load_dwordx4 v[168:171], v1, s[48:51], s3 offen offset:2048 sc1
    buffer_load_dwordx4 v[172:175], v1, s[48:51], s3 offen offset:3072 sc1
    s_waitcnt vmcnt(0)
    v_bitop3_b32 v95, v144, v148, 1 bitop3:0x2
    v_cmp_eq_u32 vcc, 0, v95
    s_nop 4
    s_cbranch_vccz gbk_233
    s_sub_u32 s99, s99, 1
    s_cmp_lg_u32 s99, 0
    s_cbranch_scc1 glp_234
    s_branch gbk_233
gst_236:
    s_mov_b32 s99, 200000
glp_238:
    s_add_u32 s3, s60, 4096
    buffer_load_dwordx4 v[152:155], v1, s[48:51], s3 offen offset:2048 sc1
    buffer_load_dwordx4 v[156:159], v1, s[48:51], s3 offen offset:3072 sc1
    s_add_u32 s3, s60, 8192
    buffer_load_dwordx4 v[160:163], v1, s[48:51], s3 offen offset:0 sc1
    buffer_load_dwordx4 v[164:167], v1, s[48:51], s3 offen offset:1024 sc1
    buffer_load_dwordx4 v[168:171], v1, s[48:51], s3 offen offset:2048 sc1
    buffer_load_dwordx4 v[172:175], v1, s[48:51], s3 offen offset:3072 sc1
    s_add_u32 s3, s60, 12288
    buffer_load_dwordx4 v[176:179], v1, s[48:51], s3 offen offset:0 sc1
    buffer_load_dwordx4 v[180:183], v1, s[48:51], s3 offen offset:1024 sc1
    s_waitcnt vmcnt(0)
    v_bitop3_b32 v95, v152, v156, 1 bitop3:0x2
    v_cmp_eq_u32 vcc, 0, v95
    s_nop 4
    s_cbranch_vccz gbk_237
    s_sub_u32 s99, s99, 1
    s_cmp_lg_u32 s99, 0
    s_cbranch_scc1 glp_238
    s_branch gbk_237
gst_240:
    s_mov_b32 s99, 200000
glp_242:
    s_add_u32 s3, s60, 8192
    buffer_load_dwordx4 v[160:163], v1, s[48:51], s3 offen offset:0 sc1
    buffer_load_dwordx4 v[164:167], v1, s[48:51], s3 offen offset:1024 sc1
    buffer_load_dwordx4 v[168:171], v1, s[48:51], s3 offen offset:2048 sc1
    buffer_load_dwordx4 v[172:175], v1, s[48:51], s3 offen offset:3072 sc1
    s_add_u32 s3, s60, 12288
    buffer_load_dwordx4 v[176:179], v1, s[48:51], s3 offen offset:0 sc1
    buffer_load_dwordx4 v[180:183], v1, s[48:51], s3 offen offset:1024 sc1
    buffer_load_dwordx4 v[184:187], v1, s[48:51], s3 offen offset:2048 sc1
    buffer_load_dwordx4 v[188:191], v1, s[48:51], s3 offen offset:3072 sc1
    s_waitcnt vmcnt(0)
    v_bitop3_b32 v95, v160, v164, 1 bitop3:0x2
    v_cmp_eq_u32 vcc, 0, v95
    s_nop 4
    s_cbranch_vccz gbk_241
    s_sub_u32 s99, s99, 1
    s_cmp_lg_u32 s99, 0
    s_cbranch_scc1 glp_242
    s_branch gbk_241
gst_244:
    s_mov_b32 s99, 200000
glp_246:
    s_add_u32 s3, s60, 8192
    buffer_load_dwordx4 v[168:171], v1, s[48:51], s3 offen offset:2048 sc1
    buffer_load_dwordx4 v[172:175], v1, s[48:51], s3 offen offset:3072 sc1
    s_add_u32 s3, s60, 12288
    buffer_load_dwordx4 v[176:179], v1, s[48:51], s3 offen offset:0 sc1
    buffer_load_dwordx4 v[180:183], v1, s[48:51], s3 offen offset:1024 sc1
    buffer_load_dwordx4 v[184:187], v1, s[48:51], s3 offen offset:2048 sc1
    buffer_load_dwordx4 v[188:191], v1, s[48:51], s3 offen offset:3072 sc1
    s_add_u32 s3, s60, 16384
    buffer_load_dwordx4 v[192:195], v1, s[48:51], s3 offen offset:0 sc1
    buffer_load_dwordx4 v[196:199], v1, s[48:51], s3 offen offset:1024 sc1
    s_waitcnt vmcnt(0)
    v_bitop3_b32 v95, v168, v172, 1 bitop3:0x2
    v_cmp_eq_u32 vcc, 0, v95
    s_nop 4
    s_cbranch_vccz gbk_245
    s_sub_u32 s99, s99, 1
    s_cmp_lg_u32 s99, 0
    s_cbranch_scc1 glp_246
    s_branch gbk_245
gst_248:
    s_mov_b32 s99, 200000
glp_250:
    s_add_u32 s3, s60, 12288
    buffer_load_dwordx4 v[176:179], v1, s[48:51], s3 offen offset:0 sc1
    buffer_load_dwordx4 v[180:183], v1, s[48:51], s3 offen offset:1024 sc1
    buffer_load_dwordx4 v[184:187], v1, s[48:51], s3 offen offset:2048 sc1
    buffer_load_dwordx4 v[188:191], v1, s[48:51], s3 offen offset:3072 sc1
    s_add_u32 s3, s60, 16384
    buffer_load_dwordx4 v[192:195], v1, s[48:51], s3 offen offset:0 sc1
    buffer_load_dwordx4 v[196:199], v1, s[48:51], s3 offen offset:1024 sc1
    buffer_load_dwordx4 v[200:203], v1, s[48:51], s3 offen offset:2048 sc1
    buffer_load_dwordx4 v[204:207], v1, s[48:51], s3 offen offset:3072 sc1
    s_waitcnt vmcnt(0)
    v_bitop3_b32 v95, v176, v180, 1 bitop3:0x2
    v_cmp_eq_u32 vcc, 0, v95
    s_nop 4
    s_cbranch_vccz gbk_249
    s_sub_u32 s99, s99, 1
    s_cmp_lg_u32 s99, 0
    s_cbranch_scc1 glp_250
    s_branch gbk_249
gst_252:
    s_mov_b32 s99, 200000
glp_254:
    s_add_u32 s3, s60, 12288
    buffer_load_dwordx4 v[184:187], v1, s[48:51], s3 offen offset:2048 sc1
    buffer_load_dwordx4 v[188:191], v1, s[48:51], s3 offen offset:3072 sc1
    s_add_u32 s3, s60, 16384
    buffer_load_dwordx4 v[192:195], v1, s[48:51], s3 offen offset:0 sc1
    buffer_load_dwordx4 v[196:199], v1, s[48:51], s3 offen offset:1024 sc1
    buffer_load_dwordx4 v[200:203], v1, s[48:51], s3 offen offset:2048 sc1
    buffer_load_dwordx4 v[204:207], v1, s[48:51], s3 offen offset:3072 sc1
    s_add_u32 s3, s60, 20480
    buffer_load_dwordx4 v[208:211], v1, s[48:51], s3 offen offset:0 sc1
    buffer_load_dwordx4 v[212:215], v1, s[48:51], s3 offen offset:1024 sc1
    s_waitcnt vmcnt(0)
    v_bitop3_b32 v95, v184, v188, 1 bitop3:0x2
    v_cmp_eq_u32 vcc, 0, v95
    s_nop 4
    s_cbranch_vccz gbk_253
    s_sub_u32 s99, s99, 1
    s_cmp_lg_u32 s99, 0
    s_cbranch_scc1 glp_254
    s_branch gbk_253
sst_256:
    s_mov_b32 s99, 200000
    s_mov_b64 s[10:11], vcc
slp_258:
    buffer_load_dwordx4 v[96:99], v1, s[48:51], s101 offen offset:0 sc1
    buffer_load_dwordx4 v[100:103], v1, s[48:51], s101 offen offset:1024 sc1
    buffer_load_dwordx4 v[104:107], v1, s[48:51], s101 offen offset:2048 sc1
    buffer_load_dwordx4 v[108:111], v1, s[48:51], s101 offen offset:3072 sc1
    s_waitcnt vmcnt(0)
    v_bitop3_b32 v93, v96, v98, v100 bitop3:0xfe
    v_bitop3_b32 v93, v93, v102, v104 bitop3:0xfe
    v_bitop3_b32 v93, v93, v106, v108 bitop3:0xfe
    v_bitop3_b32 v93, v93, v110, 1 bitop3:0x2
    v_cmp_eq_u32 vcc, 0, v93
    s_nop 4
    s_cbranch_vccz sle_259
    s_sub_u32 s99, s99, 1
    s_cmp_lg_u32 s99, 0
    s_cbranch_scc1 slp_258
sle_259:
    s_mov_b64 vcc, s[10:11]
    s_branch sbk_257
gst_260:
    s_mov_b32 s99, 200000
glp_262:
    s_add_u32 s3, s60, 16384
    buffer_load_dwordx4 v[192:195], v1, s[48:51], s3 offen offset:0 sc1
    buffer_load_dwordx4 v[196:199], v1, s[48:51], s3 offen offset:1024 sc1
    buffer_load_dwordx4 v[200:203], v1, s[48:51], s3 offen offset:2048 sc1
    buffer_load_dwordx4 v[204:207], v1, s[48:51], s3 offen offset:3072 sc1
    s_add_u32 s3, s60, 20480
    buffer_load_dwordx4 v[208:211], v1, s[48:51], s3 offen offset:0 sc1
    buffer_load_dwordx4 v[212:215], v1, s[48:51], s3 offen offset:1024 sc1
    buffer_load_dwordx4 v[216:219], v1, s[48:51], s3 offen offset:2048 sc1
    buffer_load_dwordx4 v[220:223], v1, s[48:51], s3 offen offset:3072 sc1
    s_waitcnt vmcnt(0)
    v_bitop3_b32 v95, v192, v196, 1 bitop3:0x2
    v_cmp_eq_u32 vcc, 0, v95
    s_nop 4
    s_cbranch_vccz gbk_261
    s_sub_u32 s99, s99, 1
    s_cmp_lg_u32 s99, 0
    s_cbranch_scc1 glp_262
    s_branch gbk_261
gst_264:
    s_mov_b32 s99, 200000
glp_266:
    s_add_u32 s3, s60, 16384
    buffer_load_dwordx4 v[200:203], v1, s[48:51], s3 offen offset:2048 sc1
    buffer_load_dwordx4 v[204:207], v1, s[48:51], s3 offen offset:3072 sc1
    s_add_u32 s3, s60, 20480
    buffer_load_dwordx4 v[208:211], v1, s[48:51], s3 offen offset:0 sc1
    buffer_load_dwordx4 v[212:215], v1, s[48:51], s3 offen offset:1024 sc1
    buffer_load_dwordx4 v[216:219], v1, s[48:51], s3 offen offset:2048 sc1
    buffer_load_dwordx4 v[220:223], v1, s[48:51], s3 offen offset:3072 sc1
    s_add_u32 s3, s60, 24576
    buffer_load_dwordx4 v[224:227], v1, s[48:51], s3 offen offset:0 sc1
    buffer_load_dwordx4 v[228:231], v1, s[48:51], s3 offen offset:1024 sc1
    s_waitcnt vmcnt(0)
    v_bitop3_b32 v95, v200, v204, 1 bitop3:0x2
    v_cmp_eq_u32 vcc, 0, v95
    s_nop 4
    s_cbranch_vccz gbk_265
    s_sub_u32 s99, s99, 1
    s_cmp_lg_u32 s99, 0
    s_cbranch_scc1 glp_266
    s_branch gbk_265
gst_268:
    s_mov_b32 s99, 200000
glp_270:
    s_add_u32 s3, s60, 20480
    buffer_load_dwordx4 v[208:211], v1, s[48:51], s3 offen offset:0 sc1
    buffer_load_dwordx4 v[212:215], v1, s[48:51], s3 offen offset:1024 sc1
    buffer_load_dwordx4 v[216:219], v1, s[48:51], s3 offen offset:2048 sc1
    buffer_load_dwordx4 v[220:223], v1, s[48:51], s3 offen offset:3072 sc1
    s_add_u32 s3, s60, 24576
    buffer_load_dwordx4 v[224:227], v1, s[48:51], s3 offen offset:0 sc1
    buffer_load_dwordx4 v[228:231], v1, s[48:51], s3 offen offset:1024 sc1
    buffer_load_dwordx4 v[232:235], v1, s[48:51], s3 offen offset:2048 sc1
    buffer_load_dwordx4 v[236:239], v1, s[48:51], s3 offen offset:3072 sc1
    s_waitcnt vmcnt(0)
    v_bitop3_b32 v95, v208, v212, 1 bitop3:0x2
    v_cmp_eq_u32 vcc, 0, v95
    s_nop 4
    s_cbranch_vccz gbk_269
    s_sub_u32 s99, s99, 1
    s_cmp_lg_u32 s99, 0
    s_cbranch_scc1 glp_270
    s_branch gbk_269
gst_272:
    s_mov_b32 s99, 200000
glp_274:
    s_add_u32 s3, s60, 20480
    buffer_load_dwordx4 v[216:219], v1, s[48:51], s3 offen offset:2048 sc1
    buffer_load_dwordx4 v[220:223], v1, s[48:51], s3 offen offset:3072 sc1
    s_add_u32 s3, s60, 24576
    buffer_load_dwordx4 v[224:227], v1, s[48:51], s3 offen offset:0 sc1
    buffer_load_dwordx4 v[228:231], v1, s[48:51], s3 offen offset:1024 sc1
    buffer_load_dwordx4 v[232:235], v1, s[48:51], s3 offen offset:2048 sc1
    buffer_load_dwordx4 v[236:239], v1, s[48:51], s3 offen offset:3072 sc1
    s_add_u32 s3, s60, 28672
    buffer_load_dwordx4 v[240:243], v1, s[48:51], s3 offen offset:0 sc1
    buffer_load_dwordx4 v[244:247], v1, s[48:51], s3 offen offset:1024 sc1
    s_waitcnt vmcnt(0)
    v_bitop3_b32 v95, v216, v220, 1 bitop3:0x2
    v_cmp_eq_u32 vcc, 0, v95
    s_nop 4
    s_cbranch_vccz gbk_273
    s_sub_u32 s99, s99, 1
    s_cmp_lg_u32 s99, 0
    s_cbranch_scc1 glp_274
    s_branch gbk_273
gst_276:
    s_mov_b32 s99, 200000
glp_278:
    s_add_u32 s3, s60, 24576
    buffer_load_dwordx4 v[224:227], v1, s[48:51], s3 offen offset:0 sc1
    buffer_load_dwordx4 v[228:231], v1, s[48:51], s3 offen offset:1024 sc1
    buffer_load_dwordx4 v[232:235], v1, s[48:51], s3 offen offset:2048 sc1
    buffer_load_dwordx4 v[236:239], v1, s[48:51], s3 offen offset:3072 sc1
    s_add_u32 s3, s60, 28672
    buffer_load_dwordx4 v[240:243], v1, s[48:51], s3 offen offset:0 sc1
    buffer_load_dwordx4 v[244:247], v1, s[48:51], s3 offen offset:1024 sc1
    buffer_load_dwordx4 v[248:251], v1, s[48:51], s3 offen offset:2048 sc1
    buffer_load_dwordx4 v[252:255], v1, s[48:51], s3 offen offset:3072 sc1
    s_waitcnt vmcnt(0)
    v_bitop3_b32 v95, v224, v228, 1 bitop3:0x2
    v_cmp_eq_u32 vcc, 0, v95
    s_nop 4
    s_cbranch_vccz gbk_277
    s_sub_u32 s99, s99, 1
    s_cmp_lg_u32 s99, 0
    s_cbranch_scc1 glp_278
    s_branch gbk_277
gst_280:
    s_mov_b32 s99, 200000
glp_282:
    s_add_u32 s3, s60, 24576
    buffer_load_dwordx4 v[232:235], v1, s[48:51], s3 offen offset:2048 sc1
    buffer_load_dwordx4 v[236:239], v1, s[48:51], s3 offen offset:3072 sc1
    s_add_u32 s3, s60, 28672
    buffer_load_dwordx4 v[240:243], v1, s[48:51], s3 offen offset:0 sc1
    buffer_load_dwordx4 v[244:247], v1, s[48:51], s3 offen offset:1024 sc1
    buffer_load_dwordx4 v[248:251], v1, s[48:51], s3 offen offset:2048 sc1
    buffer_load_dwordx4 v[252:255], v1, s[48:51], s3 offen offset:3072 sc1
    s_waitcnt vmcnt(0)
    v_bitop3_b32 v95, v232, v236, 1 bitop3:0x2
    v_cmp_eq_u32 vcc, 0, v95
    s_nop 4
    s_cbranch_vccz gbk_281
    s_sub_u32 s99, s99, 1
    s_cmp_lg_u32 s99, 0
    s_cbranch_scc1 glp_282
    s_branch gbk_281
gst_284:
    s_mov_b32 s99, 200000
glp_286:
    s_add_u32 s3, s60, 28672
    buffer_load_dwordx4 v[240:243], v1, s[48:51], s3 offen offset:0 sc1
    buffer_load_dwordx4 v[244:247], v1, s[48:51], s3 offen offset:1024 sc1
    buffer_load_dwordx4 v[248:251], v1, s[48:51], s3 offen offset:2048 sc1
    buffer_load_dwordx4 v[252:255], v1, s[48:51], s3 offen offset:3072 sc1
    s_waitcnt vmcnt(0)
    v_bitop3_b32 v95, v240, v244, 1 bitop3:0x2
    v_cmp_eq_u32 vcc, 0, v95
    s_nop 4
    s_cbranch_vccz gbk_285
    s_sub_u32 s99, s99, 1
    s_cmp_lg_u32 s99, 0
    s_cbranch_scc1 glp_286
    s_branch gbk_285
gst_288:
    s_mov_b32 s99, 200000
glp_290:
    s_add_u32 s3, s60, 28672
    buffer_load_dwordx4 v[248:251], v1, s[48:51], s3 offen offset:2048 sc1
    buffer_load_dwordx4 v[252:255], v1, s[48:51], s3 offen offset:3072 sc1
    s_waitcnt vmcnt(0)
    v_bitop3_b32 v95, v248, v252, 1 bitop3:0x2
    v_cmp_eq_u32 vcc, 0, v95
    s_nop 4
    s_cbranch_vccz gbk_289
    s_sub_u32 s99, s99, 1
    s_cmp_lg_u32 s99, 0
    s_cbranch_scc1 glp_290
    s_branch gbk_289
hr_294:
    s_lshl_b32 s4, s58, 13
    s_add_u32 m0, s4, 98304
    s_nop 0
    buffer_load_dwordx4 v1, s[48:51], s20 offen offset:0 sc1 lds
    buffer_load_dwordx4 v1, s[48:51], s20 offen offset:1024 sc1 lds
    buffer_load_dwordx4 v1, s[48:51], s20 offen offset:2048 sc1 lds
    buffer_load_dwordx4 v1, s[48:51], s20 offen offset:3072 sc1 lds
    s_add_u32 m0, s4, 102400
    s_nop 0
    buffer_load_dwordx4 v1, s[48:51], s21 offen offset:0 sc1 lds
    buffer_load_dwordx4 v1, s[48:51], s21 offen offset:1024 sc1 lds
    buffer_load_dwordx4 v1, s[48:51], s21 offen offset:2048 sc1 lds
    buffer_load_dwordx4 v1, s[48:51], s21 offen offset:3072 sc1 lds
    s_sub_u32 s99, s99, 1
    s_cmp_lg_u32 s99, 0
    s_cbranch_scc1 hlp_292
    s_waitcnt vmcnt(0)
    s_branch hd_293
fast_318:
    buffer_store_dwordx4 v[60:63], v1, s[48:51], s7 offen offset:0 sc0 sc1
    s_nop 1
    s_branch dend_319
fast_334:
    buffer_store_dwordx4 v[236:239], v1, s[48:51], s7 offen offset:1024 sc0 sc1
    s_nop 1
    s_branch dend_335
achk_296:
    ds_read_b128 v[64:67], v7 offset:28672
    ds_read_b128 v[68:71], v7 offset:24576
    v_exp_f32 v176, v176
    ds_read_b128 v[72:75], v7 offset:20480
    ds_read_b128 v[76:79], v7 offset:16384
    v_exp_f32 v177, v177
    s_mov_b64 exec, s[96:97]
    ds_read_b128 v[32:35], v7 offset:30720
    ds_read_b128 v[36:39], v7 offset:31744
    s_mov_b64 exec, -1
    s_waitcnt lgkmcnt(5)
    v_mfma_f32_32x32x16_bf16 v[112:127], v[64:67], v[16:19], v[192:207]
    v_exp_f32 v178, v178
    v_exp_f32 v179, v179
    v_exp_f32 v180, v180
    v_exp_f32 v181, v181
    s_waitcnt lgkmcnt(4)
    v_mfma_f32_32x32x16_bf16 v[128:143], v[68:71], v[16:19], v[192:207]
    v_exp_f32 v182, v182
    v_exp_f32 v183, v183
    v_exp_f32 v184, v184
    v_exp_f32 v185, v185
    s_waitcnt lgkmcnt(3)
    v_mfma_f32_32x32x16_bf16 v[144:159], v[72:75], v[16:19], v[192:207]
    ds_read_b128 v[80:83], v7 offset:12288
    v_exp_f32 v186, v186
    ds_read_b128 v[84:87], v7 offset:8192
    ds_read_b128 v[88:91], v7 offset:4096
    v_exp_f32 v187, v187
    v_exp_f32 v188, v188
    v_exp_f32 v189, v189
    v_exp_f32 v190, v190
    v_exp_f32 v191, v191
    v_cvt_pk_bf16_f32 v176, v176, v177
    v_cvt_pk_bf16_f32 v177, v178, v179
    v_cvt_pk_bf16_f32 v178, v180, v181
    v_cvt_pk_bf16_f32 v179, v182, v183
    v_cvt_pk_bf16_f32 v180, v184, v185
    v_cvt_pk_bf16_f32 v181, v186, v187
    v_cvt_pk_bf16_f32 v182, v188, v189
    v_cvt_pk_bf16_f32 v183, v190, v191
    v_mfma_f32_32x32x16_bf16 v[224:239], v[40:43], v[176:179], 0
    v_exp_f32 v112, v112
    v_exp_f32 v113, v113
    v_exp_f32 v114, v114
    v_exp_f32 v115, v115
    v_mfma_f32_32x32x16_bf16 v[224:239], v[44:47], v[180:183], v[224:239]
    s_mov_b64 exec, s[96:97]
    ds_read_b128 v[40:43], v7 offset:26624
    ds_read_b128 v[44:47], v7 offset:27648
    s_mov_b64 exec, -1
    v_exp_f32 v116, v116
    v_exp_f32 v117, v117
    v_exp_f32 v118, v118
    s_waitcnt lgkmcnt(7)
    v_mfma_f32_32x32x16_bf16 v[160:175], v[76:79], v[16:19], v[192:207]
    v_exp_f32 v119, v119
    v_exp_f32 v120, v120
    v_exp_f32 v121, v121
    v_exp_f32 v122, v122
    v_exp_f32 v123, v123
    v_exp_f32 v124, v124
    v_exp_f32 v125, v125
    v_exp_f32 v126, v126
    v_exp_f32_e64 v127, v127
    v_cvt_pk_bf16_f32 v112, v112, v113
    v_cvt_pk_bf16_f32 v113, v114, v115
    v_cvt_pk_bf16_f32 v114, v116, v117
    v_cvt_pk_bf16_f32 v115, v118, v119
    v_cvt_pk_bf16_f32 v116, v120, v121
    v_cvt_pk_bf16_f32 v117, v122, v123
    v_cvt_pk_bf16_f32 v118, v124, v125
    v_cvt_pk_bf16_f32 v119, v126, v127
    s_waitcnt lgkmcnt(5)
    s_cmp_lt_u32 s59, 1
    s_cbranch_scc1 sk_300
    v_mfma_f32_32x32x16_bf16 v[48:63], v[32:35], v[112:115], v[48:63]
sk_300:
    v_exp_f32 v128, v128
    v_exp_f32 v129, v129
    v_exp_f32 v130, v130
    v_exp_f32 v131, v131
    s_cmp_lt_u32 s59, 1
    s_cbranch_scc1 sk_301
    v_mfma_f32_32x32x16_bf16 v[48:63], v[36:39], v[116:119], v[48:63]
sk_301:
    s_mov_b64 exec, s[96:97]
    ds_read_b128 v[32:35], v7 offset:22528
    ds_read_b128 v[36:39], v7 offset:23552
    s_mov_b64 exec, -1
    v_exp_f32 v132, v132
    v_exp_f32 v133, v133
    v_exp_f32 v134, v134
    s_waitcnt lgkmcnt(6)
    v_mfma_f32_32x32x16_bf16 v[176:191], v[80:83], v[16:19], v[192:207]
    ds_read_b128 v[92:95], v7 offset:0
    v_exp_f32 v135, v135
    v_exp_f32 v136, v136
    v_exp_f32 v137, v137
    v_exp_f32 v138, v138
    v_exp_f32 v139, v139
    v_exp_f32 v140, v140
    v_exp_f32 v141, v141
    v_exp_f32 v142, v142
    v_exp_f32 v143, v143
    v_cvt_pk_bf16_f32 v128, v128, v129
    v_cvt_pk_bf16_f32 v129, v130, v131
    v_cvt_pk_bf16_f32 v130, v132, v133
    v_cvt_pk_bf16_f32 v131, v134, v135
    v_cvt_pk_bf16_f32 v132, v136, v137
    v_cvt_pk_bf16_f32 v133, v138, v139
    v_cvt_pk_bf16_f32 v134, v140, v141
    v_cvt_pk_bf16_f32 v135, v142, v143
    s_waitcnt lgkmcnt(3)
    s_cmp_lt_u32 s59, 2
    s_cbranch_scc1 sk_302
    v_mfma_f32_32x32x16_bf16 v[48:63], v[40:43], v[128:131], v[48:63]
sk_302:
    v_exp_f32 v144, v144
    v_exp_f32 v145, v145
    v_exp_f32 v146, v146
    v_exp_f32 v147, v147
    s_cmp_lt_u32 s59, 2
    s_cbranch_scc1 sk_303
    v_mfma_f32_32x32x16_bf16 v[48:63], v[44:47], v[132:135], v[48:63]
sk_303:
    s_mov_b64 exec, s[96:97]
    ds_read_b128 v[40:43], v7 offset:18432
    ds_read_b128 v[44:47], v7 offset:19456
    s_mov_b64 exec, -1
    v_exp_f32 v148, v148
    v_exp_f32 v149, v149
    v_exp_f32 v150, v150
    v_mfma_f32_32x32x16_bf16 v[112:127], v[84:87], v[16:19], v[192:207]
    ds_read_b128 v[96:99], v7 offset:29696
    v_exp_f32 v151, v151
    v_exp_f32 v152, v152
    v_exp_f32 v153, v153
    v_exp_f32 v154, v154
    v_exp_f32 v155, v155
    v_exp_f32 v156, v156
    v_exp_f32 v157, v157
    v_exp_f32 v158, v158
    v_exp_f32_e64 v159, v159
    v_cvt_pk_bf16_f32 v144, v144, v145
    v_cvt_pk_bf16_f32 v145, v146, v147
    v_cvt_pk_bf16_f32 v146, v148, v149
    v_cvt_pk_bf16_f32 v147, v150, v151
    v_cvt_pk_bf16_f32 v148, v152, v153
    v_cvt_pk_bf16_f32 v149, v154, v155
    v_cvt_pk_bf16_f32 v150, v156, v157
    v_cvt_pk_bf16_f32 v151, v158, v159
    s_waitcnt lgkmcnt(4)
    s_cmp_lt_u32 s59, 3
    s_cbranch_scc1 sk_304
    v_mfma_f32_32x32x16_bf16 v[48:63], v[32:35], v[144:147], v[48:63]
sk_304:
    v_exp_f32 v160, v160
    v_exp_f32 v161, v161
    v_exp_f32 v162, v162
    v_exp_f32 v163, v163
    s_cmp_lt_u32 s59, 3
    s_cbranch_scc1 sk_305
    v_mfma_f32_32x32x16_bf16 v[48:63], v[36:39], v[148:151], v[48:63]
sk_305:
    s_mov_b64 exec, s[96:97]
    ds_read_b128 v[32:35], v7 offset:14336
    ds_read_b128 v[36:39], v7 offset:15360
    s_mov_b64 exec, -1
    v_exp_f32 v164, v164
    v_exp_f32 v165, v165
    v_exp_f32 v166, v166
    v_mfma_f32_32x32x16_bf16 v[128:143], v[88:91], v[16:19], v[192:207]
    ds_read_b128 v[64:67], v7 offset:25600
    v_exp_f32 v167, v167
    v_exp_f32 v168, v168
    v_exp_f32 v169, v169
    v_exp_f32 v170, v170
    v_exp_f32 v171, v171
    v_exp_f32 v172, v172
    v_exp_f32 v173, v173
    v_exp_f32 v174, v174
    v_exp_f32_e64 v175, v175
    v_cvt_pk_bf16_f32 v160, v160, v161
    v_cvt_pk_bf16_f32 v161, v162, v163
    v_cvt_pk_bf16_f32 v162, v164, v165
    v_cvt_pk_bf16_f32 v163, v166, v167
    v_cvt_pk_bf16_f32 v164, v168, v169
    v_cvt_pk_bf16_f32 v165, v170, v171
    v_cvt_pk_bf16_f32 v166, v172, v173
    v_cvt_pk_bf16_f32 v167, v174, v175
    s_waitcnt lgkmcnt(4)
    s_cmp_lt_u32 s59, 4
    s_cbranch_scc1 sk_306
    v_mfma_f32_32x32x16_bf16 v[48:63], v[40:43], v[160:163], v[48:63]
sk_306:
    v_exp_f32 v176, v176
    v_exp_f32 v177, v177
    v_exp_f32 v178, v178
    v_exp_f32 v179, v179
    s_cmp_lt_u32 s59, 4
    s_cbranch_scc1 sk_307
    v_mfma_f32_32x32x16_bf16 v[48:63], v[44:47], v[164:167], v[48:63]
sk_307:
    s_mov_b64 exec, s[96:97]
    ds_read_b128 v[40:43], v7 offset:10240
    ds_read_b128 v[44:47], v7 offset:11264
    s_mov_b64 exec, -1
    v_exp_f32 v180, v180
    v_exp_f32 v181, v181
    v_exp_f32 v182, v182
    v_mfma_f32_32x32x16_bf16 v[144:159], v[92:95], v[16:19], v[192:207]
    ds_read_b128 v[68:71], v7 offset:21504
    v_exp_f32 v183, v183
    v_exp_f32 v184, v184
    v_exp_f32 v185, v185
    v_exp_f32 v186, v186
    v_exp_f32 v187, v187
    v_exp_f32 v188, v188
    v_exp_f32 v189, v189
    v_exp_f32 v190, v190
    v_exp_f32_e64 v191, v191
    v_cvt_pk_bf16_f32 v176, v176, v177
    v_cvt_pk_bf16_f32 v177, v178, v179
    v_cvt_pk_bf16_f32 v178, v180, v181
    v_cvt_pk_bf16_f32 v179, v182, v183
    v_cvt_pk_bf16_f32 v180, v184, v185
    v_cvt_pk_bf16_f32 v181, v186, v187
    v_cvt_pk_bf16_f32 v182, v188, v189
    v_cvt_pk_bf16_f32 v183, v190, v191
    s_waitcnt lgkmcnt(4)
    s_cmp_lt_u32 s59, 5
    s_cbranch_scc1 sk_308
    v_mfma_f32_32x32x16_bf16 v[48:63], v[32:35], v[176:179], v[48:63]
sk_308:
    v_exp_f32 v112, v112
    v_exp_f32 v113, v113
    v_exp_f32 v114, v114
    v_exp_f32 v115, v115
    s_cmp_lt_u32 s59, 5
    s_cbranch_scc1 sk_309
    v_mfma_f32_32x32x16_bf16 v[48:63], v[36:39], v[180:183], v[48:63]
sk_309:
    s_mov_b64 exec, s[96:97]
    ds_read_b128 v[32:35], v7 offset:6144
    ds_read_b128 v[36:39], v7 offset:7168
    s_mov_b64 exec, -1
    v_exp_f32 v116, v116
    v_exp_f32 v117, v117
    v_exp_f32 v118, v118
    v_mfma_f32_32x32x16_bf16 v[160:175], v[96:99], v[20:23], v[208:223]
    ds_read_b128 v[72:75], v7 offset:17408
    v_exp_f32 v119, v119
    v_exp_f32 v120, v120
    v_exp_f32 v121, v121
    v_exp_f32 v122, v122
    v_exp_f32 v123, v123
    v_exp_f32 v124, v124
    v_exp_f32 v125, v125
    v_exp_f32 v126, v126
    v_exp_f32_e64 v127, v127
    v_cvt_pk_bf16_f32 v112, v112, v113
    v_cvt_pk_bf16_f32 v113, v114, v115
    v_cvt_pk_bf16_f32 v114, v116, v117
    v_cvt_pk_bf16_f32 v115, v118, v119
    v_cvt_pk_bf16_f32 v116, v120, v121
    v_cvt_pk_bf16_f32 v117, v122, v123
    v_cvt_pk_bf16_f32 v118, v124, v125
    v_cvt_pk_bf16_f32 v119, v126, v127
    s_waitcnt lgkmcnt(4)
    s_cmp_lt_u32 s59, 6
    s_cbranch_scc1 sk_310
    v_mfma_f32_32x32x16_bf16 v[48:63], v[40:43], v[112:115], v[48:63]
sk_310:
    v_exp_f32 v128, v128
    v_exp_f32 v129, v129
    v_exp_f32 v130, v130
    v_exp_f32 v131, v131
    s_cmp_lt_u32 s59, 6
    s_cbranch_scc1 sk_311
    v_mfma_f32_32x32x16_bf16 v[48:63], v[44:47], v[116:119], v[48:63]
sk_311:
    s_mov_b64 exec, s[96:97]
    ds_read_b128 v[40:43], v7 offset:2048
    ds_read_b128 v[44:47], v7 offset:3072
    s_mov_b64 exec, -1
    v_exp_f32 v132, v132
    v_exp_f32 v133, v133
    v_exp_f32 v134, v134
    v_mfma_f32_32x32x16_bf16 v[176:191], v[64:67], v[20:23], v[208:223]
    ds_read_b128 v[76:79], v7 offset:13312
    v_exp_f32 v135, v135
    v_exp_f32 v136, v136
    v_exp_f32 v137, v137
    v_exp_f32 v138, v138
    v_exp_f32 v139, v139
    v_exp_f32 v140, v140
    v_exp_f32 v141, v141
    v_exp_f32 v142, v142
    v_exp_f32_e64 v143, v143
    v_cvt_pk_bf16_f32 v128, v128, v129
    v_cvt_pk_bf16_f32 v129, v130, v131
    v_cvt_pk_bf16_f32 v130, v132, v133
    v_cvt_pk_bf16_f32 v131, v134, v135
    v_cvt_pk_bf16_f32 v132, v136, v137
    v_cvt_pk_bf16_f32 v133, v138, v139
    v_cvt_pk_bf16_f32 v134, v140, v141
    v_cvt_pk_bf16_f32 v135, v142, v143
    s_waitcnt lgkmcnt(4)
    s_cmp_lt_u32 s59, 7
    s_cbranch_scc1 sk_312
    v_mfma_f32_32x32x16_bf16 v[48:63], v[32:35], v[128:131], v[48:63]
sk_312:
    v_exp_f32 v144, v144
    v_exp_f32 v145, v145
    v_exp_f32 v146, v146
    v_exp_f32 v147, v147
    s_cmp_lt_u32 s59, 7
    s_cbranch_scc1 sk_313
    v_mfma_f32_32x32x16_bf16 v[48:63], v[36:39], v[132:135], v[48:63]
sk_313:
    s_mov_b64 exec, s[96:97]
    ds_read_b128 v[32:35], v7 offset:30976
    ds_read_b128 v[36:39], v7 offset:32000
    s_mov_b64 exec, -1
    v_exp_f32 v148, v148
    v_exp_f32 v149, v149
    v_exp_f32 v150, v150
    v_mfma_f32_32x32x16_bf16 v[112:127], v[68:71], v[20:23], v[208:223]
    ds_read_b128 v[80:83], v7 offset:9216
    v_exp_f32 v151, v151
    v_exp_f32 v152, v152
    v_exp_f32 v153, v153
    v_exp_f32 v154, v154
    v_exp_f32 v155, v155
    v_exp_f32 v156, v156
    v_exp_f32 v157, v157
    v_exp_f32 v158, v158
    v_exp_f32_e64 v159, v159
    v_cvt_pk_bf16_f32 v144, v144, v145
    v_cvt_pk_bf16_f32 v145, v146, v147
    v_cvt_pk_bf16_f32 v146, v148, v149
    v_cvt_pk_bf16_f32 v147, v150, v151
    v_cvt_pk_bf16_f32 v148, v152, v153
    v_cvt_pk_bf16_f32 v149, v154, v155
    v_cvt_pk_bf16_f32 v150, v156, v157
    v_cvt_pk_bf16_f32 v151, v158, v159
    v_bfi_b32 v144, v24, 0, v144
    v_bfi_b32 v145, v25, 0, v145
    v_bfi_b32 v146, v26, 0, v146
    v_bfi_b32 v147, v27, 0, v147
    v_bfi_b32 v148, v28, 0, v148
    v_bfi_b32 v149, v29, 0, v149
    v_bfi_b32 v150, v30, 0, v150
    v_bfi_b32 v151, v31, 0, v151
    s_waitcnt lgkmcnt(4)
    s_cmp_lt_u32 s59, 8
    s_cbranch_scc1 sk_314
    v_mfma_f32_32x32x16_bf16 v[48:63], v[40:43], v[144:147], v[48:63]
sk_314:
    v_exp_f32 v160, v160
    v_exp_f32 v161, v161
    v_exp_f32 v162, v162
    v_exp_f32 v163, v163
    s_cmp_lt_u32 s59, 8
    s_cbranch_scc1 sk_315
    v_mfma_f32_32x32x16_bf16 v[48:63], v[44:47], v[148:151], v[48:63]
sk_315:
    s_mov_b64 exec, s[96:97]
    ds_read_b128 v[40:43], v7 offset:26880
    ds_read_b128 v[44:47], v7 offset:27904
    s_mov_b64 exec, -1
    v_exp_f32 v164, v164
    v_exp_f32 v165, v165
    v_exp_f32 v166, v166
    v_mfma_f32_32x32x16_bf16 v[128:143], v[72:75], v[20:23], v[208:223]
    ds_read_b128 v[84:87], v7 offset:5120
    v_exp_f32 v167, v167
    v_exp_f32 v168, v168
    v_exp_f32 v169, v169
    v_exp_f32 v170, v170
    v_exp_f32 v171, v171
    v_exp_f32 v172, v172
    v_exp_f32 v173, v173
    v_exp_f32 v174, v174
    v_exp_f32_e64 v175, v175
    v_cvt_pk_bf16_f32 v160, v160, v161
    v_cvt_pk_bf16_f32 v161, v162, v163
    v_cvt_pk_bf16_f32 v162, v164, v165
    v_cvt_pk_bf16_f32 v163, v166, v167
    v_cvt_pk_bf16_f32 v164, v168, v169
    v_cvt_pk_bf16_f32 v165, v170, v171
    v_cvt_pk_bf16_f32 v166, v172, v173
    v_cvt_pk_bf16_f32 v167, v174, v175
    s_waitcnt lgkmcnt(4)
    s_cmp_lt_u32 s59, 1
    s_cbranch_scc1 sk_316
    v_mfma_f32_32x32x16_bf16 v[224:239], v[32:35], v[160:163], v[224:239]
sk_316:
    v_rcp_f32 v57, v56
    v_cmp_ngt_f32 vcc, 0x71800000, v56
    s_nop 0
    s_or_b64 s[16:17], s[16:17], vcc
    v_mul_f32 v48, v48, v57
    v_mul_f32 v49, v49, v57
    v_mul_f32 v50, v50, v57
    s_cmp_lt_u32 s59, 1
    s_cbranch_scc1 sk_317
    v_mfma_f32_32x32x16_bf16 v[224:239], v[36:39], v[164:167], v[224:239]
sk_317:
    s_mov_b64 exec, s[96:97]
    ds_read_b128 v[32:35], v7 offset:22784
    ds_read_b128 v[36:39], v7 offset:23808
    s_mov_b64 exec, -1
    v_mul_f32 v51, v51, v57
    v_mul_f32 v52, v52, v57
    v_mul_f32 v53, v53, v57
    v_mul_f32 v54, v54, v57
    v_mul_f32 v55, v55, v57
    v_add_u32 v48, 0x8000, v48
    v_mfma_f32_32x32x16_bf16 v[144:159], v[76:79], v[20:23], v[208:223]
    ds_read_b128 v[88:91], v7 offset:1024
    v_cvt_pk_bf16_f32 v60, v48, v49
    v_cvt_pk_bf16_f32 v61, v50, v51
    v_cvt_pk_bf16_f32 v62, v52, v53
    v_cvt_pk_bf16_f32 v63, v54, v55
    v_and_b32 v60, -2, v60
    s_cmp_eq_u64 s[16:17], 0
    s_cselect_b32 s7, s62, 0x7f000000
    s_cselect_b32 s54, 0x7f000000, s62
    s_cmp_lg_u32 s63, 0
    s_nop 1
    s_cbranch_scc0 fast_318
    buffer_store_dwordx4 v[60:63], v1, s[48:51], s7 offen offset:0
    s_nop 1
dend_319:
    v_exp_f32 v176, v176
    v_exp_f32 v177, v177
    v_exp_f32 v178, v178
    v_exp_f32 v179, v179
    v_exp_f32 v180, v180
    v_exp_f32 v181, v181
    v_exp_f32 v182, v182
    v_exp_f32 v183, v183
    v_exp_f32 v184, v184
    v_exp_f32 v185, v185
    v_exp_f32 v186, v186
    v_exp_f32 v187, v187
    v_exp_f32 v188, v188
    v_exp_f32 v189, v189
    v_exp_f32 v190, v190
    v_exp_f32 v191, v191
    v_cvt_pk_bf16_f32 v176, v176, v177
    v_cvt_pk_bf16_f32 v177, v178, v179
    v_cvt_pk_bf16_f32 v178, v180, v181
    v_cvt_pk_bf16_f32 v179, v182, v183
    v_cvt_pk_bf16_f32 v180, v184, v185
    v_cvt_pk_bf16_f32 v181, v186, v187
    v_cvt_pk_bf16_f32 v182, v188, v189
    v_cvt_pk_bf16_f32 v183, v190, v191
    s_waitcnt lgkmcnt(4)
    s_cmp_lt_u32 s59, 2
    s_cbranch_scc1 sk_320
    v_mfma_f32_32x32x16_bf16 v[224:239], v[40:43], v[176:179], v[224:239]
sk_320:
    v_exp_f32 v112, v112
    v_exp_f32 v113, v113
    v_exp_f32 v114, v114
    v_exp_f32 v115, v115
    s_cmp_lt_u32 s59, 2
    s_cbranch_scc1 sk_321
    v_mfma_f32_32x32x16_bf16 v[224:239], v[44:47], v[180:183], v[224:239]
sk_321:
    s_mov_b64 exec, s[96:97]
    ds_read_b128 v[40:43], v7 offset:18688
    ds_read_b128 v[44:47], v7 offset:19712
    s_mov_b64 exec, -1
    v_exp_f32 v116, v116
    v_exp_f32 v117, v117
    v_exp_f32 v118, v118
    v_mfma_f32_32x32x16_bf16 v[160:175], v[80:83], v[20:23], v[208:223]
    v_exp_f32 v119, v119
    v_exp_f32 v120, v120
    v_exp_f32 v121, v121
    v_exp_f32 v122, v122
    v_exp_f32 v123, v123
    v_exp_f32 v124, v124
    v_exp_f32 v125, v125
    v_exp_f32 v126, v126
    v_exp_f32_e64 v127, v127
    v_cvt_pk_bf16_f32 v112, v112, v113
    v_cvt_pk_bf16_f32 v113, v114, v115
    v_cvt_pk_bf16_f32 v114, v116, v117
    v_cvt_pk_bf16_f32 v115, v118, v119
    v_cvt_pk_bf16_f32 v116, v120, v121
    v_cvt_pk_bf16_f32 v117, v122, v123
    v_cvt_pk_bf16_f32 v118, v124, v125
    v_cvt_pk_bf16_f32 v119, v126, v127
    s_waitcnt lgkmcnt(3)
    s_cmp_lt_u32 s59, 3
    s_cbranch_scc1 sk_322
    v_mfma_f32_32x32x16_bf16 v[224:239], v[32:35], v[112:115], v[224:239]
sk_322:
    v_exp_f32 v128, v128
    v_exp_f32 v129, v129
    v_exp_f32 v130, v130
    v_exp_f32 v131, v131
    s_cmp_lt_u32 s59, 3
    s_cbranch_scc1 sk_323
    v_mfma_f32_32x32x16_bf16 v[224:239], v[36:39], v[116:119], v[224:239]
sk_323:
    s_mov_b64 exec, s[96:97]
    ds_read_b128 v[32:35], v7 offset:14592
    ds_read_b128 v[36:39], v7 offset:15616
    s_mov_b64 exec, -1
    v_exp_f32 v132, v132
    v_exp_f32 v133, v133
    v_exp_f32 v134, v134
    v_mfma_f32_32x32x16_bf16 v[176:191], v[84:87], v[20:23], v[208:223]
    v_exp_f32 v135, v135
    v_exp_f32 v136, v136
    v_exp_f32 v137, v137
    v_exp_f32 v138, v138
    v_exp_f32 v139, v139
    v_exp_f32 v140, v140
    v_exp_f32 v141, v141
    v_exp_f32 v142, v142
    v_exp_f32_e64 v143, v143
    v_cvt_pk_bf16_f32 v128, v128, v129
    v_cvt_pk_bf16_f32 v129, v130, v131
    v_cvt_pk_bf16_f32 v130, v132, v133
    v_cvt_pk_bf16_f32 v131, v134, v135
    v_cvt_pk_bf16_f32 v132, v136, v137
    v_cvt_pk_bf16_f32 v133, v138, v139
    v_cvt_pk_bf16_f32 v134, v140, v141
    v_cvt_pk_bf16_f32 v135, v142, v143
    s_waitcnt lgkmcnt(2)
    s_cmp_lt_u32 s59, 4
    s_cbranch_scc1 sk_324
    v_mfma_f32_32x32x16_bf16 v[224:239], v[40:43], v[128:131], v[224:239]
sk_324:
    v_exp_f32 v144, v144
    v_exp_f32 v145, v145
    v_exp_f32 v146, v146
    v_exp_f32 v147, v147
    s_cmp_lt_u32 s59, 4
    s_cbranch_scc1 sk_325
    v_mfma_f32_32x32x16_bf16 v[224:239], v[44:47], v[132:135], v[224:239]
sk_325:
    s_mov_b64 exec, s[96:97]
    ds_read_b128 v[40:43], v7 offset:10496
    ds_read_b128 v[44:47], v7 offset:11520
    s_mov_b64 exec, -1
    v_exp_f32 v148, v148
    v_exp_f32 v149, v149
    v_exp_f32 v150, v150
    v_mfma_f32_32x32x16_bf16 v[112:127], v[88:91], v[20:23], v[208:223]
    v_exp_f32 v151, v151
    v_exp_f32 v152, v152
    v_exp_f32 v153, v153
    v_exp_f32 v154, v154
    v_exp_f32 v155, v155
    v_exp_f32 v156, v156
    v_exp_f32 v157, v157
    v_exp_f32 v158, v158
    v_exp_f32_e64 v159, v159
    v_cvt_pk_bf16_f32 v144, v144, v145
    v_cvt_pk_bf16_f32 v145, v146, v147
    v_cvt_pk_bf16_f32 v146, v148, v149
    v_cvt_pk_bf16_f32 v147, v150, v151
    v_cvt_pk_bf16_f32 v148, v152, v153
    v_cvt_pk_bf16_f32 v149, v154, v155
    v_cvt_pk_bf16_f32 v150, v156, v157
    v_cvt_pk_bf16_f32 v151, v158, v159
    s_waitcnt lgkmcnt(2)
    s_cmp_lt_u32 s59, 5
    s_cbranch_scc1 sk_326
    v_mfma_f32_32x32x16_bf16 v[224:239], v[32:35], v[144:147], v[224:239]
sk_326:
    v_exp_f32 v160, v160
    v_exp_f32 v161, v161
    v_exp_f32 v162, v162
    v_exp_f32 v163, v163
    s_cmp_lt_u32 s59, 5
    s_cbranch_scc1 sk_327
    v_mfma_f32_32x32x16_bf16 v[224:239], v[36:39], v[148:151], v[224:239]
sk_327:
    s_mov_b64 exec, s[96:97]
    ds_read_b128 v[32:35], v7 offset:6400
    ds_read_b128 v[36:39], v7 offset:7424
    s_mov_b64 exec, -1
    v_exp_f32 v164, v164
    v_exp_f32 v165, v165
    v_exp_f32 v166, v166
    v_exp_f32 v167, v167
    v_exp_f32 v168, v168
    v_exp_f32 v169, v169
    v_exp_f32 v170, v170
    v_exp_f32 v171, v171
    v_exp_f32 v172, v172
    v_exp_f32 v173, v173
    v_exp_f32 v174, v174
    v_exp_f32_e64 v175, v175
    v_cvt_pk_bf16_f32 v160, v160, v161
    v_cvt_pk_bf16_f32 v161, v162, v163
    v_cvt_pk_bf16_f32 v162, v164, v165
    v_cvt_pk_bf16_f32 v163, v166, v167
    v_cvt_pk_bf16_f32 v164, v168, v169
    v_cvt_pk_bf16_f32 v165, v170, v171
    v_cvt_pk_bf16_f32 v166, v172, v173
    v_cvt_pk_bf16_f32 v167, v174, v175
    s_waitcnt lgkmcnt(2)
    s_cmp_lt_u32 s59, 6
    s_cbranch_scc1 sk_328
    v_mfma_f32_32x32x16_bf16 v[224:239], v[40:43], v[160:163], v[224:239]
sk_328:
    v_exp_f32 v176, v176
    v_exp_f32 v177, v177
    v_exp_f32 v178, v178
    v_exp_f32 v179, v179
    s_cmp_lt_u32 s59, 6
    s_cbranch_scc1 sk_329
    v_mfma_f32_32x32x16_bf16 v[224:239], v[44:47], v[164:167], v[224:239]
sk_329:
    s_mov_b64 exec, s[96:97]
    ds_read_b128 v[40:43], v7 offset:2304
    ds_read_b128 v[44:47], v7 offset:3328
    s_mov_b64 exec, -1
    v_exp_f32 v180, v180
    v_exp_f32 v181, v181
    v_exp_f32 v182, v182
    v_exp_f32 v183, v183
    v_exp_f32 v184, v184
    v_exp_f32 v185, v185
    v_exp_f32 v186, v186
    v_exp_f32 v187, v187
    v_exp_f32 v188, v188
    v_exp_f32 v189, v189
    v_exp_f32 v190, v190
    v_exp_f32_e64 v191, v191
    v_cvt_pk_bf16_f32 v176, v176, v177
    v_cvt_pk_bf16_f32 v177, v178, v179
    v_cvt_pk_bf16_f32 v178, v180, v181
    v_cvt_pk_bf16_f32 v179, v182, v183
    v_cvt_pk_bf16_f32 v180, v184, v185
    v_cvt_pk_bf16_f32 v181, v186, v187
    v_cvt_pk_bf16_f32 v182, v188, v189
    v_cvt_pk_bf16_f32 v183, v190, v191
    s_waitcnt lgkmcnt(2)
    s_cmp_lt_u32 s59, 7
    s_cbranch_scc1 sk_330
    v_mfma_f32_32x32x16_bf16 v[224:239], v[32:35], v[176:179], v[224:239]
sk_330:
    v_exp_f32 v112, v112
    v_exp_f32 v113, v113
    v_exp_f32 v114, v114
    v_exp_f32 v115, v115
    s_cmp_lt_u32 s59, 7
    s_cbranch_scc1 sk_331
    v_mfma_f32_32x32x16_bf16 v[224:239], v[36:39], v[180:183], v[224:239]
sk_331:
    v_exp_f32 v116, v116
    v_exp_f32 v117, v117
    v_exp_f32 v118, v118
    v_exp_f32 v119, v119
    v_exp_f32 v120, v120
    v_exp_f32 v121, v121
    v_exp_f32 v122, v122
    v_exp_f32 v123, v123
    v_exp_f32 v124, v124
    v_exp_f32 v125, v125
    v_exp_f32 v126, v126
    v_exp_f32_e64 v127, v127
    v_cvt_pk_bf16_f32 v112, v112, v113
    v_cvt_pk_bf16_f32 v113, v114, v115
    v_cvt_pk_bf16_f32 v114, v116, v117
    v_cvt_pk_bf16_f32 v115, v118, v119
    v_cvt_pk_bf16_f32 v116, v120, v121
    v_cvt_pk_bf16_f32 v117, v122, v123
    v_cvt_pk_bf16_f32 v118, v124, v125
    v_cvt_pk_bf16_f32 v119, v126, v127
    v_bfi_b32 v112, v24, 0, v112
    v_bfi_b32 v113, v25, 0, v113
    v_bfi_b32 v114, v26, 0, v114
    v_bfi_b32 v115, v27, 0, v115
    v_bfi_b32 v116, v28, 0, v116
    v_bfi_b32 v117, v29, 0, v117
    v_bfi_b32 v118, v30, 0, v118
    v_bfi_b32 v119, v31, 0, v119
    s_waitcnt lgkmcnt(0)
    s_cmp_lt_u32 s59, 8
    s_cbranch_scc1 sk_332
    v_mfma_f32_32x32x16_bf16 v[224:239], v[40:43], v[112:115], v[224:239]
sk_332:
    s_cmp_lt_u32 s59, 8
    s_cbranch_scc1 sk_333
    v_mfma_f32_32x32x16_bf16 v[224:239], v[44:47], v[116:119], v[224:239]
sk_333:
    s_nop 11
    v_rcp_f32 v233, v232
    v_cmp_ngt_f32 vcc, 0x71800000, v232
    s_nop 0
    s_or_b64 s[16:17], s[16:17], vcc
    v_mul_f32 v224, v224, v233
    v_mul_f32 v225, v225, v233
    v_mul_f32 v226, v226, v233
    v_mul_f32 v227, v227, v233
    v_mul_f32 v228, v228, v233
    v_mul_f32 v229, v229, v233
    v_mul_f32 v230, v230, v233
    v_mul_f32_e64 v231, v231, v233
    v_add_u32 v224, 0x8000, v224
    v_cvt_pk_bf16_f32 v236, v224, v225
    v_cvt_pk_bf16_f32 v237, v226, v227
    v_cvt_pk_bf16_f32 v238, v228, v229
    v_cvt_pk_bf16_f32 v239, v230, v231
    v_and_b32 v236, -2, v236
    s_cmp_eq_u64 s[16:17], 0
    s_cselect_b32 s7, s62, 0x7f000000
    s_cmp_lg_u32 s63, 0
    s_cbranch_scc0 fast_334
    buffer_store_dwordx4 v[236:239], v1, s[48:51], s7 offen offset:1024
    s_nop 1
dend_335:
    s_branch ajoin_297
fast_336:
    buffer_store_dwordx4 v[60:63], v1, s[48:51], s7 offen offset:0 sc0 sc1
    s_nop 1
    s_branch dend_337
fast_338:
    buffer_store_dwordx4 v[236:239], v1, s[48:51], s7 offen offset:1024 sc0 sc1
    s_nop 1
    s_branch dend_339
fast_341:
    buffer_store_dwordx4 v[60:63], v1, s[48:51], s7 offen offset:0 sc0 sc1
    s_nop 1
    s_branch dend_342
fast_344:
    buffer_store_dwordx4 v[60:63], v1, s[48:51], s7 offen offset:1024 sc0 sc1
    s_nop 0
    s_nop 0
    s_branch dend_345
aslow_298:
    s_waitcnt vmcnt(0) lgkmcnt(0)
    ds_read_b128 v[64:67], v7 offset:0
    ds_read_b128 v[68:71], v7 offset:4096
    ds_read_b128 v[72:75], v7 offset:8192
    ds_read_b128 v[76:79], v7 offset:12288
    ds_read_b128 v[80:83], v7 offset:16384
    ds_read_b128 v[84:87], v7 offset:20480
    ds_read_b128 v[88:91], v7 offset:24576
    ds_read_b128 v[92:95], v7 offset:28672
    ds_read_b128 v[96:99], v7 offset:32768
    s_mov_b64 exec, s[96:97]
    ds_read_b128 v[32:35], v7 offset:34816
    ds_read_b128 v[36:39], v7 offset:35840
    s_mov_b64 exec, -1
    s_mov_b64 exec, s[96:97]
    ds_read_b128 v[40:43], v7 offset:2048
    ds_read_b128 v[44:47], v7 offset:3072
    s_mov_b64 exec, -1
    s_waitcnt lgkmcnt(0)
    v_mfma_f32_32x32x16_bf16 v[112:127], v[64:67], v[16:19], 0
    v_mfma_f32_32x32x16_bf16 v[128:143], v[68:71], v[16:19], 0
    v_mfma_f32_32x32x16_bf16 v[144:159], v[72:75], v[16:19], 0
    v_mfma_f32_32x32x16_bf16 v[160:175], v[76:79], v[16:19], 0
    v_mfma_f32_32x32x16_bf16 v[176:191], v[80:83], v[16:19], 0
    v_mfma_f32_32x32x16_bf16 v[192:207], v[84:87], v[16:19], 0
    v_mfma_f32_32x32x16_bf16 v[208:223], v[88:91], v[16:19], 0
    v_mfma_f32_32x32x16_bf16 v[224:239], v[92:95], v[16:19], 0
    v_mfma_f32_32x32x16_bf16 v[240:255], v[96:99], v[16:19], 0
    s_cmp_ge_u32 s59, 8
    s_nop 10
    s_cbranch_scc1 valid_340
    v_mov_b32 v112, 0xff800000
    v_mov_b32 v113, 0xff800000
    v_mov_b32 v114, 0xff800000
    v_mov_b32 v115, 0xff800000
    v_mov_b32 v116, 0xff800000
    v_mov_b32 v117, 0xff800000
    v_mov_b32 v118, 0xff800000
    v_mov_b32 v119, 0xff800000
    v_mov_b32 v120, 0xff800000
    v_mov_b32 v121, 0xff800000
    v_mov_b32 v122, 0xff800000
    v_mov_b32 v123, 0xff800000
    v_mov_b32 v124, 0xff800000
    v_mov_b32 v125, 0xff800000
    v_mov_b32 v126, 0xff800000
    v_mov_b32 v127, 0xff800000
    s_cmp_ge_u32 s59, 7
    s_nop 0
    s_cbranch_scc1 valid_340
    v_mov_b32 v128, 0xff800000
    v_mov_b32 v129, 0xff800000
    v_mov_b32 v130, 0xff800000
    v_mov_b32 v131, 0xff800000
    v_mov_b32 v132, 0xff800000
    v_mov_b32 v133, 0xff800000
    v_mov_b32 v134, 0xff800000
    v_mov_b32 v135, 0xff800000
    v_mov_b32 v136, 0xff800000
    v_mov_b32 v137, 0xff800000
    v_mov_b32 v138, 0xff800000
    v_mov_b32 v139, 0xff800000
    v_mov_b32 v140, 0xff800000
    v_mov_b32 v141, 0xff800000
    v_mov_b32 v142, 0xff800000
    v_mov_b32 v143, 0xff800000
    s_cmp_ge_u32 s59, 6
    s_nop 0
    s_cbranch_scc1 valid_340
    v_mov_b32 v144, 0xff800000
    v_mov_b32 v145, 0xff800000
    v_mov_b32 v146, 0xff800000
    v_mov_b32 v147, 0xff800000
    v_mov_b32 v148, 0xff800000
    v_mov_b32 v149, 0xff800000
    v_mov_b32 v150, 0xff800000
    v_mov_b32 v151, 0xff800000
    v_mov_b32 v152, 0xff800000
    v_mov_b32 v153, 0xff800000
    v_mov_b32 v154, 0xff800000
    v_mov_b32 v155, 0xff800000
    v_mov_b32 v156, 0xff800000
    v_mov_b32 v157, 0xff800000
    v_mov_b32 v158, 0xff800000
    v_mov_b32 v159, 0xff800000
    s_cmp_ge_u32 s59, 5
    s_nop 0
    s_cbranch_scc1 valid_340
    v_mov_b32 v160, 0xff800000
    v_mov_b32 v161, 0xff800000
    v_mov_b32 v162, 0xff800000
    v_mov_b32 v163, 0xff800000
    v_mov_b32 v164, 0xff800000
    v_mov_b32 v165, 0xff800000
    v_mov_b32 v166, 0xff800000
    v_mov_b32 v167, 0xff800000
    v_mov_b32 v168, 0xff800000
    v_mov_b32 v169, 0xff800000
    v_mov_b32 v170, 0xff800000
    v_mov_b32 v171, 0xff800000
    v_mov_b32 v172, 0xff800000
    v_mov_b32 v173, 0xff800000
    v_mov_b32 v174, 0xff800000
    v_mov_b32 v175, 0xff800000
    s_cmp_ge_u32 s59, 4
    s_nop 0
    s_cbranch_scc1 valid_340
    v_mov_b32 v176, 0xff800000
    v_mov_b32 v177, 0xff800000
    v_mov_b32 v178, 0xff800000
    v_mov_b32 v179, 0xff800000
    v_mov_b32 v180, 0xff800000
    v_mov_b32 v181, 0xff800000
    v_mov_b32 v182, 0xff800000
    v_mov_b32 v183, 0xff800000
    v_mov_b32 v184, 0xff800000
    v_mov_b32 v185, 0xff800000
    v_mov_b32 v186, 0xff800000
    v_mov_b32 v187, 0xff800000
    v_mov_b32 v188, 0xff800000
    v_mov_b32 v189, 0xff800000
    v_mov_b32 v190, 0xff800000
    v_mov_b32 v191, 0xff800000
    s_cmp_ge_u32 s59, 3
    s_nop 0
    s_cbranch_scc1 valid_340
    v_mov_b32 v192, 0xff800000
    v_mov_b32 v193, 0xff800000
    v_mov_b32 v194, 0xff800000
    v_mov_b32 v195, 0xff800000
    v_mov_b32 v196, 0xff800000
    v_mov_b32 v197, 0xff800000
    v_mov_b32 v198, 0xff800000
    v_mov_b32 v199, 0xff800000
    v_mov_b32 v200, 0xff800000
    v_mov_b32 v201, 0xff800000
    v_mov_b32 v202, 0xff800000
    v_mov_b32 v203, 0xff800000
    v_mov_b32 v204, 0xff800000
    v_mov_b32 v205, 0xff800000
    v_mov_b32 v206, 0xff800000
    v_mov_b32 v207, 0xff800000
    s_cmp_ge_u32 s59, 2
    s_nop 0
    s_cbranch_scc1 valid_340
    v_mov_b32 v208, 0xff800000
    v_mov_b32 v209, 0xff800000
    v_mov_b32 v210, 0xff800000
    v_mov_b32 v211, 0xff800000
    v_mov_b32 v212, 0xff800000
    v_mov_b32 v213, 0xff800000
    v_mov_b32 v214, 0xff800000
    v_mov_b32 v215, 0xff800000
    v_mov_b32 v216, 0xff800000
    v_mov_b32 v217, 0xff800000
    v_mov_b32 v218, 0xff800000
    v_mov_b32 v219, 0xff800000
    v_mov_b32 v220, 0xff800000
    v_mov_b32 v221, 0xff800000
    v_mov_b32 v222, 0xff800000
    v_mov_b32 v223, 0xff800000
    s_cmp_ge_u32 s59, 1
    s_nop 0
    s_cbranch_scc1 valid_340
    v_mov_b32 v224, 0xff800000
    v_mov_b32 v225, 0xff800000
    v_mov_b32 v226, 0xff800000
    v_mov_b32 v227, 0xff800000
    v_mov_b32 v228, 0xff800000
    v_mov_b32 v229, 0xff800000
    v_mov_b32 v230, 0xff800000
    v_mov_b32 v231, 0xff800000
    v_mov_b32 v232, 0xff800000
    v_mov_b32 v233, 0xff800000
    v_mov_b32 v234, 0xff800000
    v_mov_b32 v235, 0xff800000
    v_mov_b32 v236, 0xff800000
    v_mov_b32 v237, 0xff800000
    v_mov_b32 v238, 0xff800000
    v_mov_b32 v239, 0xff800000
    s_nop 1
valid_340:
    v_cndmask_b32 v240, v112, v240, s[64:65]
    v_cndmask_b32 v241, v113, v241, s[66:67]
    v_cndmask_b32 v242, v114, v242, s[68:69]
    v_cndmask_b32 v243, v115, v243, s[70:71]
    v_cndmask_b32 v244, v116, v244, s[72:73]
    v_cndmask_b32 v245, v117, v245, s[74:75]
    v_cndmask_b32 v246, v118, v246, s[76:77]
    v_cndmask_b32 v247, v119, v247, s[78:79]
    v_cndmask_b32 v248, v120, v248, s[80:81]
    v_cndmask_b32 v249, v121, v249, s[82:83]
    v_cndmask_b32 v250, v122, v250, s[84:85]
    v_cndmask_b32 v251, v123, v251, s[86:87]
    v_cndmask_b32 v252, v124, v252, s[88:89]
    v_cndmask_b32 v253, v125, v253, s[90:91]
    v_cndmask_b32 v254, v126, v254, s[92:93]
    v_cndmask_b32 v255, v127, v255, s[94:95]
    v_max_f32 v108, v240, v241
    v_max_f32 v109, v242, v243
    v_max3_f32 v108, v108, v244, v245
    v_max3_f32 v109, v109, v246, v247
    v_max3_f32 v108, v108, v248, v249
    v_max3_f32 v109, v109, v250, v251
    v_max3_f32 v108, v108, v252, v253
    v_max3_f32 v109, v109, v254, v255
    v_max3_f32 v108, v108, v128, v129
    v_max3_f32 v109, v109, v130, v131
    v_max3_f32 v108, v108, v132, v133
    v_max3_f32 v109, v109, v134, v135
    v_max3_f32 v108, v108, v136, v137
    v_max3_f32 v109, v109, v138, v139
    v_max3_f32 v108, v108, v140, v141
    v_max3_f32 v109, v109, v142, v143
    v_max3_f32 v108, v108, v144, v145
    v_max3_f32 v109, v109, v146, v147
    v_max3_f32 v108, v108, v148, v149
    v_max3_f32 v109, v109, v150, v151
    v_max3_f32 v108, v108, v152, v153
    v_max3_f32 v109, v109, v154, v155
    v_max3_f32 v108, v108, v156, v157
    v_max3_f32 v109, v109, v158, v159
    v_max3_f32 v108, v108, v160, v161
    v_max3_f32 v109, v109, v162, v163
    v_max3_f32 v108, v108, v164, v165
    v_max3_f32 v109, v109, v166, v167
    v_max3_f32 v108, v108, v168, v169
    v_max3_f32 v109, v109, v170, v171
    v_max3_f32 v108, v108, v172, v173
    v_max3_f32 v109, v109, v174, v175
    v_max3_f32 v108, v108, v176, v177
    v_max3_f32 v109, v109, v178, v179
    v_max3_f32 v108, v108, v180, v181
    v_max3_f32 v109, v109, v182, v183
    v_max3_f32 v108, v108, v184, v185
    v_max3_f32 v109, v109, v186, v187
    v_max3_f32 v108, v108, v188, v189
    v_max3_f32 v109, v109, v190, v191
    v_max3_f32 v108, v108, v192, v193
    v_max3_f32 v109, v109, v194, v195
    v_max3_f32 v108, v108, v196, v197
    v_max3_f32 v109, v109, v198, v199
    v_max3_f32 v108, v108, v200, v201
    v_max3_f32 v109, v109, v202, v203
    v_max3_f32 v108, v108, v204, v205
    v_max3_f32 v109, v109, v206, v207
    v_max3_f32 v108, v108, v208, v209
    v_max3_f32 v109, v109, v210, v211
    v_max3_f32 v108, v108, v212, v213
    v_max3_f32 v109, v109, v214, v215
    v_max3_f32 v108, v108, v216, v217
    v_max3_f32 v109, v109, v218, v219
    v_max3_f32 v108, v108, v220, v221
    v_max3_f32 v109, v109, v222, v223
    v_max3_f32 v108, v108, v224, v225
    v_max3_f32 v109, v109, v226, v227
    v_max3_f32 v108, v108, v228, v229
    v_max3_f32 v109, v109, v230, v231
    v_max3_f32 v108, v108, v232, v233
    v_max3_f32 v109, v109, v234, v235
    v_max3_f32 v108, v108, v236, v237
    v_max3_f32 v109, v109, v238, v239
    v_max_f32 v108, v108, v109
    v_mov_b32 v109, v108
    s_nop 1
    v_permlane32_swap_b32 v109, v108
    v_max_f32 v108, v108, v109
    v_sub_f32 v108, 0, v108
    v_pk_add_f32 v[128:129], v[128:129], v[108:109] op_sel_hi:[1,0]
    v_pk_add_f32 v[130:131], v[130:131], v[108:109] op_sel_hi:[1,0]
    v_pk_add_f32 v[132:133], v[132:133], v[108:109] op_sel_hi:[1,0]
    v_pk_add_f32 v[134:135], v[134:135], v[108:109] op_sel_hi:[1,0]
    v_pk_add_f32 v[136:137], v[136:137], v[108:109] op_sel_hi:[1,0]
    v_pk_add_f32 v[138:139], v[138:139], v[108:109] op_sel_hi:[1,0]
    v_pk_add_f32 v[140:141], v[140:141], v[108:109] op_sel_hi:[1,0]
    v_pk_add_f32 v[142:143], v[142:143], v[108:109] op_sel_hi:[1,0]
    v_exp_f32 v128, v128
    v_exp_f32 v129, v129
    v_exp_f32 v130, v130
    v_exp_f32 v131, v131
    v_exp_f32 v132, v132
    v_exp_f32 v133, v133
    v_exp_f32 v134, v134
    v_exp_f32 v135, v135
    v_exp_f32 v136, v136
    v_exp_f32 v137, v137
    v_exp_f32 v138, v138
    v_exp_f32 v139, v139
    v_exp_f32 v140, v140
    v_exp_f32 v141, v141
    v_exp_f32 v142, v142
    v_exp_f32 v143, v143
    v_cvt_pk_bf16_f32 v128, v128, v129
    v_cvt_pk_bf16_f32 v129, v130, v131
    v_cvt_pk_bf16_f32 v130, v132, v133
    v_cvt_pk_bf16_f32 v131, v134, v135
    v_cvt_pk_bf16_f32 v132, v136, v137
    v_cvt_pk_bf16_f32 v133, v138, v139
    v_cvt_pk_bf16_f32 v134, v140, v141
    v_cvt_pk_bf16_f32 v135, v142, v143
    v_pk_add_f32 v[144:145], v[144:145], v[108:109] op_sel_hi:[1,0]
    v_pk_add_f32 v[146:147], v[146:147], v[108:109] op_sel_hi:[1,0]
    v_pk_add_f32 v[148:149], v[148:149], v[108:109] op_sel_hi:[1,0]
    v_pk_add_f32 v[150:151], v[150:151], v[108:109] op_sel_hi:[1,0]
    v_pk_add_f32 v[152:153], v[152:153], v[108:109] op_sel_hi:[1,0]
    v_pk_add_f32 v[154:155], v[154:155], v[108:109] op_sel_hi:[1,0]
    v_pk_add_f32 v[156:157], v[156:157], v[108:109] op_sel_hi:[1,0]
    v_pk_add_f32 v[158:159], v[158:159], v[108:109] op_sel_hi:[1,0]
    v_exp_f32 v144, v144
    v_exp_f32 v145, v145
    v_exp_f32 v146, v146
    v_exp_f32 v147, v147
    v_exp_f32 v148, v148
    v_exp_f32 v149, v149
    v_exp_f32 v150, v150
    v_exp_f32 v151, v151
    v_exp_f32 v152, v152
    v_exp_f32 v153, v153
    v_exp_f32 v154, v154
    v_exp_f32 v155, v155
    v_exp_f32 v156, v156
    v_exp_f32 v157, v157
    v_exp_f32 v158, v158
    v_exp_f32 v159, v159
    v_cvt_pk_bf16_f32 v144, v144, v145
    v_cvt_pk_bf16_f32 v145, v146, v147
    v_cvt_pk_bf16_f32 v146, v148, v149
    v_cvt_pk_bf16_f32 v147, v150, v151
    v_cvt_pk_bf16_f32 v148, v152, v153
    v_cvt_pk_bf16_f32 v149, v154, v155
    v_cvt_pk_bf16_f32 v150, v156, v157
    v_cvt_pk_bf16_f32 v151, v158, v159
    v_pk_add_f32 v[160:161], v[160:161], v[108:109] op_sel_hi:[1,0]
    v_pk_add_f32 v[162:163], v[162:163], v[108:109] op_sel_hi:[1,0]
    v_pk_add_f32 v[164:165], v[164:165], v[108:109] op_sel_hi:[1,0]
    v_pk_add_f32 v[166:167], v[166:167], v[108:109] op_sel_hi:[1,0]
    v_pk_add_f32 v[168:169], v[168:169], v[108:109] op_sel_hi:[1,0]
    v_pk_add_f32 v[170:171], v[170:171], v[108:109] op_sel_hi:[1,0]
    v_pk_add_f32 v[172:173], v[172:173], v[108:109] op_sel_hi:[1,0]
    v_pk_add_f32 v[174:175], v[174:175], v[108:109] op_sel_hi:[1,0]
    v_exp_f32 v160, v160
    v_exp_f32 v161, v161
    v_exp_f32 v162, v162
    v_exp_f32 v163, v163
    v_exp_f32 v164, v164
    v_exp_f32 v165, v165
    v_exp_f32 v166, v166
    v_exp_f32 v167, v167
    v_exp_f32 v168, v168
    v_exp_f32 v169, v169
    v_exp_f32 v170, v170
    v_exp_f32 v171, v171
    v_exp_f32 v172, v172
    v_exp_f32 v173, v173
    v_exp_f32 v174, v174
    v_exp_f32 v175, v175
    v_cvt_pk_bf16_f32 v160, v160, v161
    v_cvt_pk_bf16_f32 v161, v162, v163
    v_cvt_pk_bf16_f32 v162, v164, v165
    v_cvt_pk_bf16_f32 v163, v166, v167
    v_cvt_pk_bf16_f32 v164, v168, v169
    v_cvt_pk_bf16_f32 v165, v170, v171
    v_cvt_pk_bf16_f32 v166, v172, v173
    v_cvt_pk_bf16_f32 v167, v174, v175
    v_pk_add_f32 v[176:177], v[176:177], v[108:109] op_sel_hi:[1,0]
    v_pk_add_f32 v[178:179], v[178:179], v[108:109] op_sel_hi:[1,0]
    v_pk_add_f32 v[180:181], v[180:181], v[108:109] op_sel_hi:[1,0]
    v_pk_add_f32 v[182:183], v[182:183], v[108:109] op_sel_hi:[1,0]
    v_pk_add_f32 v[184:185], v[184:185], v[108:109] op_sel_hi:[1,0]
    v_pk_add_f32 v[186:187], v[186:187], v[108:109] op_sel_hi:[1,0]
    v_pk_add_f32 v[188:189], v[188:189], v[108:109] op_sel_hi:[1,0]
    v_pk_add_f32 v[190:191], v[190:191], v[108:109] op_sel_hi:[1,0]
    v_exp_f32 v176, v176
    v_exp_f32 v177, v177
    v_exp_f32 v178, v178
    v_exp_f32 v179, v179
    v_exp_f32 v180, v180
    v_exp_f32 v181, v181
    v_exp_f32 v182, v182
    v_exp_f32 v183, v183
    v_exp_f32 v184, v184
    v_exp_f32 v185, v185
    v_exp_f32 v186, v186
    v_exp_f32 v187, v187
    v_exp_f32 v188, v188
    v_exp_f32 v189, v189
    v_exp_f32 v190, v190
    v_exp_f32 v191, v191
    v_cvt_pk_bf16_f32 v176, v176, v177
    v_cvt_pk_bf16_f32 v177, v178, v179
    v_cvt_pk_bf16_f32 v178, v180, v181
    v_cvt_pk_bf16_f32 v179, v182, v183
    v_cvt_pk_bf16_f32 v180, v184, v185
    v_cvt_pk_bf16_f32 v181, v186, v187
    v_cvt_pk_bf16_f32 v182, v188, v189
    v_cvt_pk_bf16_f32 v183, v190, v191
    v_pk_add_f32 v[192:193], v[192:193], v[108:109] op_sel_hi:[1,0]
    v_pk_add_f32 v[194:195], v[194:195], v[108:109] op_sel_hi:[1,0]
    v_pk_add_f32 v[196:197], v[196:197], v[108:109] op_sel_hi:[1,0]
    v_pk_add_f32 v[198:199], v[198:199], v[108:109] op_sel_hi:[1,0]
    v_pk_add_f32 v[200:201], v[200:201], v[108:109] op_sel_hi:[1,0]
    v_pk_add_f32 v[202:203], v[202:203], v[108:109] op_sel_hi:[1,0]
    v_pk_add_f32 v[204:205], v[204:205], v[108:109] op_sel_hi:[1,0]
    v_pk_add_f32 v[206:207], v[206:207], v[108:109] op_sel_hi:[1,0]
    v_exp_f32 v192, v192
    v_exp_f32 v193, v193
    v_exp_f32 v194, v194
    v_exp_f32 v195, v195
    v_exp_f32 v196, v196
    v_exp_f32 v197, v197
    v_exp_f32 v198, v198
    v_exp_f32 v199, v199
    v_exp_f32 v200, v200
    v_exp_f32 v201, v201
    v_exp_f32 v202, v202
    v_exp_f32 v203, v203
    v_exp_f32 v204, v204
    v_exp_f32 v205, v205
    v_exp_f32 v206, v206
    v_exp_f32 v207, v207
    v_cvt_pk_bf16_f32 v192, v192, v193
    v_cvt_pk_bf16_f32 v193, v194, v195
    v_cvt_pk_bf16_f32 v194, v196, v197
    v_cvt_pk_bf16_f32 v195, v198, v199
    v_cvt_pk_bf16_f32 v196, v200, v201
    v_cvt_pk_bf16_f32 v197, v202, v203
    v_cvt_pk_bf16_f32 v198, v204, v205
    v_cvt_pk_bf16_f32 v199, v206, v207
    v_pk_add_f32 v[208:209], v[208:209], v[108:109] op_sel_hi:[1,0]
    v_pk_add_f32 v[210:211], v[210:211], v[108:109] op_sel_hi:[1,0]
    v_pk_add_f32 v[212:213], v[212:213], v[108:109] op_sel_hi:[1,0]
    v_pk_add_f32 v[214:215], v[214:215], v[108:109] op_sel_hi:[1,0]
    v_pk_add_f32 v[216:217], v[216:217], v[108:109] op_sel_hi:[1,0]
    v_pk_add_f32 v[218:219], v[218:219], v[108:109] op_sel_hi:[1,0]
    v_pk_add_f32 v[220:221], v[220:221], v[108:109] op_sel_hi:[1,0]
    v_pk_add_f32 v[222:223], v[222:223], v[108:109] op_sel_hi:[1,0]
    v_exp_f32 v208, v208
    v_exp_f32 v209, v209
    v_exp_f32 v210, v210
    v_exp_f32 v211, v211
    v_exp_f32 v212, v212
    v_exp_f32 v213, v213
    v_exp_f32 v214, v214
    v_exp_f32 v215, v215
    v_exp_f32 v216, v216
    v_exp_f32 v217, v217
    v_exp_f32 v218, v218
    v_exp_f32 v219, v219
    v_exp_f32 v220, v220
    v_exp_f32 v221, v221
    v_exp_f32 v222, v222
    v_exp_f32 v223, v223
    v_cvt_pk_bf16_f32 v208, v208, v209
    v_cvt_pk_bf16_f32 v209, v210, v211
    v_cvt_pk_bf16_f32 v210, v212, v213
    v_cvt_pk_bf16_f32 v211, v214, v215
    v_cvt_pk_bf16_f32 v212, v216, v217
    v_cvt_pk_bf16_f32 v213, v218, v219
    v_cvt_pk_bf16_f32 v214, v220, v221
    v_cvt_pk_bf16_f32 v215, v222, v223
    v_pk_add_f32 v[224:225], v[224:225], v[108:109] op_sel_hi:[1,0]
    v_pk_add_f32 v[226:227], v[226:227], v[108:109] op_sel_hi:[1,0]
    v_pk_add_f32 v[228:229], v[228:229], v[108:109] op_sel_hi:[1,0]
    v_pk_add_f32 v[230:231], v[230:231], v[108:109] op_sel_hi:[1,0]
    v_pk_add_f32 v[232:233], v[232:233], v[108:109] op_sel_hi:[1,0]
    v_pk_add_f32 v[234:235], v[234:235], v[108:109] op_sel_hi:[1,0]
    v_pk_add_f32 v[236:237], v[236:237], v[108:109] op_sel_hi:[1,0]
    v_pk_add_f32 v[238:239], v[238:239], v[108:109] op_sel_hi:[1,0]
    v_exp_f32 v224, v224
    v_exp_f32 v225, v225
    v_exp_f32 v226, v226
    v_exp_f32 v227, v227
    v_exp_f32 v228, v228
    v_exp_f32 v229, v229
    v_exp_f32 v230, v230
    v_exp_f32 v231, v231
    v_exp_f32 v232, v232
    v_exp_f32 v233, v233
    v_exp_f32 v234, v234
    v_exp_f32 v235, v235
    v_exp_f32 v236, v236
    v_exp_f32 v237, v237
    v_exp_f32 v238, v238
    v_exp_f32 v239, v239
    v_cvt_pk_bf16_f32 v224, v224, v225
    v_cvt_pk_bf16_f32 v225, v226, v227
    v_cvt_pk_bf16_f32 v226, v228, v229
    v_cvt_pk_bf16_f32 v227, v230, v231
    v_cvt_pk_bf16_f32 v228, v232, v233
    v_cvt_pk_bf16_f32 v229, v234, v235
    v_cvt_pk_bf16_f32 v230, v236, v237
    v_cvt_pk_bf16_f32 v231, v238, v239
    v_pk_add_f32 v[240:241], v[240:241], v[108:109] op_sel_hi:[1,0]
    v_pk_add_f32 v[242:243], v[242:243], v[108:109] op_sel_hi:[1,0]
    v_pk_add_f32 v[244:245], v[244:245], v[108:109] op_sel_hi:[1,0]
    v_pk_add_f32 v[246:247], v[246:247], v[108:109] op_sel_hi:[1,0]
    v_pk_add_f32 v[248:249], v[248:249], v[108:109] op_sel_hi:[1,0]
    v_pk_add_f32 v[250:251], v[250:251], v[108:109] op_sel_hi:[1,0]
    v_pk_add_f32 v[252:253], v[252:253], v[108:109] op_sel_hi:[1,0]
    v_pk_add_f32 v[254:255], v[254:255], v[108:109] op_sel_hi:[1,0]
    v_exp_f32 v240, v240
    v_exp_f32 v241, v241
    v_exp_f32 v242, v242
    v_exp_f32 v243, v243
    v_exp_f32 v244, v244
    v_exp_f32 v245, v245
    v_exp_f32 v246, v246
    v_exp_f32 v247, v247
    v_exp_f32 v248, v248
    v_exp_f32 v249, v249
    v_exp_f32 v250, v250
    v_exp_f32 v251, v251
    v_exp_f32 v252, v252
    v_exp_f32 v253, v253
    v_exp_f32 v254, v254
    v_exp_f32 v255, v255
    v_cvt_pk_bf16_f32 v240, v240, v241
    v_cvt_pk_bf16_f32 v241, v242, v243
    v_cvt_pk_bf16_f32 v242, v244, v245
    v_cvt_pk_bf16_f32 v243, v246, v247
    v_cvt_pk_bf16_f32 v244, v248, v249
    v_cvt_pk_bf16_f32 v245, v250, v251
    v_cvt_pk_bf16_f32 v246, v252, v253
    v_cvt_pk_bf16_f32 v247, v254, v255
    v_bfi_b32 v100, v24, 0, v240
    v_and_b32 v240, v24, v240
    v_bfi_b32 v101, v25, 0, v241
    v_and_b32 v241, v25, v241
    v_bfi_b32 v102, v26, 0, v242
    v_and_b32 v242, v26, v242
    v_bfi_b32 v103, v27, 0, v243
    v_and_b32 v243, v27, v243
    v_bfi_b32 v104, v28, 0, v244
    v_and_b32 v244, v28, v244
    v_bfi_b32 v105, v29, 0, v245
    v_and_b32 v245, v29, v245
    v_bfi_b32 v106, v30, 0, v246
    v_and_b32 v246, v30, v246
    v_bfi_b32 v107, v31, 0, v247
    v_and_b32 v247, v31, v247
    v_mfma_f32_32x32x16_bf16 v[48:63], v[32:35], v[240:243], 0
    s_nop 0
    v_mfma_f32_32x32x16_bf16 v[48:63], v[36:39], v[244:247], v[48:63]
    v_mfma_f32_32x32x16_bf16 v[48:63], v[40:43], v[100:103], v[48:63]
    v_mfma_f32_32x32x16_bf16 v[48:63], v[44:47], v[104:107], v[48:63]
    s_nop 7
    s_mov_b64 exec, s[96:97]
    ds_read_b128 v[32:35], v7 offset:6144
    ds_read_b128 v[36:39], v7 offset:7168
    s_mov_b64 exec, -1
    s_waitcnt lgkmcnt(0)
    v_mfma_f32_32x32x16_bf16 v[48:63], v[32:35], v[128:131], v[48:63]
    v_mfma_f32_32x32x16_bf16 v[48:63], v[36:39], v[132:135], v[48:63]
    s_nop 7
    s_mov_b64 exec, s[96:97]
    ds_read_b128 v[32:35], v7 offset:10240
    ds_read_b128 v[36:39], v7 offset:11264
    s_mov_b64 exec, -1
    s_waitcnt lgkmcnt(0)
    v_mfma_f32_32x32x16_bf16 v[48:63], v[32:35], v[144:147], v[48:63]
    v_mfma_f32_32x32x16_bf16 v[48:63], v[36:39], v[148:151], v[48:63]
    s_nop 7
    s_mov_b64 exec, s[96:97]
    ds_read_b128 v[32:35], v7 offset:14336
    ds_read_b128 v[36:39], v7 offset:15360
    s_mov_b64 exec, -1
    s_waitcnt lgkmcnt(0)
    v_mfma_f32_32x32x16_bf16 v[48:63], v[32:35], v[160:163], v[48:63]
    v_mfma_f32_32x32x16_bf16 v[48:63], v[36:39], v[164:167], v[48:63]
    s_nop 7
    s_mov_b64 exec, s[96:97]
    ds_read_b128 v[32:35], v7 offset:18432
    ds_read_b128 v[36:39], v7 offset:19456
    s_mov_b64 exec, -1
    s_waitcnt lgkmcnt(0)
    v_mfma_f32_32x32x16_bf16 v[48:63], v[32:35], v[176:179], v[48:63]
    v_mfma_f32_32x32x16_bf16 v[48:63], v[36:39], v[180:183], v[48:63]
    s_nop 7
    s_mov_b64 exec, s[96:97]
    ds_read_b128 v[32:35], v7 offset:22528
    ds_read_b128 v[36:39], v7 offset:23552
    s_mov_b64 exec, -1
    s_waitcnt lgkmcnt(0)
    v_mfma_f32_32x32x16_bf16 v[48:63], v[32:35], v[192:195], v[48:63]
    v_mfma_f32_32x32x16_bf16 v[48:63], v[36:39], v[196:199], v[48:63]
    s_nop 7
    s_mov_b64 exec, s[96:97]
    ds_read_b128 v[32:35], v7 offset:26624
    ds_read_b128 v[36:39], v7 offset:27648
    s_mov_b64 exec, -1
    s_waitcnt lgkmcnt(0)
    v_mfma_f32_32x32x16_bf16 v[48:63], v[32:35], v[208:211], v[48:63]
    v_mfma_f32_32x32x16_bf16 v[48:63], v[36:39], v[212:215], v[48:63]
    s_nop 7
    s_mov_b64 exec, s[96:97]
    ds_read_b128 v[32:35], v7 offset:30720
    ds_read_b128 v[36:39], v7 offset:31744
    s_mov_b64 exec, -1
    s_waitcnt lgkmcnt(0)
    v_mfma_f32_32x32x16_bf16 v[48:63], v[32:35], v[224:227], v[48:63]
    v_mfma_f32_32x32x16_bf16 v[48:63], v[36:39], v[228:231], v[48:63]
    s_nop 11
    v_rcp_f32 v57, v56
    s_nop 0
    v_mul_f32 v48, v48, v57
    v_mul_f32 v49, v49, v57
    v_mul_f32 v50, v50, v57
    v_mul_f32 v51, v51, v57
    v_mul_f32 v52, v52, v57
    v_mul_f32 v53, v53, v57
    v_mul_f32 v54, v54, v57
    v_mul_f32 v55, v55, v57
    v_add_u32 v48, 0x8000, v48
    v_cvt_pk_bf16_f32 v60, v48, v49
    v_cvt_pk_bf16_f32 v61, v50, v51
    v_cvt_pk_bf16_f32 v62, v52, v53
    v_cvt_pk_bf16_f32 v63, v54, v55
    v_and_b32 v60, -2, v60
    s_mov_b32 s7, s54
    s_cmp_lg_u32 s63, 0
    s_cbranch_scc0 fast_341
    buffer_store_dwordx4 v[60:63], v1, s[48:51], s7 offen offset:0
    s_nop 0
    s_nop 0
dend_342:
    ds_read_b128 v[64:67], v7 offset:1024
    ds_read_b128 v[68:71], v7 offset:5120
    ds_read_b128 v[72:75], v7 offset:9216
    ds_read_b128 v[76:79], v7 offset:13312
    ds_read_b128 v[80:83], v7 offset:17408
    ds_read_b128 v[84:87], v7 offset:21504
    ds_read_b128 v[88:91], v7 offset:25600
    ds_read_b128 v[92:95], v7 offset:29696
    ds_read_b128 v[96:99], v7 offset:33792
    s_mov_b64 exec, s[96:97]
    ds_read_b128 v[32:35], v7 offset:35072
    ds_read_b128 v[36:39], v7 offset:36096
    s_mov_b64 exec, -1
    s_mov_b64 exec, s[96:97]
    ds_read_b128 v[40:43], v7 offset:2304
    ds_read_b128 v[44:47], v7 offset:3328
    s_mov_b64 exec, -1
    s_waitcnt lgkmcnt(0)
    v_mfma_f32_32x32x16_bf16 v[112:127], v[64:67], v[20:23], 0
    v_mfma_f32_32x32x16_bf16 v[128:143], v[68:71], v[20:23], 0
    v_mfma_f32_32x32x16_bf16 v[144:159], v[72:75], v[20:23], 0
    v_mfma_f32_32x32x16_bf16 v[160:175], v[76:79], v[20:23], 0
    v_mfma_f32_32x32x16_bf16 v[176:191], v[80:83], v[20:23], 0
    v_mfma_f32_32x32x16_bf16 v[192:207], v[84:87], v[20:23], 0
    v_mfma_f32_32x32x16_bf16 v[208:223], v[88:91], v[20:23], 0
    v_mfma_f32_32x32x16_bf16 v[224:239], v[92:95], v[20:23], 0
    v_mfma_f32_32x32x16_bf16 v[240:255], v[96:99], v[20:23], 0
    s_cmp_ge_u32 s59, 8
    s_nop 10
    s_cbranch_scc1 valid_343
    v_mov_b32 v112, 0xff800000
    v_mov_b32 v113, 0xff800000
    v_mov_b32 v114, 0xff800000
    v_mov_b32 v115, 0xff800000
    v_mov_b32 v116, 0xff800000
    v_mov_b32 v117, 0xff800000
    v_mov_b32 v118, 0xff800000
    v_mov_b32 v119, 0xff800000
    v_mov_b32 v120, 0xff800000
    v_mov_b32 v121, 0xff800000
    v_mov_b32 v122, 0xff800000
    v_mov_b32 v123, 0xff800000
    v_mov_b32 v124, 0xff800000
    v_mov_b32 v125, 0xff800000
    v_mov_b32 v126, 0xff800000
    v_mov_b32 v127, 0xff800000
    s_cmp_ge_u32 s59, 7
    s_nop 0
    s_cbranch_scc1 valid_343
    v_mov_b32 v128, 0xff800000
    v_mov_b32 v129, 0xff800000
    v_mov_b32 v130, 0xff800000
    v_mov_b32 v131, 0xff800000
    v_mov_b32 v132, 0xff800000
    v_mov_b32 v133, 0xff800000
    v_mov_b32 v134, 0xff800000
    v_mov_b32 v135, 0xff800000
    v_mov_b32 v136, 0xff800000
    v_mov_b32 v137, 0xff800000
    v_mov_b32 v138, 0xff800000
    v_mov_b32 v139, 0xff800000
    v_mov_b32 v140, 0xff800000
    v_mov_b32 v141, 0xff800000
    v_mov_b32 v142, 0xff800000
    v_mov_b32 v143, 0xff800000
    s_cmp_ge_u32 s59, 6
    s_nop 0
    s_cbranch_scc1 valid_343
    v_mov_b32 v144, 0xff800000
    v_mov_b32 v145, 0xff800000
    v_mov_b32 v146, 0xff800000
    v_mov_b32 v147, 0xff800000
    v_mov_b32 v148, 0xff800000
    v_mov_b32 v149, 0xff800000
    v_mov_b32 v150, 0xff800000
    v_mov_b32 v151, 0xff800000
    v_mov_b32 v152, 0xff800000
    v_mov_b32 v153, 0xff800000
    v_mov_b32 v154, 0xff800000
    v_mov_b32 v155, 0xff800000
    v_mov_b32 v156, 0xff800000
    v_mov_b32 v157, 0xff800000
    v_mov_b32 v158, 0xff800000
    v_mov_b32 v159, 0xff800000
    s_cmp_ge_u32 s59, 5
    s_nop 0
    s_cbranch_scc1 valid_343
    v_mov_b32 v160, 0xff800000
    v_mov_b32 v161, 0xff800000
    v_mov_b32 v162, 0xff800000
    v_mov_b32 v163, 0xff800000
    v_mov_b32 v164, 0xff800000
    v_mov_b32 v165, 0xff800000
    v_mov_b32 v166, 0xff800000
    v_mov_b32 v167, 0xff800000
    v_mov_b32 v168, 0xff800000
    v_mov_b32 v169, 0xff800000
    v_mov_b32 v170, 0xff800000
    v_mov_b32 v171, 0xff800000
    v_mov_b32 v172, 0xff800000
    v_mov_b32 v173, 0xff800000
    v_mov_b32 v174, 0xff800000
    v_mov_b32 v175, 0xff800000
    s_cmp_ge_u32 s59, 4
    s_nop 0
    s_cbranch_scc1 valid_343
    v_mov_b32 v176, 0xff800000
    v_mov_b32 v177, 0xff800000
    v_mov_b32 v178, 0xff800000
    v_mov_b32 v179, 0xff800000
    v_mov_b32 v180, 0xff800000
    v_mov_b32 v181, 0xff800000
    v_mov_b32 v182, 0xff800000
    v_mov_b32 v183, 0xff800000
    v_mov_b32 v184, 0xff800000
    v_mov_b32 v185, 0xff800000
    v_mov_b32 v186, 0xff800000
    v_mov_b32 v187, 0xff800000
    v_mov_b32 v188, 0xff800000
    v_mov_b32 v189, 0xff800000
    v_mov_b32 v190, 0xff800000
    v_mov_b32 v191, 0xff800000
    s_cmp_ge_u32 s59, 3
    s_nop 0
    s_cbranch_scc1 valid_343
    v_mov_b32 v192, 0xff800000
    v_mov_b32 v193, 0xff800000
    v_mov_b32 v194, 0xff800000
    v_mov_b32 v195, 0xff800000
    v_mov_b32 v196, 0xff800000
    v_mov_b32 v197, 0xff800000
    v_mov_b32 v198, 0xff800000
    v_mov_b32 v199, 0xff800000
    v_mov_b32 v200, 0xff800000
    v_mov_b32 v201, 0xff800000
    v_mov_b32 v202, 0xff800000
    v_mov_b32 v203, 0xff800000
    v_mov_b32 v204, 0xff800000
    v_mov_b32 v205, 0xff800000
    v_mov_b32 v206, 0xff800000
    v_mov_b32 v207, 0xff800000
    s_cmp_ge_u32 s59, 2
    s_nop 0
    s_cbranch_scc1 valid_343
    v_mov_b32 v208, 0xff800000
    v_mov_b32 v209, 0xff800000
    v_mov_b32 v210, 0xff800000
    v_mov_b32 v211, 0xff800000
    v_mov_b32 v212, 0xff800000
    v_mov_b32 v213, 0xff800000
    v_mov_b32 v214, 0xff800000
    v_mov_b32 v215, 0xff800000
    v_mov_b32 v216, 0xff800000
    v_mov_b32 v217, 0xff800000
    v_mov_b32 v218, 0xff800000
    v_mov_b32 v219, 0xff800000
    v_mov_b32 v220, 0xff800000
    v_mov_b32 v221, 0xff800000
    v_mov_b32 v222, 0xff800000
    v_mov_b32 v223, 0xff800000
    s_cmp_ge_u32 s59, 1
    s_nop 0
    s_cbranch_scc1 valid_343
    v_mov_b32 v224, 0xff800000
    v_mov_b32 v225, 0xff800000
    v_mov_b32 v226, 0xff800000
    v_mov_b32 v227, 0xff800000
    v_mov_b32 v228, 0xff800000
    v_mov_b32 v229, 0xff800000
    v_mov_b32 v230, 0xff800000
    v_mov_b32 v231, 0xff800000
    v_mov_b32 v232, 0xff800000
    v_mov_b32 v233, 0xff800000
    v_mov_b32 v234, 0xff800000
    v_mov_b32 v235, 0xff800000
    v_mov_b32 v236, 0xff800000
    v_mov_b32 v237, 0xff800000
    v_mov_b32 v238, 0xff800000
    v_mov_b32 v239, 0xff800000
    s_nop 1
valid_343:
    v_cndmask_b32 v240, v112, v240, s[64:65]
    v_cndmask_b32 v241, v113, v241, s[66:67]
    v_cndmask_b32 v242, v114, v242, s[68:69]
    v_cndmask_b32 v243, v115, v243, s[70:71]
    v_cndmask_b32 v244, v116, v244, s[72:73]
    v_cndmask_b32 v245, v117, v245, s[74:75]
    v_cndmask_b32 v246, v118, v246, s[76:77]
    v_cndmask_b32 v247, v119, v247, s[78:79]
    v_cndmask_b32 v248, v120, v248, s[80:81]
    v_cndmask_b32 v249, v121, v249, s[82:83]
    v_cndmask_b32 v250, v122, v250, s[84:85]
    v_cndmask_b32 v251, v123, v251, s[86:87]
    v_cndmask_b32 v252, v124, v252, s[88:89]
    v_cndmask_b32 v253, v125, v253, s[90:91]
    v_cndmask_b32 v254, v126, v254, s[92:93]
    v_cndmask_b32 v255, v127, v255, s[94:95]
    v_max_f32 v108, v240, v241
    v_max_f32 v109, v242, v243
    v_max3_f32 v108, v108, v244, v245
    v_max3_f32 v109, v109, v246, v247
    v_max3_f32 v108, v108, v248, v249
    v_max3_f32 v109, v109, v250, v251
    v_max3_f32 v108, v108, v252, v253
    v_max3_f32 v109, v109, v254, v255
    v_max3_f32 v108, v108, v128, v129
    v_max3_f32 v109, v109, v130, v131
    v_max3_f32 v108, v108, v132, v133
    v_max3_f32 v109, v109, v134, v135
    v_max3_f32 v108, v108, v136, v137
    v_max3_f32 v109, v109, v138, v139
    v_max3_f32 v108, v108, v140, v141
    v_max3_f32 v109, v109, v142, v143
    v_max3_f32 v108, v108, v144, v145
    v_max3_f32 v109, v109, v146, v147
    v_max3_f32 v108, v108, v148, v149
    v_max3_f32 v109, v109, v150, v151
    v_max3_f32 v108, v108, v152, v153
    v_max3_f32 v109, v109, v154, v155
    v_max3_f32 v108, v108, v156, v157
    v_max3_f32 v109, v109, v158, v159
    v_max3_f32 v108, v108, v160, v161
    v_max3_f32 v109, v109, v162, v163
    v_max3_f32 v108, v108, v164, v165
    v_max3_f32 v109, v109, v166, v167
    v_max3_f32 v108, v108, v168, v169
    v_max3_f32 v109, v109, v170, v171
    v_max3_f32 v108, v108, v172, v173
    v_max3_f32 v109, v109, v174, v175
    v_max3_f32 v108, v108, v176, v177
    v_max3_f32 v109, v109, v178, v179
    v_max3_f32 v108, v108, v180, v181
    v_max3_f32 v109, v109, v182, v183
    v_max3_f32 v108, v108, v184, v185
    v_max3_f32 v109, v109, v186, v187
    v_max3_f32 v108, v108, v188, v189
    v_max3_f32 v109, v109, v190, v191
    v_max3_f32 v108, v108, v192, v193
    v_max3_f32 v109, v109, v194, v195
    v_max3_f32 v108, v108, v196, v197
    v_max3_f32 v109, v109, v198, v199
    v_max3_f32 v108, v108, v200, v201
    v_max3_f32 v109, v109, v202, v203
    v_max3_f32 v108, v108, v204, v205
    v_max3_f32 v109, v109, v206, v207
    v_max3_f32 v108, v108, v208, v209
    v_max3_f32 v109, v109, v210, v211
    v_max3_f32 v108, v108, v212, v213
    v_max3_f32 v109, v109, v214, v215
    v_max3_f32 v108, v108, v216, v217
    v_max3_f32 v109, v109, v218, v219
    v_max3_f32 v108, v108, v220, v221
    v_max3_f32 v109, v109, v222, v223
    v_max3_f32 v108, v108, v224, v225
    v_max3_f32 v109, v109, v226, v227
    v_max3_f32 v108, v108, v228, v229
    v_max3_f32 v109, v109, v230, v231
    v_max3_f32 v108, v108, v232, v233
    v_max3_f32 v109, v109, v234, v235
    v_max3_f32 v108, v108, v236, v237
    v_max3_f32 v109, v109, v238, v239
    v_max_f32 v108, v108, v109
    v_mov_b32 v109, v108
    s_nop 1
    v_permlane32_swap_b32 v109, v108
    v_max_f32 v108, v108, v109
    v_sub_f32 v108, 0, v108
    v_pk_add_f32 v[128:129], v[128:129], v[108:109] op_sel_hi:[1,0]
    v_pk_add_f32 v[130:131], v[130:131], v[108:109] op_sel_hi:[1,0]
    v_pk_add_f32 v[132:133], v[132:133], v[108:109] op_sel_hi:[1,0]
    v_pk_add_f32 v[134:135], v[134:135], v[108:109] op_sel_hi:[1,0]
    v_pk_add_f32 v[136:137], v[136:137], v[108:109] op_sel_hi:[1,0]
    v_pk_add_f32 v[138:139], v[138:139], v[108:109] op_sel_hi:[1,0]
    v_pk_add_f32 v[140:141], v[140:141], v[108:109] op_sel_hi:[1,0]
    v_pk_add_f32 v[142:143], v[142:143], v[108:109] op_sel_hi:[1,0]
    v_exp_f32 v128, v128
    v_exp_f32 v129, v129
    v_exp_f32 v130, v130
    v_exp_f32 v131, v131
    v_exp_f32 v132, v132
    v_exp_f32 v133, v133
    v_exp_f32 v134, v134
    v_exp_f32 v135, v135
    v_exp_f32 v136, v136
    v_exp_f32 v137, v137
    v_exp_f32 v138, v138
    v_exp_f32 v139, v139
    v_exp_f32 v140, v140
    v_exp_f32 v141, v141
    v_exp_f32 v142, v142
    v_exp_f32 v143, v143
    v_cvt_pk_bf16_f32 v128, v128, v129
    v_cvt_pk_bf16_f32 v129, v130, v131
    v_cvt_pk_bf16_f32 v130, v132, v133
    v_cvt_pk_bf16_f32 v131, v134, v135
    v_cvt_pk_bf16_f32 v132, v136, v137
    v_cvt_pk_bf16_f32 v133, v138, v139
    v_cvt_pk_bf16_f32 v134, v140, v141
    v_cvt_pk_bf16_f32 v135, v142, v143
    v_pk_add_f32 v[144:145], v[144:145], v[108:109] op_sel_hi:[1,0]
    v_pk_add_f32 v[146:147], v[146:147], v[108:109] op_sel_hi:[1,0]
    v_pk_add_f32 v[148:149], v[148:149], v[108:109] op_sel_hi:[1,0]
    v_pk_add_f32 v[150:151], v[150:151], v[108:109] op_sel_hi:[1,0]
    v_pk_add_f32 v[152:153], v[152:153], v[108:109] op_sel_hi:[1,0]
    v_pk_add_f32 v[154:155], v[154:155], v[108:109] op_sel_hi:[1,0]
    v_pk_add_f32 v[156:157], v[156:157], v[108:109] op_sel_hi:[1,0]
    v_pk_add_f32 v[158:159], v[158:159], v[108:109] op_sel_hi:[1,0]
    v_exp_f32 v144, v144
    v_exp_f32 v145, v145
    v_exp_f32 v146, v146
    v_exp_f32 v147, v147
    v_exp_f32 v148, v148
    v_exp_f32 v149, v149
    v_exp_f32 v150, v150
    v_exp_f32 v151, v151
    v_exp_f32 v152, v152
    v_exp_f32 v153, v153
    v_exp_f32 v154, v154
    v_exp_f32 v155, v155
    v_exp_f32 v156, v156
    v_exp_f32 v157, v157
    v_exp_f32 v158, v158
    v_exp_f32 v159, v159
    v_cvt_pk_bf16_f32 v144, v144, v145
    v_cvt_pk_bf16_f32 v145, v146, v147
    v_cvt_pk_bf16_f32 v146, v148, v149
    v_cvt_pk_bf16_f32 v147, v150, v151
    v_cvt_pk_bf16_f32 v148, v152, v153
    v_cvt_pk_bf16_f32 v149, v154, v155
    v_cvt_pk_bf16_f32 v150, v156, v157
    v_cvt_pk_bf16_f32 v151, v158, v159
    v_pk_add_f32 v[160:161], v[160:161], v[108:109] op_sel_hi:[1,0]
    v_pk_add_f32 v[162:163], v[162:163], v[108:109] op_sel_hi:[1,0]
    v_pk_add_f32 v[164:165], v[164:165], v[108:109] op_sel_hi:[1,0]
    v_pk_add_f32 v[166:167], v[166:167], v[108:109] op_sel_hi:[1,0]
    v_pk_add_f32 v[168:169], v[168:169], v[108:109] op_sel_hi:[1,0]
    v_pk_add_f32 v[170:171], v[170:171], v[108:109] op_sel_hi:[1,0]
    v_pk_add_f32 v[172:173], v[172:173], v[108:109] op_sel_hi:[1,0]
    v_pk_add_f32 v[174:175], v[174:175], v[108:109] op_sel_hi:[1,0]
    v_exp_f32 v160, v160
    v_exp_f32 v161, v161
    v_exp_f32 v162, v162
    v_exp_f32 v163, v163
    v_exp_f32 v164, v164
    v_exp_f32 v165, v165
    v_exp_f32 v166, v166
    v_exp_f32 v167, v167
    v_exp_f32 v168, v168
    v_exp_f32 v169, v169
    v_exp_f32 v170, v170
    v_exp_f32 v171, v171
    v_exp_f32 v172, v172
    v_exp_f32 v173, v173
    v_exp_f32 v174, v174
    v_exp_f32 v175, v175
    v_cvt_pk_bf16_f32 v160, v160, v161
    v_cvt_pk_bf16_f32 v161, v162, v163
    v_cvt_pk_bf16_f32 v162, v164, v165
    v_cvt_pk_bf16_f32 v163, v166, v167
    v_cvt_pk_bf16_f32 v164, v168, v169
    v_cvt_pk_bf16_f32 v165, v170, v171
    v_cvt_pk_bf16_f32 v166, v172, v173
    v_cvt_pk_bf16_f32 v167, v174, v175
    v_pk_add_f32 v[176:177], v[176:177], v[108:109] op_sel_hi:[1,0]
    v_pk_add_f32 v[178:179], v[178:179], v[108:109] op_sel_hi:[1,0]
    v_pk_add_f32 v[180:181], v[180:181], v[108:109] op_sel_hi:[1,0]
    v_pk_add_f32 v[182:183], v[182:183], v[108:109] op_sel_hi:[1,0]
    v_pk_add_f32 v[184:185], v[184:185], v[108:109] op_sel_hi:[1,0]
    v_pk_add_f32 v[186:187], v[186:187], v[108:109] op_sel_hi:[1,0]
    v_pk_add_f32 v[188:189], v[188:189], v[108:109] op_sel_hi:[1,0]
    v_pk_add_f32 v[190:191], v[190:191], v[108:109] op_sel_hi:[1,0]
    v_exp_f32 v176, v176
    v_exp_f32 v177, v177
    v_exp_f32 v178, v178
    v_exp_f32 v179, v179
    v_exp_f32 v180, v180
    v_exp_f32 v181, v181
    v_exp_f32 v182, v182
    v_exp_f32 v183, v183
    v_exp_f32 v184, v184
    v_exp_f32 v185, v185
    v_exp_f32 v186, v186
    v_exp_f32 v187, v187
    v_exp_f32 v188, v188
    v_exp_f32 v189, v189
    v_exp_f32 v190, v190
    v_exp_f32 v191, v191
    v_cvt_pk_bf16_f32 v176, v176, v177
    v_cvt_pk_bf16_f32 v177, v178, v179
    v_cvt_pk_bf16_f32 v178, v180, v181
    v_cvt_pk_bf16_f32 v179, v182, v183
    v_cvt_pk_bf16_f32 v180, v184, v185
    v_cvt_pk_bf16_f32 v181, v186, v187
    v_cvt_pk_bf16_f32 v182, v188, v189
    v_cvt_pk_bf16_f32 v183, v190, v191
    v_pk_add_f32 v[192:193], v[192:193], v[108:109] op_sel_hi:[1,0]
    v_pk_add_f32 v[194:195], v[194:195], v[108:109] op_sel_hi:[1,0]
    v_pk_add_f32 v[196:197], v[196:197], v[108:109] op_sel_hi:[1,0]
    v_pk_add_f32 v[198:199], v[198:199], v[108:109] op_sel_hi:[1,0]
    v_pk_add_f32 v[200:201], v[200:201], v[108:109] op_sel_hi:[1,0]
    v_pk_add_f32 v[202:203], v[202:203], v[108:109] op_sel_hi:[1,0]
    v_pk_add_f32 v[204:205], v[204:205], v[108:109] op_sel_hi:[1,0]
    v_pk_add_f32 v[206:207], v[206:207], v[108:109] op_sel_hi:[1,0]
    v_exp_f32 v192, v192
    v_exp_f32 v193, v193
    v_exp_f32 v194, v194
    v_exp_f32 v195, v195
    v_exp_f32 v196, v196
    v_exp_f32 v197, v197
    v_exp_f32 v198, v198
    v_exp_f32 v199, v199
    v_exp_f32 v200, v200
    v_exp_f32 v201, v201
    v_exp_f32 v202, v202
    v_exp_f32 v203, v203
    v_exp_f32 v204, v204
    v_exp_f32 v205, v205
    v_exp_f32 v206, v206
    v_exp_f32 v207, v207
    v_cvt_pk_bf16_f32 v192, v192, v193
    v_cvt_pk_bf16_f32 v193, v194, v195
    v_cvt_pk_bf16_f32 v194, v196, v197
    v_cvt_pk_bf16_f32 v195, v198, v199
    v_cvt_pk_bf16_f32 v196, v200, v201
    v_cvt_pk_bf16_f32 v197, v202, v203
    v_cvt_pk_bf16_f32 v198, v204, v205
    v_cvt_pk_bf16_f32 v199, v206, v207
    v_pk_add_f32 v[208:209], v[208:209], v[108:109] op_sel_hi:[1,0]
    v_pk_add_f32 v[210:211], v[210:211], v[108:109] op_sel_hi:[1,0]
    v_pk_add_f32 v[212:213], v[212:213], v[108:109] op_sel_hi:[1,0]
    v_pk_add_f32 v[214:215], v[214:215], v[108:109] op_sel_hi:[1,0]
    v_pk_add_f32 v[216:217], v[216:217], v[108:109] op_sel_hi:[1,0]
    v_pk_add_f32 v[218:219], v[218:219], v[108:109] op_sel_hi:[1,0]
    v_pk_add_f32 v[220:221], v[220:221], v[108:109] op_sel_hi:[1,0]
    v_pk_add_f32 v[222:223], v[222:223], v[108:109] op_sel_hi:[1,0]
    v_exp_f32 v208, v208
    v_exp_f32 v209, v209
    v_exp_f32 v210, v210
    v_exp_f32 v211, v211
    v_exp_f32 v212, v212
    v_exp_f32 v213, v213
    v_exp_f32 v214, v214
    v_exp_f32 v215, v215
    v_exp_f32 v216, v216
    v_exp_f32 v217, v217
    v_exp_f32 v218, v218
    v_exp_f32 v219, v219
    v_exp_f32 v220, v220
    v_exp_f32 v221, v221
    v_exp_f32 v222, v222
    v_exp_f32 v223, v223
    v_cvt_pk_bf16_f32 v208, v208, v209
    v_cvt_pk_bf16_f32 v209, v210, v211
    v_cvt_pk_bf16_f32 v210, v212, v213
    v_cvt_pk_bf16_f32 v211, v214, v215
    v_cvt_pk_bf16_f32 v212, v216, v217
    v_cvt_pk_bf16_f32 v213, v218, v219
    v_cvt_pk_bf16_f32 v214, v220, v221
    v_cvt_pk_bf16_f32 v215, v222, v223
    v_pk_add_f32 v[224:225], v[224:225], v[108:109] op_sel_hi:[1,0]
    v_pk_add_f32 v[226:227], v[226:227], v[108:109] op_sel_hi:[1,0]
    v_pk_add_f32 v[228:229], v[228:229], v[108:109] op_sel_hi:[1,0]
    v_pk_add_f32 v[230:231], v[230:231], v[108:109] op_sel_hi:[1,0]
    v_pk_add_f32 v[232:233], v[232:233], v[108:109] op_sel_hi:[1,0]
    v_pk_add_f32 v[234:235], v[234:235], v[108:109] op_sel_hi:[1,0]
    v_pk_add_f32 v[236:237], v[236:237], v[108:109] op_sel_hi:[1,0]
    v_pk_add_f32 v[238:239], v[238:239], v[108:109] op_sel_hi:[1,0]
    v_exp_f32 v224, v224
    v_exp_f32 v225, v225
    v_exp_f32 v226, v226
    v_exp_f32 v227, v227
    v_exp_f32 v228, v228
    v_exp_f32 v229, v229
    v_exp_f32 v230, v230
    v_exp_f32 v231, v231
    v_exp_f32 v232, v232
    v_exp_f32 v233, v233
    v_exp_f32 v234, v234
    v_exp_f32 v235, v235
    v_exp_f32 v236, v236
    v_exp_f32 v237, v237
    v_exp_f32 v238, v238
    v_exp_f32 v239, v239
    v_cvt_pk_bf16_f32 v224, v224, v225
    v_cvt_pk_bf16_f32 v225, v226, v227
    v_cvt_pk_bf16_f32 v226, v228, v229
    v_cvt_pk_bf16_f32 v227, v230, v231
    v_cvt_pk_bf16_f32 v228, v232, v233
    v_cvt_pk_bf16_f32 v229, v234, v235
    v_cvt_pk_bf16_f32 v230, v236, v237
    v_cvt_pk_bf16_f32 v231, v238, v239
    v_pk_add_f32 v[240:241], v[240:241], v[108:109] op_sel_hi:[1,0]
    v_pk_add_f32 v[242:243], v[242:243], v[108:109] op_sel_hi:[1,0]
    v_pk_add_f32 v[244:245], v[244:245], v[108:109] op_sel_hi:[1,0]
    v_pk_add_f32 v[246:247], v[246:247], v[108:109] op_sel_hi:[1,0]
    v_pk_add_f32 v[248:249], v[248:249], v[108:109] op_sel_hi:[1,0]
    v_pk_add_f32 v[250:251], v[250:251], v[108:109] op_sel_hi:[1,0]
    v_pk_add_f32 v[252:253], v[252:253], v[108:109] op_sel_hi:[1,0]
    v_pk_add_f32 v[254:255], v[254:255], v[108:109] op_sel_hi:[1,0]
    v_exp_f32 v240, v240
    v_exp_f32 v241, v241
    v_exp_f32 v242, v242
    v_exp_f32 v243, v243
    v_exp_f32 v244, v244
    v_exp_f32 v245, v245
    v_exp_f32 v246, v246
    v_exp_f32 v247, v247
    v_exp_f32 v248, v248
    v_exp_f32 v249, v249
    v_exp_f32 v250, v250
    v_exp_f32 v251, v251
    v_exp_f32 v252, v252
    v_exp_f32 v253, v253
    v_exp_f32 v254, v254
    v_exp_f32 v255, v255
    v_cvt_pk_bf16_f32 v240, v240, v241
    v_cvt_pk_bf16_f32 v241, v242, v243
    v_cvt_pk_bf16_f32 v242, v244, v245
    v_cvt_pk_bf16_f32 v243, v246, v247
    v_cvt_pk_bf16_f32 v244, v248, v249
    v_cvt_pk_bf16_f32 v245, v250, v251
    v_cvt_pk_bf16_f32 v246, v252, v253
    v_cvt_pk_bf16_f32 v247, v254, v255
    v_bfi_b32 v100, v24, 0, v240
    v_and_b32 v240, v24, v240
    v_bfi_b32 v101, v25, 0, v241
    v_and_b32 v241, v25, v241
    v_bfi_b32 v102, v26, 0, v242
    v_and_b32 v242, v26, v242
    v_bfi_b32 v103, v27, 0, v243
    v_and_b32 v243, v27, v243
    v_bfi_b32 v104, v28, 0, v244
    v_and_b32 v244, v28, v244
    v_bfi_b32 v105, v29, 0, v245
    v_and_b32 v245, v29, v245
    v_bfi_b32 v106, v30, 0, v246
    v_and_b32 v246, v30, v246
    v_bfi_b32 v107, v31, 0, v247
    v_and_b32 v247, v31, v247
    v_mfma_f32_32x32x16_bf16 v[48:63], v[32:35], v[240:243], 0
    s_nop 0
    v_mfma_f32_32x32x16_bf16 v[48:63], v[36:39], v[244:247], v[48:63]
    v_mfma_f32_32x32x16_bf16 v[48:63], v[40:43], v[100:103], v[48:63]
    v_mfma_f32_32x32x16_bf16 v[48:63], v[44:47], v[104:107], v[48:63]
    s_nop 7
    s_mov_b64 exec, s[96:97]
    ds_read_b128 v[32:35], v7 offset:6400
    ds_read_b128 v[36:39], v7 offset:7424
    s_mov_b64 exec, -1
    s_waitcnt lgkmcnt(0)
    v_mfma_f32_32x32x16_bf16 v[48:63], v[32:35], v[128:131], v[48:63]
    v_mfma_f32_32x32x16_bf16 v[48:63], v[36:39], v[132:135], v[48:63]
    s_nop 7
    s_mov_b64 exec, s[96:97]
    ds_read_b128 v[32:35], v7 offset:10496
    ds_read_b128 v[36:39], v7 offset:11520
    s_mov_b64 exec, -1
    s_waitcnt lgkmcnt(0)
    v_mfma_f32_32x32x16_bf16 v[48:63], v[32:35], v[144:147], v[48:63]
    v_mfma_f32_32x32x16_bf16 v[48:63], v[36:39], v[148:151], v[48:63]
    s_nop 7
    s_mov_b64 exec, s[96:97]
    ds_read_b128 v[32:35], v7 offset:14592
    ds_read_b128 v[36:39], v7 offset:15616
    s_mov_b64 exec, -1
    s_waitcnt lgkmcnt(0)
    v_mfma_f32_32x32x16_bf16 v[48:63], v[32:35], v[160:163], v[48:63]
    v_mfma_f32_32x32x16_bf16 v[48:63], v[36:39], v[164:167], v[48:63]
    s_nop 7
    s_mov_b64 exec, s[96:97]
    ds_read_b128 v[32:35], v7 offset:18688
    ds_read_b128 v[36:39], v7 offset:19712
    s_mov_b64 exec, -1
    s_waitcnt lgkmcnt(0)
    v_mfma_f32_32x32x16_bf16 v[48:63], v[32:35], v[176:179], v[48:63]
    v_mfma_f32_32x32x16_bf16 v[48:63], v[36:39], v[180:183], v[48:63]
    s_nop 7
    s_mov_b64 exec, s[96:97]
    ds_read_b128 v[32:35], v7 offset:22784
    ds_read_b128 v[36:39], v7 offset:23808
    s_mov_b64 exec, -1
    s_waitcnt lgkmcnt(0)
    v_mfma_f32_32x32x16_bf16 v[48:63], v[32:35], v[192:195], v[48:63]
    v_mfma_f32_32x32x16_bf16 v[48:63], v[36:39], v[196:199], v[48:63]
    s_nop 7
    s_mov_b64 exec, s[96:97]
    ds_read_b128 v[32:35], v7 offset:26880
    ds_read_b128 v[36:39], v7 offset:27904
    s_mov_b64 exec, -1
    s_waitcnt lgkmcnt(0)
    v_mfma_f32_32x32x16_bf16 v[48:63], v[32:35], v[208:211], v[48:63]
    v_mfma_f32_32x32x16_bf16 v[48:63], v[36:39], v[212:215], v[48:63]
    s_nop 7
    s_mov_b64 exec, s[96:97]
    ds_read_b128 v[32:35], v7 offset:30976
    ds_read_b128 v[36:39], v7 offset:32000
    s_mov_b64 exec, -1
    s_waitcnt lgkmcnt(0)
    v_mfma_f32_32x32x16_bf16 v[48:63], v[32:35], v[224:227], v[48:63]
    v_mfma_f32_32x32x16_bf16 v[48:63], v[36:39], v[228:231], v[48:63]
    s_nop 11
    v_rcp_f32 v57, v56
    s_nop 0
    v_mul_f32 v48, v48, v57
    v_mul_f32 v49, v49, v57
    v_mul_f32 v50, v50, v57
    v_mul_f32 v51, v51, v57
    v_mul_f32 v52, v52, v57
    v_mul_f32 v53, v53, v57
    v_mul_f32 v54, v54, v57
    v_mul_f32 v55, v55, v57
    v_add_u32 v48, 0x8000, v48
    v_cvt_pk_bf16_f32 v60, v48, v49
    v_cvt_pk_bf16_f32 v61, v50, v51
    v_cvt_pk_bf16_f32 v62, v52, v53
    v_cvt_pk_bf16_f32 v63, v54, v55
    v_and_b32 v60, -2, v60
    s_mov_b32 s7, s62
    s_cmp_lg_u32 s63, 0
    s_cbranch_scc0 fast_344
    buffer_store_dwordx4 v[60:63], v1, s[48:51], s7 offen offset:1024
    s_nop 1
dend_345:
    s_waitcnt vmcnt(0)
    s_branch adone_299
gst_346:
    s_mov_b32 s99, 200000
glp_348:
    s_add_u32 s3, s100, 0
    buffer_load_dwordx4 v[128:131], v1, s[48:51], s3 offen offset:0 sc1
    buffer_load_dwordx4 v[132:135], v1, s[48:51], s3 offen offset:1024 sc1
    buffer_load_dwordx4 v[136:139], v1, s[48:51], s3 offen offset:2048 sc1
    buffer_load_dwordx4 v[140:143], v1, s[48:51], s3 offen offset:3072 sc1
    s_add_u32 s3, s100, 4096
    buffer_load_dwordx4 v[144:147], v1, s[48:51], s3 offen offset:0 sc1
    buffer_load_dwordx4 v[148:151], v1, s[48:51], s3 offen offset:1024 sc1
    buffer_load_dwordx4 v[152:155], v1, s[48:51], s3 offen offset:2048 sc1
    buffer_load_dwordx4 v[156:159], v1, s[48:51], s3 offen offset:3072 sc1
    s_waitcnt vmcnt(0)
    v_bitop3_b32 v95, v128, v132, 1 bitop3:0x2
    v_cmp_eq_u32 vcc, 0, v95
    s_nop 4
    s_cbranch_vccz gbk_347
    s_sub_u32 s99, s99, 1
    s_cmp_lg_u32 s99, 0
    s_cbranch_scc1 glp_348
    s_branch gbk_347
gst_350:
    s_mov_b32 s99, 200000
glp_352:
    s_add_u32 s3, s100, 0
    buffer_load_dwordx4 v[136:139], v1, s[48:51], s3 offen offset:2048 sc1
    buffer_load_dwordx4 v[140:143], v1, s[48:51], s3 offen offset:3072 sc1
    s_add_u32 s3, s100, 4096
    buffer_load_dwordx4 v[144:147], v1, s[48:51], s3 offen offset:0 sc1
    buffer_load_dwordx4 v[148:151], v1, s[48:51], s3 offen offset:1024 sc1
    buffer_load_dwordx4 v[152:155], v1, s[48:51], s3 offen offset:2048 sc1
    buffer_load_dwordx4 v[156:159], v1, s[48:51], s3 offen offset:3072 sc1
    s_add_u32 s3, s100, 8192
    buffer_load_dwordx4 v[160:163], v1, s[48:51], s3 offen offset:0 sc1
    buffer_load_dwordx4 v[164:167], v1, s[48:51], s3 offen offset:1024 sc1
    s_waitcnt vmcnt(0)
    v_bitop3_b32 v95, v136, v140, 1 bitop3:0x2
    v_cmp_eq_u32 vcc, 0, v95
    s_nop 4
    s_cbranch_vccz gbk_351
    s_sub_u32 s99, s99, 1
    s_cmp_lg_u32 s99, 0
    s_cbranch_scc1 glp_352
    s_branch gbk_351
gst_354:
    s_mov_b32 s99, 200000
glp_356:
    s_add_u32 s3, s100, 4096
    buffer_load_dwordx4 v[144:147], v1, s[48:51], s3 offen offset:0 sc1
    buffer_load_dwordx4 v[148:151], v1, s[48:51], s3 offen offset:1024 sc1
    buffer_load_dwordx4 v[152:155], v1, s[48:51], s3 offen offset:2048 sc1
    buffer_load_dwordx4 v[156:159], v1, s[48:51], s3 offen offset:3072 sc1
    s_add_u32 s3, s100, 8192
    buffer_load_dwordx4 v[160:163], v1, s[48:51], s3 offen offset:0 sc1
    buffer_load_dwordx4 v[164:167], v1, s[48:51], s3 offen offset:1024 sc1
    buffer_load_dwordx4 v[168:171], v1, s[48:51], s3 offen offset:2048 sc1
    buffer_load_dwordx4 v[172:175], v1, s[48:51], s3 offen offset:3072 sc1
    s_waitcnt vmcnt(0)
    v_bitop3_b32 v95, v144, v148, 1 bitop3:0x2
    v_cmp_eq_u32 vcc, 0, v95
    s_nop 4
    s_cbranch_vccz gbk_355
    s_sub_u32 s99, s99, 1
    s_cmp_lg_u32 s99, 0
    s_cbranch_scc1 glp_356
    s_branch gbk_355
gst_358:
    s_mov_b32 s99, 200000
glp_360:
    s_add_u32 s3, s100, 4096
    buffer_load_dwordx4 v[152:155], v1, s[48:51], s3 offen offset:2048 sc1
    buffer_load_dwordx4 v[156:159], v1, s[48:51], s3 offen offset:3072 sc1
    s_add_u32 s3, s100, 8192
    buffer_load_dwordx4 v[160:163], v1, s[48:51], s3 offen offset:0 sc1
    buffer_load_dwordx4 v[164:167], v1, s[48:51], s3 offen offset:1024 sc1
    buffer_load_dwordx4 v[168:171], v1, s[48:51], s3 offen offset:2048 sc1
    buffer_load_dwordx4 v[172:175], v1, s[48:51], s3 offen offset:3072 sc1
    s_add_u32 s3, s100, 12288
    buffer_load_dwordx4 v[176:179], v1, s[48:51], s3 offen offset:0 sc1
    buffer_load_dwordx4 v[180:183], v1, s[48:51], s3 offen offset:1024 sc1
    s_waitcnt vmcnt(0)
    v_bitop3_b32 v95, v152, v156, 1 bitop3:0x2
    v_cmp_eq_u32 vcc, 0, v95
    s_nop 4
    s_cbranch_vccz gbk_359
    s_sub_u32 s99, s99, 1
    s_cmp_lg_u32 s99, 0
    s_cbranch_scc1 glp_360
    s_branch gbk_359
gst_362:
    s_mov_b32 s99, 200000
glp_364:
    s_add_u32 s3, s100, 8192
    buffer_load_dwordx4 v[160:163], v1, s[48:51], s3 offen offset:0 sc1
    buffer_load_dwordx4 v[164:167], v1, s[48:51], s3 offen offset:1024 sc1
    buffer_load_dwordx4 v[168:171], v1, s[48:51], s3 offen offset:2048 sc1
    buffer_load_dwordx4 v[172:175], v1, s[48:51], s3 offen offset:3072 sc1
    s_add_u32 s3, s100, 12288
    buffer_load_dwordx4 v[176:179], v1, s[48:51], s3 offen offset:0 sc1
    buffer_load_dwordx4 v[180:183], v1, s[48:51], s3 offen offset:1024 sc1
    buffer_load_dwordx4 v[184:187], v1, s[48:51], s3 offen offset:2048 sc1
    buffer_load_dwordx4 v[188:191], v1, s[48:51], s3 offen offset:3072 sc1
    s_waitcnt vmcnt(0)
    v_bitop3_b32 v95, v160, v164, 1 bitop3:0x2
    v_cmp_eq_u32 vcc, 0, v95
    s_nop 4
    s_cbranch_vccz gbk_363
    s_sub_u32 s99, s99, 1
    s_cmp_lg_u32 s99, 0
    s_cbranch_scc1 glp_364
    s_branch gbk_363
gst_366:
    s_mov_b32 s99, 200000
glp_368:
    s_add_u32 s3, s100, 8192
    buffer_load_dwordx4 v[168:171], v1, s[48:51], s3 offen offset:2048 sc1
    buffer_load_dwordx4 v[172:175], v1, s[48:51], s3 offen offset:3072 sc1
    s_add_u32 s3, s100, 12288
    buffer_load_dwordx4 v[176:179], v1, s[48:51], s3 offen offset:0 sc1
    buffer_load_dwordx4 v[180:183], v1, s[48:51], s3 offen offset:1024 sc1
    buffer_load_dwordx4 v[184:187], v1, s[48:51], s3 offen offset:2048 sc1
    buffer_load_dwordx4 v[188:191], v1, s[48:51], s3 offen offset:3072 sc1
    s_add_u32 s3, s100, 16384
    buffer_load_dwordx4 v[192:195], v1, s[48:51], s3 offen offset:0 sc1
    buffer_load_dwordx4 v[196:199], v1, s[48:51], s3 offen offset:1024 sc1
    s_waitcnt vmcnt(0)
    v_bitop3_b32 v95, v168, v172, 1 bitop3:0x2
    v_cmp_eq_u32 vcc, 0, v95
    s_nop 4
    s_cbranch_vccz gbk_367
    s_sub_u32 s99, s99, 1
    s_cmp_lg_u32 s99, 0
    s_cbranch_scc1 glp_368
    s_branch gbk_367
gst_370:
    s_mov_b32 s99, 200000
glp_372:
    s_add_u32 s3, s100, 12288
    buffer_load_dwordx4 v[176:179], v1, s[48:51], s3 offen offset:0 sc1
    buffer_load_dwordx4 v[180:183], v1, s[48:51], s3 offen offset:1024 sc1
    buffer_load_dwordx4 v[184:187], v1, s[48:51], s3 offen offset:2048 sc1
    buffer_load_dwordx4 v[188:191], v1, s[48:51], s3 offen offset:3072 sc1
    s_add_u32 s3, s100, 16384
    buffer_load_dwordx4 v[192:195], v1, s[48:51], s3 offen offset:0 sc1
    buffer_load_dwordx4 v[196:199], v1, s[48:51], s3 offen offset:1024 sc1
    buffer_load_dwordx4 v[200:203], v1, s[48:51], s3 offen offset:2048 sc1
    buffer_load_dwordx4 v[204:207], v1, s[48:51], s3 offen offset:3072 sc1
    s_waitcnt vmcnt(0)
    v_bitop3_b32 v95, v176, v180, 1 bitop3:0x2
    v_cmp_eq_u32 vcc, 0, v95
    s_nop 4
    s_cbranch_vccz gbk_371
    s_sub_u32 s99, s99, 1
    s_cmp_lg_u32 s99, 0
    s_cbranch_scc1 glp_372
    s_branch gbk_371
gst_374:
    s_mov_b32 s99, 200000
glp_376:
    s_add_u32 s3, s100, 12288
    buffer_load_dwordx4 v[184:187], v1, s[48:51], s3 offen offset:2048 sc1
    buffer_load_dwordx4 v[188:191], v1, s[48:51], s3 offen offset:3072 sc1
    s_add_u32 s3, s100, 16384
    buffer_load_dwordx4 v[192:195], v1, s[48:51], s3 offen offset:0 sc1
    buffer_load_dwordx4 v[196:199], v1, s[48:51], s3 offen offset:1024 sc1
    buffer_load_dwordx4 v[200:203], v1, s[48:51], s3 offen offset:2048 sc1
    buffer_load_dwordx4 v[204:207], v1, s[48:51], s3 offen offset:3072 sc1
    s_add_u32 s3, s100, 20480
    buffer_load_dwordx4 v[208:211], v1, s[48:51], s3 offen offset:0 sc1
    buffer_load_dwordx4 v[212:215], v1, s[48:51], s3 offen offset:1024 sc1
    s_waitcnt vmcnt(0)
    v_bitop3_b32 v95, v184, v188, 1 bitop3:0x2
    v_cmp_eq_u32 vcc, 0, v95
    s_nop 4
    s_cbranch_vccz gbk_375
    s_sub_u32 s99, s99, 1
    s_cmp_lg_u32 s99, 0
    s_cbranch_scc1 glp_376
    s_branch gbk_375
gst_378:
    s_mov_b32 s99, 200000
glp_380:
    s_add_u32 s3, s100, 16384
    buffer_load_dwordx4 v[192:195], v1, s[48:51], s3 offen offset:0 sc1
    buffer_load_dwordx4 v[196:199], v1, s[48:51], s3 offen offset:1024 sc1
    buffer_load_dwordx4 v[200:203], v1, s[48:51], s3 offen offset:2048 sc1
    buffer_load_dwordx4 v[204:207], v1, s[48:51], s3 offen offset:3072 sc1
    s_add_u32 s3, s100, 20480
    buffer_load_dwordx4 v[208:211], v1, s[48:51], s3 offen offset:0 sc1
    buffer_load_dwordx4 v[212:215], v1, s[48:51], s3 offen offset:1024 sc1
    buffer_load_dwordx4 v[216:219], v1, s[48:51], s3 offen offset:2048 sc1
    buffer_load_dwordx4 v[220:223], v1, s[48:51], s3 offen offset:3072 sc1
    s_waitcnt vmcnt(0)
    v_bitop3_b32 v95, v192, v196, 1 bitop3:0x2
    v_cmp_eq_u32 vcc, 0, v95
    s_nop 4
    s_cbranch_vccz gbk_379
    s_sub_u32 s99, s99, 1
    s_cmp_lg_u32 s99, 0
    s_cbranch_scc1 glp_380
    s_branch gbk_379
gst_382:
    s_mov_b32 s99, 200000
glp_384:
    s_add_u32 s3, s100, 16384
    buffer_load_dwordx4 v[200:203], v1, s[48:51], s3 offen offset:2048 sc1
    buffer_load_dwordx4 v[204:207], v1, s[48:51], s3 offen offset:3072 sc1
    s_add_u32 s3, s100, 20480
    buffer_load_dwordx4 v[208:211], v1, s[48:51], s3 offen offset:0 sc1
    buffer_load_dwordx4 v[212:215], v1, s[48:51], s3 offen offset:1024 sc1
    buffer_load_dwordx4 v[216:219], v1, s[48:51], s3 offen offset:2048 sc1
    buffer_load_dwordx4 v[220:223], v1, s[48:51], s3 offen offset:3072 sc1
    s_add_u32 s3, s100, 24576
    buffer_load_dwordx4 v[224:227], v1, s[48:51], s3 offen offset:0 sc1
    buffer_load_dwordx4 v[228:231], v1, s[48:51], s3 offen offset:1024 sc1
    s_waitcnt vmcnt(0)
    v_bitop3_b32 v95, v200, v204, 1 bitop3:0x2
    v_cmp_eq_u32 vcc, 0, v95
    s_nop 4
    s_cbranch_vccz gbk_383
    s_sub_u32 s99, s99, 1
    s_cmp_lg_u32 s99, 0
    s_cbranch_scc1 glp_384
    s_branch gbk_383
gst_386:
    s_mov_b32 s99, 200000
glp_388:
    s_add_u32 s3, s100, 20480
    buffer_load_dwordx4 v[208:211], v1, s[48:51], s3 offen offset:0 sc1
    buffer_load_dwordx4 v[212:215], v1, s[48:51], s3 offen offset:1024 sc1
    buffer_load_dwordx4 v[216:219], v1, s[48:51], s3 offen offset:2048 sc1
    buffer_load_dwordx4 v[220:223], v1, s[48:51], s3 offen offset:3072 sc1
    s_add_u32 s3, s100, 24576
    buffer_load_dwordx4 v[224:227], v1, s[48:51], s3 offen offset:0 sc1
    buffer_load_dwordx4 v[228:231], v1, s[48:51], s3 offen offset:1024 sc1
    buffer_load_dwordx4 v[232:235], v1, s[48:51], s3 offen offset:2048 sc1
    buffer_load_dwordx4 v[236:239], v1, s[48:51], s3 offen offset:3072 sc1
    s_waitcnt vmcnt(0)
    v_bitop3_b32 v95, v208, v212, 1 bitop3:0x2
    v_cmp_eq_u32 vcc, 0, v95
    s_nop 4
    s_cbranch_vccz gbk_387
    s_sub_u32 s99, s99, 1
    s_cmp_lg_u32 s99, 0
    s_cbranch_scc1 glp_388
    s_branch gbk_387
gst_390:
    s_mov_b32 s99, 200000
glp_392:
    s_add_u32 s3, s100, 20480
    buffer_load_dwordx4 v[216:219], v1, s[48:51], s3 offen offset:2048 sc1
    buffer_load_dwordx4 v[220:223], v1, s[48:51], s3 offen offset:3072 sc1
    s_add_u32 s3, s100, 24576
    buffer_load_dwordx4 v[224:227], v1, s[48:51], s3 offen offset:0 sc1
    buffer_load_dwordx4 v[228:231], v1, s[48:51], s3 offen offset:1024 sc1
    buffer_load_dwordx4 v[232:235], v1, s[48:51], s3 offen offset:2048 sc1
    buffer_load_dwordx4 v[236:239], v1, s[48:51], s3 offen offset:3072 sc1
    s_add_u32 s3, s100, 28672
    buffer_load_dwordx4 v[240:243], v1, s[48:51], s3 offen offset:0 sc1
    buffer_load_dwordx4 v[244:247], v1, s[48:51], s3 offen offset:1024 sc1
    s_waitcnt vmcnt(0)
    v_bitop3_b32 v95, v216, v220, 1 bitop3:0x2
    v_cmp_eq_u32 vcc, 0, v95
    s_nop 4
    s_cbranch_vccz gbk_391
    s_sub_u32 s99, s99, 1
    s_cmp_lg_u32 s99, 0
    s_cbranch_scc1 glp_392
    s_branch gbk_391
gst_394:
    s_mov_b32 s99, 200000
glp_396:
    s_add_u32 s3, s100, 24576
    buffer_load_dwordx4 v[224:227], v1, s[48:51], s3 offen offset:0 sc1
    buffer_load_dwordx4 v[228:231], v1, s[48:51], s3 offen offset:1024 sc1
    buffer_load_dwordx4 v[232:235], v1, s[48:51], s3 offen offset:2048 sc1
    buffer_load_dwordx4 v[236:239], v1, s[48:51], s3 offen offset:3072 sc1
    s_add_u32 s3, s100, 28672
    buffer_load_dwordx4 v[240:243], v1, s[48:51], s3 offen offset:0 sc1
    buffer_load_dwordx4 v[244:247], v1, s[48:51], s3 offen offset:1024 sc1
    buffer_load_dwordx4 v[248:251], v1, s[48:51], s3 offen offset:2048 sc1
    buffer_load_dwordx4 v[252:255], v1, s[48:51], s3 offen offset:3072 sc1
    s_waitcnt vmcnt(0)
    v_bitop3_b32 v95, v224, v228, 1 bitop3:0x2
    v_cmp_eq_u32 vcc, 0, v95
    s_nop 4
    s_cbranch_vccz gbk_395
    s_sub_u32 s99, s99, 1
    s_cmp_lg_u32 s99, 0
    s_cbranch_scc1 glp_396
    s_branch gbk_395
gst_398:
    s_mov_b32 s99, 200000
glp_400:
    s_add_u32 s3, s100, 24576
    buffer_load_dwordx4 v[232:235], v1, s[48:51], s3 offen offset:2048 sc1
    buffer_load_dwordx4 v[236:239], v1, s[48:51], s3 offen offset:3072 sc1
    s_add_u32 s3, s100, 28672
    buffer_load_dwordx4 v[240:243], v1, s[48:51], s3 offen offset:0 sc1
    buffer_load_dwordx4 v[244:247], v1, s[48:51], s3 offen offset:1024 sc1
    buffer_load_dwordx4 v[248:251], v1, s[48:51], s3 offen offset:2048 sc1
    buffer_load_dwordx4 v[252:255], v1, s[48:51], s3 offen offset:3072 sc1
    s_waitcnt vmcnt(0)
    v_bitop3_b32 v95, v232, v236, 1 bitop3:0x2
    v_cmp_eq_u32 vcc, 0, v95
    s_nop 4
    s_cbranch_vccz gbk_399
    s_sub_u32 s99, s99, 1
    s_cmp_lg_u32 s99, 0
    s_cbranch_scc1 glp_400
    s_branch gbk_399
gst_402:
    s_mov_b32 s99, 200000
glp_404:
    s_add_u32 s3, s100, 28672
    buffer_load_dwordx4 v[240:243], v1, s[48:51], s3 offen offset:0 sc1
    buffer_load_dwordx4 v[244:247], v1, s[48:51], s3 offen offset:1024 sc1
    buffer_load_dwordx4 v[248:251], v1, s[48:51], s3 offen offset:2048 sc1
    buffer_load_dwordx4 v[252:255], v1, s[48:51], s3 offen offset:3072 sc1
    s_waitcnt vmcnt(0)
    v_bitop3_b32 v95, v240, v244, 1 bitop3:0x2
    v_cmp_eq_u32 vcc, 0, v95
    s_nop 4
    s_cbranch_vccz gbk_403
    s_sub_u32 s99, s99, 1
    s_cmp_lg_u32 s99, 0
    s_cbranch_scc1 glp_404
    s_branch gbk_403
gst_406:
    s_mov_b32 s99, 200000
glp_408:
    s_add_u32 s3, s100, 28672
    buffer_load_dwordx4 v[248:251], v1, s[48:51], s3 offen offset:2048 sc1
    buffer_load_dwordx4 v[252:255], v1, s[48:51], s3 offen offset:3072 sc1
    s_waitcnt vmcnt(0)
    v_bitop3_b32 v95, v248, v252, 1 bitop3:0x2
    v_cmp_eq_u32 vcc, 0, v95
    s_nop 4
    s_cbranch_vccz gbk_407
    s_sub_u32 s99, s99, 1
    s_cmp_lg_u32 s99, 0
    s_cbranch_scc1 glp_408
    s_branch gbk_407
fast_410:
    buffer_store_dwordx4 v[16:19], v1, s[48:51], s61 offen sc0 sc1
    buffer_store_dwordx4 v[20:23], v1, s[48:51], s61 offen offset:1024 sc0 sc1
    v_mov_b32 v94, 0
    v_mov_b32 v95, 0
    v_dot2c_f32_bf16 v94, s22, v16
    v_dot2c_f32_bf16 v95, v16, v16
    v_dot2c_f32_bf16 v94, s22, v17
    v_dot2c_f32_bf16 v95, v17, v17
    v_dot2c_f32_bf16 v94, s22, v18
    v_dot2c_f32_bf16 v95, v18, v18
    v_dot2c_f32_bf16 v94, s22, v19
    v_dot2c_f32_bf16 v95, v19, v19
    v_dot2c_f32_bf16 v94, s22, v20
    v_dot2c_f32_bf16 v95, v20, v20
    v_dot2c_f32_bf16 v94, s22, v21
    v_dot2c_f32_bf16 v95, v21, v21
    v_dot2c_f32_bf16 v94, s22, v22
    v_dot2c_f32_bf16 v95, v22, v22
    v_dot2c_f32_bf16 v94, s22, v23
    v_dot2c_f32_bf16 v95, v23, v23
    s_nop 1
    v_mov_b32 v92, v94
    v_mov_b32 v93, v95
    s_nop 0
    v_permlane32_swap_b32 v92, v94
    v_permlane32_swap_b32 v93, v95
    v_pk_add_f32 v[94:95], v[94:95], v[92:93]
    v_or_b32 v94, 1, v94
    buffer_store_dwordx2 v[94:95], v6, s[48:51], s101 offen sc0 sc1
    s_nop 0
    s_branch dend_411
gst_412:
    s_mov_b32 s99, 200000
glp_414:
    s_add_u32 s3, s60, 0
    buffer_load_dwordx4 v[128:131], v1, s[48:51], s3 offen offset:0 sc1
    buffer_load_dwordx4 v[132:135], v1, s[48:51], s3 offen offset:1024 sc1
    buffer_load_dwordx4 v[136:139], v1, s[48:51], s3 offen offset:2048 sc1
    buffer_load_dwordx4 v[140:143], v1, s[48:51], s3 offen offset:3072 sc1
    s_add_u32 s3, s60, 4096
    buffer_load_dwordx4 v[144:147], v1, s[48:51], s3 offen offset:0 sc1
    buffer_load_dwordx4 v[148:151], v1, s[48:51], s3 offen offset:1024 sc1
    buffer_load_dwordx4 v[152:155], v1, s[48:51], s3 offen offset:2048 sc1
    buffer_load_dwordx4 v[156:159], v1, s[48:51], s3 offen offset:3072 sc1
    s_waitcnt vmcnt(0)
    v_bitop3_b32 v95, v128, v132, 1 bitop3:0x80
    v_cmp_eq_u32 vcc, 0, v95
    s_nop 4
    s_cbranch_vccz gbk_413
    s_sub_u32 s99, s99, 1
    s_cmp_lg_u32 s99, 0
    s_cbranch_scc1 glp_414
    s_branch gbk_413
gst_416:
    s_mov_b32 s99, 200000
glp_418:
    s_add_u32 s3, s60, 0
    buffer_load_dwordx4 v[136:139], v1, s[48:51], s3 offen offset:2048 sc1
    buffer_load_dwordx4 v[140:143], v1, s[48:51], s3 offen offset:3072 sc1
    s_add_u32 s3, s60, 4096
    buffer_load_dwordx4 v[144:147], v1, s[48:51], s3 offen offset:0 sc1
    buffer_load_dwordx4 v[148:151], v1, s[48:51], s3 offen offset:1024 sc1
    buffer_load_dwordx4 v[152:155], v1, s[48:51], s3 offen offset:2048 sc1
    buffer_load_dwordx4 v[156:159], v1, s[48:51], s3 offen offset:3072 sc1
    s_add_u32 s3, s60, 8192
    buffer_load_dwordx4 v[160:163], v1, s[48:51], s3 offen offset:0 sc1
    buffer_load_dwordx4 v[164:167], v1, s[48:51], s3 offen offset:1024 sc1
    s_waitcnt vmcnt(0)
    v_bitop3_b32 v95, v136, v140, 1 bitop3:0x80
    v_cmp_eq_u32 vcc, 0, v95
    s_nop 4
    s_cbranch_vccz gbk_417
    s_sub_u32 s99, s99, 1
    s_cmp_lg_u32 s99, 0
    s_cbranch_scc1 glp_418
    s_branch gbk_417
gst_420:
    s_mov_b32 s99, 200000
glp_422:
    s_add_u32 s3, s60, 4096
    buffer_load_dwordx4 v[144:147], v1, s[48:51], s3 offen offset:0 sc1
    buffer_load_dwordx4 v[148:151], v1, s[48:51], s3 offen offset:1024 sc1
    buffer_load_dwordx4 v[152:155], v1, s[48:51], s3 offen offset:2048 sc1
    buffer_load_dwordx4 v[156:159], v1, s[48:51], s3 offen offset:3072 sc1
    s_add_u32 s3, s60, 8192
    buffer_load_dwordx4 v[160:163], v1, s[48:51], s3 offen offset:0 sc1
    buffer_load_dwordx4 v[164:167], v1, s[48:51], s3 offen offset:1024 sc1
    buffer_load_dwordx4 v[168:171], v1, s[48:51], s3 offen offset:2048 sc1
    buffer_load_dwordx4 v[172:175], v1, s[48:51], s3 offen offset:3072 sc1
    s_waitcnt vmcnt(0)
    v_bitop3_b32 v95, v144, v148, 1 bitop3:0x80
    v_cmp_eq_u32 vcc, 0, v95
    s_nop 4
    s_cbranch_vccz gbk_421
    s_sub_u32 s99, s99, 1
    s_cmp_lg_u32 s99, 0
    s_cbranch_scc1 glp_422
    s_branch gbk_421
gst_424:
    s_mov_b32 s99, 200000
glp_426:
    s_add_u32 s3, s60, 4096
    buffer_load_dwordx4 v[152:155], v1, s[48:51], s3 offen offset:2048 sc1
    buffer_load_dwordx4 v[156:159], v1, s[48:51], s3 offen offset:3072 sc1
    s_add_u32 s3, s60, 8192
    buffer_load_dwordx4 v[160:163], v1, s[48:51], s3 offen offset:0 sc1
    buffer_load_dwordx4 v[164:167], v1, s[48:51], s3 offen offset:1024 sc1
    buffer_load_dwordx4 v[168:171], v1, s[48:51], s3 offen offset:2048 sc1
    buffer_load_dwordx4 v[172:175], v1, s[48:51], s3 offen offset:3072 sc1
    s_add_u32 s3, s60, 12288
    buffer_load_dwordx4 v[176:179], v1, s[48:51], s3 offen offset:0 sc1
    buffer_load_dwordx4 v[180:183], v1, s[48:51], s3 offen offset:1024 sc1
    s_waitcnt vmcnt(0)
    v_bitop3_b32 v95, v152, v156, 1 bitop3:0x80
    v_cmp_eq_u32 vcc, 0, v95
    s_nop 4
    s_cbranch_vccz gbk_425
    s_sub_u32 s99, s99, 1
    s_cmp_lg_u32 s99, 0
    s_cbranch_scc1 glp_426
    s_branch gbk_425
gst_428:
    s_mov_b32 s99, 200000
glp_430:
    s_add_u32 s3, s60, 8192
    buffer_load_dwordx4 v[160:163], v1, s[48:51], s3 offen offset:0 sc1
    buffer_load_dwordx4 v[164:167], v1, s[48:51], s3 offen offset:1024 sc1
    buffer_load_dwordx4 v[168:171], v1, s[48:51], s3 offen offset:2048 sc1
    buffer_load_dwordx4 v[172:175], v1, s[48:51], s3 offen offset:3072 sc1
    s_add_u32 s3, s60, 12288
    buffer_load_dwordx4 v[176:179], v1, s[48:51], s3 offen offset:0 sc1
    buffer_load_dwordx4 v[180:183], v1, s[48:51], s3 offen offset:1024 sc1
    buffer_load_dwordx4 v[184:187], v1, s[48:51], s3 offen offset:2048 sc1
    buffer_load_dwordx4 v[188:191], v1, s[48:51], s3 offen offset:3072 sc1
    s_waitcnt vmcnt(0)
    v_bitop3_b32 v95, v160, v164, 1 bitop3:0x80
    v_cmp_eq_u32 vcc, 0, v95
    s_nop 4
    s_cbranch_vccz gbk_429
    s_sub_u32 s99, s99, 1
    s_cmp_lg_u32 s99, 0
    s_cbranch_scc1 glp_430
    s_branch gbk_429
gst_432:
    s_mov_b32 s99, 200000
glp_434:
    s_add_u32 s3, s60, 8192
    buffer_load_dwordx4 v[168:171], v1, s[48:51], s3 offen offset:2048 sc1
    buffer_load_dwordx4 v[172:175], v1, s[48:51], s3 offen offset:3072 sc1
    s_add_u32 s3, s60, 12288
    buffer_load_dwordx4 v[176:179], v1, s[48:51], s3 offen offset:0 sc1
    buffer_load_dwordx4 v[180:183], v1, s[48:51], s3 offen offset:1024 sc1
    buffer_load_dwordx4 v[184:187], v1, s[48:51], s3 offen offset:2048 sc1
    buffer_load_dwordx4 v[188:191], v1, s[48:51], s3 offen offset:3072 sc1
    s_add_u32 s3, s60, 16384
    buffer_load_dwordx4 v[192:195], v1, s[48:51], s3 offen offset:0 sc1
    buffer_load_dwordx4 v[196:199], v1, s[48:51], s3 offen offset:1024 sc1
    s_waitcnt vmcnt(0)
    v_bitop3_b32 v95, v168, v172, 1 bitop3:0x80
    v_cmp_eq_u32 vcc, 0, v95
    s_nop 4
    s_cbranch_vccz gbk_433
    s_sub_u32 s99, s99, 1
    s_cmp_lg_u32 s99, 0
    s_cbranch_scc1 glp_434
    s_branch gbk_433
gst_436:
    s_mov_b32 s99, 200000
glp_438:
    s_add_u32 s3, s60, 12288
    buffer_load_dwordx4 v[176:179], v1, s[48:51], s3 offen offset:0 sc1
    buffer_load_dwordx4 v[180:183], v1, s[48:51], s3 offen offset:1024 sc1
    buffer_load_dwordx4 v[184:187], v1, s[48:51], s3 offen offset:2048 sc1
    buffer_load_dwordx4 v[188:191], v1, s[48:51], s3 offen offset:3072 sc1
    s_add_u32 s3, s60, 16384
    buffer_load_dwordx4 v[192:195], v1, s[48:51], s3 offen offset:0 sc1
    buffer_load_dwordx4 v[196:199], v1, s[48:51], s3 offen offset:1024 sc1
    buffer_load_dwordx4 v[200:203], v1, s[48:51], s3 offen offset:2048 sc1
    buffer_load_dwordx4 v[204:207], v1, s[48:51], s3 offen offset:3072 sc1
    s_waitcnt vmcnt(0)
    v_bitop3_b32 v95, v176, v180, 1 bitop3:0x80
    v_cmp_eq_u32 vcc, 0, v95
    s_nop 4
    s_cbranch_vccz gbk_437
    s_sub_u32 s99, s99, 1
    s_cmp_lg_u32 s99, 0
    s_cbranch_scc1 glp_438
    s_branch gbk_437
gst_440:
    s_mov_b32 s99, 200000
glp_442:
    s_add_u32 s3, s60, 12288
    buffer_load_dwordx4 v[184:187], v1, s[48:51], s3 offen offset:2048 sc1
    buffer_load_dwordx4 v[188:191], v1, s[48:51], s3 offen offset:3072 sc1
    s_add_u32 s3, s60, 16384
    buffer_load_dwordx4 v[192:195], v1, s[48:51], s3 offen offset:0 sc1
    buffer_load_dwordx4 v[196:199], v1, s[48:51], s3 offen offset:1024 sc1
    buffer_load_dwordx4 v[200:203], v1, s[48:51], s3 offen offset:2048 sc1
    buffer_load_dwordx4 v[204:207], v1, s[48:51], s3 offen offset:3072 sc1
    s_add_u32 s3, s60, 20480
    buffer_load_dwordx4 v[208:211], v1, s[48:51], s3 offen offset:0 sc1
    buffer_load_dwordx4 v[212:215], v1, s[48:51], s3 offen offset:1024 sc1
    s_waitcnt vmcnt(0)
    v_bitop3_b32 v95, v184, v188, 1 bitop3:0x80
    v_cmp_eq_u32 vcc, 0, v95
    s_nop 4
    s_cbranch_vccz gbk_441
    s_sub_u32 s99, s99, 1
    s_cmp_lg_u32 s99, 0
    s_cbranch_scc1 glp_442
    s_branch gbk_441
gst_444:
    s_mov_b32 s99, 200000
glp_446:
    s_add_u32 s3, s60, 16384
    buffer_load_dwordx4 v[192:195], v1, s[48:51], s3 offen offset:0 sc1
    buffer_load_dwordx4 v[196:199], v1, s[48:51], s3 offen offset:1024 sc1
    buffer_load_dwordx4 v[200:203], v1, s[48:51], s3 offen offset:2048 sc1
    buffer_load_dwordx4 v[204:207], v1, s[48:51], s3 offen offset:3072 sc1
    s_add_u32 s3, s60, 20480
    buffer_load_dwordx4 v[208:211], v1, s[48:51], s3 offen offset:0 sc1
    buffer_load_dwordx4 v[212:215], v1, s[48:51], s3 offen offset:1024 sc1
    buffer_load_dwordx4 v[216:219], v1, s[48:51], s3 offen offset:2048 sc1
    buffer_load_dwordx4 v[220:223], v1, s[48:51], s3 offen offset:3072 sc1
    s_waitcnt vmcnt(0)
    v_bitop3_b32 v95, v192, v196, 1 bitop3:0x80
    v_cmp_eq_u32 vcc, 0, v95
    s_nop 4
    s_cbranch_vccz gbk_445
    s_sub_u32 s99, s99, 1
    s_cmp_lg_u32 s99, 0
    s_cbranch_scc1 glp_446
    s_branch gbk_445
sst_448:
    s_mov_b32 s99, 200000
    s_mov_b64 s[10:11], vcc
slp_450:
    buffer_load_dwordx4 v[96:99], v1, s[48:51], s101 offen offset:0 sc1
    buffer_load_dwordx4 v[100:103], v1, s[48:51], s101 offen offset:1024 sc1
    buffer_load_dwordx4 v[104:107], v1, s[48:51], s101 offen offset:2048 sc1
    buffer_load_dwordx4 v[108:111], v1, s[48:51], s101 offen offset:3072 sc1
    s_waitcnt vmcnt(0)
    v_bitop3_b32 v93, v96, v98, v100 bitop3:0x80
    v_bitop3_b32 v93, v93, v102, v104 bitop3:0x80
    v_bitop3_b32 v93, v93, v106, v108 bitop3:0x80
    v_bitop3_b32 v93, v93, v110, 1 bitop3:0x80
    v_cmp_eq_u32 vcc, 0, v93
    s_nop 4
    s_cbranch_vccz sle_451
    s_sub_u32 s99, s99, 1
    s_cmp_lg_u32 s99, 0
    s_cbranch_scc1 slp_450
sle_451:
    s_mov_b64 vcc, s[10:11]
    s_branch sbk_449
gst_452:
    s_mov_b32 s99, 200000
glp_454:
    s_add_u32 s3, s60, 16384
    buffer_load_dwordx4 v[200:203], v1, s[48:51], s3 offen offset:2048 sc1
    buffer_load_dwordx4 v[204:207], v1, s[48:51], s3 offen offset:3072 sc1
    s_add_u32 s3, s60, 20480
    buffer_load_dwordx4 v[208:211], v1, s[48:51], s3 offen offset:0 sc1
    buffer_load_dwordx4 v[212:215], v1, s[48:51], s3 offen offset:1024 sc1
    buffer_load_dwordx4 v[216:219], v1, s[48:51], s3 offen offset:2048 sc1
    buffer_load_dwordx4 v[220:223], v1, s[48:51], s3 offen offset:3072 sc1
    s_add_u32 s3, s60, 24576
    buffer_load_dwordx4 v[224:227], v1, s[48:51], s3 offen offset:0 sc1
    buffer_load_dwordx4 v[228:231], v1, s[48:51], s3 offen offset:1024 sc1
    s_waitcnt vmcnt(0)
    v_bitop3_b32 v95, v200, v204, 1 bitop3:0x80
    v_cmp_eq_u32 vcc, 0, v95
    s_nop 4
    s_cbranch_vccz gbk_453
    s_sub_u32 s99, s99, 1
    s_cmp_lg_u32 s99, 0
    s_cbranch_scc1 glp_454
    s_branch gbk_453
gst_456:
    s_mov_b32 s99, 200000
glp_458:
    s_add_u32 s3, s60, 20480
    buffer_load_dwordx4 v[208:211], v1, s[48:51], s3 offen offset:0 sc1
    buffer_load_dwordx4 v[212:215], v1, s[48:51], s3 offen offset:1024 sc1
    buffer_load_dwordx4 v[216:219], v1, s[48:51], s3 offen offset:2048 sc1
    buffer_load_dwordx4 v[220:223], v1, s[48:51], s3 offen offset:3072 sc1
    s_add_u32 s3, s60, 24576
    buffer_load_dwordx4 v[224:227], v1, s[48:51], s3 offen offset:0 sc1
    buffer_load_dwordx4 v[228:231], v1, s[48:51], s3 offen offset:1024 sc1
    buffer_load_dwordx4 v[232:235], v1, s[48:51], s3 offen offset:2048 sc1
    buffer_load_dwordx4 v[236:239], v1, s[48:51], s3 offen offset:3072 sc1
    s_waitcnt vmcnt(0)
    v_bitop3_b32 v95, v208, v212, 1 bitop3:0x80
    v_cmp_eq_u32 vcc, 0, v95
    s_nop 4
    s_cbranch_vccz gbk_457
    s_sub_u32 s99, s99, 1
    s_cmp_lg_u32 s99, 0
    s_cbranch_scc1 glp_458
    s_branch gbk_457
gst_460:
    s_mov_b32 s99, 200000
glp_462:
    s_add_u32 s3, s60, 20480
    buffer_load_dwordx4 v[216:219], v1, s[48:51], s3 offen offset:2048 sc1
    buffer_load_dwordx4 v[220:223], v1, s[48:51], s3 offen offset:3072 sc1
    s_add_u32 s3, s60, 24576
    buffer_load_dwordx4 v[224:227], v1, s[48:51], s3 offen offset:0 sc1
    buffer_load_dwordx4 v[228:231], v1, s[48:51], s3 offen offset:1024 sc1
    buffer_load_dwordx4 v[232:235], v1, s[48:51], s3 offen offset:2048 sc1
    buffer_load_dwordx4 v[236:239], v1, s[48:51], s3 offen offset:3072 sc1
    s_add_u32 s3, s60, 28672
    buffer_load_dwordx4 v[240:243], v1, s[48:51], s3 offen offset:0 sc1
    buffer_load_dwordx4 v[244:247], v1, s[48:51], s3 offen offset:1024 sc1
    s_waitcnt vmcnt(0)
    v_bitop3_b32 v95, v216, v220, 1 bitop3:0x80
    v_cmp_eq_u32 vcc, 0, v95
    s_nop 4
    s_cbranch_vccz gbk_461
    s_sub_u32 s99, s99, 1
    s_cmp_lg_u32 s99, 0
    s_cbranch_scc1 glp_462
    s_branch gbk_461
gst_464:
    s_mov_b32 s99, 200000
glp_466:
    s_add_u32 s3, s60, 24576
    buffer_load_dwordx4 v[224:227], v1, s[48:51], s3 offen offset:0 sc1
    buffer_load_dwordx4 v[228:231], v1, s[48:51], s3 offen offset:1024 sc1
    buffer_load_dwordx4 v[232:235], v1, s[48:51], s3 offen offset:2048 sc1
    buffer_load_dwordx4 v[236:239], v1, s[48:51], s3 offen offset:3072 sc1
    s_add_u32 s3, s60, 28672
    buffer_load_dwordx4 v[240:243], v1, s[48:51], s3 offen offset:0 sc1
    buffer_load_dwordx4 v[244:247], v1, s[48:51], s3 offen offset:1024 sc1
    buffer_load_dwordx4 v[248:251], v1, s[48:51], s3 offen offset:2048 sc1
    buffer_load_dwordx4 v[252:255], v1, s[48:51], s3 offen offset:3072 sc1
    s_waitcnt vmcnt(0)
    v_bitop3_b32 v95, v224, v228, 1 bitop3:0x80
    v_cmp_eq_u32 vcc, 0, v95
    s_nop 4
    s_cbranch_vccz gbk_465
    s_sub_u32 s99, s99, 1
    s_cmp_lg_u32 s99, 0
    s_cbranch_scc1 glp_466
    s_branch gbk_465
gst_468:
    s_mov_b32 s99, 200000
glp_470:
    s_add_u32 s3, s60, 24576
    buffer_load_dwordx4 v[232:235], v1, s[48:51], s3 offen offset:2048 sc1
    buffer_load_dwordx4 v[236:239], v1, s[48:51], s3 offen offset:3072 sc1
    s_add_u32 s3, s60, 28672
    buffer_load_dwordx4 v[240:243], v1, s[48:51], s3 offen offset:0 sc1
    buffer_load_dwordx4 v[244:247], v1, s[48:51], s3 offen offset:1024 sc1
    buffer_load_dwordx4 v[248:251], v1, s[48:51], s3 offen offset:2048 sc1
    buffer_load_dwordx4 v[252:255], v1, s[48:51], s3 offen offset:3072 sc1
    s_waitcnt vmcnt(0)
    v_bitop3_b32 v95, v232, v236, 1 bitop3:0x80
    v_cmp_eq_u32 vcc, 0, v95
    s_nop 4
    s_cbranch_vccz gbk_469
    s_sub_u32 s99, s99, 1
    s_cmp_lg_u32 s99, 0
    s_cbranch_scc1 glp_470
    s_branch gbk_469
gst_472:
    s_mov_b32 s99, 200000
glp_474:
    s_add_u32 s3, s60, 28672
    buffer_load_dwordx4 v[240:243], v1, s[48:51], s3 offen offset:0 sc1
    buffer_load_dwordx4 v[244:247], v1, s[48:51], s3 offen offset:1024 sc1
    buffer_load_dwordx4 v[248:251], v1, s[48:51], s3 offen offset:2048 sc1
    buffer_load_dwordx4 v[252:255], v1, s[48:51], s3 offen offset:3072 sc1
    s_waitcnt vmcnt(0)
    v_bitop3_b32 v95, v240, v244, 1 bitop3:0x80
    v_cmp_eq_u32 vcc, 0, v95
    s_nop 4
    s_cbranch_vccz gbk_473
    s_sub_u32 s99, s99, 1
    s_cmp_lg_u32 s99, 0
    s_cbranch_scc1 glp_474
    s_branch gbk_473
gst_476:
    s_mov_b32 s99, 200000
glp_478:
    s_add_u32 s3, s60, 28672
    buffer_load_dwordx4 v[248:251], v1, s[48:51], s3 offen offset:2048 sc1
    buffer_load_dwordx4 v[252:255], v1, s[48:51], s3 offen offset:3072 sc1
    s_waitcnt vmcnt(0)
    v_bitop3_b32 v95, v248, v252, 1 bitop3:0x80
    v_cmp_eq_u32 vcc, 0, v95
    s_nop 4
    s_cbranch_vccz gbk_477
    s_sub_u32 s99, s99, 1
    s_cmp_lg_u32 s99, 0
    s_cbranch_scc1 glp_478
    s_branch gbk_477
kr_482:
    v_and_b32 v192, 1, v128
    v_and_b32 v193, 1, v132
    v_and_b32 v194, 1, v136
    v_and_b32 v195, 1, v140
    v_and_b32 v196, 1, v144
    v_and_b32 v197, 1, v148
    v_and_b32 v198, 1, v152
    v_and_b32 v199, 1, v156
    v_and_b32 v200, 1, v60
    v_cmp_eq_u32 vcc, 0, v192
    s_cbranch_vccz ks_483
    s_add_u32 s7, s20, 0
    buffer_load_dwordx4 v[128:131], v1, s[48:51], s7 offen sc1
ks_483:
    v_cmp_eq_u32 vcc, 0, v193
    s_cbranch_vccz ks_484
    s_add_u32 s7, s20, 4096
    buffer_load_dwordx4 v[132:135], v1, s[48:51], s7 offen sc1
ks_484:
    v_cmp_eq_u32 vcc, 0, v194
    s_cbranch_vccz ks_485
    s_add_u32 s7, s20, 8192
    buffer_load_dwordx4 v[136:139], v1, s[48:51], s7 offen sc1
ks_485:
    v_cmp_eq_u32 vcc, 0, v195
    s_cbranch_vccz ks_486
    s_add_u32 s7, s20, 12288
    buffer_load_dwordx4 v[140:143], v1, s[48:51], s7 offen sc1
ks_486:
    v_cmp_eq_u32 vcc, 0, v196
    s_cbranch_vccz ks_487
    s_add_u32 s7, s20, 16384
    buffer_load_dwordx4 v[144:147], v1, s[48:51], s7 offen sc1
ks_487:
    v_cmp_eq_u32 vcc, 0, v197
    s_cbranch_vccz ks_488
    s_add_u32 s7, s20, 20480
    buffer_load_dwordx4 v[148:151], v1, s[48:51], s7 offen sc1
ks_488:
    v_cmp_eq_u32 vcc, 0, v198
    s_cbranch_vccz ks_489
    s_add_u32 s7, s20, 24576
    buffer_load_dwordx4 v[152:155], v1, s[48:51], s7 offen sc1
ks_489:
    v_cmp_eq_u32 vcc, 0, v199
    s_cbranch_vccz ks_490
    s_add_u32 s7, s20, 28672
    buffer_load_dwordx4 v[156:159], v1, s[48:51], s7 offen sc1
ks_490:
    v_cmp_eq_u32 vcc, 0, v200
    s_cbranch_vccz ks_491
    buffer_load_dwordx4 v[60:63], v57, s[48:51], s21 offen offset:2048 sc1
ks_491:
    s_sub_u32 s99, s99, 1
    s_cmp_lg_u32 s99, 0
    s_nop 1
    s_cbranch_scc1 klp_480
    s_waitcnt vmcnt(0)
    s_branch kd_481
fast_492:
    buffer_store_dwordx4 v[104:107], v1, s[48:51], s62 offen offset:0 sc0 sc1
    s_nop 1
    s_branch dend_493
fast_494:
    buffer_store_dwordx4 v[108:111], v1, s[48:51], s62 offen offset:1024 sc0 sc1
    s_nop 1
    s_branch dend_495
gst_496:
    s_mov_b32 s99, 200000
glp_498:
    s_add_u32 s3, s100, 0
    buffer_load_dwordx4 v[128:131], v1, s[48:51], s3 offen offset:0 sc1
    buffer_load_dwordx4 v[132:135], v1, s[48:51], s3 offen offset:1024 sc1
    buffer_load_dwordx4 v[136:139], v1, s[48:51], s3 offen offset:2048 sc1
    buffer_load_dwordx4 v[140:143], v1, s[48:51], s3 offen offset:3072 sc1
    s_add_u32 s3, s100, 4096
    buffer_load_dwordx4 v[144:147], v1, s[48:51], s3 offen offset:0 sc1
    buffer_load_dwordx4 v[148:151], v1, s[48:51], s3 offen offset:1024 sc1
    buffer_load_dwordx4 v[152:155], v1, s[48:51], s3 offen offset:2048 sc1
    buffer_load_dwordx4 v[156:159], v1, s[48:51], s3 offen offset:3072 sc1
    s_waitcnt vmcnt(0)
    v_bitop3_b32 v95, v128, v132, 1 bitop3:0x80
    v_cmp_eq_u32 vcc, 0, v95
    s_nop 4
    s_cbranch_vccz gbk_497
    s_sub_u32 s99, s99, 1
    s_cmp_lg_u32 s99, 0
    s_cbranch_scc1 glp_498
    s_branch gbk_497
gst_500:
    s_mov_b32 s99, 200000
glp_502:
    s_add_u32 s3, s100, 0
    buffer_load_dwordx4 v[136:139], v1, s[48:51], s3 offen offset:2048 sc1
    buffer_load_dwordx4 v[140:143], v1, s[48:51], s3 offen offset:3072 sc1
    s_add_u32 s3, s100, 4096
    buffer_load_dwordx4 v[144:147], v1, s[48:51], s3 offen offset:0 sc1
    buffer_load_dwordx4 v[148:151], v1, s[48:51], s3 offen offset:1024 sc1
    buffer_load_dwordx4 v[152:155], v1, s[48:51], s3 offen offset:2048 sc1
    buffer_load_dwordx4 v[156:159], v1, s[48:51], s3 offen offset:3072 sc1
    s_add_u32 s3, s100, 8192
    buffer_load_dwordx4 v[160:163], v1, s[48:51], s3 offen offset:0 sc1
    buffer_load_dwordx4 v[164:167], v1, s[48:51], s3 offen offset:1024 sc1
    s_waitcnt vmcnt(0)
    v_bitop3_b32 v95, v136, v140, 1 bitop3:0x80
    v_cmp_eq_u32 vcc, 0, v95
    s_nop 4
    s_cbranch_vccz gbk_501
    s_sub_u32 s99, s99, 1
    s_cmp_lg_u32 s99, 0
    s_cbranch_scc1 glp_502
    s_branch gbk_501
gst_504:
    s_mov_b32 s99, 200000
glp_506:
    s_add_u32 s3, s100, 4096
    buffer_load_dwordx4 v[144:147], v1, s[48:51], s3 offen offset:0 sc1
    buffer_load_dwordx4 v[148:151], v1, s[48:51], s3 offen offset:1024 sc1
    buffer_load_dwordx4 v[152:155], v1, s[48:51], s3 offen offset:2048 sc1
    buffer_load_dwordx4 v[156:159], v1, s[48:51], s3 offen offset:3072 sc1
    s_add_u32 s3, s100, 8192
    buffer_load_dwordx4 v[160:163], v1, s[48:51], s3 offen offset:0 sc1
    buffer_load_dwordx4 v[164:167], v1, s[48:51], s3 offen offset:1024 sc1
    buffer_load_dwordx4 v[168:171], v1, s[48:51], s3 offen offset:2048 sc1
    buffer_load_dwordx4 v[172:175], v1, s[48:51], s3 offen offset:3072 sc1
    s_waitcnt vmcnt(0)
    v_bitop3_b32 v95, v144, v148, 1 bitop3:0x80
    v_cmp_eq_u32 vcc, 0, v95
    s_nop 4
    s_cbranch_vccz gbk_505
    s_sub_u32 s99, s99, 1
    s_cmp_lg_u32 s99, 0
    s_cbranch_scc1 glp_506
    s_branch gbk_505
gst_508:
    s_mov_b32 s99, 200000
glp_510:
    s_add_u32 s3, s100, 4096
    buffer_load_dwordx4 v[152:155], v1, s[48:51], s3 offen offset:2048 sc1
    buffer_load_dwordx4 v[156:159], v1, s[48:51], s3 offen offset:3072 sc1
    s_add_u32 s3, s100, 8192
    buffer_load_dwordx4 v[160:163], v1, s[48:51], s3 offen offset:0 sc1
    buffer_load_dwordx4 v[164:167], v1, s[48:51], s3 offen offset:1024 sc1
    buffer_load_dwordx4 v[168:171], v1, s[48:51], s3 offen offset:2048 sc1
    buffer_load_dwordx4 v[172:175], v1, s[48:51], s3 offen offset:3072 sc1
    s_add_u32 s3, s100, 12288
    buffer_load_dwordx4 v[176:179], v1, s[48:51], s3 offen offset:0 sc1
    buffer_load_dwordx4 v[180:183], v1, s[48:51], s3 offen offset:1024 sc1
    s_waitcnt vmcnt(0)
    v_bitop3_b32 v95, v152, v156, 1 bitop3:0x80
    v_cmp_eq_u32 vcc, 0, v95
    s_nop 4
    s_cbranch_vccz gbk_509
    s_sub_u32 s99, s99, 1
    s_cmp_lg_u32 s99, 0
    s_cbranch_scc1 glp_510
    s_branch gbk_509
gst_512:
    s_mov_b32 s99, 200000
glp_514:
    s_add_u32 s3, s100, 8192
    buffer_load_dwordx4 v[160:163], v1, s[48:51], s3 offen offset:0 sc1
    buffer_load_dwordx4 v[164:167], v1, s[48:51], s3 offen offset:1024 sc1
    buffer_load_dwordx4 v[168:171], v1, s[48:51], s3 offen offset:2048 sc1
    buffer_load_dwordx4 v[172:175], v1, s[48:51], s3 offen offset:3072 sc1
    s_add_u32 s3, s100, 12288
    buffer_load_dwordx4 v[176:179], v1, s[48:51], s3 offen offset:0 sc1
    buffer_load_dwordx4 v[180:183], v1, s[48:51], s3 offen offset:1024 sc1
    buffer_load_dwordx4 v[184:187], v1, s[48:51], s3 offen offset:2048 sc1
    buffer_load_dwordx4 v[188:191], v1, s[48:51], s3 offen offset:3072 sc1
    s_waitcnt vmcnt(0)
    v_bitop3_b32 v95, v160, v164, 1 bitop3:0x80
    v_cmp_eq_u32 vcc, 0, v95
    s_nop 4
    s_cbranch_vccz gbk_513
    s_sub_u32 s99, s99, 1
    s_cmp_lg_u32 s99, 0
    s_cbranch_scc1 glp_514
    s_branch gbk_513
gst_516:
    s_mov_b32 s99, 200000
glp_518:
    s_add_u32 s3, s100, 8192
    buffer_load_dwordx4 v[168:171], v1, s[48:51], s3 offen offset:2048 sc1
    buffer_load_dwordx4 v[172:175], v1, s[48:51], s3 offen offset:3072 sc1
    s_add_u32 s3, s100, 12288
    buffer_load_dwordx4 v[176:179], v1, s[48:51], s3 offen offset:0 sc1
    buffer_load_dwordx4 v[180:183], v1, s[48:51], s3 offen offset:1024 sc1
    buffer_load_dwordx4 v[184:187], v1, s[48:51], s3 offen offset:2048 sc1
    buffer_load_dwordx4 v[188:191], v1, s[48:51], s3 offen offset:3072 sc1
    s_add_u32 s3, s100, 16384
    buffer_load_dwordx4 v[192:195], v1, s[48:51], s3 offen offset:0 sc1
    buffer_load_dwordx4 v[196:199], v1, s[48:51], s3 offen offset:1024 sc1
    s_waitcnt vmcnt(0)
    v_bitop3_b32 v95, v168, v172, 1 bitop3:0x80
    v_cmp_eq_u32 vcc, 0, v95
    s_nop 4
    s_cbranch_vccz gbk_517
    s_sub_u32 s99, s99, 1
    s_cmp_lg_u32 s99, 0
    s_cbranch_scc1 glp_518
    s_branch gbk_517
gst_520:
    s_mov_b32 s99, 200000
glp_522:
    s_add_u32 s3, s100, 12288
    buffer_load_dwordx4 v[176:179], v1, s[48:51], s3 offen offset:0 sc1
    buffer_load_dwordx4 v[180:183], v1, s[48:51], s3 offen offset:1024 sc1
    buffer_load_dwordx4 v[184:187], v1, s[48:51], s3 offen offset:2048 sc1
    buffer_load_dwordx4 v[188:191], v1, s[48:51], s3 offen offset:3072 sc1
    s_add_u32 s3, s100, 16384
    buffer_load_dwordx4 v[192:195], v1, s[48:51], s3 offen offset:0 sc1
    buffer_load_dwordx4 v[196:199], v1, s[48:51], s3 offen offset:1024 sc1
    buffer_load_dwordx4 v[200:203], v1, s[48:51], s3 offen offset:2048 sc1
    buffer_load_dwordx4 v[204:207], v1, s[48:51], s3 offen offset:3072 sc1
    s_waitcnt vmcnt(0)
    v_bitop3_b32 v95, v176, v180, 1 bitop3:0x80
    v_cmp_eq_u32 vcc, 0, v95
    s_nop 4
    s_cbranch_vccz gbk_521
    s_sub_u32 s99, s99, 1
    s_cmp_lg_u32 s99, 0
    s_cbranch_scc1 glp_522
    s_branch gbk_521
gst_524:
    s_mov_b32 s99, 200000
glp_526:
    s_add_u32 s3, s100, 12288
    buffer_load_dwordx4 v[184:187], v1, s[48:51], s3 offen offset:2048 sc1
    buffer_load_dwordx4 v[188:191], v1, s[48:51], s3 offen offset:3072 sc1
    s_add_u32 s3, s100, 16384
    buffer_load_dwordx4 v[192:195], v1, s[48:51], s3 offen offset:0 sc1
    buffer_load_dwordx4 v[196:199], v1, s[48:51], s3 offen offset:1024 sc1
    buffer_load_dwordx4 v[200:203], v1, s[48:51], s3 offen offset:2048 sc1
    buffer_load_dwordx4 v[204:207], v1, s[48:51], s3 offen offset:3072 sc1
    s_add_u32 s3, s100, 20480
    buffer_load_dwordx4 v[208:211], v1, s[48:51], s3 offen offset:0 sc1
    buffer_load_dwordx4 v[212:215], v1, s[48:51], s3 offen offset:1024 sc1
    s_waitcnt vmcnt(0)
    v_bitop3_b32 v95, v184, v188, 1 bitop3:0x80
    v_cmp_eq_u32 vcc, 0, v95
    s_nop 4
    s_cbranch_vccz gbk_525
    s_sub_u32 s99, s99, 1
    s_cmp_lg_u32 s99, 0
    s_cbranch_scc1 glp_526
    s_branch gbk_525
gst_528:
    s_mov_b32 s99, 200000
glp_530:
    s_add_u32 s3, s100, 16384
    buffer_load_dwordx4 v[192:195], v1, s[48:51], s3 offen offset:0 sc1
    buffer_load_dwordx4 v[196:199], v1, s[48:51], s3 offen offset:1024 sc1
    buffer_load_dwordx4 v[200:203], v1, s[48:51], s3 offen offset:2048 sc1
    buffer_load_dwordx4 v[204:207], v1, s[48:51], s3 offen offset:3072 sc1
    s_add_u32 s3, s100, 20480
    buffer_load_dwordx4 v[208:211], v1, s[48:51], s3 offen offset:0 sc1
    buffer_load_dwordx4 v[212:215], v1, s[48:51], s3 offen offset:1024 sc1
    buffer_load_dwordx4 v[216:219], v1, s[48:51], s3 offen offset:2048 sc1
    buffer_load_dwordx4 v[220:223], v1, s[48:51], s3 offen offset:3072 sc1
    s_waitcnt vmcnt(0)
    v_bitop3_b32 v95, v192, v196, 1 bitop3:0x80
    v_cmp_eq_u32 vcc, 0, v95
    s_nop 4
    s_cbranch_vccz gbk_529
    s_sub_u32 s99, s99, 1
    s_cmp_lg_u32 s99, 0
    s_cbranch_scc1 glp_530
    s_branch gbk_529
gst_532:
    s_mov_b32 s99, 200000
glp_534:
    s_add_u32 s3, s100, 16384
    buffer_load_dwordx4 v[200:203], v1, s[48:51], s3 offen offset:2048 sc1
    buffer_load_dwordx4 v[204:207], v1, s[48:51], s3 offen offset:3072 sc1
    s_add_u32 s3, s100, 20480
    buffer_load_dwordx4 v[208:211], v1, s[48:51], s3 offen offset:0 sc1
    buffer_load_dwordx4 v[212:215], v1, s[48:51], s3 offen offset:1024 sc1
    buffer_load_dwordx4 v[216:219], v1, s[48:51], s3 offen offset:2048 sc1
    buffer_load_dwordx4 v[220:223], v1, s[48:51], s3 offen offset:3072 sc1
    s_add_u32 s3, s100, 24576
    buffer_load_dwordx4 v[224:227], v1, s[48:51], s3 offen offset:0 sc1
    buffer_load_dwordx4 v[228:231], v1, s[48:51], s3 offen offset:1024 sc1
    s_waitcnt vmcnt(0)
    v_bitop3_b32 v95, v200, v204, 1 bitop3:0x80
    v_cmp_eq_u32 vcc, 0, v95
    s_nop 4
    s_cbranch_vccz gbk_533
    s_sub_u32 s99, s99, 1
    s_cmp_lg_u32 s99, 0
    s_cbranch_scc1 glp_534
    s_branch gbk_533
gst_536:
    s_mov_b32 s99, 200000
glp_538:
    s_add_u32 s3, s100, 20480
    buffer_load_dwordx4 v[208:211], v1, s[48:51], s3 offen offset:0 sc1
    buffer_load_dwordx4 v[212:215], v1, s[48:51], s3 offen offset:1024 sc1
    buffer_load_dwordx4 v[216:219], v1, s[48:51], s3 offen offset:2048 sc1
    buffer_load_dwordx4 v[220:223], v1, s[48:51], s3 offen offset:3072 sc1
    s_add_u32 s3, s100, 24576
    buffer_load_dwordx4 v[224:227], v1, s[48:51], s3 offen offset:0 sc1
    buffer_load_dwordx4 v[228:231], v1, s[48:51], s3 offen offset:1024 sc1
    buffer_load_dwordx4 v[232:235], v1, s[48:51], s3 offen offset:2048 sc1
    buffer_load_dwordx4 v[236:239], v1, s[48:51], s3 offen offset:3072 sc1
    s_waitcnt vmcnt(0)
    v_bitop3_b32 v95, v208, v212, 1 bitop3:0x80
    v_cmp_eq_u32 vcc, 0, v95
    s_nop 4
    s_cbranch_vccz gbk_537
    s_sub_u32 s99, s99, 1
    s_cmp_lg_u32 s99, 0
    s_cbranch_scc1 glp_538
    s_branch gbk_537
gst_540:
    s_mov_b32 s99, 200000
glp_542:
    s_add_u32 s3, s100, 20480
    buffer_load_dwordx4 v[216:219], v1, s[48:51], s3 offen offset:2048 sc1
    buffer_load_dwordx4 v[220:223], v1, s[48:51], s3 offen offset:3072 sc1
    s_add_u32 s3, s100, 24576
    buffer_load_dwordx4 v[224:227], v1, s[48:51], s3 offen offset:0 sc1
    buffer_load_dwordx4 v[228:231], v1, s[48:51], s3 offen offset:1024 sc1
    buffer_load_dwordx4 v[232:235], v1, s[48:51], s3 offen offset:2048 sc1
    buffer_load_dwordx4 v[236:239], v1, s[48:51], s3 offen offset:3072 sc1
    s_add_u32 s3, s100, 28672
    buffer_load_dwordx4 v[240:243], v1, s[48:51], s3 offen offset:0 sc1
    buffer_load_dwordx4 v[244:247], v1, s[48:51], s3 offen offset:1024 sc1
    s_waitcnt vmcnt(0)
    v_bitop3_b32 v95, v216, v220, 1 bitop3:0x80
    v_cmp_eq_u32 vcc, 0, v95
    s_nop 4
    s_cbranch_vccz gbk_541
    s_sub_u32 s99, s99, 1
    s_cmp_lg_u32 s99, 0
    s_cbranch_scc1 glp_542
    s_branch gbk_541
gst_544:
    s_mov_b32 s99, 200000
glp_546:
    s_add_u32 s3, s100, 24576
    buffer_load_dwordx4 v[224:227], v1, s[48:51], s3 offen offset:0 sc1
    buffer_load_dwordx4 v[228:231], v1, s[48:51], s3 offen offset:1024 sc1
    buffer_load_dwordx4 v[232:235], v1, s[48:51], s3 offen offset:2048 sc1
    buffer_load_dwordx4 v[236:239], v1, s[48:51], s3 offen offset:3072 sc1
    s_add_u32 s3, s100, 28672
    buffer_load_dwordx4 v[240:243], v1, s[48:51], s3 offen offset:0 sc1
    buffer_load_dwordx4 v[244:247], v1, s[48:51], s3 offen offset:1024 sc1
    buffer_load_dwordx4 v[248:251], v1, s[48:51], s3 offen offset:2048 sc1
    buffer_load_dwordx4 v[252:255], v1, s[48:51], s3 offen offset:3072 sc1
    s_waitcnt vmcnt(0)
    v_bitop3_b32 v95, v224, v228, 1 bitop3:0x80
    v_cmp_eq_u32 vcc, 0, v95
    s_nop 4
    s_cbranch_vccz gbk_545
    s_sub_u32 s99, s99, 1
    s_cmp_lg_u32 s99, 0
    s_cbranch_scc1 glp_546
    s_branch gbk_545
gst_548:
    s_mov_b32 s99, 200000
glp_550:
    s_add_u32 s3, s100, 24576
    buffer_load_dwordx4 v[232:235], v1, s[48:51], s3 offen offset:2048 sc1
    buffer_load_dwordx4 v[236:239], v1, s[48:51], s3 offen offset:3072 sc1
    s_add_u32 s3, s100, 28672
    buffer_load_dwordx4 v[240:243], v1, s[48:51], s3 offen offset:0 sc1
    buffer_load_dwordx4 v[244:247], v1, s[48:51], s3 offen offset:1024 sc1
    buffer_load_dwordx4 v[248:251], v1, s[48:51], s3 offen offset:2048 sc1
    buffer_load_dwordx4 v[252:255], v1, s[48:51], s3 offen offset:3072 sc1
    s_waitcnt vmcnt(0)
    v_bitop3_b32 v95, v232, v236, 1 bitop3:0x80
    v_cmp_eq_u32 vcc, 0, v95
    s_nop 4
    s_cbranch_vccz gbk_549
    s_sub_u32 s99, s99, 1
    s_cmp_lg_u32 s99, 0
    s_cbranch_scc1 glp_550
    s_branch gbk_549
gst_552:
    s_mov_b32 s99, 200000
glp_554:
    s_add_u32 s3, s100, 28672
    buffer_load_dwordx4 v[240:243], v1, s[48:51], s3 offen offset:0 sc1
    buffer_load_dwordx4 v[244:247], v1, s[48:51], s3 offen offset:1024 sc1
    buffer_load_dwordx4 v[248:251], v1, s[48:51], s3 offen offset:2048 sc1
    buffer_load_dwordx4 v[252:255], v1, s[48:51], s3 offen offset:3072 sc1
    s_waitcnt vmcnt(0)
    v_bitop3_b32 v95, v240, v244, 1 bitop3:0x80
    v_cmp_eq_u32 vcc, 0, v95
    s_nop 4
    s_cbranch_vccz gbk_553
    s_sub_u32 s99, s99, 1
    s_cmp_lg_u32 s99, 0
    s_cbranch_scc1 glp_554
    s_branch gbk_553
gst_556:
    s_mov_b32 s99, 200000
glp_558:
    s_add_u32 s3, s100, 28672
    buffer_load_dwordx4 v[248:251], v1, s[48:51], s3 offen offset:2048 sc1
    buffer_load_dwordx4 v[252:255], v1, s[48:51], s3 offen offset:3072 sc1
    s_waitcnt vmcnt(0)
    v_bitop3_b32 v95, v248, v252, 1 bitop3:0x80
    v_cmp_eq_u32 vcc, 0, v95
    s_nop 4
    s_cbranch_vccz gbk_557
    s_sub_u32 s99, s99, 1
    s_cmp_lg_u32 s99, 0
    s_cbranch_scc1 glp_558
    s_branch gbk_557
L_codeend:
.section .rodata,"a"
.p2align 6
.amdhsa_kernel interleave_layers__sliding_block__linear_attn_block__prompt_kernel
  .amdhsa_next_free_vgpr 512
  .amdhsa_next_free_sgpr 102
  .amdhsa_accum_offset 256
  .amdhsa_group_segment_fixed_size 0
  .amdhsa_kernarg_size 72
  .amdhsa_user_sgpr_count 2
  .amdhsa_user_sgpr_kernarg_segment_ptr 1
  .amdhsa_system_sgpr_workgroup_id_x 1
.end_amdhsa_kernel
```
